```python
import torch

def _softmax(x, axis=-1):
    return torch.softmax(x, dim=axis)

def _gelu(x):
    return torch.nn.functional.gelu(x, approximate='tanh')

def _silu(x):
    return torch.nn.functional.silu(x)

def _sigmoid(x):
    return torch.sigmoid(x)

def _layernorm(x, axis=-1, eps=1e-05):
    m = x.mean(dim=axis, keepdim=True)
    v = x.var(dim=axis, keepdim=True, unbiased=False)
    return (x - m) / torch.sqrt(v + eps)

def _scatter_add(tgt, idx, src, axis=0):
    return tgt.clone().index_add_(axis, idx, src)

def _segment_sum(src, seg, n):
    out = torch.zeros((n,) + src.shape[1:], dtype=src.dtype)
    return out.index_add_(0, seg, src)

def _pad(x, pw):
    flat = tuple((v for pair in reversed(pw) for v in pair))
    return torch.nn.functional.pad(x, flat)
kernel_name = 'concat_heads__grouped_kv_mqa__memory_aug_recurrent_mem_tr__prompt'

def setup_inputs():

    _w = lambda a: (lambda t: t.to(torch.bfloat16) if t.is_floating_point() else t)(torch.as_tensor(a))

    def _A_setup():
        B, S, D, H = (1, 2048, 576, 32)
        Dh = D // H
        return {'x': _w((lambda *s: torch.randn(*s, dtype=torch.bfloat16) * 0.05)(B, S, D)), 'wq': _w((lambda *s: torch.randn(*s, dtype=torch.bfloat16) * 1.6)(D, H * Dh)), 'wk': _w((lambda *s: torch.randn(*s, dtype=torch.bfloat16) * 1.6)(D, Dh)), 'wv': _w((lambda *s: torch.randn(*s, dtype=torch.bfloat16) * 0.05)(D, Dh)), 'wo': _w((lambda *s: torch.randn(*s, dtype=torch.bfloat16) * 0.05)(H * Dh, D))}
    _A_in = _A_setup()

    def _B_setup():
        B, S, Dm = (1, 2048, 576)
        H, Dh = (32, 128)
        M, seg = (8, 32)
        seg = min(seg, S)
        S = S // seg * seg
        return {'x': _w((lambda *s: torch.randn(*s, dtype=torch.bfloat16) * 0.05)(B, S, Dm)), 'mem0': _w((lambda *s: torch.randn(*s, dtype=torch.bfloat16) * 0.8)(B, M, Dm)), 'Wq': _w((lambda *s: torch.randn(*s, dtype=torch.bfloat16) * 1.6)(Dm, H, Dh) * Dm ** (-0.5)), 'Wk': _w((lambda *s: torch.randn(*s, dtype=torch.bfloat16) * 1.6)(Dm, H, Dh) * Dm ** (-0.5)), 'Wv': _w((lambda *s: torch.randn(*s, dtype=torch.bfloat16) * 0.8)(Dm, H, Dh) * Dm ** (-0.5)), 'Wo': _w((lambda *s: torch.randn(*s, dtype=torch.bfloat16) * 0.8)(H, Dh, Dm) * (H * Dh) ** (-0.5)), 'seg_len': seg}
    _B_in = _B_setup()
    return {'A_x': _A_in['x'], 'A_wq': _A_in['wq'], 'A_wk': _A_in['wk'], 'A_wv': _A_in['wv'], 'A_wo': _A_in['wo'], 'B_x': _B_in['x'], 'B_mem0': _B_in['mem0'], 'B_Wq': _B_in['Wq'], 'B_Wk': _B_in['Wk'], 'B_Wv': _B_in['Wv'], 'B_Wo': _B_in['Wo'], 'B_seg_len': _B_in['seg_len']}

def reference(A_x, A_wq, A_wk, A_wv, A_wo, B_x, B_mem0, B_Wq, B_Wk, B_Wv, B_Wo, B_seg_len):

    def _A_ref(x, wq, wk, wv, wo):
        B, S, D = x.shape
        H = 32
        Dh = D // H
        q = (lambda x, *d: x.permute(*d))((x @ wq).reshape(B, S, H, Dh), 0, 2, 1, 3)
        k = x @ wk
        v = x @ wv
        scores = torch.einsum('bhqd,bkd->bhqk', q, k) * Dh ** (-0.5)
        p = _softmax(scores, axis=-1)
        o = torch.einsum('bhqk,bkd->bhqd', p, v)
        return (lambda x, *d: x.permute(*d))(o, 0, 2, 1, 3).reshape(B, S, H * Dh) @ wo

    def _B_ref(x, mem0, Wq, Wk, Wv, Wo, seg_len):
        B, S, Dm = x.shape
        H, Dh = (Wq.shape[1], Wq.shape[2])
        M = mem0.shape[1]
        scale = Dh ** (-0.5)
        n_seg = S // seg_len
        L = M + seg_len
        idx = torch.arange(L)
        mask = (idx[:, None] < M) | (idx[:, None] >= idx[None, :])
        mem = mem0
        outs = []
        for s in range(n_seg):
            xs = x[:, s * seg_len:(s + 1) * seg_len, :].clone()
            h = torch.concatenate([mem, xs], axis=1)
            q = torch.einsum('btd,dhe->bhte', h, Wq)
            k = torch.einsum('btd,dhe->bhte', h, Wk)
            v = torch.einsum('btd,dhe->bhte', h, Wv)
            scores = torch.einsum('bhqe,bhke->bhqk', q, k) * scale
            scores = torch.where(mask[None, None], scores, -1000000000.0)
            p = _softmax(scores, axis=-1)
            o = torch.einsum('bhqk,bhke->bhqe', p, v)
            o = torch.einsum('bhte,hed->btd', o, Wo)
            mem = o[:, :M, :].clone()
            outs.append(o[:, M:, :])
        return torch.concatenate(outs, axis=1)
    a = _A_ref(A_x, A_wq, A_wk, A_wv, A_wo)
    b = _B_ref(B_x, B_mem0, B_Wq, B_Wk, B_Wv, B_Wo, B_seg_len)
    return torch.concatenate([a, b], axis=-1)
```

```asm
; @launch grid=(256,1,1) block=(256,1,1) lds=163840
.amdgcn_target "amdgcn-amd-amdhsa--gfx950"
.macro i0 a:vararg
ds_read_b64_tr_b16 \a
.endm
.macro i1 a:vararg
buffer_load_dwordx4 \a
.endm
.macro i2 a:vararg
v_mfma_f32_16x16x32_bf16 \a
.endm
.macro i3 a:vararg
v_cvt_pk_bf16_f32 \a
.endm
.macro i4 a:vararg
v_smfmac_f32_16x16x64_bf16 \a
.endm
.macro i5 a:vararg
s_mov_b32 \a
.endm
.macro i6 a:vararg
s_add_u32 \a
.endm
.macro i7 a:vararg
v_mfma_f32_32x32x16_bf16 \a
.endm
.macro i8 a:vararg
s_waitcnt \a
.endm
.macro i9 a:vararg
ds_read_b128 \a
.endm
.macro i10 a:vararg
v_accvgpr_read_b32 \a
.endm
.macro i11 a:vararg
v_mov_b32 \a
.endm
.macro i12 a:vararg
v_accvgpr_write_b32 \a
.endm
.macro i13 a:vararg
buffer_store_dwordx4 \a
.endm
.macro i14 a:vararg
v_mov_b64 \a
.endm
.macro i15 a:vararg
s_nop \a
.endm
.macro i16 a:vararg
v_pk_mul_f32 \a
.endm
.macro i17 a:vararg
v_lshl_add_u32 \a
.endm
.macro i18 a:vararg
v_and_b32 \a
.endm
.macro i19 a:vararg
v_exp_f32 \a
.endm
.macro i20 a:vararg
v_add_u32 \a
.endm
.macro i21 a:vararg
ds_write_b128 \a
.endm
.macro i22 a:vararg
s_cbranch_scc1 \a
.endm
.macro i23 a:vararg
v_lshrrev_b32 \a
.endm
.macro i24 a:vararg
v_lshl_or_b32 \a
.endm
.macro i25 a:vararg
v_cmp_eq_u32 \a
.endm
.macro i26 a:vararg
v_cndmask_b32 \a
.endm
.macro i27 a:vararg
v_mfma_f32_16x16x16_bf16 \a
.endm
.macro i28 a:vararg
s_cselect_b32 \a
.endm
.macro i29 a:vararg
v_add_f32_dpp \a
.endm
.macro i30 a:vararg
ds_read_u16 \a
.endm
.macro i31 a:vararg
v_lshlrev_b32 \a
.endm
.macro i32 a:vararg
s_lshl_b32 \a
.endm
.macro i33 a:vararg
v_sub_f32 \a
.endm
.macro i34 a:vararg
v_bfe_u32 \a
.endm
.macro i35 a:vararg
s_cmp_gt_u32 \a
.endm
.macro i36 a:vararg
buffer_load_dword \a
.endm
.macro i37 a:vararg
v_readfirstlane_b32 \a
.endm
.macro i38 a:vararg
v_max3_f32 \a
.endm
.macro i39 a:vararg
s_mov_b64 \a
.endm
.macro i40 a:vararg
v_permlane32_swap_b32 \a
.endm
.macro i41 a:vararg
buffer_store_dwordx2 \a
.endm
.macro i42 a:vararg
v_bitop3_b32 \a
.endm
.macro i43 a:vararg
v_mul_u32_u24 \a
.endm
.macro i44 a:vararg
s_branch \a
.endm
.macro i45 a:vararg
v_mad_u32_u24 \a
.endm
.macro i46 a:vararg
s_cmp_lg_u32 \a
.endm
.macro i47 a:vararg
s_cmp_eq_u32 \a
.endm
.macro i48 a:vararg
v_max3_u32 \a
.endm
.macro i49 a:vararg
s_cbranch_vccnz \a
.endm
.macro i50 a:vararg
s_load_dwordx2 \a
.endm
.macro i51 a:vararg
v_mul_f32 \a
.endm
.macro i52 a:vararg
buffer_store_dword \a
.endm
.macro i53 a:vararg
s_or_b64 \a
.endm
.macro i54 a:vararg
s_movk_i32 \a
.endm
.macro i55 a:vararg
global_load_dword \a
.endm
.text
.globl concat_heads__grouped_kv_mqa__memory_aug_recurrent_mem_tr__prompt_kernel
.p2align 8
.type concat_heads__grouped_kv_mqa__memory_aug_recurrent_mem_tr__prompt_kernel,@function
concat_heads__grouped_kv_mqa__memory_aug_recurrent_mem_tr__prompt_kernel:
s_cmp_ge_u32 s2, 256
i22 L_end
i50 s[8:9],s[0:1],112
i50 s[100:101],s[0:1],104
i50 s[60:61],s[0:1],56
i50 s[64:65],s[0:1],64
i50 s[68:69],s[0:1],72
i50 s[72:73],s[0:1],80
s_getreg_b32 s96, hwreg(HW_REG_XCC_ID, 0, 3)
i23 v1,6,v0
i15 0
i37 s21,v1
i18 v0,63,v0
i31 v0,4,v0
i5 s99,0
i8 lgkmcnt(0)
i5 s10,0x10000000
i5 s11,0x20000
i32 s3,s96,2
i11 v40,s3
i11 v41,1
i11 v43,0
i46 s21,0
i22 L_noatom
i39 exec,1
global_atomic_add v42, v40, v41, s[100:101] offset:0 sc0
i39 exec,-1
L_noatom:
s_getpc_b64 s[88:89]
L_pc0:
i5 s3,L_cw3-L_pc0
i47 s21,0
i28 s3,L_cw0-L_pc0,s3
i47 s21,1
i28 s3,L_cw1-L_pc0,s3
i47 s21,2
i28 s3,L_cw2-L_pc0,s3
i32 s4,s21,13
s_cmp_lt_u32 s96, 3
i28 s5,L_half-L_pc0,s4
i28 s6,0,L_g1-L_pc0
i6 s5,s5,s6
i47 s96,0
i28 s3,s3,s5
i6 s88,s88,s3
s_addc_u32 s89, s89, 0
i31 v44,2,v0
i20 v45,4096,v44
i55 v102,v44,s[88:89]
i55 v102,v45,s[88:89]
s_lshr_b32 s3, s2, 3
s_mul_i32 s3, s3, 147456
i47 s96,0
i28 s3,s3,0x80000000
i32 s4,s21,2
i6 m0,s4,60
i15 0
s_movrels_b64 s[88:89], s[0:1]
i5 s90,4718592
i5 s91,0x20000
i31 v44,8,v0
v_min_u32 v44, 143360, v44
i36 v102,v44,s[88:91],s3 offen
i46 s21,0
i22 L_tk
i39 exec,1
i8 vmcnt(3)
global_atomic_add v43, v41, s[100:101] offset:160
ds_write_b32 v43, v42
i39 exec,-1
i8 lgkmcnt(0)
L_tk:
s_barrier
i11 v43,0
ds_read_b32 v42, v43
i8 lgkmcnt(0)
i37 s97,v42
s_barrier
i5 s98,s96
i5 s20,s97
s_cmp_lt_u32 s97, 32
i22 L_role
i46 s99,0
i22 L_v0k
i11 v40,0
i5 s94,0
i46 s21,0
i22 L_v0ab
i39 exec,1
L_v0a:
i55 v41,v40,s[100:101] offset:160 sc1
i6 s94,s94,1
i35 s94,400000
i22 L_end
i8 vmcnt(0)
v_cmp_gt_u32 vcc, 0x100, v41
i49 L_v0az
i44 L_v0ak
L_v0az:
s_sleep 2
i44 L_v0a
L_v0ak:
i39 exec,-1
L_v0ab:
s_barrier
global_load_dwordx4 v[44:47], v40, s[100:101] offset:0 sc1
global_load_dwordx4 v[48:51], v40, s[100:101] offset:16 sc1
i8 vmcnt(0)
i5 s93,0
i5 s94,s97
i37 s92,v44
i15 0
i46 s92,32
i28 s93,1,s93
i35 s96,0
i28 s92,s92,0
i6 s94,s94,s92
i37 s92,v45
i15 0
i46 s92,32
i28 s93,1,s93
i35 s96,1
i28 s92,s92,0
i6 s94,s94,s92
i37 s92,v46
i15 0
i46 s92,32
i28 s93,1,s93
i35 s96,2
i28 s92,s92,0
i6 s94,s94,s92
i37 s92,v47
i15 0
i46 s92,32
i28 s93,1,s93
i35 s96,3
i28 s92,s92,0
i6 s94,s94,s92
i37 s92,v48
i15 0
i46 s92,32
i28 s93,1,s93
i35 s96,4
i28 s92,s92,0
i6 s94,s94,s92
i37 s92,v49
i15 0
i46 s92,32
i28 s93,1,s93
i35 s96,5
i28 s92,s92,0
i6 s94,s94,s92
i37 s92,v50
i15 0
i46 s92,32
i28 s93,1,s93
i35 s96,6
i28 s92,s92,0
i6 s94,s94,s92
i37 s92,v51
i15 0
i46 s92,32
i28 s93,1,s93
i35 s96,7
i28 s92,s92,0
i6 s94,s94,s92
i5 s99,1
i47 s93,0
i22 L_v0k
i5 s99,2
s_lshr_b32 s98, s94, 5
s_and_b32 s20, s94, 31
i8 vmcnt(0) lgkmcnt(0)
s_barrier
i44 L_role
L_v0k:
L_role:
i5 s95,0
i47 s98,0
i22 L_chain
s_cmp_lt_u32 s98, 3
i22 L_half
i35 s98,3
i22 L_lin
i46 s99,0
i22 L_v3k
i11 v40,0
i5 s94,0
i46 s21,0
i22 L_v3ab
i39 exec,1
L_v3a:
i55 v41,v40,s[100:101] offset:160 sc1
i6 s94,s94,1
i35 s94,400000
i22 L_end
i8 vmcnt(0)
v_cmp_gt_u32 vcc, 0x100, v41
i49 L_v3az
i44 L_v3ak
L_v3az:
s_sleep 2
i44 L_v3a
L_v3ak:
i39 exec,-1
L_v3ab:
s_barrier
global_load_dwordx4 v[44:47], v40, s[100:101] offset:0 sc1
global_load_dwordx4 v[48:51], v40, s[100:101] offset:16 sc1
i8 vmcnt(0)
i5 s93,0
i5 s94,s97
i37 s92,v44
i15 0
i46 s92,32
i28 s93,1,s93
i35 s96,0
i28 s92,s92,0
i6 s94,s94,s92
i37 s92,v45
i15 0
i46 s92,32
i28 s93,1,s93
i35 s96,1
i28 s92,s92,0
i6 s94,s94,s92
i37 s92,v46
i15 0
i46 s92,32
i28 s93,1,s93
i35 s96,2
i28 s92,s92,0
i6 s94,s94,s92
i37 s92,v47
i15 0
i46 s92,32
i28 s93,1,s93
i35 s96,3
i28 s92,s92,0
i6 s94,s94,s92
i37 s92,v48
i15 0
i46 s92,32
i28 s93,1,s93
i35 s96,4
i28 s92,s92,0
i6 s94,s94,s92
i37 s92,v49
i15 0
i46 s92,32
i28 s93,1,s93
i35 s96,5
i28 s92,s92,0
i6 s94,s94,s92
i37 s92,v50
i15 0
i46 s92,32
i28 s93,1,s93
i35 s96,6
i28 s92,s92,0
i6 s94,s94,s92
i37 s92,v51
i15 0
i46 s92,32
i28 s93,1,s93
i35 s96,7
i28 s92,s92,0
i6 s94,s94,s92
i5 s99,1
i47 s93,0
i22 L_v3k
i5 s99,2
s_lshr_b32 s98, s94, 5
s_and_b32 s20, s94, 31
i8 vmcnt(0) lgkmcnt(0)
s_barrier
i44 L_role
L_v3k:
i32 s3,s20,15
i32 s4,s21,13
i6 s3,s3,s4
i6 s3,s3,72351744
i6 s4,s3,4096
i14 v[40:41],-1
i14 v[42:43],-1
i13 v[40:43],v0,s[8:11],s3 offen offset:0 sc1
i13 v[40:43],v0,s[8:11],s3 offen offset:1024 sc1
i13 v[40:43],v0,s[8:11],s3 offen offset:2048 sc1
i13 v[40:43],v0,s[8:11],s3 offen offset:3072 sc1
i13 v[40:43],v0,s[8:11],s4 offen offset:0 sc1
i13 v[40:43],v0,s[8:11],s4 offen offset:1024 sc1
i13 v[40:43],v0,s[8:11],s4 offen offset:2048 sc1
i13 v[40:43],v0,s[8:11],s4 offen offset:3072 sc1
i32 s3,s21,7
i32 s4,s20,2
i6 s3,s3,s4
i6 s3,s3,74448896
i11 v44,0
i39 exec,1
i52 v44,v44,s[8:11],s3 offen sc1
i39 exec,-1
i8 vmcnt(0)
s_barrier
i46 s21,0
i22 L_s2
i11 v40,48
i11 v41,1
i39 exec,1
global_atomic_add v40, v41, s[100:101]
i39 exec,-1
L_s2:
L_lin:
i50 s[64:65],s[0:1],64
i50 s[66:67],s[0:1],72
i50 s[68:69],s[0:1],40
i50 s[70:71],s[0:1],56
i50 s[72:73],s[0:1],80
s_sub_u32 s3, s98, 3
i32 s3,s3,5
i6 s3,s3,s20
i32 s3,s3,2
i6 s3,s3,s21
i32 s3,s3,12
i6 s4,s3,2621440
i31 v101,2,v0
i5 s91,0x20000
i8 lgkmcnt(0)
i39 s[88:89],s[64:65]
i5 s90,4718592
i36 v100,v101,s[88:91],s3 offen
i36 v100,v101,s[88:91],s4 offen
i39 s[88:89],s[66:67]
i5 s90,4718592
i36 v100,v101,s[88:91],s3 offen
i36 v100,v101,s[88:91],s4 offen
i39 s[88:89],s[68:69]
i5 s90,2359296
i36 v100,v101,s[88:91],s3 offen
i39 s[88:89],s[70:71]
i5 s90,4718592
i36 v100,v101,s[88:91],s3 offen
i36 v100,v101,s[88:91],s4 offen
i39 s[88:89],s[72:73]
i5 s90,4718592
i36 v100,v101,s[88:91],s3 offen
i36 v100,v101,s[88:91],s4 offen
i44 L_g1
L_half:
s_sub_u32 s32, s98, 1
s_and_b32 s30, s20, 1
s_lshr_b32 s31, s20, 1
i50 s[36:37],s[0:1],40
i47 s32,0
i28 s44,64,72
i47 s32,2
i28 s44,56,s44
i50 s[40:41],s[0:1],s44
i23 v10,4,v0
i23 v11,3,v10
i18 v12,7,v10
v_xor_b32 v12, v12, v11
i31 v12,4,v12
i54 s45,1152
i45 v1,v11,s45,v12
i23 v11,5,v10
i18 v12,31,v10
i31 v13,2,v11
v_xor_b32 v12, v12, v13
i31 v12,4,v12
i17 v2,v11,13,v12
v_xor_b32 v3, 128, v2
s_lshr_b32 s44, s21, 1
i32 s44,s44,13
i18 v11,31,v10
i23 v12,5,v10
i18 v13,7,v10
v_xor_b32 v13, v13, v12
i31 v13,4,v13
i17 v4,v11,7,v13
i20 v4,s44,v4
i34 v11,v10,2,2
i17 v13,v12,3,v11
i31 v13,9,v13
i34 v14,v10,4,1
i18 v15,3,v10
i31 v15,3,v15
i24 v15,v14,5,v15
i24 v15,v11,6,v15
i20 v6,v13,v15
s_and_b32 s44, s21, 1
i32 s44,s44,8
i6 s44,s44,16384
i20 v6,s44,v6
i8 lgkmcnt(0)
i5 s38,2359296
i5 s39,0x20000
i5 s42,4718592
i5 s43,0x20000
i32 s47,s30,7
i32 s44,s21,5
i6 s47,s47,s44
s_mul_i32 s47, s47, 1152
i32 s48,s21,17
i32 s44,s31,9
i6 s48,s48,s44
i32 s49,s21,13
i32 s52,s21,12
v_xor_b32 v5, 32, v4
v_xor_b32 v12, 64, v4
v_xor_b32 v13, 96, v4
v_xor_b32 v7, 64, v6
v_xor_b32 v14, 128, v6
v_xor_b32 v15, 192, v6
i6 m0,s52,0
i6 s44,s47,0
i1 v1,s[36:39],s44 offen lds
i6 m0,s49,16384
i6 s44,s48,0
i1 v2,s[40:43],s44 offen lds
i6 m0,s52,1024
i6 s44,s47,9216
i1 v1,s[36:39],s44 offen lds
i6 m0,s49,17408
i6 s44,s48,16384
i1 v3,s[40:43],s44 offen lds
i6 m0,s52,2048
i6 s44,s47,18432
i1 v1,s[36:39],s44 offen lds
i6 m0,s49,18432
i6 s44,s48,32768
i1 v2,s[40:43],s44 offen lds
i6 m0,s52,3072
i6 s44,s47,27648
i1 v1,s[36:39],s44 offen lds
i6 m0,s49,19456
i6 s44,s48,49152
i1 v3,s[40:43],s44 offen lds
i6 m0,s49,20480
i6 s44,s48,65536
i1 v2,s[40:43],s44 offen lds
i6 m0,s49,21504
i6 s44,s48,81920
i1 v3,s[40:43],s44 offen lds
i6 m0,s49,22528
i6 s44,s48,98304
i1 v2,s[40:43],s44 offen lds
i6 m0,s49,23552
i6 s44,s48,114688
i1 v3,s[40:43],s44 offen lds
i6 s47,s47,128
i6 s48,s48,524288
i6 m0,s52,49152
i6 s44,s47,0
i1 v1,s[36:39],s44 offen lds
i6 m0,s49,65536
i6 s44,s48,0
i1 v2,s[40:43],s44 offen lds
i6 m0,s52,50176
i6 s44,s47,9216
i1 v1,s[36:39],s44 offen lds
i6 m0,s49,66560
i6 s44,s48,16384
i1 v3,s[40:43],s44 offen lds
i6 m0,s52,51200
i6 s44,s47,18432
i1 v1,s[36:39],s44 offen lds
i6 m0,s49,67584
i6 s44,s48,32768
i1 v2,s[40:43],s44 offen lds
i6 m0,s52,52224
i6 s44,s47,27648
i1 v1,s[36:39],s44 offen lds
i6 m0,s49,68608
i6 s44,s48,49152
i1 v3,s[40:43],s44 offen lds
i6 m0,s49,69632
i6 s44,s48,65536
i1 v2,s[40:43],s44 offen lds
i6 m0,s49,70656
i6 s44,s48,81920
i1 v3,s[40:43],s44 offen lds
i6 m0,s49,71680
i6 s44,s48,98304
i1 v2,s[40:43],s44 offen lds
i6 m0,s49,72704
i6 s44,s48,114688
i1 v3,s[40:43],s44 offen lds
i6 s47,s47,128
i6 s48,s48,524288
i12 a0,0
i12 a1,0
i12 a2,0
i12 a3,0
i12 a4,0
i12 a5,0
i12 a6,0
i12 a7,0
i12 a8,0
i12 a9,0
i12 a10,0
i12 a11,0
i12 a12,0
i12 a13,0
i12 a14,0
i12 a15,0
i12 a16,0
i12 a17,0
i12 a18,0
i12 a19,0
i12 a20,0
i12 a21,0
i12 a22,0
i12 a23,0
i12 a24,0
i12 a25,0
i12 a26,0
i12 a27,0
i12 a28,0
i12 a29,0
i12 a30,0
i12 a31,0
i12 a64,0
i12 a65,0
i12 a66,0
i12 a67,0
i12 a68,0
i12 a69,0
i12 a70,0
i12 a71,0
i12 a72,0
i12 a73,0
i12 a74,0
i12 a75,0
i12 a76,0
i12 a77,0
i12 a78,0
i12 a79,0
i12 a80,0
i12 a81,0
i12 a82,0
i12 a83,0
i12 a84,0
i12 a85,0
i12 a86,0
i12 a87,0
i12 a88,0
i12 a89,0
i12 a90,0
i12 a91,0
i12 a92,0
i12 a93,0
i12 a94,0
i12 a95,0
i12 a128,0
i12 a129,0
i12 a130,0
i12 a131,0
i12 a132,0
i12 a133,0
i12 a134,0
i12 a135,0
i12 a136,0
i12 a137,0
i12 a138,0
i12 a139,0
i12 a140,0
i12 a141,0
i12 a142,0
i12 a143,0
i12 a144,0
i12 a145,0
i12 a146,0
i12 a147,0
i12 a148,0
i12 a149,0
i12 a150,0
i12 a151,0
i12 a152,0
i12 a153,0
i12 a154,0
i12 a155,0
i12 a156,0
i12 a157,0
i12 a158,0
i12 a159,0
i12 a192,0
i12 a193,0
i12 a194,0
i12 a195,0
i12 a196,0
i12 a197,0
i12 a198,0
i12 a199,0
i12 a200,0
i12 a201,0
i12 a202,0
i12 a203,0
i12 a204,0
i12 a205,0
i12 a206,0
i12 a207,0
i12 a208,0
i12 a209,0
i12 a210,0
i12 a211,0
i12 a212,0
i12 a213,0
i12 a214,0
i12 a215,0
i12 a216,0
i12 a217,0
i12 a218,0
i12 a219,0
i12 a220,0
i12 a221,0
i12 a222,0
i12 a223,0
i47 s32,1
i22 Lh_v
i5 s46,0
Lhk_loop:
i8 vmcnt(12)
s_barrier
i9 v[16:19],v4 offset:0
i0 v[48:49],v6 offset:0
i0 v[50:51],v6 offset:2048
i9 v[20:23],v4 offset:4096
i0 v[52:53],v7 offset:0
i0 v[54:55],v7 offset:2048
i0 v[56:57],v14 offset:0
i0 v[58:59],v14 offset:2048
i0 v[60:61],v15 offset:0
i0 v[62:63],v15 offset:2048
i8 lgkmcnt(0)
i7 a[0:15],v[48:51],v[16:19],a[0:15]
i9 v[32:35],v5 offset:0
i0 v[64:65],v6 offset:8192
i6 m0,s52,98304
i6 s44,s47,0
i1 v1,s[36:39],s44 offen lds
i7 a[16:31],v[48:51],v[20:23],a[16:31]
i0 v[66:67],v6 offset:10240
i9 v[36:39],v5 offset:4096
i6 m0,s49,114688
i6 s44,s48,0
i1 v2,s[40:43],s44 offen lds
i7 a[64:79],v[52:55],v[16:19],a[64:79]
i0 v[68:69],v7 offset:8192
i0 v[70:71],v7 offset:10240
i6 m0,s52,99328
i6 s44,s47,9216
i1 v1,s[36:39],s44 offen lds
i7 a[80:95],v[52:55],v[20:23],a[80:95]
i0 v[72:73],v14 offset:8192
i0 v[74:75],v14 offset:10240
i6 m0,s49,115712
i6 s44,s48,16384
i1 v3,s[40:43],s44 offen lds
i7 a[128:143],v[56:59],v[16:19],a[128:143]
i0 v[76:77],v15 offset:8192
i0 v[78:79],v15 offset:10240
i6 m0,s52,100352
i6 s44,s47,18432
i1 v1,s[36:39],s44 offen lds
i7 a[144:159],v[56:59],v[20:23],a[144:159]
i6 m0,s49,116736
i6 s44,s48,32768
i1 v2,s[40:43],s44 offen lds
i7 a[192:207],v[60:63],v[16:19],a[192:207]
i6 m0,s52,101376
i6 s44,s47,27648
i1 v1,s[36:39],s44 offen lds
i7 a[208:223],v[60:63],v[20:23],a[208:223]
i6 m0,s49,117760
i6 s44,s48,49152
i1 v3,s[40:43],s44 offen lds
i8 lgkmcnt(0)
i7 a[0:15],v[64:67],v[32:35],a[0:15]
i9 v[16:19],v12 offset:0
i0 v[48:49],v6 offset:16384
i6 m0,s49,118784
i6 s44,s48,65536
i1 v2,s[40:43],s44 offen lds
i7 a[16:31],v[64:67],v[36:39],a[16:31]
i0 v[50:51],v6 offset:18432
i9 v[20:23],v12 offset:4096
i6 m0,s49,119808
i6 s44,s48,81920
i1 v3,s[40:43],s44 offen lds
i7 a[64:79],v[68:71],v[32:35],a[64:79]
i0 v[52:53],v7 offset:16384
i0 v[54:55],v7 offset:18432
i6 m0,s49,120832
i6 s44,s48,98304
i1 v2,s[40:43],s44 offen lds
i7 a[80:95],v[68:71],v[36:39],a[80:95]
i0 v[56:57],v14 offset:16384
i0 v[58:59],v14 offset:18432
i6 m0,s49,121856
i6 s44,s48,114688
i1 v3,s[40:43],s44 offen lds
i7 a[128:143],v[72:75],v[32:35],a[128:143]
i0 v[60:61],v15 offset:16384
i0 v[62:63],v15 offset:18432
i7 a[144:159],v[72:75],v[36:39],a[144:159]
i7 a[192:207],v[76:79],v[32:35],a[192:207]
i7 a[208:223],v[76:79],v[36:39],a[208:223]
i8 lgkmcnt(0)
i7 a[0:15],v[48:51],v[16:19],a[0:15]
i9 v[32:35],v13 offset:0
i0 v[64:65],v6 offset:24576
i7 a[16:31],v[48:51],v[20:23],a[16:31]
i0 v[66:67],v6 offset:26624
i9 v[36:39],v13 offset:4096
i7 a[64:79],v[52:55],v[16:19],a[64:79]
i0 v[68:69],v7 offset:24576
i0 v[70:71],v7 offset:26624
i7 a[80:95],v[52:55],v[20:23],a[80:95]
i0 v[72:73],v14 offset:24576
i0 v[74:75],v14 offset:26624
i7 a[128:143],v[56:59],v[16:19],a[128:143]
i0 v[76:77],v15 offset:24576
i0 v[78:79],v15 offset:26624
i7 a[144:159],v[56:59],v[20:23],a[144:159]
i7 a[192:207],v[60:63],v[16:19],a[192:207]
i7 a[208:223],v[60:63],v[20:23],a[208:223]
i8 lgkmcnt(0)
i7 a[0:15],v[64:67],v[32:35],a[0:15]
i7 a[16:31],v[64:67],v[36:39],a[16:31]
i7 a[64:79],v[68:71],v[32:35],a[64:79]
i7 a[80:95],v[68:71],v[36:39],a[80:95]
i7 a[128:143],v[72:75],v[32:35],a[128:143]
i7 a[144:159],v[72:75],v[36:39],a[144:159]
i7 a[192:207],v[76:79],v[32:35],a[192:207]
i7 a[208:223],v[76:79],v[36:39],a[208:223]
i6 s47,s47,128
i6 s48,s48,524288
i20 v4,49152,v4
i20 v5,49152,v5
i20 v12,49152,v12
i20 v13,49152,v13
i20 v6,49152,v6
i20 v7,49152,v7
i20 v14,49152,v14
i20 v15,49152,v15
i8 vmcnt(12)
s_barrier
i9 v[16:19],v4 offset:0
i0 v[48:49],v6 offset:0
i0 v[50:51],v6 offset:2048
i9 v[20:23],v4 offset:4096
i0 v[52:53],v7 offset:0
i0 v[54:55],v7 offset:2048
i0 v[56:57],v14 offset:0
i0 v[58:59],v14 offset:2048
i0 v[60:61],v15 offset:0
i0 v[62:63],v15 offset:2048
i8 lgkmcnt(0)
i7 a[0:15],v[48:51],v[16:19],a[0:15]
i9 v[32:35],v5 offset:0
i0 v[64:65],v6 offset:8192
i6 m0,s52,0
i6 s44,s47,0
i1 v1,s[36:39],s44 offen lds
i7 a[16:31],v[48:51],v[20:23],a[16:31]
i0 v[66:67],v6 offset:10240
i9 v[36:39],v5 offset:4096
i6 m0,s49,16384
i6 s44,s48,0
i1 v2,s[40:43],s44 offen lds
i7 a[64:79],v[52:55],v[16:19],a[64:79]
i0 v[68:69],v7 offset:8192
i0 v[70:71],v7 offset:10240
i6 m0,s52,1024
i6 s44,s47,9216
i1 v1,s[36:39],s44 offen lds
i7 a[80:95],v[52:55],v[20:23],a[80:95]
i0 v[72:73],v14 offset:8192
i0 v[74:75],v14 offset:10240
i6 m0,s49,17408
i6 s44,s48,16384
i1 v3,s[40:43],s44 offen lds
i7 a[128:143],v[56:59],v[16:19],a[128:143]
i0 v[76:77],v15 offset:8192
i0 v[78:79],v15 offset:10240
i6 m0,s52,2048
i6 s44,s47,18432
i1 v1,s[36:39],s44 offen lds
i7 a[144:159],v[56:59],v[20:23],a[144:159]
i6 m0,s49,18432
i6 s44,s48,32768
i1 v2,s[40:43],s44 offen lds
i7 a[192:207],v[60:63],v[16:19],a[192:207]
i6 m0,s52,3072
i6 s44,s47,27648
i1 v1,s[36:39],s44 offen lds
i7 a[208:223],v[60:63],v[20:23],a[208:223]
i6 m0,s49,19456
i6 s44,s48,49152
i1 v3,s[40:43],s44 offen lds
i8 lgkmcnt(0)
i7 a[0:15],v[64:67],v[32:35],a[0:15]
i9 v[16:19],v12 offset:0
i0 v[48:49],v6 offset:16384
i6 m0,s49,20480
i6 s44,s48,65536
i1 v2,s[40:43],s44 offen lds
i7 a[16:31],v[64:67],v[36:39],a[16:31]
i0 v[50:51],v6 offset:18432
i9 v[20:23],v12 offset:4096
i6 m0,s49,21504
i6 s44,s48,81920
i1 v3,s[40:43],s44 offen lds
i7 a[64:79],v[68:71],v[32:35],a[64:79]
i0 v[52:53],v7 offset:16384
i0 v[54:55],v7 offset:18432
i6 m0,s49,22528
i6 s44,s48,98304
i1 v2,s[40:43],s44 offen lds
i7 a[80:95],v[68:71],v[36:39],a[80:95]
i0 v[56:57],v14 offset:16384
i0 v[58:59],v14 offset:18432
i6 m0,s49,23552
i6 s44,s48,114688
i1 v3,s[40:43],s44 offen lds
i7 a[128:143],v[72:75],v[32:35],a[128:143]
i0 v[60:61],v15 offset:16384
i0 v[62:63],v15 offset:18432
i7 a[144:159],v[72:75],v[36:39],a[144:159]
i7 a[192:207],v[76:79],v[32:35],a[192:207]
i7 a[208:223],v[76:79],v[36:39],a[208:223]
i8 lgkmcnt(0)
i7 a[0:15],v[48:51],v[16:19],a[0:15]
i9 v[32:35],v13 offset:0
i0 v[64:65],v6 offset:24576
i7 a[16:31],v[48:51],v[20:23],a[16:31]
i0 v[66:67],v6 offset:26624
i9 v[36:39],v13 offset:4096
i7 a[64:79],v[52:55],v[16:19],a[64:79]
i0 v[68:69],v7 offset:24576
i0 v[70:71],v7 offset:26624
i7 a[80:95],v[52:55],v[20:23],a[80:95]
i0 v[72:73],v14 offset:24576
i0 v[74:75],v14 offset:26624
i7 a[128:143],v[56:59],v[16:19],a[128:143]
i0 v[76:77],v15 offset:24576
i0 v[78:79],v15 offset:26624
i7 a[144:159],v[56:59],v[20:23],a[144:159]
i7 a[192:207],v[60:63],v[16:19],a[192:207]
i7 a[208:223],v[60:63],v[20:23],a[208:223]
i8 lgkmcnt(0)
i7 a[0:15],v[64:67],v[32:35],a[0:15]
i7 a[16:31],v[64:67],v[36:39],a[16:31]
i7 a[64:79],v[68:71],v[32:35],a[64:79]
i7 a[80:95],v[68:71],v[36:39],a[80:95]
i7 a[128:143],v[72:75],v[32:35],a[128:143]
i7 a[144:159],v[72:75],v[36:39],a[144:159]
i7 a[192:207],v[76:79],v[32:35],a[192:207]
i7 a[208:223],v[76:79],v[36:39],a[208:223]
i6 s47,s47,128
i6 s48,s48,524288
i20 v4,49152,v4
i20 v5,49152,v5
i20 v12,49152,v12
i20 v13,49152,v13
i20 v6,49152,v6
i20 v7,49152,v7
i20 v14,49152,v14
i20 v15,49152,v15
i8 vmcnt(12)
s_barrier
i9 v[16:19],v4 offset:0
i0 v[48:49],v6 offset:0
i0 v[50:51],v6 offset:2048
i9 v[20:23],v4 offset:4096
i0 v[52:53],v7 offset:0
i0 v[54:55],v7 offset:2048
i0 v[56:57],v14 offset:0
i0 v[58:59],v14 offset:2048
i0 v[60:61],v15 offset:0
i0 v[62:63],v15 offset:2048
i8 lgkmcnt(0)
i7 a[0:15],v[48:51],v[16:19],a[0:15]
i9 v[32:35],v5 offset:0
i0 v[64:65],v6 offset:8192
i6 m0,s52,49152
i6 s44,s47,0
i1 v1,s[36:39],s44 offen lds
i7 a[16:31],v[48:51],v[20:23],a[16:31]
i0 v[66:67],v6 offset:10240
i9 v[36:39],v5 offset:4096
i6 m0,s49,65536
i6 s44,s48,0
i1 v2,s[40:43],s44 offen lds
i7 a[64:79],v[52:55],v[16:19],a[64:79]
i0 v[68:69],v7 offset:8192
i0 v[70:71],v7 offset:10240
i6 m0,s52,50176
i6 s44,s47,9216
i1 v1,s[36:39],s44 offen lds
i7 a[80:95],v[52:55],v[20:23],a[80:95]
i0 v[72:73],v14 offset:8192
i0 v[74:75],v14 offset:10240
i6 m0,s49,66560
i6 s44,s48,16384
i1 v3,s[40:43],s44 offen lds
i7 a[128:143],v[56:59],v[16:19],a[128:143]
i0 v[76:77],v15 offset:8192
i0 v[78:79],v15 offset:10240
i6 m0,s52,51200
i6 s44,s47,18432
i1 v1,s[36:39],s44 offen lds
i7 a[144:159],v[56:59],v[20:23],a[144:159]
i6 m0,s49,67584
i6 s44,s48,32768
i1 v2,s[40:43],s44 offen lds
i7 a[192:207],v[60:63],v[16:19],a[192:207]
i6 m0,s52,52224
i6 s44,s47,27648
i1 v1,s[36:39],s44 offen lds
i7 a[208:223],v[60:63],v[20:23],a[208:223]
i6 m0,s49,68608
i6 s44,s48,49152
i1 v3,s[40:43],s44 offen lds
i8 lgkmcnt(0)
i7 a[0:15],v[64:67],v[32:35],a[0:15]
i9 v[16:19],v12 offset:0
i0 v[48:49],v6 offset:16384
i6 m0,s49,69632
i6 s44,s48,65536
i1 v2,s[40:43],s44 offen lds
i7 a[16:31],v[64:67],v[36:39],a[16:31]
i0 v[50:51],v6 offset:18432
i9 v[20:23],v12 offset:4096
i6 m0,s49,70656
i6 s44,s48,81920
i1 v3,s[40:43],s44 offen lds
i7 a[64:79],v[68:71],v[32:35],a[64:79]
i0 v[52:53],v7 offset:16384
i0 v[54:55],v7 offset:18432
i6 m0,s49,71680
i6 s44,s48,98304
i1 v2,s[40:43],s44 offen lds
i7 a[80:95],v[68:71],v[36:39],a[80:95]
i0 v[56:57],v14 offset:16384
i0 v[58:59],v14 offset:18432
i6 m0,s49,72704
i6 s44,s48,114688
i1 v3,s[40:43],s44 offen lds
i7 a[128:143],v[72:75],v[32:35],a[128:143]
i0 v[60:61],v15 offset:16384
i0 v[62:63],v15 offset:18432
i7 a[144:159],v[72:75],v[36:39],a[144:159]
i7 a[192:207],v[76:79],v[32:35],a[192:207]
i7 a[208:223],v[76:79],v[36:39],a[208:223]
i8 lgkmcnt(0)
i7 a[0:15],v[48:51],v[16:19],a[0:15]
i9 v[32:35],v13 offset:0
i0 v[64:65],v6 offset:24576
i7 a[16:31],v[48:51],v[20:23],a[16:31]
i0 v[66:67],v6 offset:26624
i9 v[36:39],v13 offset:4096
i7 a[64:79],v[52:55],v[16:19],a[64:79]
i0 v[68:69],v7 offset:24576
i0 v[70:71],v7 offset:26624
i7 a[80:95],v[52:55],v[20:23],a[80:95]
i0 v[72:73],v14 offset:24576
i0 v[74:75],v14 offset:26624
i7 a[128:143],v[56:59],v[16:19],a[128:143]
i0 v[76:77],v15 offset:24576
i0 v[78:79],v15 offset:26624
i7 a[144:159],v[56:59],v[20:23],a[144:159]
i7 a[192:207],v[60:63],v[16:19],a[192:207]
i7 a[208:223],v[60:63],v[20:23],a[208:223]
i8 lgkmcnt(0)
i7 a[0:15],v[64:67],v[32:35],a[0:15]
i7 a[16:31],v[64:67],v[36:39],a[16:31]
i7 a[64:79],v[68:71],v[32:35],a[64:79]
i7 a[80:95],v[68:71],v[36:39],a[80:95]
i7 a[128:143],v[72:75],v[32:35],a[128:143]
i7 a[144:159],v[72:75],v[36:39],a[144:159]
i7 a[192:207],v[76:79],v[32:35],a[192:207]
i7 a[208:223],v[76:79],v[36:39],a[208:223]
i6 s47,s47,128
i6 s48,s48,524288
i20 v4,4294868992,v4
i20 v5,4294868992,v5
i20 v12,4294868992,v12
i20 v13,4294868992,v13
i20 v6,4294868992,v6
i20 v7,4294868992,v7
i20 v14,4294868992,v14
i20 v15,4294868992,v15
i6 s46,s46,1
s_cmp_lt_u32 s46, 2
i22 Lhk_loop
i8 vmcnt(12)
s_barrier
i9 v[16:19],v4 offset:0
i0 v[48:49],v6 offset:0
i0 v[50:51],v6 offset:2048
i9 v[20:23],v4 offset:4096
i0 v[52:53],v7 offset:0
i0 v[54:55],v7 offset:2048
i0 v[56:57],v14 offset:0
i0 v[58:59],v14 offset:2048
i0 v[60:61],v15 offset:0
i0 v[62:63],v15 offset:2048
i8 lgkmcnt(0)
i7 a[0:15],v[48:51],v[16:19],a[0:15]
i9 v[32:35],v5 offset:0
i0 v[64:65],v6 offset:8192
i6 m0,s52,98304
i6 s44,s47,0
i1 v1,s[36:39],s44 offen lds
i7 a[16:31],v[48:51],v[20:23],a[16:31]
i0 v[66:67],v6 offset:10240
i9 v[36:39],v5 offset:4096
i6 m0,s49,114688
i6 s44,s48,0
i1 v2,s[40:43],s44 offen lds
i7 a[64:79],v[52:55],v[16:19],a[64:79]
i0 v[68:69],v7 offset:8192
i0 v[70:71],v7 offset:10240
i6 m0,s52,99328
i6 s44,s47,9216
i1 v1,s[36:39],s44 offen lds
i7 a[80:95],v[52:55],v[20:23],a[80:95]
i0 v[72:73],v14 offset:8192
i0 v[74:75],v14 offset:10240
i6 m0,s49,115712
i6 s44,s48,16384
i1 v3,s[40:43],s44 offen lds
i7 a[128:143],v[56:59],v[16:19],a[128:143]
i0 v[76:77],v15 offset:8192
i0 v[78:79],v15 offset:10240
i6 m0,s52,100352
i6 s44,s47,18432
i1 v1,s[36:39],s44 offen lds
i7 a[144:159],v[56:59],v[20:23],a[144:159]
i6 m0,s49,116736
i6 s44,s48,32768
i1 v2,s[40:43],s44 offen lds
i7 a[192:207],v[60:63],v[16:19],a[192:207]
i6 m0,s52,101376
i6 s44,s47,27648
i1 v1,s[36:39],s44 offen lds
i7 a[208:223],v[60:63],v[20:23],a[208:223]
i6 m0,s49,117760
i6 s44,s48,49152
i1 v3,s[40:43],s44 offen lds
i8 lgkmcnt(0)
i7 a[0:15],v[64:67],v[32:35],a[0:15]
i9 v[16:19],v12 offset:0
i0 v[48:49],v6 offset:16384
i6 m0,s49,118784
i6 s44,s48,65536
i1 v2,s[40:43],s44 offen lds
i7 a[16:31],v[64:67],v[36:39],a[16:31]
i0 v[50:51],v6 offset:18432
i9 v[20:23],v12 offset:4096
i6 m0,s49,119808
i6 s44,s48,81920
i1 v3,s[40:43],s44 offen lds
i7 a[64:79],v[68:71],v[32:35],a[64:79]
i0 v[52:53],v7 offset:16384
i0 v[54:55],v7 offset:18432
i6 m0,s49,120832
i6 s44,s48,98304
i1 v2,s[40:43],s44 offen lds
i7 a[80:95],v[68:71],v[36:39],a[80:95]
i0 v[56:57],v14 offset:16384
i0 v[58:59],v14 offset:18432
i6 m0,s49,121856
i6 s44,s48,114688
i1 v3,s[40:43],s44 offen lds
i7 a[128:143],v[72:75],v[32:35],a[128:143]
i0 v[60:61],v15 offset:16384
i0 v[62:63],v15 offset:18432
i7 a[144:159],v[72:75],v[36:39],a[144:159]
i7 a[192:207],v[76:79],v[32:35],a[192:207]
i7 a[208:223],v[76:79],v[36:39],a[208:223]
i8 lgkmcnt(0)
i7 a[0:15],v[48:51],v[16:19],a[0:15]
i9 v[32:35],v13 offset:0
i0 v[64:65],v6 offset:24576
i7 a[16:31],v[48:51],v[20:23],a[16:31]
i0 v[66:67],v6 offset:26624
i9 v[36:39],v13 offset:4096
i7 a[64:79],v[52:55],v[16:19],a[64:79]
i0 v[68:69],v7 offset:24576
i0 v[70:71],v7 offset:26624
i7 a[80:95],v[52:55],v[20:23],a[80:95]
i0 v[72:73],v14 offset:24576
i0 v[74:75],v14 offset:26624
i7 a[128:143],v[56:59],v[16:19],a[128:143]
i0 v[76:77],v15 offset:24576
i0 v[78:79],v15 offset:26624
i7 a[144:159],v[56:59],v[20:23],a[144:159]
i7 a[192:207],v[60:63],v[16:19],a[192:207]
i7 a[208:223],v[60:63],v[20:23],a[208:223]
i8 lgkmcnt(0)
i7 a[0:15],v[64:67],v[32:35],a[0:15]
i7 a[16:31],v[64:67],v[36:39],a[16:31]
i7 a[64:79],v[68:71],v[32:35],a[64:79]
i7 a[80:95],v[68:71],v[36:39],a[80:95]
i7 a[128:143],v[72:75],v[32:35],a[128:143]
i7 a[144:159],v[72:75],v[36:39],a[144:159]
i7 a[192:207],v[76:79],v[32:35],a[192:207]
i7 a[208:223],v[76:79],v[36:39],a[208:223]
i6 s47,s47,128
i6 s48,s48,524288
i20 v4,49152,v4
i20 v5,49152,v5
i20 v12,49152,v12
i20 v13,49152,v13
i20 v6,49152,v6
i20 v7,49152,v7
i20 v14,49152,v14
i20 v15,49152,v15
i8 vmcnt(12)
s_barrier
i9 v[16:19],v4 offset:0
i0 v[48:49],v6 offset:0
i0 v[50:51],v6 offset:2048
i9 v[20:23],v4 offset:4096
i0 v[52:53],v7 offset:0
i0 v[54:55],v7 offset:2048
i0 v[56:57],v14 offset:0
i0 v[58:59],v14 offset:2048
i0 v[60:61],v15 offset:0
i0 v[62:63],v15 offset:2048
i8 lgkmcnt(0)
i7 a[0:15],v[48:51],v[16:19],a[0:15]
i9 v[32:35],v5 offset:0
i0 v[64:65],v6 offset:8192
i7 a[16:31],v[48:51],v[20:23],a[16:31]
i0 v[66:67],v6 offset:10240
i9 v[36:39],v5 offset:4096
i7 a[64:79],v[52:55],v[16:19],a[64:79]
i0 v[68:69],v7 offset:8192
i0 v[70:71],v7 offset:10240
i7 a[80:95],v[52:55],v[20:23],a[80:95]
i0 v[72:73],v14 offset:8192
i0 v[74:75],v14 offset:10240
i7 a[128:143],v[56:59],v[16:19],a[128:143]
i0 v[76:77],v15 offset:8192
i0 v[78:79],v15 offset:10240
i7 a[144:159],v[56:59],v[20:23],a[144:159]
i7 a[192:207],v[60:63],v[16:19],a[192:207]
i7 a[208:223],v[60:63],v[20:23],a[208:223]
i8 lgkmcnt(0)
i7 a[0:15],v[64:67],v[32:35],a[0:15]
i9 v[16:19],v12 offset:0
i0 v[48:49],v6 offset:16384
i7 a[16:31],v[64:67],v[36:39],a[16:31]
i0 v[50:51],v6 offset:18432
i9 v[20:23],v12 offset:4096
i7 a[64:79],v[68:71],v[32:35],a[64:79]
i0 v[52:53],v7 offset:16384
i0 v[54:55],v7 offset:18432
i7 a[80:95],v[68:71],v[36:39],a[80:95]
i0 v[56:57],v14 offset:16384
i0 v[58:59],v14 offset:18432
i7 a[128:143],v[72:75],v[32:35],a[128:143]
i0 v[60:61],v15 offset:16384
i0 v[62:63],v15 offset:18432
i7 a[144:159],v[72:75],v[36:39],a[144:159]
i7 a[192:207],v[76:79],v[32:35],a[192:207]
i7 a[208:223],v[76:79],v[36:39],a[208:223]
i8 lgkmcnt(0)
i7 a[0:15],v[48:51],v[16:19],a[0:15]
i9 v[32:35],v13 offset:0
i0 v[64:65],v6 offset:24576
i7 a[16:31],v[48:51],v[20:23],a[16:31]
i0 v[66:67],v6 offset:26624
i9 v[36:39],v13 offset:4096
i7 a[64:79],v[52:55],v[16:19],a[64:79]
i0 v[68:69],v7 offset:24576
i0 v[70:71],v7 offset:26624
i7 a[80:95],v[52:55],v[20:23],a[80:95]
i0 v[72:73],v14 offset:24576
i0 v[74:75],v14 offset:26624
i7 a[128:143],v[56:59],v[16:19],a[128:143]
i0 v[76:77],v15 offset:24576
i0 v[78:79],v15 offset:26624
i7 a[144:159],v[56:59],v[20:23],a[144:159]
i7 a[192:207],v[60:63],v[16:19],a[192:207]
i7 a[208:223],v[60:63],v[20:23],a[208:223]
i8 lgkmcnt(0)
i7 a[0:15],v[64:67],v[32:35],a[0:15]
i7 a[16:31],v[64:67],v[36:39],a[16:31]
i7 a[64:79],v[68:71],v[32:35],a[64:79]
i7 a[80:95],v[68:71],v[36:39],a[80:95]
i7 a[128:143],v[72:75],v[32:35],a[128:143]
i7 a[144:159],v[72:75],v[36:39],a[144:159]
i7 a[192:207],v[76:79],v[32:35],a[192:207]
i7 a[208:223],v[76:79],v[36:39],a[208:223]
i20 v4,49152,v4
i20 v5,49152,v5
i20 v12,49152,v12
i20 v13,49152,v13
i20 v6,49152,v6
i20 v7,49152,v7
i20 v14,49152,v14
i20 v15,49152,v15
i8 vmcnt(0)
s_barrier
i9 v[16:19],v4 offset:0
i0 v[48:49],v6 offset:0
i0 v[50:51],v6 offset:2048
i9 v[20:23],v4 offset:4096
i0 v[52:53],v7 offset:0
i0 v[54:55],v7 offset:2048
i0 v[56:57],v14 offset:0
i0 v[58:59],v14 offset:2048
i0 v[60:61],v15 offset:0
i0 v[62:63],v15 offset:2048
i8 lgkmcnt(0)
i7 a[0:15],v[48:51],v[16:19],a[0:15]
i9 v[32:35],v5 offset:0
i0 v[64:65],v6 offset:8192
i7 a[16:31],v[48:51],v[20:23],a[16:31]
i0 v[66:67],v6 offset:10240
i9 v[36:39],v5 offset:4096
i7 a[64:79],v[52:55],v[16:19],a[64:79]
i0 v[68:69],v7 offset:8192
i0 v[70:71],v7 offset:10240
i7 a[80:95],v[52:55],v[20:23],a[80:95]
i0 v[72:73],v14 offset:8192
i0 v[74:75],v14 offset:10240
i7 a[128:143],v[56:59],v[16:19],a[128:143]
i0 v[76:77],v15 offset:8192
i0 v[78:79],v15 offset:10240
i7 a[144:159],v[56:59],v[20:23],a[144:159]
i7 a[192:207],v[60:63],v[16:19],a[192:207]
i7 a[208:223],v[60:63],v[20:23],a[208:223]
i8 lgkmcnt(0)
i7 a[0:15],v[64:67],v[32:35],a[0:15]
i9 v[16:19],v12 offset:0
i0 v[48:49],v6 offset:16384
i7 a[16:31],v[64:67],v[36:39],a[16:31]
i0 v[50:51],v6 offset:18432
i9 v[20:23],v12 offset:4096
i7 a[64:79],v[68:71],v[32:35],a[64:79]
i0 v[52:53],v7 offset:16384
i0 v[54:55],v7 offset:18432
i7 a[80:95],v[68:71],v[36:39],a[80:95]
i0 v[56:57],v14 offset:16384
i0 v[58:59],v14 offset:18432
i7 a[128:143],v[72:75],v[32:35],a[128:143]
i0 v[60:61],v15 offset:16384
i0 v[62:63],v15 offset:18432
i7 a[144:159],v[72:75],v[36:39],a[144:159]
i7 a[192:207],v[76:79],v[32:35],a[192:207]
i7 a[208:223],v[76:79],v[36:39],a[208:223]
i8 lgkmcnt(0)
i7 a[0:15],v[48:51],v[16:19],a[0:15]
i9 v[32:35],v13 offset:0
i0 v[64:65],v6 offset:24576
i7 a[16:31],v[48:51],v[20:23],a[16:31]
i0 v[66:67],v6 offset:26624
i9 v[36:39],v13 offset:4096
i7 a[64:79],v[52:55],v[16:19],a[64:79]
i0 v[68:69],v7 offset:24576
i0 v[70:71],v7 offset:26624
i7 a[80:95],v[52:55],v[20:23],a[80:95]
i0 v[72:73],v14 offset:24576
i0 v[74:75],v14 offset:26624
i7 a[128:143],v[56:59],v[16:19],a[128:143]
i0 v[76:77],v15 offset:24576
i0 v[78:79],v15 offset:26624
i7 a[144:159],v[56:59],v[20:23],a[144:159]
i7 a[192:207],v[60:63],v[16:19],a[192:207]
i7 a[208:223],v[60:63],v[20:23],a[208:223]
i8 lgkmcnt(0)
i7 a[0:15],v[64:67],v[32:35],a[0:15]
i7 a[16:31],v[64:67],v[36:39],a[16:31]
i7 a[64:79],v[68:71],v[32:35],a[64:79]
i7 a[80:95],v[68:71],v[36:39],a[80:95]
i7 a[128:143],v[72:75],v[32:35],a[128:143]
i7 a[144:159],v[72:75],v[36:39],a[144:159]
i7 a[192:207],v[76:79],v[32:35],a[192:207]
i7 a[208:223],v[76:79],v[36:39],a[208:223]
i23 v10,4,v0
i23 v11,5,v10
i31 v11,8,v11
i34 v12,v10,3,1
i24 v11,v12,10,v11
i34 v12,v10,4,1
i24 v11,v12,7,v11
i18 v12,0x70,v0
v_or_b32 v8, v11, v12
i32 s44,s30,2
s_lshr_b32 s45, s21, 1
i32 s45,s45,1
i6 s44,s44,s45
i32 s49,s44,18
i32 s44,s31,1
s_and_b32 s45, s21, 1
i6 s44,s44,s45
i32 s44,s44,13
i6 s49,s49,s44
i32 s44,s32,24
i6 s49,s49,s44
i47 s32,0
i28 s50,1040356334,1.0
i5 s51,s50
i15 7
i15 7
i6 s44,s49,0
i10 v16,a0
i10 v17,a1
i10 v18,a2
i10 v19,a3
i10 v20,a4
i10 v21,a5
i10 v22,a6
i10 v23,a7
i16 v[16:17],v[16:17],s[50:51]
i16 v[18:19],v[18:19],s[50:51]
i16 v[20:21],v[20:21],s[50:51]
i16 v[22:23],v[22:23],s[50:51]
i3 v24,v16,v17
i3 v25,v18,v19
i3 v26,v20,v21
i3 v27,v22,v23
i13 v[24:27],v8,s[8:11],s44 offen offset:0 sc1
i10 v28,a8
i10 v29,a9
i10 v30,a10
i10 v31,a11
i10 v32,a12
i10 v33,a13
i10 v34,a14
i10 v35,a15
i16 v[28:29],v[28:29],s[50:51]
i16 v[30:31],v[30:31],s[50:51]
i16 v[32:33],v[32:33],s[50:51]
i16 v[34:35],v[34:35],s[50:51]
i3 v36,v28,v29
i3 v37,v30,v31
i3 v38,v32,v33
i3 v39,v34,v35
i13 v[36:39],v8,s[8:11],s44 offen offset:512 sc1
i6 s44,s49,2048
i10 v40,a64
i10 v41,a65
i10 v42,a66
i10 v43,a67
i10 v44,a68
i10 v45,a69
i10 v46,a70
i10 v47,a71
i16 v[40:41],v[40:41],s[50:51]
i16 v[42:43],v[42:43],s[50:51]
i16 v[44:45],v[44:45],s[50:51]
i16 v[46:47],v[46:47],s[50:51]
i3 v48,v40,v41
i3 v49,v42,v43
i3 v50,v44,v45
i3 v51,v46,v47
i13 v[48:51],v8,s[8:11],s44 offen offset:0 sc1
i10 v52,a72
i10 v53,a73
i10 v54,a74
i10 v55,a75
i10 v56,a76
i10 v57,a77
i10 v58,a78
i10 v59,a79
i16 v[52:53],v[52:53],s[50:51]
i16 v[54:55],v[54:55],s[50:51]
i16 v[56:57],v[56:57],s[50:51]
i16 v[58:59],v[58:59],s[50:51]
i3 v60,v52,v53
i3 v61,v54,v55
i3 v62,v56,v57
i3 v63,v58,v59
i13 v[60:63],v8,s[8:11],s44 offen offset:512 sc1
i6 s44,s49,4096
i10 v16,a128
i10 v17,a129
i10 v18,a130
i10 v19,a131
i10 v20,a132
i10 v21,a133
i10 v22,a134
i10 v23,a135
i16 v[16:17],v[16:17],s[50:51]
i16 v[18:19],v[18:19],s[50:51]
i16 v[20:21],v[20:21],s[50:51]
i16 v[22:23],v[22:23],s[50:51]
i3 v24,v16,v17
i3 v25,v18,v19
i3 v26,v20,v21
i3 v27,v22,v23
i13 v[24:27],v8,s[8:11],s44 offen offset:0 sc1
i10 v28,a136
i10 v29,a137
i10 v30,a138
i10 v31,a139
i10 v32,a140
i10 v33,a141
i10 v34,a142
i10 v35,a143
i16 v[28:29],v[28:29],s[50:51]
i16 v[30:31],v[30:31],s[50:51]
i16 v[32:33],v[32:33],s[50:51]
i16 v[34:35],v[34:35],s[50:51]
i3 v36,v28,v29
i3 v37,v30,v31
i3 v38,v32,v33
i3 v39,v34,v35
i13 v[36:39],v8,s[8:11],s44 offen offset:512 sc1
i6 s44,s49,6144
i10 v40,a192
i10 v41,a193
i10 v42,a194
i10 v43,a195
i10 v44,a196
i10 v45,a197
i10 v46,a198
i10 v47,a199
i16 v[40:41],v[40:41],s[50:51]
i16 v[42:43],v[42:43],s[50:51]
i16 v[44:45],v[44:45],s[50:51]
i16 v[46:47],v[46:47],s[50:51]
i3 v48,v40,v41
i3 v49,v42,v43
i3 v50,v44,v45
i3 v51,v46,v47
i13 v[48:51],v8,s[8:11],s44 offen offset:0 sc1
i10 v52,a200
i10 v53,a201
i10 v54,a202
i10 v55,a203
i10 v56,a204
i10 v57,a205
i10 v58,a206
i10 v59,a207
i16 v[52:53],v[52:53],s[50:51]
i16 v[54:55],v[54:55],s[50:51]
i16 v[56:57],v[56:57],s[50:51]
i16 v[58:59],v[58:59],s[50:51]
i3 v60,v52,v53
i3 v61,v54,v55
i3 v62,v56,v57
i3 v63,v58,v59
i13 v[60:63],v8,s[8:11],s44 offen offset:512 sc1
i6 s44,s49,262144
i10 v16,a16
i10 v17,a17
i10 v18,a18
i10 v19,a19
i10 v20,a20
i10 v21,a21
i10 v22,a22
i10 v23,a23
i16 v[16:17],v[16:17],s[50:51]
i16 v[18:19],v[18:19],s[50:51]
i16 v[20:21],v[20:21],s[50:51]
i16 v[22:23],v[22:23],s[50:51]
i3 v24,v16,v17
i3 v25,v18,v19
i3 v26,v20,v21
i3 v27,v22,v23
i13 v[24:27],v8,s[8:11],s44 offen offset:0 sc1
i10 v28,a24
i10 v29,a25
i10 v30,a26
i10 v31,a27
i10 v32,a28
i10 v33,a29
i10 v34,a30
i10 v35,a31
i16 v[28:29],v[28:29],s[50:51]
i16 v[30:31],v[30:31],s[50:51]
i16 v[32:33],v[32:33],s[50:51]
i16 v[34:35],v[34:35],s[50:51]
i3 v36,v28,v29
i3 v37,v30,v31
i3 v38,v32,v33
i3 v39,v34,v35
i13 v[36:39],v8,s[8:11],s44 offen offset:512 sc1
i6 s44,s49,264192
i10 v40,a80
i10 v41,a81
i10 v42,a82
i10 v43,a83
i10 v44,a84
i10 v45,a85
i10 v46,a86
i10 v47,a87
i16 v[40:41],v[40:41],s[50:51]
i16 v[42:43],v[42:43],s[50:51]
i16 v[44:45],v[44:45],s[50:51]
i16 v[46:47],v[46:47],s[50:51]
i3 v48,v40,v41
i3 v49,v42,v43
i3 v50,v44,v45
i3 v51,v46,v47
i13 v[48:51],v8,s[8:11],s44 offen offset:0 sc1
i10 v52,a88
i10 v53,a89
i10 v54,a90
i10 v55,a91
i10 v56,a92
i10 v57,a93
i10 v58,a94
i10 v59,a95
i16 v[52:53],v[52:53],s[50:51]
i16 v[54:55],v[54:55],s[50:51]
i16 v[56:57],v[56:57],s[50:51]
i16 v[58:59],v[58:59],s[50:51]
i3 v60,v52,v53
i3 v61,v54,v55
i3 v62,v56,v57
i3 v63,v58,v59
i13 v[60:63],v8,s[8:11],s44 offen offset:512 sc1
i6 s44,s49,266240
i10 v16,a144
i10 v17,a145
i10 v18,a146
i10 v19,a147
i10 v20,a148
i10 v21,a149
i10 v22,a150
i10 v23,a151
i16 v[16:17],v[16:17],s[50:51]
i16 v[18:19],v[18:19],s[50:51]
i16 v[20:21],v[20:21],s[50:51]
i16 v[22:23],v[22:23],s[50:51]
i3 v24,v16,v17
i3 v25,v18,v19
i3 v26,v20,v21
i3 v27,v22,v23
i13 v[24:27],v8,s[8:11],s44 offen offset:0 sc1
i10 v28,a152
i10 v29,a153
i10 v30,a154
i10 v31,a155
i10 v32,a156
i10 v33,a157
i10 v34,a158
i10 v35,a159
i16 v[28:29],v[28:29],s[50:51]
i16 v[30:31],v[30:31],s[50:51]
i16 v[32:33],v[32:33],s[50:51]
i16 v[34:35],v[34:35],s[50:51]
i3 v36,v28,v29
i3 v37,v30,v31
i3 v38,v32,v33
i3 v39,v34,v35
i13 v[36:39],v8,s[8:11],s44 offen offset:512 sc1
i6 s44,s49,268288
i10 v40,a208
i10 v41,a209
i10 v42,a210
i10 v43,a211
i10 v44,a212
i10 v45,a213
i10 v46,a214
i10 v47,a215
i16 v[40:41],v[40:41],s[50:51]
i16 v[42:43],v[42:43],s[50:51]
i16 v[44:45],v[44:45],s[50:51]
i16 v[46:47],v[46:47],s[50:51]
i3 v48,v40,v41
i3 v49,v42,v43
i3 v50,v44,v45
i3 v51,v46,v47
i13 v[48:51],v8,s[8:11],s44 offen offset:0 sc1
i10 v52,a216
i10 v53,a217
i10 v54,a218
i10 v55,a219
i10 v56,a220
i10 v57,a221
i10 v58,a222
i10 v59,a223
i16 v[52:53],v[52:53],s[50:51]
i16 v[54:55],v[54:55],s[50:51]
i16 v[56:57],v[56:57],s[50:51]
i16 v[58:59],v[58:59],s[50:51]
i3 v60,v52,v53
i3 v61,v54,v55
i3 v62,v56,v57
i3 v63,v58,v59
i13 v[60:63],v8,s[8:11],s44 offen offset:512 sc1
i44 Lh_end
Lh_v:
i5 s46,0
Lhv_loop:
i8 vmcnt(12)
s_barrier
i9 v[16:19],v4 offset:0
i0 v[48:49],v6 offset:0
i0 v[50:51],v6 offset:2048
i9 v[20:23],v4 offset:4096
i0 v[52:53],v7 offset:0
i0 v[54:55],v7 offset:2048
i0 v[56:57],v14 offset:0
i0 v[58:59],v14 offset:2048
i0 v[60:61],v15 offset:0
i0 v[62:63],v15 offset:2048
i8 lgkmcnt(0)
i7 a[0:15],v[16:19],v[48:51],a[0:15]
i9 v[32:35],v5 offset:0
i0 v[64:65],v6 offset:8192
i6 m0,s52,98304
i6 s44,s47,0
i1 v1,s[36:39],s44 offen lds
i7 a[16:31],v[20:23],v[48:51],a[16:31]
i0 v[66:67],v6 offset:10240
i9 v[36:39],v5 offset:4096
i6 m0,s49,114688
i6 s44,s48,0
i1 v2,s[40:43],s44 offen lds
i7 a[64:79],v[16:19],v[52:55],a[64:79]
i0 v[68:69],v7 offset:8192
i0 v[70:71],v7 offset:10240
i6 m0,s52,99328
i6 s44,s47,9216
i1 v1,s[36:39],s44 offen lds
i7 a[80:95],v[20:23],v[52:55],a[80:95]
i0 v[72:73],v14 offset:8192
i0 v[74:75],v14 offset:10240
i6 m0,s49,115712
i6 s44,s48,16384
i1 v3,s[40:43],s44 offen lds
i7 a[128:143],v[16:19],v[56:59],a[128:143]
i0 v[76:77],v15 offset:8192
i0 v[78:79],v15 offset:10240
i6 m0,s52,100352
i6 s44,s47,18432
i1 v1,s[36:39],s44 offen lds
i7 a[144:159],v[20:23],v[56:59],a[144:159]
i6 m0,s49,116736
i6 s44,s48,32768
i1 v2,s[40:43],s44 offen lds
i7 a[192:207],v[16:19],v[60:63],a[192:207]
i6 m0,s52,101376
i6 s44,s47,27648
i1 v1,s[36:39],s44 offen lds
i7 a[208:223],v[20:23],v[60:63],a[208:223]
i6 m0,s49,117760
i6 s44,s48,49152
i1 v3,s[40:43],s44 offen lds
i8 lgkmcnt(0)
i7 a[0:15],v[32:35],v[64:67],a[0:15]
i9 v[16:19],v12 offset:0
i0 v[48:49],v6 offset:16384
i6 m0,s49,118784
i6 s44,s48,65536
i1 v2,s[40:43],s44 offen lds
i7 a[16:31],v[36:39],v[64:67],a[16:31]
i0 v[50:51],v6 offset:18432
i9 v[20:23],v12 offset:4096
i6 m0,s49,119808
i6 s44,s48,81920
i1 v3,s[40:43],s44 offen lds
i7 a[64:79],v[32:35],v[68:71],a[64:79]
i0 v[52:53],v7 offset:16384
i0 v[54:55],v7 offset:18432
i6 m0,s49,120832
i6 s44,s48,98304
i1 v2,s[40:43],s44 offen lds
i7 a[80:95],v[36:39],v[68:71],a[80:95]
i0 v[56:57],v14 offset:16384
i0 v[58:59],v14 offset:18432
i6 m0,s49,121856
i6 s44,s48,114688
i1 v3,s[40:43],s44 offen lds
i7 a[128:143],v[32:35],v[72:75],a[128:143]
i0 v[60:61],v15 offset:16384
i0 v[62:63],v15 offset:18432
i7 a[144:159],v[36:39],v[72:75],a[144:159]
i7 a[192:207],v[32:35],v[76:79],a[192:207]
i7 a[208:223],v[36:39],v[76:79],a[208:223]
i8 lgkmcnt(0)
i7 a[0:15],v[16:19],v[48:51],a[0:15]
i9 v[32:35],v13 offset:0
i0 v[64:65],v6 offset:24576
i7 a[16:31],v[20:23],v[48:51],a[16:31]
i0 v[66:67],v6 offset:26624
i9 v[36:39],v13 offset:4096
i7 a[64:79],v[16:19],v[52:55],a[64:79]
i0 v[68:69],v7 offset:24576
i0 v[70:71],v7 offset:26624
i7 a[80:95],v[20:23],v[52:55],a[80:95]
i0 v[72:73],v14 offset:24576
i0 v[74:75],v14 offset:26624
i7 a[128:143],v[16:19],v[56:59],a[128:143]
i0 v[76:77],v15 offset:24576
i0 v[78:79],v15 offset:26624
i7 a[144:159],v[20:23],v[56:59],a[144:159]
i7 a[192:207],v[16:19],v[60:63],a[192:207]
i7 a[208:223],v[20:23],v[60:63],a[208:223]
i8 lgkmcnt(0)
i7 a[0:15],v[32:35],v[64:67],a[0:15]
i7 a[16:31],v[36:39],v[64:67],a[16:31]
i7 a[64:79],v[32:35],v[68:71],a[64:79]
i7 a[80:95],v[36:39],v[68:71],a[80:95]
i7 a[128:143],v[32:35],v[72:75],a[128:143]
i7 a[144:159],v[36:39],v[72:75],a[144:159]
i7 a[192:207],v[32:35],v[76:79],a[192:207]
i7 a[208:223],v[36:39],v[76:79],a[208:223]
i6 s47,s47,128
i6 s48,s48,524288
i20 v4,49152,v4
i20 v5,49152,v5
i20 v12,49152,v12
i20 v13,49152,v13
i20 v6,49152,v6
i20 v7,49152,v7
i20 v14,49152,v14
i20 v15,49152,v15
i8 vmcnt(12)
s_barrier
i9 v[16:19],v4 offset:0
i0 v[48:49],v6 offset:0
i0 v[50:51],v6 offset:2048
i9 v[20:23],v4 offset:4096
i0 v[52:53],v7 offset:0
i0 v[54:55],v7 offset:2048
i0 v[56:57],v14 offset:0
i0 v[58:59],v14 offset:2048
i0 v[60:61],v15 offset:0
i0 v[62:63],v15 offset:2048
i8 lgkmcnt(0)
i7 a[0:15],v[16:19],v[48:51],a[0:15]
i9 v[32:35],v5 offset:0
i0 v[64:65],v6 offset:8192
i6 m0,s52,0
i6 s44,s47,0
i1 v1,s[36:39],s44 offen lds
i7 a[16:31],v[20:23],v[48:51],a[16:31]
i0 v[66:67],v6 offset:10240
i9 v[36:39],v5 offset:4096
i6 m0,s49,16384
i6 s44,s48,0
i1 v2,s[40:43],s44 offen lds
i7 a[64:79],v[16:19],v[52:55],a[64:79]
i0 v[68:69],v7 offset:8192
i0 v[70:71],v7 offset:10240
i6 m0,s52,1024
i6 s44,s47,9216
i1 v1,s[36:39],s44 offen lds
i7 a[80:95],v[20:23],v[52:55],a[80:95]
i0 v[72:73],v14 offset:8192
i0 v[74:75],v14 offset:10240
i6 m0,s49,17408
i6 s44,s48,16384
i1 v3,s[40:43],s44 offen lds
i7 a[128:143],v[16:19],v[56:59],a[128:143]
i0 v[76:77],v15 offset:8192
i0 v[78:79],v15 offset:10240
i6 m0,s52,2048
i6 s44,s47,18432
i1 v1,s[36:39],s44 offen lds
i7 a[144:159],v[20:23],v[56:59],a[144:159]
i6 m0,s49,18432
i6 s44,s48,32768
i1 v2,s[40:43],s44 offen lds
i7 a[192:207],v[16:19],v[60:63],a[192:207]
i6 m0,s52,3072
i6 s44,s47,27648
i1 v1,s[36:39],s44 offen lds
i7 a[208:223],v[20:23],v[60:63],a[208:223]
i6 m0,s49,19456
i6 s44,s48,49152
i1 v3,s[40:43],s44 offen lds
i8 lgkmcnt(0)
i7 a[0:15],v[32:35],v[64:67],a[0:15]
i9 v[16:19],v12 offset:0
i0 v[48:49],v6 offset:16384
i6 m0,s49,20480
i6 s44,s48,65536
i1 v2,s[40:43],s44 offen lds
i7 a[16:31],v[36:39],v[64:67],a[16:31]
i0 v[50:51],v6 offset:18432
i9 v[20:23],v12 offset:4096
i6 m0,s49,21504
i6 s44,s48,81920
i1 v3,s[40:43],s44 offen lds
i7 a[64:79],v[32:35],v[68:71],a[64:79]
i0 v[52:53],v7 offset:16384
i0 v[54:55],v7 offset:18432
i6 m0,s49,22528
i6 s44,s48,98304
i1 v2,s[40:43],s44 offen lds
i7 a[80:95],v[36:39],v[68:71],a[80:95]
i0 v[56:57],v14 offset:16384
i0 v[58:59],v14 offset:18432
i6 m0,s49,23552
i6 s44,s48,114688
i1 v3,s[40:43],s44 offen lds
i7 a[128:143],v[32:35],v[72:75],a[128:143]
i0 v[60:61],v15 offset:16384
i0 v[62:63],v15 offset:18432
i7 a[144:159],v[36:39],v[72:75],a[144:159]
i7 a[192:207],v[32:35],v[76:79],a[192:207]
i7 a[208:223],v[36:39],v[76:79],a[208:223]
i8 lgkmcnt(0)
i7 a[0:15],v[16:19],v[48:51],a[0:15]
i9 v[32:35],v13 offset:0
i0 v[64:65],v6 offset:24576
i7 a[16:31],v[20:23],v[48:51],a[16:31]
i0 v[66:67],v6 offset:26624
i9 v[36:39],v13 offset:4096
i7 a[64:79],v[16:19],v[52:55],a[64:79]
i0 v[68:69],v7 offset:24576
i0 v[70:71],v7 offset:26624
i7 a[80:95],v[20:23],v[52:55],a[80:95]
i0 v[72:73],v14 offset:24576
i0 v[74:75],v14 offset:26624
i7 a[128:143],v[16:19],v[56:59],a[128:143]
i0 v[76:77],v15 offset:24576
i0 v[78:79],v15 offset:26624
i7 a[144:159],v[20:23],v[56:59],a[144:159]
i7 a[192:207],v[16:19],v[60:63],a[192:207]
i7 a[208:223],v[20:23],v[60:63],a[208:223]
i8 lgkmcnt(0)
i7 a[0:15],v[32:35],v[64:67],a[0:15]
i7 a[16:31],v[36:39],v[64:67],a[16:31]
i7 a[64:79],v[32:35],v[68:71],a[64:79]
i7 a[80:95],v[36:39],v[68:71],a[80:95]
i7 a[128:143],v[32:35],v[72:75],a[128:143]
i7 a[144:159],v[36:39],v[72:75],a[144:159]
i7 a[192:207],v[32:35],v[76:79],a[192:207]
i7 a[208:223],v[36:39],v[76:79],a[208:223]
i6 s47,s47,128
i6 s48,s48,524288
i20 v4,49152,v4
i20 v5,49152,v5
i20 v12,49152,v12
i20 v13,49152,v13
i20 v6,49152,v6
i20 v7,49152,v7
i20 v14,49152,v14
i20 v15,49152,v15
i8 vmcnt(12)
s_barrier
i9 v[16:19],v4 offset:0
i0 v[48:49],v6 offset:0
i0 v[50:51],v6 offset:2048
i9 v[20:23],v4 offset:4096
i0 v[52:53],v7 offset:0
i0 v[54:55],v7 offset:2048
i0 v[56:57],v14 offset:0
i0 v[58:59],v14 offset:2048
i0 v[60:61],v15 offset:0
i0 v[62:63],v15 offset:2048
i8 lgkmcnt(0)
i7 a[0:15],v[16:19],v[48:51],a[0:15]
i9 v[32:35],v5 offset:0
i0 v[64:65],v6 offset:8192
i6 m0,s52,49152
i6 s44,s47,0
i1 v1,s[36:39],s44 offen lds
i7 a[16:31],v[20:23],v[48:51],a[16:31]
i0 v[66:67],v6 offset:10240
i9 v[36:39],v5 offset:4096
i6 m0,s49,65536
i6 s44,s48,0
i1 v2,s[40:43],s44 offen lds
i7 a[64:79],v[16:19],v[52:55],a[64:79]
i0 v[68:69],v7 offset:8192
i0 v[70:71],v7 offset:10240
i6 m0,s52,50176
i6 s44,s47,9216
i1 v1,s[36:39],s44 offen lds
i7 a[80:95],v[20:23],v[52:55],a[80:95]
i0 v[72:73],v14 offset:8192
i0 v[74:75],v14 offset:10240
i6 m0,s49,66560
i6 s44,s48,16384
i1 v3,s[40:43],s44 offen lds
i7 a[128:143],v[16:19],v[56:59],a[128:143]
i0 v[76:77],v15 offset:8192
i0 v[78:79],v15 offset:10240
i6 m0,s52,51200
i6 s44,s47,18432
i1 v1,s[36:39],s44 offen lds
i7 a[144:159],v[20:23],v[56:59],a[144:159]
i6 m0,s49,67584
i6 s44,s48,32768
i1 v2,s[40:43],s44 offen lds
i7 a[192:207],v[16:19],v[60:63],a[192:207]
i6 m0,s52,52224
i6 s44,s47,27648
i1 v1,s[36:39],s44 offen lds
i7 a[208:223],v[20:23],v[60:63],a[208:223]
i6 m0,s49,68608
i6 s44,s48,49152
i1 v3,s[40:43],s44 offen lds
i8 lgkmcnt(0)
i7 a[0:15],v[32:35],v[64:67],a[0:15]
i9 v[16:19],v12 offset:0
i0 v[48:49],v6 offset:16384
i6 m0,s49,69632
i6 s44,s48,65536
i1 v2,s[40:43],s44 offen lds
i7 a[16:31],v[36:39],v[64:67],a[16:31]
i0 v[50:51],v6 offset:18432
i9 v[20:23],v12 offset:4096
i6 m0,s49,70656
i6 s44,s48,81920
i1 v3,s[40:43],s44 offen lds
i7 a[64:79],v[32:35],v[68:71],a[64:79]
i0 v[52:53],v7 offset:16384
i0 v[54:55],v7 offset:18432
i6 m0,s49,71680
i6 s44,s48,98304
i1 v2,s[40:43],s44 offen lds
i7 a[80:95],v[36:39],v[68:71],a[80:95]
i0 v[56:57],v14 offset:16384
i0 v[58:59],v14 offset:18432
i6 m0,s49,72704
i6 s44,s48,114688
i1 v3,s[40:43],s44 offen lds
i7 a[128:143],v[32:35],v[72:75],a[128:143]
i0 v[60:61],v15 offset:16384
i0 v[62:63],v15 offset:18432
i7 a[144:159],v[36:39],v[72:75],a[144:159]
i7 a[192:207],v[32:35],v[76:79],a[192:207]
i7 a[208:223],v[36:39],v[76:79],a[208:223]
i8 lgkmcnt(0)
i7 a[0:15],v[16:19],v[48:51],a[0:15]
i9 v[32:35],v13 offset:0
i0 v[64:65],v6 offset:24576
i7 a[16:31],v[20:23],v[48:51],a[16:31]
i0 v[66:67],v6 offset:26624
i9 v[36:39],v13 offset:4096
i7 a[64:79],v[16:19],v[52:55],a[64:79]
i0 v[68:69],v7 offset:24576
i0 v[70:71],v7 offset:26624
i7 a[80:95],v[20:23],v[52:55],a[80:95]
i0 v[72:73],v14 offset:24576
i0 v[74:75],v14 offset:26624
i7 a[128:143],v[16:19],v[56:59],a[128:143]
i0 v[76:77],v15 offset:24576
i0 v[78:79],v15 offset:26624
i7 a[144:159],v[20:23],v[56:59],a[144:159]
i7 a[192:207],v[16:19],v[60:63],a[192:207]
i7 a[208:223],v[20:23],v[60:63],a[208:223]
i8 lgkmcnt(0)
i7 a[0:15],v[32:35],v[64:67],a[0:15]
i7 a[16:31],v[36:39],v[64:67],a[16:31]
i7 a[64:79],v[32:35],v[68:71],a[64:79]
i7 a[80:95],v[36:39],v[68:71],a[80:95]
i7 a[128:143],v[32:35],v[72:75],a[128:143]
i7 a[144:159],v[36:39],v[72:75],a[144:159]
i7 a[192:207],v[32:35],v[76:79],a[192:207]
i7 a[208:223],v[36:39],v[76:79],a[208:223]
i6 s47,s47,128
i6 s48,s48,524288
i20 v4,4294868992,v4
i20 v5,4294868992,v5
i20 v12,4294868992,v12
i20 v13,4294868992,v13
i20 v6,4294868992,v6
i20 v7,4294868992,v7
i20 v14,4294868992,v14
i20 v15,4294868992,v15
i6 s46,s46,1
s_cmp_lt_u32 s46, 2
i22 Lhv_loop
i8 vmcnt(12)
s_barrier
i9 v[16:19],v4 offset:0
i0 v[48:49],v6 offset:0
i0 v[50:51],v6 offset:2048
i9 v[20:23],v4 offset:4096
i0 v[52:53],v7 offset:0
i0 v[54:55],v7 offset:2048
i0 v[56:57],v14 offset:0
i0 v[58:59],v14 offset:2048
i0 v[60:61],v15 offset:0
i0 v[62:63],v15 offset:2048
i8 lgkmcnt(0)
i7 a[0:15],v[16:19],v[48:51],a[0:15]
i9 v[32:35],v5 offset:0
i0 v[64:65],v6 offset:8192
i6 m0,s52,98304
i6 s44,s47,0
i1 v1,s[36:39],s44 offen lds
i7 a[16:31],v[20:23],v[48:51],a[16:31]
i0 v[66:67],v6 offset:10240
i9 v[36:39],v5 offset:4096
i6 m0,s49,114688
i6 s44,s48,0
i1 v2,s[40:43],s44 offen lds
i7 a[64:79],v[16:19],v[52:55],a[64:79]
i0 v[68:69],v7 offset:8192
i0 v[70:71],v7 offset:10240
i6 m0,s52,99328
i6 s44,s47,9216
i1 v1,s[36:39],s44 offen lds
i7 a[80:95],v[20:23],v[52:55],a[80:95]
i0 v[72:73],v14 offset:8192
i0 v[74:75],v14 offset:10240
i6 m0,s49,115712
i6 s44,s48,16384
i1 v3,s[40:43],s44 offen lds
i7 a[128:143],v[16:19],v[56:59],a[128:143]
i0 v[76:77],v15 offset:8192
i0 v[78:79],v15 offset:10240
i6 m0,s52,100352
i6 s44,s47,18432
i1 v1,s[36:39],s44 offen lds
i7 a[144:159],v[20:23],v[56:59],a[144:159]
i6 m0,s49,116736
i6 s44,s48,32768
i1 v2,s[40:43],s44 offen lds
i7 a[192:207],v[16:19],v[60:63],a[192:207]
i6 m0,s52,101376
i6 s44,s47,27648
i1 v1,s[36:39],s44 offen lds
i7 a[208:223],v[20:23],v[60:63],a[208:223]
i6 m0,s49,117760
i6 s44,s48,49152
i1 v3,s[40:43],s44 offen lds
i8 lgkmcnt(0)
i7 a[0:15],v[32:35],v[64:67],a[0:15]
i9 v[16:19],v12 offset:0
i0 v[48:49],v6 offset:16384
i6 m0,s49,118784
i6 s44,s48,65536
i1 v2,s[40:43],s44 offen lds
i7 a[16:31],v[36:39],v[64:67],a[16:31]
i0 v[50:51],v6 offset:18432
i9 v[20:23],v12 offset:4096
i6 m0,s49,119808
i6 s44,s48,81920
i1 v3,s[40:43],s44 offen lds
i7 a[64:79],v[32:35],v[68:71],a[64:79]
i0 v[52:53],v7 offset:16384
i0 v[54:55],v7 offset:18432
i6 m0,s49,120832
i6 s44,s48,98304
i1 v2,s[40:43],s44 offen lds
i7 a[80:95],v[36:39],v[68:71],a[80:95]
i0 v[56:57],v14 offset:16384
i0 v[58:59],v14 offset:18432
i6 m0,s49,121856
i6 s44,s48,114688
i1 v3,s[40:43],s44 offen lds
i7 a[128:143],v[32:35],v[72:75],a[128:143]
i0 v[60:61],v15 offset:16384
i0 v[62:63],v15 offset:18432
i7 a[144:159],v[36:39],v[72:75],a[144:159]
i7 a[192:207],v[32:35],v[76:79],a[192:207]
i7 a[208:223],v[36:39],v[76:79],a[208:223]
i8 lgkmcnt(0)
i7 a[0:15],v[16:19],v[48:51],a[0:15]
i9 v[32:35],v13 offset:0
i0 v[64:65],v6 offset:24576
i7 a[16:31],v[20:23],v[48:51],a[16:31]
i0 v[66:67],v6 offset:26624
i9 v[36:39],v13 offset:4096
i7 a[64:79],v[16:19],v[52:55],a[64:79]
i0 v[68:69],v7 offset:24576
i0 v[70:71],v7 offset:26624
i7 a[80:95],v[20:23],v[52:55],a[80:95]
i0 v[72:73],v14 offset:24576
i0 v[74:75],v14 offset:26624
i7 a[128:143],v[16:19],v[56:59],a[128:143]
i0 v[76:77],v15 offset:24576
i0 v[78:79],v15 offset:26624
i7 a[144:159],v[20:23],v[56:59],a[144:159]
i7 a[192:207],v[16:19],v[60:63],a[192:207]
i7 a[208:223],v[20:23],v[60:63],a[208:223]
i8 lgkmcnt(0)
i7 a[0:15],v[32:35],v[64:67],a[0:15]
i7 a[16:31],v[36:39],v[64:67],a[16:31]
i7 a[64:79],v[32:35],v[68:71],a[64:79]
i7 a[80:95],v[36:39],v[68:71],a[80:95]
i7 a[128:143],v[32:35],v[72:75],a[128:143]
i7 a[144:159],v[36:39],v[72:75],a[144:159]
i7 a[192:207],v[32:35],v[76:79],a[192:207]
i7 a[208:223],v[36:39],v[76:79],a[208:223]
i6 s47,s47,128
i6 s48,s48,524288
i20 v4,49152,v4
i20 v5,49152,v5
i20 v12,49152,v12
i20 v13,49152,v13
i20 v6,49152,v6
i20 v7,49152,v7
i20 v14,49152,v14
i20 v15,49152,v15
i8 vmcnt(12)
s_barrier
i9 v[16:19],v4 offset:0
i0 v[48:49],v6 offset:0
i0 v[50:51],v6 offset:2048
i9 v[20:23],v4 offset:4096
i0 v[52:53],v7 offset:0
i0 v[54:55],v7 offset:2048
i0 v[56:57],v14 offset:0
i0 v[58:59],v14 offset:2048
i0 v[60:61],v15 offset:0
i0 v[62:63],v15 offset:2048
i8 lgkmcnt(0)
i7 a[0:15],v[16:19],v[48:51],a[0:15]
i9 v[32:35],v5 offset:0
i0 v[64:65],v6 offset:8192
i7 a[16:31],v[20:23],v[48:51],a[16:31]
i0 v[66:67],v6 offset:10240
i9 v[36:39],v5 offset:4096
i7 a[64:79],v[16:19],v[52:55],a[64:79]
i0 v[68:69],v7 offset:8192
i0 v[70:71],v7 offset:10240
i7 a[80:95],v[20:23],v[52:55],a[80:95]
i0 v[72:73],v14 offset:8192
i0 v[74:75],v14 offset:10240
i7 a[128:143],v[16:19],v[56:59],a[128:143]
i0 v[76:77],v15 offset:8192
i0 v[78:79],v15 offset:10240
i7 a[144:159],v[20:23],v[56:59],a[144:159]
i7 a[192:207],v[16:19],v[60:63],a[192:207]
i7 a[208:223],v[20:23],v[60:63],a[208:223]
i8 lgkmcnt(0)
i7 a[0:15],v[32:35],v[64:67],a[0:15]
i9 v[16:19],v12 offset:0
i0 v[48:49],v6 offset:16384
i7 a[16:31],v[36:39],v[64:67],a[16:31]
i0 v[50:51],v6 offset:18432
i9 v[20:23],v12 offset:4096
i7 a[64:79],v[32:35],v[68:71],a[64:79]
i0 v[52:53],v7 offset:16384
i0 v[54:55],v7 offset:18432
i7 a[80:95],v[36:39],v[68:71],a[80:95]
i0 v[56:57],v14 offset:16384
i0 v[58:59],v14 offset:18432
i7 a[128:143],v[32:35],v[72:75],a[128:143]
i0 v[60:61],v15 offset:16384
i0 v[62:63],v15 offset:18432
i7 a[144:159],v[36:39],v[72:75],a[144:159]
i7 a[192:207],v[32:35],v[76:79],a[192:207]
i7 a[208:223],v[36:39],v[76:79],a[208:223]
i8 lgkmcnt(0)
i7 a[0:15],v[16:19],v[48:51],a[0:15]
i9 v[32:35],v13 offset:0
i0 v[64:65],v6 offset:24576
i7 a[16:31],v[20:23],v[48:51],a[16:31]
i0 v[66:67],v6 offset:26624
i9 v[36:39],v13 offset:4096
i7 a[64:79],v[16:19],v[52:55],a[64:79]
i0 v[68:69],v7 offset:24576
i0 v[70:71],v7 offset:26624
i7 a[80:95],v[20:23],v[52:55],a[80:95]
i0 v[72:73],v14 offset:24576
i0 v[74:75],v14 offset:26624
i7 a[128:143],v[16:19],v[56:59],a[128:143]
i0 v[76:77],v15 offset:24576
i0 v[78:79],v15 offset:26624
i7 a[144:159],v[20:23],v[56:59],a[144:159]
i7 a[192:207],v[16:19],v[60:63],a[192:207]
i7 a[208:223],v[20:23],v[60:63],a[208:223]
i8 lgkmcnt(0)
i7 a[0:15],v[32:35],v[64:67],a[0:15]
i7 a[16:31],v[36:39],v[64:67],a[16:31]
i7 a[64:79],v[32:35],v[68:71],a[64:79]
i7 a[80:95],v[36:39],v[68:71],a[80:95]
i7 a[128:143],v[32:35],v[72:75],a[128:143]
i7 a[144:159],v[36:39],v[72:75],a[144:159]
i7 a[192:207],v[32:35],v[76:79],a[192:207]
i7 a[208:223],v[36:39],v[76:79],a[208:223]
i20 v4,49152,v4
i20 v5,49152,v5
i20 v12,49152,v12
i20 v13,49152,v13
i20 v6,49152,v6
i20 v7,49152,v7
i20 v14,49152,v14
i20 v15,49152,v15
i8 vmcnt(0)
s_barrier
i9 v[16:19],v4 offset:0
i0 v[48:49],v6 offset:0
i0 v[50:51],v6 offset:2048
i9 v[20:23],v4 offset:4096
i0 v[52:53],v7 offset:0
i0 v[54:55],v7 offset:2048
i0 v[56:57],v14 offset:0
i0 v[58:59],v14 offset:2048
i0 v[60:61],v15 offset:0
i0 v[62:63],v15 offset:2048
i8 lgkmcnt(0)
i7 a[0:15],v[16:19],v[48:51],a[0:15]
i9 v[32:35],v5 offset:0
i0 v[64:65],v6 offset:8192
i7 a[16:31],v[20:23],v[48:51],a[16:31]
i0 v[66:67],v6 offset:10240
i9 v[36:39],v5 offset:4096
i7 a[64:79],v[16:19],v[52:55],a[64:79]
i0 v[68:69],v7 offset:8192
i0 v[70:71],v7 offset:10240
i7 a[80:95],v[20:23],v[52:55],a[80:95]
i0 v[72:73],v14 offset:8192
i0 v[74:75],v14 offset:10240
i7 a[128:143],v[16:19],v[56:59],a[128:143]
i0 v[76:77],v15 offset:8192
i0 v[78:79],v15 offset:10240
i7 a[144:159],v[20:23],v[56:59],a[144:159]
i7 a[192:207],v[16:19],v[60:63],a[192:207]
i7 a[208:223],v[20:23],v[60:63],a[208:223]
i8 lgkmcnt(0)
i7 a[0:15],v[32:35],v[64:67],a[0:15]
i9 v[16:19],v12 offset:0
i0 v[48:49],v6 offset:16384
i7 a[16:31],v[36:39],v[64:67],a[16:31]
i0 v[50:51],v6 offset:18432
i9 v[20:23],v12 offset:4096
i7 a[64:79],v[32:35],v[68:71],a[64:79]
i0 v[52:53],v7 offset:16384
i0 v[54:55],v7 offset:18432
i7 a[80:95],v[36:39],v[68:71],a[80:95]
i0 v[56:57],v14 offset:16384
i0 v[58:59],v14 offset:18432
i7 a[128:143],v[32:35],v[72:75],a[128:143]
i0 v[60:61],v15 offset:16384
i0 v[62:63],v15 offset:18432
i7 a[144:159],v[36:39],v[72:75],a[144:159]
i7 a[192:207],v[32:35],v[76:79],a[192:207]
i7 a[208:223],v[36:39],v[76:79],a[208:223]
i8 lgkmcnt(0)
i7 a[0:15],v[16:19],v[48:51],a[0:15]
i9 v[32:35],v13 offset:0
i0 v[64:65],v6 offset:24576
i7 a[16:31],v[20:23],v[48:51],a[16:31]
i0 v[66:67],v6 offset:26624
i9 v[36:39],v13 offset:4096
i7 a[64:79],v[16:19],v[52:55],a[64:79]
i0 v[68:69],v7 offset:24576
i0 v[70:71],v7 offset:26624
i7 a[80:95],v[20:23],v[52:55],a[80:95]
i0 v[72:73],v14 offset:24576
i0 v[74:75],v14 offset:26624
i7 a[128:143],v[16:19],v[56:59],a[128:143]
i0 v[76:77],v15 offset:24576
i0 v[78:79],v15 offset:26624
i7 a[144:159],v[20:23],v[56:59],a[144:159]
i7 a[192:207],v[16:19],v[60:63],a[192:207]
i7 a[208:223],v[20:23],v[60:63],a[208:223]
i8 lgkmcnt(0)
i7 a[0:15],v[32:35],v[64:67],a[0:15]
i7 a[16:31],v[36:39],v[64:67],a[16:31]
i7 a[64:79],v[32:35],v[68:71],a[64:79]
i7 a[80:95],v[36:39],v[68:71],a[80:95]
i7 a[128:143],v[32:35],v[72:75],a[128:143]
i7 a[144:159],v[36:39],v[72:75],a[144:159]
i7 a[192:207],v[32:35],v[76:79],a[192:207]
i7 a[208:223],v[36:39],v[76:79],a[208:223]
i23 v10,4,v0
i23 v11,5,v10
i31 v11,8,v11
i34 v12,v10,4,1
i24 v11,v12,10,v11
i18 v12,0xf0,v0
v_or_b32 v8, v11, v12
i32 s44,s30,2
s_lshr_b32 s45, s21, 1
i32 s45,s45,1
i6 s44,s44,s45
i32 s49,s44,18
i32 s44,s31,1
s_and_b32 s45, s21, 1
i6 s44,s44,s45
i32 s44,s44,13
i6 s49,s49,s44
i32 s44,s32,24
i6 s49,s49,s44
i47 s32,0
i28 s50,1040356334,1.0
i5 s51,s50
i15 7
i15 7
i6 s44,s49,0
i10 v16,a0
i10 v17,a1
i10 v18,a2
i10 v19,a3
i10 v20,a4
i10 v21,a5
i10 v22,a6
i10 v23,a7
i3 v24,v16,v17
i3 v25,v18,v19
i3 v26,v20,v21
i3 v27,v22,v23
i13 v[24:27],v8,s[8:11],s44 offen offset:0 sc1
i10 v28,a8
i10 v29,a9
i10 v30,a10
i10 v31,a11
i10 v32,a12
i10 v33,a13
i10 v34,a14
i10 v35,a15
i3 v36,v28,v29
i3 v37,v30,v31
i3 v38,v32,v33
i3 v39,v34,v35
i13 v[36:39],v8,s[8:11],s44 offen offset:512 sc1
i6 s44,s49,2048
i10 v40,a64
i10 v41,a65
i10 v42,a66
i10 v43,a67
i10 v44,a68
i10 v45,a69
i10 v46,a70
i10 v47,a71
i3 v48,v40,v41
i3 v49,v42,v43
i3 v50,v44,v45
i3 v51,v46,v47
i13 v[48:51],v8,s[8:11],s44 offen offset:0 sc1
i10 v52,a72
i10 v53,a73
i10 v54,a74
i10 v55,a75
i10 v56,a76
i10 v57,a77
i10 v58,a78
i10 v59,a79
i3 v60,v52,v53
i3 v61,v54,v55
i3 v62,v56,v57
i3 v63,v58,v59
i13 v[60:63],v8,s[8:11],s44 offen offset:512 sc1
i6 s44,s49,4096
i10 v16,a128
i10 v17,a129
i10 v18,a130
i10 v19,a131
i10 v20,a132
i10 v21,a133
i10 v22,a134
i10 v23,a135
i3 v24,v16,v17
i3 v25,v18,v19
i3 v26,v20,v21
i3 v27,v22,v23
i13 v[24:27],v8,s[8:11],s44 offen offset:0 sc1
i10 v28,a136
i10 v29,a137
i10 v30,a138
i10 v31,a139
i10 v32,a140
i10 v33,a141
i10 v34,a142
i10 v35,a143
i3 v36,v28,v29
i3 v37,v30,v31
i3 v38,v32,v33
i3 v39,v34,v35
i13 v[36:39],v8,s[8:11],s44 offen offset:512 sc1
i6 s44,s49,6144
i10 v40,a192
i10 v41,a193
i10 v42,a194
i10 v43,a195
i10 v44,a196
i10 v45,a197
i10 v46,a198
i10 v47,a199
i3 v48,v40,v41
i3 v49,v42,v43
i3 v50,v44,v45
i3 v51,v46,v47
i13 v[48:51],v8,s[8:11],s44 offen offset:0 sc1
i10 v52,a200
i10 v53,a201
i10 v54,a202
i10 v55,a203
i10 v56,a204
i10 v57,a205
i10 v58,a206
i10 v59,a207
i3 v60,v52,v53
i3 v61,v54,v55
i3 v62,v56,v57
i3 v63,v58,v59
i13 v[60:63],v8,s[8:11],s44 offen offset:512 sc1
i6 s44,s49,262144
i10 v16,a16
i10 v17,a17
i10 v18,a18
i10 v19,a19
i10 v20,a20
i10 v21,a21
i10 v22,a22
i10 v23,a23
i3 v24,v16,v17
i3 v25,v18,v19
i3 v26,v20,v21
i3 v27,v22,v23
i13 v[24:27],v8,s[8:11],s44 offen offset:0 sc1
i10 v28,a24
i10 v29,a25
i10 v30,a26
i10 v31,a27
i10 v32,a28
i10 v33,a29
i10 v34,a30
i10 v35,a31
i3 v36,v28,v29
i3 v37,v30,v31
i3 v38,v32,v33
i3 v39,v34,v35
i13 v[36:39],v8,s[8:11],s44 offen offset:512 sc1
i6 s44,s49,264192
i10 v40,a80
i10 v41,a81
i10 v42,a82
i10 v43,a83
i10 v44,a84
i10 v45,a85
i10 v46,a86
i10 v47,a87
i3 v48,v40,v41
i3 v49,v42,v43
i3 v50,v44,v45
i3 v51,v46,v47
i13 v[48:51],v8,s[8:11],s44 offen offset:0 sc1
i10 v52,a88
i10 v53,a89
i10 v54,a90
i10 v55,a91
i10 v56,a92
i10 v57,a93
i10 v58,a94
i10 v59,a95
i3 v60,v52,v53
i3 v61,v54,v55
i3 v62,v56,v57
i3 v63,v58,v59
i13 v[60:63],v8,s[8:11],s44 offen offset:512 sc1
i6 s44,s49,266240
i10 v16,a144
i10 v17,a145
i10 v18,a146
i10 v19,a147
i10 v20,a148
i10 v21,a149
i10 v22,a150
i10 v23,a151
i3 v24,v16,v17
i3 v25,v18,v19
i3 v26,v20,v21
i3 v27,v22,v23
i13 v[24:27],v8,s[8:11],s44 offen offset:0 sc1
i10 v28,a152
i10 v29,a153
i10 v30,a154
i10 v31,a155
i10 v32,a156
i10 v33,a157
i10 v34,a158
i10 v35,a159
i3 v36,v28,v29
i3 v37,v30,v31
i3 v38,v32,v33
i3 v39,v34,v35
i13 v[36:39],v8,s[8:11],s44 offen offset:512 sc1
i6 s44,s49,268288
i10 v40,a208
i10 v41,a209
i10 v42,a210
i10 v43,a211
i10 v44,a212
i10 v45,a213
i10 v46,a214
i10 v47,a215
i3 v48,v40,v41
i3 v49,v42,v43
i3 v50,v44,v45
i3 v51,v46,v47
i13 v[48:51],v8,s[8:11],s44 offen offset:0 sc1
i10 v52,a216
i10 v53,a217
i10 v54,a218
i10 v55,a219
i10 v56,a220
i10 v57,a221
i10 v58,a222
i10 v59,a223
i3 v60,v52,v53
i3 v61,v54,v55
i3 v62,v56,v57
i3 v63,v58,v59
i13 v[60:63],v8,s[8:11],s44 offen offset:512 sc1
Lh_end:
i8 vmcnt(0)
s_barrier
i46 s99,0
i22 L_v4k
i11 v40,0
i5 s94,0
i46 s21,0
i22 L_v4ab
i39 exec,1
L_v4a:
i55 v41,v40,s[100:101] offset:160 sc1
i6 s94,s94,1
i35 s94,400000
i22 L_end
i8 vmcnt(0)
v_cmp_gt_u32 vcc, 0x100, v41
i49 L_v4az
i44 L_v4ak
L_v4az:
s_sleep 2
i44 L_v4a
L_v4ak:
i39 exec,-1
L_v4ab:
s_barrier
global_load_dwordx4 v[44:47], v40, s[100:101] offset:0 sc1
global_load_dwordx4 v[48:51], v40, s[100:101] offset:16 sc1
i8 vmcnt(0)
i5 s93,0
i5 s94,s97
i37 s92,v44
i15 0
i46 s92,32
i28 s93,1,s93
i35 s96,0
i28 s92,s92,0
i6 s94,s94,s92
i37 s92,v45
i15 0
i46 s92,32
i28 s93,1,s93
i35 s96,1
i28 s92,s92,0
i6 s94,s94,s92
i37 s92,v46
i15 0
i46 s92,32
i28 s93,1,s93
i35 s96,2
i28 s92,s92,0
i6 s94,s94,s92
i37 s92,v47
i15 0
i46 s92,32
i28 s93,1,s93
i35 s96,3
i28 s92,s92,0
i6 s94,s94,s92
i37 s92,v48
i15 0
i46 s92,32
i28 s93,1,s93
i35 s96,4
i28 s92,s92,0
i6 s94,s94,s92
i37 s92,v49
i15 0
i46 s92,32
i28 s93,1,s93
i35 s96,5
i28 s92,s92,0
i6 s94,s94,s92
i37 s92,v50
i15 0
i46 s92,32
i28 s93,1,s93
i35 s96,6
i28 s92,s92,0
i6 s94,s94,s92
i37 s92,v51
i15 0
i46 s92,32
i28 s93,1,s93
i35 s96,7
i28 s92,s92,0
i6 s94,s94,s92
i5 s99,1
i47 s93,0
i22 L_v4k
i5 s99,2
s_lshr_b32 s98, s94, 5
s_and_b32 s20, s94, 31
i8 vmcnt(0) lgkmcnt(0)
s_barrier
i44 L_role
L_v4k:
i46 s21,0
i22 L_s0
i11 v40,64
i11 v41,1
i39 exec,1
global_atomic_add v40, v41, s[100:101]
i39 exec,-1
L_s0:
L_g1:
i6 s3,s98,4
s_cmp_ge_u32 s98, 4
i28 s4,8,0
s_sub_u32 s3, s3, s4
i47 s98,3
i28 s3,4,s3
i6 s4,s98,3
i47 s95,1
i28 s3,s4,s3
s_cmp_ge_u32 s3, 3
i22 L_g1b
i32 s3,s3,5
i6 s3,s3,s20
s_mul_i32 s4, s3, 21846
s_lshr_b32 s4, s4, 16
s_mul_i32 s5, s4, 3
s_sub_u32 s3, s3, s5
i6 s30,s3,1
i44 L_g1c
L_g1b:
s_and_b32 s30, s20, 3
s_cmp_ge_u32 s3, 5
i28 s4,4,0
i28 s5,5,-1
i6 s30,s30,s4
s_sub_u32 s3, s3, s5
i32 s3,s3,3
s_lshr_b32 s4, s20, 2
i6 s4,s4,s3
L_g1c:
s_and_b32 s31, s4, 15
s_lshr_b32 s32, s4, 4
i50 s[36:37],s[0:1],40
i47 s32,0
i28 s44,64,72
i47 s32,2
i28 s44,56,s44
i50 s[40:41],s[0:1],s44
i23 v10,4,v0
i23 v11,3,v10
i18 v12,7,v10
v_xor_b32 v12, v12, v11
i31 v12,4,v12
i54 s45,1152
i45 v1,v11,s45,v12
i23 v11,5,v10
i18 v12,31,v10
i31 v13,2,v11
v_xor_b32 v12, v12, v13
i31 v12,4,v12
i17 v2,v11,13,v12
v_xor_b32 v3, 128, v2
s_lshr_b32 s44, s21, 1
i32 s44,s44,14
i18 v11,31,v10
i23 v12,5,v10
i18 v13,7,v10
v_xor_b32 v13, v13, v12
i31 v13,4,v13
i17 v4,v11,7,v13
i20 v4,s44,v4
i34 v11,v10,2,2
i17 v13,v12,3,v11
i31 v13,9,v13
i34 v14,v10,4,1
i18 v15,3,v10
i31 v15,3,v15
i24 v15,v14,5,v15
i24 v15,v11,6,v15
i20 v6,v13,v15
s_and_b32 s44, s21, 1
i32 s44,s44,8
i6 s44,s44,32768
i20 v6,s44,v6
i8 lgkmcnt(0)
i5 s38,2359296
i5 s39,0x20000
i5 s42,4718592
i5 s43,0x20000
i32 s47,s30,8
i32 s44,s21,6
i6 s47,s47,s44
s_mul_i32 s47, s47, 1152
i32 s48,s21,17
i32 s44,s31,9
i6 s48,s48,s44
i32 s49,s21,13
i32 s52,s21,13
v_xor_b32 v5, 32, v4
v_xor_b32 v12, 64, v4
v_xor_b32 v13, 96, v4
v_xor_b32 v7, 64, v6
v_xor_b32 v14, 128, v6
v_xor_b32 v15, 192, v6
i6 m0,s52,0
i6 s44,s47,0
i1 v1,s[36:39],s44 offen lds
i6 m0,s49,32768
i6 s44,s48,0
i1 v2,s[40:43],s44 offen lds
i6 m0,s52,1024
i6 s44,s47,9216
i1 v1,s[36:39],s44 offen lds
i6 m0,s49,33792
i6 s44,s48,16384
i1 v3,s[40:43],s44 offen lds
i6 m0,s52,2048
i6 s44,s47,18432
i1 v1,s[36:39],s44 offen lds
i6 m0,s49,34816
i6 s44,s48,32768
i1 v2,s[40:43],s44 offen lds
i6 m0,s52,3072
i6 s44,s47,27648
i1 v1,s[36:39],s44 offen lds
i6 m0,s49,35840
i6 s44,s48,49152
i1 v3,s[40:43],s44 offen lds
i6 m0,s52,4096
i6 s44,s47,36864
i1 v1,s[36:39],s44 offen lds
i6 m0,s49,36864
i6 s44,s48,65536
i1 v2,s[40:43],s44 offen lds
i6 m0,s52,5120
i6 s44,s47,46080
i1 v1,s[36:39],s44 offen lds
i6 m0,s49,37888
i6 s44,s48,81920
i1 v3,s[40:43],s44 offen lds
i6 m0,s52,6144
i6 s44,s47,55296
i1 v1,s[36:39],s44 offen lds
i6 m0,s49,38912
i6 s44,s48,98304
i1 v2,s[40:43],s44 offen lds
i6 m0,s52,7168
i6 s44,s47,64512
i1 v1,s[36:39],s44 offen lds
i6 m0,s49,39936
i6 s44,s48,114688
i1 v3,s[40:43],s44 offen lds
i6 s47,s47,128
i6 s48,s48,524288
i12 a0,0
i12 a1,0
i12 a2,0
i12 a3,0
i12 a4,0
i12 a5,0
i12 a6,0
i12 a7,0
i12 a8,0
i12 a9,0
i12 a10,0
i12 a11,0
i12 a12,0
i12 a13,0
i12 a14,0
i12 a15,0
i12 a16,0
i12 a17,0
i12 a18,0
i12 a19,0
i12 a20,0
i12 a21,0
i12 a22,0
i12 a23,0
i12 a24,0
i12 a25,0
i12 a26,0
i12 a27,0
i12 a28,0
i12 a29,0
i12 a30,0
i12 a31,0
i12 a32,0
i12 a33,0
i12 a34,0
i12 a35,0
i12 a36,0
i12 a37,0
i12 a38,0
i12 a39,0
i12 a40,0
i12 a41,0
i12 a42,0
i12 a43,0
i12 a44,0
i12 a45,0
i12 a46,0
i12 a47,0
i12 a48,0
i12 a49,0
i12 a50,0
i12 a51,0
i12 a52,0
i12 a53,0
i12 a54,0
i12 a55,0
i12 a56,0
i12 a57,0
i12 a58,0
i12 a59,0
i12 a60,0
i12 a61,0
i12 a62,0
i12 a63,0
i12 a64,0
i12 a65,0
i12 a66,0
i12 a67,0
i12 a68,0
i12 a69,0
i12 a70,0
i12 a71,0
i12 a72,0
i12 a73,0
i12 a74,0
i12 a75,0
i12 a76,0
i12 a77,0
i12 a78,0
i12 a79,0
i12 a80,0
i12 a81,0
i12 a82,0
i12 a83,0
i12 a84,0
i12 a85,0
i12 a86,0
i12 a87,0
i12 a88,0
i12 a89,0
i12 a90,0
i12 a91,0
i12 a92,0
i12 a93,0
i12 a94,0
i12 a95,0
i12 a96,0
i12 a97,0
i12 a98,0
i12 a99,0
i12 a100,0
i12 a101,0
i12 a102,0
i12 a103,0
i12 a104,0
i12 a105,0
i12 a106,0
i12 a107,0
i12 a108,0
i12 a109,0
i12 a110,0
i12 a111,0
i12 a112,0
i12 a113,0
i12 a114,0
i12 a115,0
i12 a116,0
i12 a117,0
i12 a118,0
i12 a119,0
i12 a120,0
i12 a121,0
i12 a122,0
i12 a123,0
i12 a124,0
i12 a125,0
i12 a126,0
i12 a127,0
i12 a128,0
i12 a129,0
i12 a130,0
i12 a131,0
i12 a132,0
i12 a133,0
i12 a134,0
i12 a135,0
i12 a136,0
i12 a137,0
i12 a138,0
i12 a139,0
i12 a140,0
i12 a141,0
i12 a142,0
i12 a143,0
i12 a144,0
i12 a145,0
i12 a146,0
i12 a147,0
i12 a148,0
i12 a149,0
i12 a150,0
i12 a151,0
i12 a152,0
i12 a153,0
i12 a154,0
i12 a155,0
i12 a156,0
i12 a157,0
i12 a158,0
i12 a159,0
i12 a160,0
i12 a161,0
i12 a162,0
i12 a163,0
i12 a164,0
i12 a165,0
i12 a166,0
i12 a167,0
i12 a168,0
i12 a169,0
i12 a170,0
i12 a171,0
i12 a172,0
i12 a173,0
i12 a174,0
i12 a175,0
i12 a176,0
i12 a177,0
i12 a178,0
i12 a179,0
i12 a180,0
i12 a181,0
i12 a182,0
i12 a183,0
i12 a184,0
i12 a185,0
i12 a186,0
i12 a187,0
i12 a188,0
i12 a189,0
i12 a190,0
i12 a191,0
i12 a192,0
i12 a193,0
i12 a194,0
i12 a195,0
i12 a196,0
i12 a197,0
i12 a198,0
i12 a199,0
i12 a200,0
i12 a201,0
i12 a202,0
i12 a203,0
i12 a204,0
i12 a205,0
i12 a206,0
i12 a207,0
i12 a208,0
i12 a209,0
i12 a210,0
i12 a211,0
i12 a212,0
i12 a213,0
i12 a214,0
i12 a215,0
i12 a216,0
i12 a217,0
i12 a218,0
i12 a219,0
i12 a220,0
i12 a221,0
i12 a222,0
i12 a223,0
i12 a224,0
i12 a225,0
i12 a226,0
i12 a227,0
i12 a228,0
i12 a229,0
i12 a230,0
i12 a231,0
i12 a232,0
i12 a233,0
i12 a234,0
i12 a235,0
i12 a236,0
i12 a237,0
i12 a238,0
i12 a239,0
i12 a240,0
i12 a241,0
i12 a242,0
i12 a243,0
i12 a244,0
i12 a245,0
i12 a246,0
i12 a247,0
i12 a248,0
i12 a249,0
i12 a250,0
i12 a251,0
i12 a252,0
i12 a253,0
i12 a254,0
i12 a255,0
i47 s32,1
i22 Lg_v
i5 s46,0
Lgk_loop:
i8 vmcnt(0)
s_barrier
i9 v[16:19],v4 offset:0
i0 v[48:49],v6 offset:0
i0 v[50:51],v6 offset:2048
i9 v[20:23],v4 offset:4096
i0 v[52:53],v7 offset:0
i0 v[54:55],v7 offset:2048
i9 v[24:27],v4 offset:8192
i0 v[56:57],v14 offset:0
i0 v[58:59],v14 offset:2048
i9 v[28:31],v4 offset:12288
i0 v[60:61],v15 offset:0
i0 v[62:63],v15 offset:2048
i8 lgkmcnt(0)
i7 a[0:15],v[48:51],v[16:19],a[0:15]
i9 v[32:35],v5 offset:0
i7 a[16:31],v[48:51],v[20:23],a[16:31]
i0 v[64:65],v6 offset:8192
i6 m0,s52,65536
i6 s44,s47,0
i1 v1,s[36:39],s44 offen lds
i7 a[64:79],v[52:55],v[16:19],a[64:79]
i0 v[66:67],v6 offset:10240
i7 a[80:95],v[52:55],v[20:23],a[80:95]
i9 v[36:39],v5 offset:4096
i6 m0,s49,98304
i6 s44,s48,0
i1 v2,s[40:43],s44 offen lds
i7 a[32:47],v[48:51],v[24:27],a[32:47]
i0 v[68:69],v7 offset:8192
i7 a[96:111],v[52:55],v[24:27],a[96:111]
i0 v[70:71],v7 offset:10240
i6 m0,s52,66560
i6 s44,s47,9216
i1 v1,s[36:39],s44 offen lds
i7 a[128:143],v[56:59],v[16:19],a[128:143]
i9 v[40:43],v5 offset:8192
i7 a[144:159],v[56:59],v[20:23],a[144:159]
i0 v[72:73],v14 offset:8192
i6 m0,s49,99328
i6 s44,s48,16384
i1 v3,s[40:43],s44 offen lds
i7 a[160:175],v[56:59],v[24:27],a[160:175]
i0 v[74:75],v14 offset:10240
i7 a[48:63],v[48:51],v[28:31],a[48:63]
i9 v[44:47],v5 offset:12288
i6 m0,s52,67584
i6 s44,s47,18432
i1 v1,s[36:39],s44 offen lds
i7 a[112:127],v[52:55],v[28:31],a[112:127]
i0 v[76:77],v15 offset:8192
i7 a[176:191],v[56:59],v[28:31],a[176:191]
i0 v[78:79],v15 offset:10240
i6 m0,s49,100352
i6 s44,s48,32768
i1 v2,s[40:43],s44 offen lds
i7 a[192:207],v[60:63],v[16:19],a[192:207]
i7 a[208:223],v[60:63],v[20:23],a[208:223]
i6 m0,s52,68608
i6 s44,s47,27648
i1 v1,s[36:39],s44 offen lds
i7 a[224:239],v[60:63],v[24:27],a[224:239]
i7 a[240:255],v[60:63],v[28:31],a[240:255]
i6 m0,s49,101376
i6 s44,s48,49152
i1 v3,s[40:43],s44 offen lds
i8 lgkmcnt(0)
i7 a[0:15],v[64:67],v[32:35],a[0:15]
i9 v[16:19],v12 offset:0
i7 a[16:31],v[64:67],v[36:39],a[16:31]
i0 v[48:49],v6 offset:16384
i6 m0,s52,69632
i6 s44,s47,36864
i1 v1,s[36:39],s44 offen lds
i7 a[64:79],v[68:71],v[32:35],a[64:79]
i0 v[50:51],v6 offset:18432
i7 a[80:95],v[68:71],v[36:39],a[80:95]
i9 v[20:23],v12 offset:4096
i6 m0,s49,102400
i6 s44,s48,65536
i1 v2,s[40:43],s44 offen lds
i7 a[32:47],v[64:67],v[40:43],a[32:47]
i0 v[52:53],v7 offset:16384
i7 a[96:111],v[68:71],v[40:43],a[96:111]
i0 v[54:55],v7 offset:18432
i6 m0,s52,70656
i6 s44,s47,46080
i1 v1,s[36:39],s44 offen lds
i7 a[128:143],v[72:75],v[32:35],a[128:143]
i9 v[24:27],v12 offset:8192
i7 a[144:159],v[72:75],v[36:39],a[144:159]
i0 v[56:57],v14 offset:16384
i6 m0,s49,103424
i6 s44,s48,81920
i1 v3,s[40:43],s44 offen lds
i7 a[160:175],v[72:75],v[40:43],a[160:175]
i0 v[58:59],v14 offset:18432
i7 a[48:63],v[64:67],v[44:47],a[48:63]
i9 v[28:31],v12 offset:12288
i6 m0,s52,71680
i6 s44,s47,55296
i1 v1,s[36:39],s44 offen lds
i7 a[112:127],v[68:71],v[44:47],a[112:127]
i0 v[60:61],v15 offset:16384
i7 a[176:191],v[72:75],v[44:47],a[176:191]
i0 v[62:63],v15 offset:18432
i6 m0,s49,104448
i6 s44,s48,98304
i1 v2,s[40:43],s44 offen lds
i7 a[192:207],v[76:79],v[32:35],a[192:207]
i7 a[208:223],v[76:79],v[36:39],a[208:223]
i6 m0,s52,72704
i6 s44,s47,64512
i1 v1,s[36:39],s44 offen lds
i7 a[224:239],v[76:79],v[40:43],a[224:239]
i7 a[240:255],v[76:79],v[44:47],a[240:255]
i6 m0,s49,105472
i6 s44,s48,114688
i1 v3,s[40:43],s44 offen lds
i8 lgkmcnt(0)
i7 a[0:15],v[48:51],v[16:19],a[0:15]
i9 v[32:35],v13 offset:0
i7 a[16:31],v[48:51],v[20:23],a[16:31]
i0 v[64:65],v6 offset:24576
i7 a[64:79],v[52:55],v[16:19],a[64:79]
i0 v[66:67],v6 offset:26624
i7 a[80:95],v[52:55],v[20:23],a[80:95]
i9 v[36:39],v13 offset:4096
i7 a[32:47],v[48:51],v[24:27],a[32:47]
i0 v[68:69],v7 offset:24576
i7 a[96:111],v[52:55],v[24:27],a[96:111]
i0 v[70:71],v7 offset:26624
i7 a[128:143],v[56:59],v[16:19],a[128:143]
i9 v[40:43],v13 offset:8192
i7 a[144:159],v[56:59],v[20:23],a[144:159]
i0 v[72:73],v14 offset:24576
i7 a[160:175],v[56:59],v[24:27],a[160:175]
i0 v[74:75],v14 offset:26624
i7 a[48:63],v[48:51],v[28:31],a[48:63]
i9 v[44:47],v13 offset:12288
i7 a[112:127],v[52:55],v[28:31],a[112:127]
i0 v[76:77],v15 offset:24576
i7 a[176:191],v[56:59],v[28:31],a[176:191]
i0 v[78:79],v15 offset:26624
i7 a[192:207],v[60:63],v[16:19],a[192:207]
i7 a[208:223],v[60:63],v[20:23],a[208:223]
i7 a[224:239],v[60:63],v[24:27],a[224:239]
i7 a[240:255],v[60:63],v[28:31],a[240:255]
i8 lgkmcnt(0)
i7 a[0:15],v[64:67],v[32:35],a[0:15]
i7 a[16:31],v[64:67],v[36:39],a[16:31]
i7 a[64:79],v[68:71],v[32:35],a[64:79]
i7 a[80:95],v[68:71],v[36:39],a[80:95]
i7 a[32:47],v[64:67],v[40:43],a[32:47]
i7 a[96:111],v[68:71],v[40:43],a[96:111]
i7 a[128:143],v[72:75],v[32:35],a[128:143]
i7 a[144:159],v[72:75],v[36:39],a[144:159]
i7 a[160:175],v[72:75],v[40:43],a[160:175]
i7 a[48:63],v[64:67],v[44:47],a[48:63]
i7 a[112:127],v[68:71],v[44:47],a[112:127]
i7 a[176:191],v[72:75],v[44:47],a[176:191]
i7 a[192:207],v[76:79],v[32:35],a[192:207]
i7 a[208:223],v[76:79],v[36:39],a[208:223]
i7 a[224:239],v[76:79],v[40:43],a[224:239]
i7 a[240:255],v[76:79],v[44:47],a[240:255]
i6 s47,s47,128
i6 s48,s48,524288
i20 v4,65536,v4
i20 v5,65536,v5
i20 v12,65536,v12
i20 v13,65536,v13
i20 v6,65536,v6
i20 v7,65536,v7
i20 v14,65536,v14
i20 v15,65536,v15
i8 vmcnt(0)
s_barrier
i9 v[16:19],v4 offset:0
i0 v[48:49],v6 offset:0
i0 v[50:51],v6 offset:2048
i9 v[20:23],v4 offset:4096
i0 v[52:53],v7 offset:0
i0 v[54:55],v7 offset:2048
i9 v[24:27],v4 offset:8192
i0 v[56:57],v14 offset:0
i0 v[58:59],v14 offset:2048
i9 v[28:31],v4 offset:12288
i0 v[60:61],v15 offset:0
i0 v[62:63],v15 offset:2048
i8 lgkmcnt(0)
i7 a[0:15],v[48:51],v[16:19],a[0:15]
i9 v[32:35],v5 offset:0
i7 a[16:31],v[48:51],v[20:23],a[16:31]
i0 v[64:65],v6 offset:8192
i6 m0,s52,0
i6 s44,s47,0
i1 v1,s[36:39],s44 offen lds
i7 a[64:79],v[52:55],v[16:19],a[64:79]
i0 v[66:67],v6 offset:10240
i7 a[80:95],v[52:55],v[20:23],a[80:95]
i9 v[36:39],v5 offset:4096
i6 m0,s49,32768
i6 s44,s48,0
i1 v2,s[40:43],s44 offen lds
i7 a[32:47],v[48:51],v[24:27],a[32:47]
i0 v[68:69],v7 offset:8192
i7 a[96:111],v[52:55],v[24:27],a[96:111]
i0 v[70:71],v7 offset:10240
i6 m0,s52,1024
i6 s44,s47,9216
i1 v1,s[36:39],s44 offen lds
i7 a[128:143],v[56:59],v[16:19],a[128:143]
i9 v[40:43],v5 offset:8192
i7 a[144:159],v[56:59],v[20:23],a[144:159]
i0 v[72:73],v14 offset:8192
i6 m0,s49,33792
i6 s44,s48,16384
i1 v3,s[40:43],s44 offen lds
i7 a[160:175],v[56:59],v[24:27],a[160:175]
i0 v[74:75],v14 offset:10240
i7 a[48:63],v[48:51],v[28:31],a[48:63]
i9 v[44:47],v5 offset:12288
i6 m0,s52,2048
i6 s44,s47,18432
i1 v1,s[36:39],s44 offen lds
i7 a[112:127],v[52:55],v[28:31],a[112:127]
i0 v[76:77],v15 offset:8192
i7 a[176:191],v[56:59],v[28:31],a[176:191]
i0 v[78:79],v15 offset:10240
i6 m0,s49,34816
i6 s44,s48,32768
i1 v2,s[40:43],s44 offen lds
i7 a[192:207],v[60:63],v[16:19],a[192:207]
i7 a[208:223],v[60:63],v[20:23],a[208:223]
i6 m0,s52,3072
i6 s44,s47,27648
i1 v1,s[36:39],s44 offen lds
i7 a[224:239],v[60:63],v[24:27],a[224:239]
i7 a[240:255],v[60:63],v[28:31],a[240:255]
i6 m0,s49,35840
i6 s44,s48,49152
i1 v3,s[40:43],s44 offen lds
i8 lgkmcnt(0)
i7 a[0:15],v[64:67],v[32:35],a[0:15]
i9 v[16:19],v12 offset:0
i7 a[16:31],v[64:67],v[36:39],a[16:31]
i0 v[48:49],v6 offset:16384
i6 m0,s52,4096
i6 s44,s47,36864
i1 v1,s[36:39],s44 offen lds
i7 a[64:79],v[68:71],v[32:35],a[64:79]
i0 v[50:51],v6 offset:18432
i7 a[80:95],v[68:71],v[36:39],a[80:95]
i9 v[20:23],v12 offset:4096
i6 m0,s49,36864
i6 s44,s48,65536
i1 v2,s[40:43],s44 offen lds
i7 a[32:47],v[64:67],v[40:43],a[32:47]
i0 v[52:53],v7 offset:16384
i7 a[96:111],v[68:71],v[40:43],a[96:111]
i0 v[54:55],v7 offset:18432
i6 m0,s52,5120
i6 s44,s47,46080
i1 v1,s[36:39],s44 offen lds
i7 a[128:143],v[72:75],v[32:35],a[128:143]
i9 v[24:27],v12 offset:8192
i7 a[144:159],v[72:75],v[36:39],a[144:159]
i0 v[56:57],v14 offset:16384
i6 m0,s49,37888
i6 s44,s48,81920
i1 v3,s[40:43],s44 offen lds
i7 a[160:175],v[72:75],v[40:43],a[160:175]
i0 v[58:59],v14 offset:18432
i7 a[48:63],v[64:67],v[44:47],a[48:63]
i9 v[28:31],v12 offset:12288
i6 m0,s52,6144
i6 s44,s47,55296
i1 v1,s[36:39],s44 offen lds
i7 a[112:127],v[68:71],v[44:47],a[112:127]
i0 v[60:61],v15 offset:16384
i7 a[176:191],v[72:75],v[44:47],a[176:191]
i0 v[62:63],v15 offset:18432
i6 m0,s49,38912
i6 s44,s48,98304
i1 v2,s[40:43],s44 offen lds
i7 a[192:207],v[76:79],v[32:35],a[192:207]
i7 a[208:223],v[76:79],v[36:39],a[208:223]
i6 m0,s52,7168
i6 s44,s47,64512
i1 v1,s[36:39],s44 offen lds
i7 a[224:239],v[76:79],v[40:43],a[224:239]
i7 a[240:255],v[76:79],v[44:47],a[240:255]
i6 m0,s49,39936
i6 s44,s48,114688
i1 v3,s[40:43],s44 offen lds
i8 lgkmcnt(0)
i7 a[0:15],v[48:51],v[16:19],a[0:15]
i9 v[32:35],v13 offset:0
i7 a[16:31],v[48:51],v[20:23],a[16:31]
i0 v[64:65],v6 offset:24576
i7 a[64:79],v[52:55],v[16:19],a[64:79]
i0 v[66:67],v6 offset:26624
i7 a[80:95],v[52:55],v[20:23],a[80:95]
i9 v[36:39],v13 offset:4096
i7 a[32:47],v[48:51],v[24:27],a[32:47]
i0 v[68:69],v7 offset:24576
i7 a[96:111],v[52:55],v[24:27],a[96:111]
i0 v[70:71],v7 offset:26624
i7 a[128:143],v[56:59],v[16:19],a[128:143]
i9 v[40:43],v13 offset:8192
i7 a[144:159],v[56:59],v[20:23],a[144:159]
i0 v[72:73],v14 offset:24576
i7 a[160:175],v[56:59],v[24:27],a[160:175]
i0 v[74:75],v14 offset:26624
i7 a[48:63],v[48:51],v[28:31],a[48:63]
i9 v[44:47],v13 offset:12288
i7 a[112:127],v[52:55],v[28:31],a[112:127]
i0 v[76:77],v15 offset:24576
i7 a[176:191],v[56:59],v[28:31],a[176:191]
i0 v[78:79],v15 offset:26624
i7 a[192:207],v[60:63],v[16:19],a[192:207]
i7 a[208:223],v[60:63],v[20:23],a[208:223]
i7 a[224:239],v[60:63],v[24:27],a[224:239]
i7 a[240:255],v[60:63],v[28:31],a[240:255]
i8 lgkmcnt(0)
i7 a[0:15],v[64:67],v[32:35],a[0:15]
i7 a[16:31],v[64:67],v[36:39],a[16:31]
i7 a[64:79],v[68:71],v[32:35],a[64:79]
i7 a[80:95],v[68:71],v[36:39],a[80:95]
i7 a[32:47],v[64:67],v[40:43],a[32:47]
i7 a[96:111],v[68:71],v[40:43],a[96:111]
i7 a[128:143],v[72:75],v[32:35],a[128:143]
i7 a[144:159],v[72:75],v[36:39],a[144:159]
i7 a[160:175],v[72:75],v[40:43],a[160:175]
i7 a[48:63],v[64:67],v[44:47],a[48:63]
i7 a[112:127],v[68:71],v[44:47],a[112:127]
i7 a[176:191],v[72:75],v[44:47],a[176:191]
i7 a[192:207],v[76:79],v[32:35],a[192:207]
i7 a[208:223],v[76:79],v[36:39],a[208:223]
i7 a[224:239],v[76:79],v[40:43],a[224:239]
i7 a[240:255],v[76:79],v[44:47],a[240:255]
i6 s47,s47,128
i6 s48,s48,524288
i20 v4,4294901760,v4
i20 v5,4294901760,v5
i20 v12,4294901760,v12
i20 v13,4294901760,v13
i20 v6,4294901760,v6
i20 v7,4294901760,v7
i20 v14,4294901760,v14
i20 v15,4294901760,v15
i6 s46,s46,1
s_cmp_lt_u32 s46, 4
i22 Lgk_loop
i8 vmcnt(0)
s_barrier
i9 v[16:19],v4 offset:0
i0 v[48:49],v6 offset:0
i0 v[50:51],v6 offset:2048
i9 v[20:23],v4 offset:4096
i0 v[52:53],v7 offset:0
i0 v[54:55],v7 offset:2048
i9 v[24:27],v4 offset:8192
i0 v[56:57],v14 offset:0
i0 v[58:59],v14 offset:2048
i9 v[28:31],v4 offset:12288
i0 v[60:61],v15 offset:0
i0 v[62:63],v15 offset:2048
i8 lgkmcnt(0)
i7 a[0:15],v[48:51],v[16:19],a[0:15]
i9 v[32:35],v5 offset:0
i7 a[16:31],v[48:51],v[20:23],a[16:31]
i0 v[64:65],v6 offset:8192
i7 a[64:79],v[52:55],v[16:19],a[64:79]
i0 v[66:67],v6 offset:10240
i7 a[80:95],v[52:55],v[20:23],a[80:95]
i9 v[36:39],v5 offset:4096
i7 a[32:47],v[48:51],v[24:27],a[32:47]
i0 v[68:69],v7 offset:8192
i7 a[96:111],v[52:55],v[24:27],a[96:111]
i0 v[70:71],v7 offset:10240
i7 a[128:143],v[56:59],v[16:19],a[128:143]
i9 v[40:43],v5 offset:8192
i7 a[144:159],v[56:59],v[20:23],a[144:159]
i0 v[72:73],v14 offset:8192
i7 a[160:175],v[56:59],v[24:27],a[160:175]
i0 v[74:75],v14 offset:10240
i7 a[48:63],v[48:51],v[28:31],a[48:63]
i9 v[44:47],v5 offset:12288
i7 a[112:127],v[52:55],v[28:31],a[112:127]
i0 v[76:77],v15 offset:8192
i7 a[176:191],v[56:59],v[28:31],a[176:191]
i0 v[78:79],v15 offset:10240
i7 a[192:207],v[60:63],v[16:19],a[192:207]
i7 a[208:223],v[60:63],v[20:23],a[208:223]
i7 a[224:239],v[60:63],v[24:27],a[224:239]
i7 a[240:255],v[60:63],v[28:31],a[240:255]
i8 lgkmcnt(0)
i7 a[0:15],v[64:67],v[32:35],a[0:15]
i9 v[16:19],v12 offset:0
i7 a[16:31],v[64:67],v[36:39],a[16:31]
i0 v[48:49],v6 offset:16384
i7 a[64:79],v[68:71],v[32:35],a[64:79]
i0 v[50:51],v6 offset:18432
i7 a[80:95],v[68:71],v[36:39],a[80:95]
i9 v[20:23],v12 offset:4096
i7 a[32:47],v[64:67],v[40:43],a[32:47]
i0 v[52:53],v7 offset:16384
i7 a[96:111],v[68:71],v[40:43],a[96:111]
i0 v[54:55],v7 offset:18432
i7 a[128:143],v[72:75],v[32:35],a[128:143]
i9 v[24:27],v12 offset:8192
i7 a[144:159],v[72:75],v[36:39],a[144:159]
i0 v[56:57],v14 offset:16384
i7 a[160:175],v[72:75],v[40:43],a[160:175]
i0 v[58:59],v14 offset:18432
i7 a[48:63],v[64:67],v[44:47],a[48:63]
i9 v[28:31],v12 offset:12288
i7 a[112:127],v[68:71],v[44:47],a[112:127]
i0 v[60:61],v15 offset:16384
i7 a[176:191],v[72:75],v[44:47],a[176:191]
i0 v[62:63],v15 offset:18432
i7 a[192:207],v[76:79],v[32:35],a[192:207]
i7 a[208:223],v[76:79],v[36:39],a[208:223]
i7 a[224:239],v[76:79],v[40:43],a[224:239]
i7 a[240:255],v[76:79],v[44:47],a[240:255]
i8 lgkmcnt(0)
i7 a[0:15],v[48:51],v[16:19],a[0:15]
i9 v[32:35],v13 offset:0
i7 a[16:31],v[48:51],v[20:23],a[16:31]
i0 v[64:65],v6 offset:24576
i7 a[64:79],v[52:55],v[16:19],a[64:79]
i0 v[66:67],v6 offset:26624
i7 a[80:95],v[52:55],v[20:23],a[80:95]
i9 v[36:39],v13 offset:4096
i7 a[32:47],v[48:51],v[24:27],a[32:47]
i0 v[68:69],v7 offset:24576
i7 a[96:111],v[52:55],v[24:27],a[96:111]
i0 v[70:71],v7 offset:26624
i7 a[128:143],v[56:59],v[16:19],a[128:143]
i9 v[40:43],v13 offset:8192
i7 a[144:159],v[56:59],v[20:23],a[144:159]
i0 v[72:73],v14 offset:24576
i7 a[160:175],v[56:59],v[24:27],a[160:175]
i0 v[74:75],v14 offset:26624
i7 a[48:63],v[48:51],v[28:31],a[48:63]
i9 v[44:47],v13 offset:12288
i7 a[112:127],v[52:55],v[28:31],a[112:127]
i0 v[76:77],v15 offset:24576
i7 a[176:191],v[56:59],v[28:31],a[176:191]
i0 v[78:79],v15 offset:26624
i7 a[192:207],v[60:63],v[16:19],a[192:207]
i7 a[208:223],v[60:63],v[20:23],a[208:223]
i7 a[224:239],v[60:63],v[24:27],a[224:239]
i7 a[240:255],v[60:63],v[28:31],a[240:255]
i8 lgkmcnt(0)
i7 a[0:15],v[64:67],v[32:35],a[0:15]
i7 a[16:31],v[64:67],v[36:39],a[16:31]
i7 a[64:79],v[68:71],v[32:35],a[64:79]
i7 a[80:95],v[68:71],v[36:39],a[80:95]
i7 a[32:47],v[64:67],v[40:43],a[32:47]
i7 a[96:111],v[68:71],v[40:43],a[96:111]
i7 a[128:143],v[72:75],v[32:35],a[128:143]
i7 a[144:159],v[72:75],v[36:39],a[144:159]
i7 a[160:175],v[72:75],v[40:43],a[160:175]
i7 a[48:63],v[64:67],v[44:47],a[48:63]
i7 a[112:127],v[68:71],v[44:47],a[112:127]
i7 a[176:191],v[72:75],v[44:47],a[176:191]
i7 a[192:207],v[76:79],v[32:35],a[192:207]
i7 a[208:223],v[76:79],v[36:39],a[208:223]
i7 a[224:239],v[76:79],v[40:43],a[224:239]
i7 a[240:255],v[76:79],v[44:47],a[240:255]
i46 s99,0
i22 L_v1gkk
i11 v40,0
i5 s94,0
i46 s21,0
i22 L_v1gkab
i39 exec,1
L_v1gka:
i55 v41,v40,s[100:101] offset:160 sc1
i6 s94,s94,1
i35 s94,400000
i22 L_end
i8 vmcnt(0)
v_cmp_gt_u32 vcc, 0x100, v41
i49 L_v1gkaz
i44 L_v1gkak
L_v1gkaz:
s_sleep 2
i44 L_v1gka
L_v1gkak:
i39 exec,-1
L_v1gkab:
s_barrier
global_load_dwordx4 v[44:47], v40, s[100:101] offset:0 sc1
global_load_dwordx4 v[48:51], v40, s[100:101] offset:16 sc1
i8 vmcnt(0)
i5 s93,0
i5 s94,s97
i37 s92,v44
i15 0
i46 s92,32
i28 s93,1,s93
i35 s96,0
i28 s92,s92,0
i6 s94,s94,s92
i37 s92,v45
i15 0
i46 s92,32
i28 s93,1,s93
i35 s96,1
i28 s92,s92,0
i6 s94,s94,s92
i37 s92,v46
i15 0
i46 s92,32
i28 s93,1,s93
i35 s96,2
i28 s92,s92,0
i6 s94,s94,s92
i37 s92,v47
i15 0
i46 s92,32
i28 s93,1,s93
i35 s96,3
i28 s92,s92,0
i6 s94,s94,s92
i37 s92,v48
i15 0
i46 s92,32
i28 s93,1,s93
i35 s96,4
i28 s92,s92,0
i6 s94,s94,s92
i37 s92,v49
i15 0
i46 s92,32
i28 s93,1,s93
i35 s96,5
i28 s92,s92,0
i6 s94,s94,s92
i37 s92,v50
i15 0
i46 s92,32
i28 s93,1,s93
i35 s96,6
i28 s92,s92,0
i6 s94,s94,s92
i37 s92,v51
i15 0
i46 s92,32
i28 s93,1,s93
i35 s96,7
i28 s92,s92,0
i6 s94,s94,s92
i5 s99,1
i47 s93,0
i22 L_v1gkk
i5 s99,2
s_lshr_b32 s98, s94, 5
s_and_b32 s20, s94, 31
i8 vmcnt(0) lgkmcnt(0)
s_barrier
i44 L_role
L_v1gkk:
s_lshr_b32 s3, s32, 1
i6 s3,s3,s30
i47 s3,1
i28 s3,s30,0
i47 s3,1
i22 L_hgke
i11 v40,0
i5 s94,0
i46 s21,0
i22 L_hgkb
i39 exec,1
L_hgk:
i55 v41,v40,s[100:101] offset:68 sc1
i6 s94,s94,1
i35 s94,400000
i22 L_end
i8 vmcnt(0)
v_cmp_gt_u32 vcc, 64, v41
i49 L_hgkz
i44 L_hgkk
L_hgkz:
s_sleep 12
i44 L_hgk
L_hgkk:
i39 exec,-1
L_hgkb:
s_barrier
L_hgke:
i23 v10,4,v0
i23 v11,5,v10
i31 v11,8,v11
i34 v12,v10,3,1
i24 v11,v12,10,v11
i34 v12,v10,4,1
i24 v11,v12,7,v11
i18 v12,0x70,v0
v_or_b32 v8, v11, v12
i32 s44,s30,3
s_lshr_b32 s45, s21, 1
i32 s45,s45,2
i6 s44,s44,s45
i32 s49,s44,18
i32 s44,s31,1
s_and_b32 s45, s21, 1
i6 s44,s44,s45
i32 s44,s44,13
i6 s49,s49,s44
i32 s44,s32,24
i6 s49,s49,s44
i47 s32,0
i28 s50,1040356334,1.0
i5 s51,s50
i15 7
i15 7
i6 s44,s49,0
i10 v16,a0
i10 v17,a1
i10 v18,a2
i10 v19,a3
i10 v20,a4
i10 v21,a5
i10 v22,a6
i10 v23,a7
i16 v[16:17],v[16:17],s[50:51]
i16 v[18:19],v[18:19],s[50:51]
i16 v[20:21],v[20:21],s[50:51]
i16 v[22:23],v[22:23],s[50:51]
i3 v24,v16,v17
i3 v25,v18,v19
i3 v26,v20,v21
i3 v27,v22,v23
i13 v[24:27],v8,s[8:11],s44 offen offset:0 sc1
i10 v28,a8
i10 v29,a9
i10 v30,a10
i10 v31,a11
i10 v32,a12
i10 v33,a13
i10 v34,a14
i10 v35,a15
i16 v[28:29],v[28:29],s[50:51]
i16 v[30:31],v[30:31],s[50:51]
i16 v[32:33],v[32:33],s[50:51]
i16 v[34:35],v[34:35],s[50:51]
i3 v36,v28,v29
i3 v37,v30,v31
i3 v38,v32,v33
i3 v39,v34,v35
i13 v[36:39],v8,s[8:11],s44 offen offset:512 sc1
i6 s44,s49,2048
i10 v40,a64
i10 v41,a65
i10 v42,a66
i10 v43,a67
i10 v44,a68
i10 v45,a69
i10 v46,a70
i10 v47,a71
i16 v[40:41],v[40:41],s[50:51]
i16 v[42:43],v[42:43],s[50:51]
i16 v[44:45],v[44:45],s[50:51]
i16 v[46:47],v[46:47],s[50:51]
i3 v48,v40,v41
i3 v49,v42,v43
i3 v50,v44,v45
i3 v51,v46,v47
i13 v[48:51],v8,s[8:11],s44 offen offset:0 sc1
i10 v52,a72
i10 v53,a73
i10 v54,a74
i10 v55,a75
i10 v56,a76
i10 v57,a77
i10 v58,a78
i10 v59,a79
i16 v[52:53],v[52:53],s[50:51]
i16 v[54:55],v[54:55],s[50:51]
i16 v[56:57],v[56:57],s[50:51]
i16 v[58:59],v[58:59],s[50:51]
i3 v60,v52,v53
i3 v61,v54,v55
i3 v62,v56,v57
i3 v63,v58,v59
i13 v[60:63],v8,s[8:11],s44 offen offset:512 sc1
i6 s44,s49,4096
i10 v16,a128
i10 v17,a129
i10 v18,a130
i10 v19,a131
i10 v20,a132
i10 v21,a133
i10 v22,a134
i10 v23,a135
i16 v[16:17],v[16:17],s[50:51]
i16 v[18:19],v[18:19],s[50:51]
i16 v[20:21],v[20:21],s[50:51]
i16 v[22:23],v[22:23],s[50:51]
i3 v24,v16,v17
i3 v25,v18,v19
i3 v26,v20,v21
i3 v27,v22,v23
i13 v[24:27],v8,s[8:11],s44 offen offset:0 sc1
i10 v28,a136
i10 v29,a137
i10 v30,a138
i10 v31,a139
i10 v32,a140
i10 v33,a141
i10 v34,a142
i10 v35,a143
i16 v[28:29],v[28:29],s[50:51]
i16 v[30:31],v[30:31],s[50:51]
i16 v[32:33],v[32:33],s[50:51]
i16 v[34:35],v[34:35],s[50:51]
i3 v36,v28,v29
i3 v37,v30,v31
i3 v38,v32,v33
i3 v39,v34,v35
i13 v[36:39],v8,s[8:11],s44 offen offset:512 sc1
i6 s44,s49,6144
i10 v40,a192
i10 v41,a193
i10 v42,a194
i10 v43,a195
i10 v44,a196
i10 v45,a197
i10 v46,a198
i10 v47,a199
i16 v[40:41],v[40:41],s[50:51]
i16 v[42:43],v[42:43],s[50:51]
i16 v[44:45],v[44:45],s[50:51]
i16 v[46:47],v[46:47],s[50:51]
i3 v48,v40,v41
i3 v49,v42,v43
i3 v50,v44,v45
i3 v51,v46,v47
i13 v[48:51],v8,s[8:11],s44 offen offset:0 sc1
i10 v52,a200
i10 v53,a201
i10 v54,a202
i10 v55,a203
i10 v56,a204
i10 v57,a205
i10 v58,a206
i10 v59,a207
i16 v[52:53],v[52:53],s[50:51]
i16 v[54:55],v[54:55],s[50:51]
i16 v[56:57],v[56:57],s[50:51]
i16 v[58:59],v[58:59],s[50:51]
i3 v60,v52,v53
i3 v61,v54,v55
i3 v62,v56,v57
i3 v63,v58,v59
i13 v[60:63],v8,s[8:11],s44 offen offset:512 sc1
i6 s44,s49,262144
i10 v16,a16
i10 v17,a17
i10 v18,a18
i10 v19,a19
i10 v20,a20
i10 v21,a21
i10 v22,a22
i10 v23,a23
i16 v[16:17],v[16:17],s[50:51]
i16 v[18:19],v[18:19],s[50:51]
i16 v[20:21],v[20:21],s[50:51]
i16 v[22:23],v[22:23],s[50:51]
i3 v24,v16,v17
i3 v25,v18,v19
i3 v26,v20,v21
i3 v27,v22,v23
i13 v[24:27],v8,s[8:11],s44 offen offset:0 sc1
i10 v28,a24
i10 v29,a25
i10 v30,a26
i10 v31,a27
i10 v32,a28
i10 v33,a29
i10 v34,a30
i10 v35,a31
i16 v[28:29],v[28:29],s[50:51]
i16 v[30:31],v[30:31],s[50:51]
i16 v[32:33],v[32:33],s[50:51]
i16 v[34:35],v[34:35],s[50:51]
i3 v36,v28,v29
i3 v37,v30,v31
i3 v38,v32,v33
i3 v39,v34,v35
i13 v[36:39],v8,s[8:11],s44 offen offset:512 sc1
i6 s44,s49,264192
i10 v40,a80
i10 v41,a81
i10 v42,a82
i10 v43,a83
i10 v44,a84
i10 v45,a85
i10 v46,a86
i10 v47,a87
i16 v[40:41],v[40:41],s[50:51]
i16 v[42:43],v[42:43],s[50:51]
i16 v[44:45],v[44:45],s[50:51]
i16 v[46:47],v[46:47],s[50:51]
i3 v48,v40,v41
i3 v49,v42,v43
i3 v50,v44,v45
i3 v51,v46,v47
i13 v[48:51],v8,s[8:11],s44 offen offset:0 sc1
i10 v52,a88
i10 v53,a89
i10 v54,a90
i10 v55,a91
i10 v56,a92
i10 v57,a93
i10 v58,a94
i10 v59,a95
i16 v[52:53],v[52:53],s[50:51]
i16 v[54:55],v[54:55],s[50:51]
i16 v[56:57],v[56:57],s[50:51]
i16 v[58:59],v[58:59],s[50:51]
i3 v60,v52,v53
i3 v61,v54,v55
i3 v62,v56,v57
i3 v63,v58,v59
i13 v[60:63],v8,s[8:11],s44 offen offset:512 sc1
i6 s44,s49,266240
i10 v16,a144
i10 v17,a145
i10 v18,a146
i10 v19,a147
i10 v20,a148
i10 v21,a149
i10 v22,a150
i10 v23,a151
i16 v[16:17],v[16:17],s[50:51]
i16 v[18:19],v[18:19],s[50:51]
i16 v[20:21],v[20:21],s[50:51]
i16 v[22:23],v[22:23],s[50:51]
i3 v24,v16,v17
i3 v25,v18,v19
i3 v26,v20,v21
i3 v27,v22,v23
i13 v[24:27],v8,s[8:11],s44 offen offset:0 sc1
i10 v28,a152
i10 v29,a153
i10 v30,a154
i10 v31,a155
i10 v32,a156
i10 v33,a157
i10 v34,a158
i10 v35,a159
i16 v[28:29],v[28:29],s[50:51]
i16 v[30:31],v[30:31],s[50:51]
i16 v[32:33],v[32:33],s[50:51]
i16 v[34:35],v[34:35],s[50:51]
i3 v36,v28,v29
i3 v37,v30,v31
i3 v38,v32,v33
i3 v39,v34,v35
i13 v[36:39],v8,s[8:11],s44 offen offset:512 sc1
i6 s44,s49,268288
i10 v40,a208
i10 v41,a209
i10 v42,a210
i10 v43,a211
i10 v44,a212
i10 v45,a213
i10 v46,a214
i10 v47,a215
i16 v[40:41],v[40:41],s[50:51]
i16 v[42:43],v[42:43],s[50:51]
i16 v[44:45],v[44:45],s[50:51]
i16 v[46:47],v[46:47],s[50:51]
i3 v48,v40,v41
i3 v49,v42,v43
i3 v50,v44,v45
i3 v51,v46,v47
i13 v[48:51],v8,s[8:11],s44 offen offset:0 sc1
i10 v52,a216
i10 v53,a217
i10 v54,a218
i10 v55,a219
i10 v56,a220
i10 v57,a221
i10 v58,a222
i10 v59,a223
i16 v[52:53],v[52:53],s[50:51]
i16 v[54:55],v[54:55],s[50:51]
i16 v[56:57],v[56:57],s[50:51]
i16 v[58:59],v[58:59],s[50:51]
i3 v60,v52,v53
i3 v61,v54,v55
i3 v62,v56,v57
i3 v63,v58,v59
i13 v[60:63],v8,s[8:11],s44 offen offset:512 sc1
i6 s44,s49,524288
i10 v16,a32
i10 v17,a33
i10 v18,a34
i10 v19,a35
i10 v20,a36
i10 v21,a37
i10 v22,a38
i10 v23,a39
i16 v[16:17],v[16:17],s[50:51]
i16 v[18:19],v[18:19],s[50:51]
i16 v[20:21],v[20:21],s[50:51]
i16 v[22:23],v[22:23],s[50:51]
i3 v24,v16,v17
i3 v25,v18,v19
i3 v26,v20,v21
i3 v27,v22,v23
i13 v[24:27],v8,s[8:11],s44 offen offset:0 sc1
i10 v28,a40
i10 v29,a41
i10 v30,a42
i10 v31,a43
i10 v32,a44
i10 v33,a45
i10 v34,a46
i10 v35,a47
i16 v[28:29],v[28:29],s[50:51]
i16 v[30:31],v[30:31],s[50:51]
i16 v[32:33],v[32:33],s[50:51]
i16 v[34:35],v[34:35],s[50:51]
i3 v36,v28,v29
i3 v37,v30,v31
i3 v38,v32,v33
i3 v39,v34,v35
i13 v[36:39],v8,s[8:11],s44 offen offset:512 sc1
i6 s44,s49,526336
i10 v40,a96
i10 v41,a97
i10 v42,a98
i10 v43,a99
i10 v44,a100
i10 v45,a101
i10 v46,a102
i10 v47,a103
i16 v[40:41],v[40:41],s[50:51]
i16 v[42:43],v[42:43],s[50:51]
i16 v[44:45],v[44:45],s[50:51]
i16 v[46:47],v[46:47],s[50:51]
i3 v48,v40,v41
i3 v49,v42,v43
i3 v50,v44,v45
i3 v51,v46,v47
i13 v[48:51],v8,s[8:11],s44 offen offset:0 sc1
i10 v52,a104
i10 v53,a105
i10 v54,a106
i10 v55,a107
i10 v56,a108
i10 v57,a109
i10 v58,a110
i10 v59,a111
i16 v[52:53],v[52:53],s[50:51]
i16 v[54:55],v[54:55],s[50:51]
i16 v[56:57],v[56:57],s[50:51]
i16 v[58:59],v[58:59],s[50:51]
i3 v60,v52,v53
i3 v61,v54,v55
i3 v62,v56,v57
i3 v63,v58,v59
i13 v[60:63],v8,s[8:11],s44 offen offset:512 sc1
i6 s44,s49,528384
i10 v16,a160
i10 v17,a161
i10 v18,a162
i10 v19,a163
i10 v20,a164
i10 v21,a165
i10 v22,a166
i10 v23,a167
i16 v[16:17],v[16:17],s[50:51]
i16 v[18:19],v[18:19],s[50:51]
i16 v[20:21],v[20:21],s[50:51]
i16 v[22:23],v[22:23],s[50:51]
i3 v24,v16,v17
i3 v25,v18,v19
i3 v26,v20,v21
i3 v27,v22,v23
i13 v[24:27],v8,s[8:11],s44 offen offset:0 sc1
i10 v28,a168
i10 v29,a169
i10 v30,a170
i10 v31,a171
i10 v32,a172
i10 v33,a173
i10 v34,a174
i10 v35,a175
i16 v[28:29],v[28:29],s[50:51]
i16 v[30:31],v[30:31],s[50:51]
i16 v[32:33],v[32:33],s[50:51]
i16 v[34:35],v[34:35],s[50:51]
i3 v36,v28,v29
i3 v37,v30,v31
i3 v38,v32,v33
i3 v39,v34,v35
i13 v[36:39],v8,s[8:11],s44 offen offset:512 sc1
i6 s44,s49,530432
i10 v40,a224
i10 v41,a225
i10 v42,a226
i10 v43,a227
i10 v44,a228
i10 v45,a229
i10 v46,a230
i10 v47,a231
i16 v[40:41],v[40:41],s[50:51]
i16 v[42:43],v[42:43],s[50:51]
i16 v[44:45],v[44:45],s[50:51]
i16 v[46:47],v[46:47],s[50:51]
i3 v48,v40,v41
i3 v49,v42,v43
i3 v50,v44,v45
i3 v51,v46,v47
i13 v[48:51],v8,s[8:11],s44 offen offset:0 sc1
i10 v52,a232
i10 v53,a233
i10 v54,a234
i10 v55,a235
i10 v56,a236
i10 v57,a237
i10 v58,a238
i10 v59,a239
i16 v[52:53],v[52:53],s[50:51]
i16 v[54:55],v[54:55],s[50:51]
i16 v[56:57],v[56:57],s[50:51]
i16 v[58:59],v[58:59],s[50:51]
i3 v60,v52,v53
i3 v61,v54,v55
i3 v62,v56,v57
i3 v63,v58,v59
i13 v[60:63],v8,s[8:11],s44 offen offset:512 sc1
i6 s44,s49,786432
i10 v16,a48
i10 v17,a49
i10 v18,a50
i10 v19,a51
i10 v20,a52
i10 v21,a53
i10 v22,a54
i10 v23,a55
i16 v[16:17],v[16:17],s[50:51]
i16 v[18:19],v[18:19],s[50:51]
i16 v[20:21],v[20:21],s[50:51]
i16 v[22:23],v[22:23],s[50:51]
i3 v24,v16,v17
i3 v25,v18,v19
i3 v26,v20,v21
i3 v27,v22,v23
i13 v[24:27],v8,s[8:11],s44 offen offset:0 sc1
i10 v28,a56
i10 v29,a57
i10 v30,a58
i10 v31,a59
i10 v32,a60
i10 v33,a61
i10 v34,a62
i10 v35,a63
i16 v[28:29],v[28:29],s[50:51]
i16 v[30:31],v[30:31],s[50:51]
i16 v[32:33],v[32:33],s[50:51]
i16 v[34:35],v[34:35],s[50:51]
i3 v36,v28,v29
i3 v37,v30,v31
i3 v38,v32,v33
i3 v39,v34,v35
i13 v[36:39],v8,s[8:11],s44 offen offset:512 sc1
i6 s44,s49,788480
i10 v40,a112
i10 v41,a113
i10 v42,a114
i10 v43,a115
i10 v44,a116
i10 v45,a117
i10 v46,a118
i10 v47,a119
i16 v[40:41],v[40:41],s[50:51]
i16 v[42:43],v[42:43],s[50:51]
i16 v[44:45],v[44:45],s[50:51]
i16 v[46:47],v[46:47],s[50:51]
i3 v48,v40,v41
i3 v49,v42,v43
i3 v50,v44,v45
i3 v51,v46,v47
i13 v[48:51],v8,s[8:11],s44 offen offset:0 sc1
i10 v52,a120
i10 v53,a121
i10 v54,a122
i10 v55,a123
i10 v56,a124
i10 v57,a125
i10 v58,a126
i10 v59,a127
i16 v[52:53],v[52:53],s[50:51]
i16 v[54:55],v[54:55],s[50:51]
i16 v[56:57],v[56:57],s[50:51]
i16 v[58:59],v[58:59],s[50:51]
i3 v60,v52,v53
i3 v61,v54,v55
i3 v62,v56,v57
i3 v63,v58,v59
i13 v[60:63],v8,s[8:11],s44 offen offset:512 sc1
i6 s44,s49,790528
i10 v16,a176
i10 v17,a177
i10 v18,a178
i10 v19,a179
i10 v20,a180
i10 v21,a181
i10 v22,a182
i10 v23,a183
i16 v[16:17],v[16:17],s[50:51]
i16 v[18:19],v[18:19],s[50:51]
i16 v[20:21],v[20:21],s[50:51]
i16 v[22:23],v[22:23],s[50:51]
i3 v24,v16,v17
i3 v25,v18,v19
i3 v26,v20,v21
i3 v27,v22,v23
i13 v[24:27],v8,s[8:11],s44 offen offset:0 sc1
i10 v28,a184
i10 v29,a185
i10 v30,a186
i10 v31,a187
i10 v32,a188
i10 v33,a189
i10 v34,a190
i10 v35,a191
i16 v[28:29],v[28:29],s[50:51]
i16 v[30:31],v[30:31],s[50:51]
i16 v[32:33],v[32:33],s[50:51]
i16 v[34:35],v[34:35],s[50:51]
i3 v36,v28,v29
i3 v37,v30,v31
i3 v38,v32,v33
i3 v39,v34,v35
i13 v[36:39],v8,s[8:11],s44 offen offset:512 sc1
i6 s44,s49,792576
i10 v40,a240
i10 v41,a241
i10 v42,a242
i10 v43,a243
i10 v44,a244
i10 v45,a245
i10 v46,a246
i10 v47,a247
i16 v[40:41],v[40:41],s[50:51]
i16 v[42:43],v[42:43],s[50:51]
i16 v[44:45],v[44:45],s[50:51]
i16 v[46:47],v[46:47],s[50:51]
i3 v48,v40,v41
i3 v49,v42,v43
i3 v50,v44,v45
i3 v51,v46,v47
i13 v[48:51],v8,s[8:11],s44 offen offset:0 sc1
i10 v52,a248
i10 v53,a249
i10 v54,a250
i10 v55,a251
i10 v56,a252
i10 v57,a253
i10 v58,a254
i10 v59,a255
i16 v[52:53],v[52:53],s[50:51]
i16 v[54:55],v[54:55],s[50:51]
i16 v[56:57],v[56:57],s[50:51]
i16 v[58:59],v[58:59],s[50:51]
i3 v60,v52,v53
i3 v61,v54,v55
i3 v62,v56,v57
i3 v63,v58,v59
i13 v[60:63],v8,s[8:11],s44 offen offset:512 sc1
i44 Lg_end
Lg_v:
i5 s46,0
Lgv_loop:
i8 vmcnt(0)
s_barrier
i9 v[16:19],v4 offset:0
i0 v[48:49],v6 offset:0
i0 v[50:51],v6 offset:2048
i9 v[20:23],v4 offset:4096
i0 v[52:53],v7 offset:0
i0 v[54:55],v7 offset:2048
i9 v[24:27],v4 offset:8192
i0 v[56:57],v14 offset:0
i0 v[58:59],v14 offset:2048
i9 v[28:31],v4 offset:12288
i0 v[60:61],v15 offset:0
i0 v[62:63],v15 offset:2048
i8 lgkmcnt(0)
i7 a[0:15],v[16:19],v[48:51],a[0:15]
i9 v[32:35],v5 offset:0
i7 a[16:31],v[20:23],v[48:51],a[16:31]
i0 v[64:65],v6 offset:8192
i6 m0,s52,65536
i6 s44,s47,0
i1 v1,s[36:39],s44 offen lds
i7 a[64:79],v[16:19],v[52:55],a[64:79]
i0 v[66:67],v6 offset:10240
i7 a[80:95],v[20:23],v[52:55],a[80:95]
i9 v[36:39],v5 offset:4096
i6 m0,s49,98304
i6 s44,s48,0
i1 v2,s[40:43],s44 offen lds
i7 a[32:47],v[24:27],v[48:51],a[32:47]
i0 v[68:69],v7 offset:8192
i7 a[96:111],v[24:27],v[52:55],a[96:111]
i0 v[70:71],v7 offset:10240
i6 m0,s52,66560
i6 s44,s47,9216
i1 v1,s[36:39],s44 offen lds
i7 a[128:143],v[16:19],v[56:59],a[128:143]
i9 v[40:43],v5 offset:8192
i7 a[144:159],v[20:23],v[56:59],a[144:159]
i0 v[72:73],v14 offset:8192
i6 m0,s49,99328
i6 s44,s48,16384
i1 v3,s[40:43],s44 offen lds
i7 a[160:175],v[24:27],v[56:59],a[160:175]
i0 v[74:75],v14 offset:10240
i7 a[48:63],v[28:31],v[48:51],a[48:63]
i9 v[44:47],v5 offset:12288
i6 m0,s52,67584
i6 s44,s47,18432
i1 v1,s[36:39],s44 offen lds
i7 a[112:127],v[28:31],v[52:55],a[112:127]
i0 v[76:77],v15 offset:8192
i7 a[176:191],v[28:31],v[56:59],a[176:191]
i0 v[78:79],v15 offset:10240
i6 m0,s49,100352
i6 s44,s48,32768
i1 v2,s[40:43],s44 offen lds
i7 a[192:207],v[16:19],v[60:63],a[192:207]
i7 a[208:223],v[20:23],v[60:63],a[208:223]
i6 m0,s52,68608
i6 s44,s47,27648
i1 v1,s[36:39],s44 offen lds
i7 a[224:239],v[24:27],v[60:63],a[224:239]
i7 a[240:255],v[28:31],v[60:63],a[240:255]
i6 m0,s49,101376
i6 s44,s48,49152
i1 v3,s[40:43],s44 offen lds
i8 lgkmcnt(0)
i7 a[0:15],v[32:35],v[64:67],a[0:15]
i9 v[16:19],v12 offset:0
i7 a[16:31],v[36:39],v[64:67],a[16:31]
i0 v[48:49],v6 offset:16384
i6 m0,s52,69632
i6 s44,s47,36864
i1 v1,s[36:39],s44 offen lds
i7 a[64:79],v[32:35],v[68:71],a[64:79]
i0 v[50:51],v6 offset:18432
i7 a[80:95],v[36:39],v[68:71],a[80:95]
i9 v[20:23],v12 offset:4096
i6 m0,s49,102400
i6 s44,s48,65536
i1 v2,s[40:43],s44 offen lds
i7 a[32:47],v[40:43],v[64:67],a[32:47]
i0 v[52:53],v7 offset:16384
i7 a[96:111],v[40:43],v[68:71],a[96:111]
i0 v[54:55],v7 offset:18432
i6 m0,s52,70656
i6 s44,s47,46080
i1 v1,s[36:39],s44 offen lds
i7 a[128:143],v[32:35],v[72:75],a[128:143]
i9 v[24:27],v12 offset:8192
i7 a[144:159],v[36:39],v[72:75],a[144:159]
i0 v[56:57],v14 offset:16384
i6 m0,s49,103424
i6 s44,s48,81920
i1 v3,s[40:43],s44 offen lds
i7 a[160:175],v[40:43],v[72:75],a[160:175]
i0 v[58:59],v14 offset:18432
i7 a[48:63],v[44:47],v[64:67],a[48:63]
i9 v[28:31],v12 offset:12288
i6 m0,s52,71680
i6 s44,s47,55296
i1 v1,s[36:39],s44 offen lds
i7 a[112:127],v[44:47],v[68:71],a[112:127]
i0 v[60:61],v15 offset:16384
i7 a[176:191],v[44:47],v[72:75],a[176:191]
i0 v[62:63],v15 offset:18432
i6 m0,s49,104448
i6 s44,s48,98304
i1 v2,s[40:43],s44 offen lds
i7 a[192:207],v[32:35],v[76:79],a[192:207]
i7 a[208:223],v[36:39],v[76:79],a[208:223]
i6 m0,s52,72704
i6 s44,s47,64512
i1 v1,s[36:39],s44 offen lds
i7 a[224:239],v[40:43],v[76:79],a[224:239]
i7 a[240:255],v[44:47],v[76:79],a[240:255]
i6 m0,s49,105472
i6 s44,s48,114688
i1 v3,s[40:43],s44 offen lds
i8 lgkmcnt(0)
i7 a[0:15],v[16:19],v[48:51],a[0:15]
i9 v[32:35],v13 offset:0
i7 a[16:31],v[20:23],v[48:51],a[16:31]
i0 v[64:65],v6 offset:24576
i7 a[64:79],v[16:19],v[52:55],a[64:79]
i0 v[66:67],v6 offset:26624
i7 a[80:95],v[20:23],v[52:55],a[80:95]
i9 v[36:39],v13 offset:4096
i7 a[32:47],v[24:27],v[48:51],a[32:47]
i0 v[68:69],v7 offset:24576
i7 a[96:111],v[24:27],v[52:55],a[96:111]
i0 v[70:71],v7 offset:26624
i7 a[128:143],v[16:19],v[56:59],a[128:143]
i9 v[40:43],v13 offset:8192
i7 a[144:159],v[20:23],v[56:59],a[144:159]
i0 v[72:73],v14 offset:24576
i7 a[160:175],v[24:27],v[56:59],a[160:175]
i0 v[74:75],v14 offset:26624
i7 a[48:63],v[28:31],v[48:51],a[48:63]
i9 v[44:47],v13 offset:12288
i7 a[112:127],v[28:31],v[52:55],a[112:127]
i0 v[76:77],v15 offset:24576
i7 a[176:191],v[28:31],v[56:59],a[176:191]
i0 v[78:79],v15 offset:26624
i7 a[192:207],v[16:19],v[60:63],a[192:207]
i7 a[208:223],v[20:23],v[60:63],a[208:223]
i7 a[224:239],v[24:27],v[60:63],a[224:239]
i7 a[240:255],v[28:31],v[60:63],a[240:255]
i8 lgkmcnt(0)
i7 a[0:15],v[32:35],v[64:67],a[0:15]
i7 a[16:31],v[36:39],v[64:67],a[16:31]
i7 a[64:79],v[32:35],v[68:71],a[64:79]
i7 a[80:95],v[36:39],v[68:71],a[80:95]
i7 a[32:47],v[40:43],v[64:67],a[32:47]
i7 a[96:111],v[40:43],v[68:71],a[96:111]
i7 a[128:143],v[32:35],v[72:75],a[128:143]
i7 a[144:159],v[36:39],v[72:75],a[144:159]
i7 a[160:175],v[40:43],v[72:75],a[160:175]
i7 a[48:63],v[44:47],v[64:67],a[48:63]
i7 a[112:127],v[44:47],v[68:71],a[112:127]
i7 a[176:191],v[44:47],v[72:75],a[176:191]
i7 a[192:207],v[32:35],v[76:79],a[192:207]
i7 a[208:223],v[36:39],v[76:79],a[208:223]
i7 a[224:239],v[40:43],v[76:79],a[224:239]
i7 a[240:255],v[44:47],v[76:79],a[240:255]
i6 s47,s47,128
i6 s48,s48,524288
i20 v4,65536,v4
i20 v5,65536,v5
i20 v12,65536,v12
i20 v13,65536,v13
i20 v6,65536,v6
i20 v7,65536,v7
i20 v14,65536,v14
i20 v15,65536,v15
i8 vmcnt(0)
s_barrier
i9 v[16:19],v4 offset:0
i0 v[48:49],v6 offset:0
i0 v[50:51],v6 offset:2048
i9 v[20:23],v4 offset:4096
i0 v[52:53],v7 offset:0
i0 v[54:55],v7 offset:2048
i9 v[24:27],v4 offset:8192
i0 v[56:57],v14 offset:0
i0 v[58:59],v14 offset:2048
i9 v[28:31],v4 offset:12288
i0 v[60:61],v15 offset:0
i0 v[62:63],v15 offset:2048
i8 lgkmcnt(0)
i7 a[0:15],v[16:19],v[48:51],a[0:15]
i9 v[32:35],v5 offset:0
i7 a[16:31],v[20:23],v[48:51],a[16:31]
i0 v[64:65],v6 offset:8192
i6 m0,s52,0
i6 s44,s47,0
i1 v1,s[36:39],s44 offen lds
i7 a[64:79],v[16:19],v[52:55],a[64:79]
i0 v[66:67],v6 offset:10240
i7 a[80:95],v[20:23],v[52:55],a[80:95]
i9 v[36:39],v5 offset:4096
i6 m0,s49,32768
i6 s44,s48,0
i1 v2,s[40:43],s44 offen lds
i7 a[32:47],v[24:27],v[48:51],a[32:47]
i0 v[68:69],v7 offset:8192
i7 a[96:111],v[24:27],v[52:55],a[96:111]
i0 v[70:71],v7 offset:10240
i6 m0,s52,1024
i6 s44,s47,9216
i1 v1,s[36:39],s44 offen lds
i7 a[128:143],v[16:19],v[56:59],a[128:143]
i9 v[40:43],v5 offset:8192
i7 a[144:159],v[20:23],v[56:59],a[144:159]
i0 v[72:73],v14 offset:8192
i6 m0,s49,33792
i6 s44,s48,16384
i1 v3,s[40:43],s44 offen lds
i7 a[160:175],v[24:27],v[56:59],a[160:175]
i0 v[74:75],v14 offset:10240
i7 a[48:63],v[28:31],v[48:51],a[48:63]
i9 v[44:47],v5 offset:12288
i6 m0,s52,2048
i6 s44,s47,18432
i1 v1,s[36:39],s44 offen lds
i7 a[112:127],v[28:31],v[52:55],a[112:127]
i0 v[76:77],v15 offset:8192
i7 a[176:191],v[28:31],v[56:59],a[176:191]
i0 v[78:79],v15 offset:10240
i6 m0,s49,34816
i6 s44,s48,32768
i1 v2,s[40:43],s44 offen lds
i7 a[192:207],v[16:19],v[60:63],a[192:207]
i7 a[208:223],v[20:23],v[60:63],a[208:223]
i6 m0,s52,3072
i6 s44,s47,27648
i1 v1,s[36:39],s44 offen lds
i7 a[224:239],v[24:27],v[60:63],a[224:239]
i7 a[240:255],v[28:31],v[60:63],a[240:255]
i6 m0,s49,35840
i6 s44,s48,49152
i1 v3,s[40:43],s44 offen lds
i8 lgkmcnt(0)
i7 a[0:15],v[32:35],v[64:67],a[0:15]
i9 v[16:19],v12 offset:0
i7 a[16:31],v[36:39],v[64:67],a[16:31]
i0 v[48:49],v6 offset:16384
i6 m0,s52,4096
i6 s44,s47,36864
i1 v1,s[36:39],s44 offen lds
i7 a[64:79],v[32:35],v[68:71],a[64:79]
i0 v[50:51],v6 offset:18432
i7 a[80:95],v[36:39],v[68:71],a[80:95]
i9 v[20:23],v12 offset:4096
i6 m0,s49,36864
i6 s44,s48,65536
i1 v2,s[40:43],s44 offen lds
i7 a[32:47],v[40:43],v[64:67],a[32:47]
i0 v[52:53],v7 offset:16384
i7 a[96:111],v[40:43],v[68:71],a[96:111]
i0 v[54:55],v7 offset:18432
i6 m0,s52,5120
i6 s44,s47,46080
i1 v1,s[36:39],s44 offen lds
i7 a[128:143],v[32:35],v[72:75],a[128:143]
i9 v[24:27],v12 offset:8192
i7 a[144:159],v[36:39],v[72:75],a[144:159]
i0 v[56:57],v14 offset:16384
i6 m0,s49,37888
i6 s44,s48,81920
i1 v3,s[40:43],s44 offen lds
i7 a[160:175],v[40:43],v[72:75],a[160:175]
i0 v[58:59],v14 offset:18432
i7 a[48:63],v[44:47],v[64:67],a[48:63]
i9 v[28:31],v12 offset:12288
i6 m0,s52,6144
i6 s44,s47,55296
i1 v1,s[36:39],s44 offen lds
i7 a[112:127],v[44:47],v[68:71],a[112:127]
i0 v[60:61],v15 offset:16384
i7 a[176:191],v[44:47],v[72:75],a[176:191]
i0 v[62:63],v15 offset:18432
i6 m0,s49,38912
i6 s44,s48,98304
i1 v2,s[40:43],s44 offen lds
i7 a[192:207],v[32:35],v[76:79],a[192:207]
i7 a[208:223],v[36:39],v[76:79],a[208:223]
i6 m0,s52,7168
i6 s44,s47,64512
i1 v1,s[36:39],s44 offen lds
i7 a[224:239],v[40:43],v[76:79],a[224:239]
i7 a[240:255],v[44:47],v[76:79],a[240:255]
i6 m0,s49,39936
i6 s44,s48,114688
i1 v3,s[40:43],s44 offen lds
i8 lgkmcnt(0)
i7 a[0:15],v[16:19],v[48:51],a[0:15]
i9 v[32:35],v13 offset:0
i7 a[16:31],v[20:23],v[48:51],a[16:31]
i0 v[64:65],v6 offset:24576
i7 a[64:79],v[16:19],v[52:55],a[64:79]
i0 v[66:67],v6 offset:26624
i7 a[80:95],v[20:23],v[52:55],a[80:95]
i9 v[36:39],v13 offset:4096
i7 a[32:47],v[24:27],v[48:51],a[32:47]
i0 v[68:69],v7 offset:24576
i7 a[96:111],v[24:27],v[52:55],a[96:111]
i0 v[70:71],v7 offset:26624
i7 a[128:143],v[16:19],v[56:59],a[128:143]
i9 v[40:43],v13 offset:8192
i7 a[144:159],v[20:23],v[56:59],a[144:159]
i0 v[72:73],v14 offset:24576
i7 a[160:175],v[24:27],v[56:59],a[160:175]
i0 v[74:75],v14 offset:26624
i7 a[48:63],v[28:31],v[48:51],a[48:63]
i9 v[44:47],v13 offset:12288
i7 a[112:127],v[28:31],v[52:55],a[112:127]
i0 v[76:77],v15 offset:24576
i7 a[176:191],v[28:31],v[56:59],a[176:191]
i0 v[78:79],v15 offset:26624
i7 a[192:207],v[16:19],v[60:63],a[192:207]
i7 a[208:223],v[20:23],v[60:63],a[208:223]
i7 a[224:239],v[24:27],v[60:63],a[224:239]
i7 a[240:255],v[28:31],v[60:63],a[240:255]
i8 lgkmcnt(0)
i7 a[0:15],v[32:35],v[64:67],a[0:15]
i7 a[16:31],v[36:39],v[64:67],a[16:31]
i7 a[64:79],v[32:35],v[68:71],a[64:79]
i7 a[80:95],v[36:39],v[68:71],a[80:95]
i7 a[32:47],v[40:43],v[64:67],a[32:47]
i7 a[96:111],v[40:43],v[68:71],a[96:111]
i7 a[128:143],v[32:35],v[72:75],a[128:143]
i7 a[144:159],v[36:39],v[72:75],a[144:159]
i7 a[160:175],v[40:43],v[72:75],a[160:175]
i7 a[48:63],v[44:47],v[64:67],a[48:63]
i7 a[112:127],v[44:47],v[68:71],a[112:127]
i7 a[176:191],v[44:47],v[72:75],a[176:191]
i7 a[192:207],v[32:35],v[76:79],a[192:207]
i7 a[208:223],v[36:39],v[76:79],a[208:223]
i7 a[224:239],v[40:43],v[76:79],a[224:239]
i7 a[240:255],v[44:47],v[76:79],a[240:255]
i6 s47,s47,128
i6 s48,s48,524288
i20 v4,4294901760,v4
i20 v5,4294901760,v5
i20 v12,4294901760,v12
i20 v13,4294901760,v13
i20 v6,4294901760,v6
i20 v7,4294901760,v7
i20 v14,4294901760,v14
i20 v15,4294901760,v15
i6 s46,s46,1
s_cmp_lt_u32 s46, 4
i22 Lgv_loop
i8 vmcnt(0)
s_barrier
i9 v[16:19],v4 offset:0
i0 v[48:49],v6 offset:0
i0 v[50:51],v6 offset:2048
i9 v[20:23],v4 offset:4096
i0 v[52:53],v7 offset:0
i0 v[54:55],v7 offset:2048
i9 v[24:27],v4 offset:8192
i0 v[56:57],v14 offset:0
i0 v[58:59],v14 offset:2048
i9 v[28:31],v4 offset:12288
i0 v[60:61],v15 offset:0
i0 v[62:63],v15 offset:2048
i8 lgkmcnt(0)
i7 a[0:15],v[16:19],v[48:51],a[0:15]
i9 v[32:35],v5 offset:0
i7 a[16:31],v[20:23],v[48:51],a[16:31]
i0 v[64:65],v6 offset:8192
i7 a[64:79],v[16:19],v[52:55],a[64:79]
i0 v[66:67],v6 offset:10240
i7 a[80:95],v[20:23],v[52:55],a[80:95]
i9 v[36:39],v5 offset:4096
i7 a[32:47],v[24:27],v[48:51],a[32:47]
i0 v[68:69],v7 offset:8192
i7 a[96:111],v[24:27],v[52:55],a[96:111]
i0 v[70:71],v7 offset:10240
i7 a[128:143],v[16:19],v[56:59],a[128:143]
i9 v[40:43],v5 offset:8192
i7 a[144:159],v[20:23],v[56:59],a[144:159]
i0 v[72:73],v14 offset:8192
i7 a[160:175],v[24:27],v[56:59],a[160:175]
i0 v[74:75],v14 offset:10240
i7 a[48:63],v[28:31],v[48:51],a[48:63]
i9 v[44:47],v5 offset:12288
i7 a[112:127],v[28:31],v[52:55],a[112:127]
i0 v[76:77],v15 offset:8192
i7 a[176:191],v[28:31],v[56:59],a[176:191]
i0 v[78:79],v15 offset:10240
i7 a[192:207],v[16:19],v[60:63],a[192:207]
i7 a[208:223],v[20:23],v[60:63],a[208:223]
i7 a[224:239],v[24:27],v[60:63],a[224:239]
i7 a[240:255],v[28:31],v[60:63],a[240:255]
i8 lgkmcnt(0)
i7 a[0:15],v[32:35],v[64:67],a[0:15]
i9 v[16:19],v12 offset:0
i7 a[16:31],v[36:39],v[64:67],a[16:31]
i0 v[48:49],v6 offset:16384
i7 a[64:79],v[32:35],v[68:71],a[64:79]
i0 v[50:51],v6 offset:18432
i7 a[80:95],v[36:39],v[68:71],a[80:95]
i9 v[20:23],v12 offset:4096
i7 a[32:47],v[40:43],v[64:67],a[32:47]
i0 v[52:53],v7 offset:16384
i7 a[96:111],v[40:43],v[68:71],a[96:111]
i0 v[54:55],v7 offset:18432
i7 a[128:143],v[32:35],v[72:75],a[128:143]
i9 v[24:27],v12 offset:8192
i7 a[144:159],v[36:39],v[72:75],a[144:159]
i0 v[56:57],v14 offset:16384
i7 a[160:175],v[40:43],v[72:75],a[160:175]
i0 v[58:59],v14 offset:18432
i7 a[48:63],v[44:47],v[64:67],a[48:63]
i9 v[28:31],v12 offset:12288
i7 a[112:127],v[44:47],v[68:71],a[112:127]
i0 v[60:61],v15 offset:16384
i7 a[176:191],v[44:47],v[72:75],a[176:191]
i0 v[62:63],v15 offset:18432
i7 a[192:207],v[32:35],v[76:79],a[192:207]
i7 a[208:223],v[36:39],v[76:79],a[208:223]
i7 a[224:239],v[40:43],v[76:79],a[224:239]
i7 a[240:255],v[44:47],v[76:79],a[240:255]
i8 lgkmcnt(0)
i7 a[0:15],v[16:19],v[48:51],a[0:15]
i9 v[32:35],v13 offset:0
i7 a[16:31],v[20:23],v[48:51],a[16:31]
i0 v[64:65],v6 offset:24576
i7 a[64:79],v[16:19],v[52:55],a[64:79]
i0 v[66:67],v6 offset:26624
i7 a[80:95],v[20:23],v[52:55],a[80:95]
i9 v[36:39],v13 offset:4096
i7 a[32:47],v[24:27],v[48:51],a[32:47]
i0 v[68:69],v7 offset:24576
i7 a[96:111],v[24:27],v[52:55],a[96:111]
i0 v[70:71],v7 offset:26624
i7 a[128:143],v[16:19],v[56:59],a[128:143]
i9 v[40:43],v13 offset:8192
i7 a[144:159],v[20:23],v[56:59],a[144:159]
i0 v[72:73],v14 offset:24576
i7 a[160:175],v[24:27],v[56:59],a[160:175]
i0 v[74:75],v14 offset:26624
i7 a[48:63],v[28:31],v[48:51],a[48:63]
i9 v[44:47],v13 offset:12288
i7 a[112:127],v[28:31],v[52:55],a[112:127]
i0 v[76:77],v15 offset:24576
i7 a[176:191],v[28:31],v[56:59],a[176:191]
i0 v[78:79],v15 offset:26624
i7 a[192:207],v[16:19],v[60:63],a[192:207]
i7 a[208:223],v[20:23],v[60:63],a[208:223]
i7 a[224:239],v[24:27],v[60:63],a[224:239]
i7 a[240:255],v[28:31],v[60:63],a[240:255]
i8 lgkmcnt(0)
i7 a[0:15],v[32:35],v[64:67],a[0:15]
i7 a[16:31],v[36:39],v[64:67],a[16:31]
i7 a[64:79],v[32:35],v[68:71],a[64:79]
i7 a[80:95],v[36:39],v[68:71],a[80:95]
i7 a[32:47],v[40:43],v[64:67],a[32:47]
i7 a[96:111],v[40:43],v[68:71],a[96:111]
i7 a[128:143],v[32:35],v[72:75],a[128:143]
i7 a[144:159],v[36:39],v[72:75],a[144:159]
i7 a[160:175],v[40:43],v[72:75],a[160:175]
i7 a[48:63],v[44:47],v[64:67],a[48:63]
i7 a[112:127],v[44:47],v[68:71],a[112:127]
i7 a[176:191],v[44:47],v[72:75],a[176:191]
i7 a[192:207],v[32:35],v[76:79],a[192:207]
i7 a[208:223],v[36:39],v[76:79],a[208:223]
i7 a[224:239],v[40:43],v[76:79],a[224:239]
i7 a[240:255],v[44:47],v[76:79],a[240:255]
i46 s99,0
i22 L_v1gvk
i11 v40,0
i5 s94,0
i46 s21,0
i22 L_v1gvab
i39 exec,1
L_v1gva:
i55 v41,v40,s[100:101] offset:160 sc1
i6 s94,s94,1
i35 s94,400000
i22 L_end
i8 vmcnt(0)
v_cmp_gt_u32 vcc, 0x100, v41
i49 L_v1gvaz
i44 L_v1gvak
L_v1gvaz:
s_sleep 2
i44 L_v1gva
L_v1gvak:
i39 exec,-1
L_v1gvab:
s_barrier
global_load_dwordx4 v[44:47], v40, s[100:101] offset:0 sc1
global_load_dwordx4 v[48:51], v40, s[100:101] offset:16 sc1
i8 vmcnt(0)
i5 s93,0
i5 s94,s97
i37 s92,v44
i15 0
i46 s92,32
i28 s93,1,s93
i35 s96,0
i28 s92,s92,0
i6 s94,s94,s92
i37 s92,v45
i15 0
i46 s92,32
i28 s93,1,s93
i35 s96,1
i28 s92,s92,0
i6 s94,s94,s92
i37 s92,v46
i15 0
i46 s92,32
i28 s93,1,s93
i35 s96,2
i28 s92,s92,0
i6 s94,s94,s92
i37 s92,v47
i15 0
i46 s92,32
i28 s93,1,s93
i35 s96,3
i28 s92,s92,0
i6 s94,s94,s92
i37 s92,v48
i15 0
i46 s92,32
i28 s93,1,s93
i35 s96,4
i28 s92,s92,0
i6 s94,s94,s92
i37 s92,v49
i15 0
i46 s92,32
i28 s93,1,s93
i35 s96,5
i28 s92,s92,0
i6 s94,s94,s92
i37 s92,v50
i15 0
i46 s92,32
i28 s93,1,s93
i35 s96,6
i28 s92,s92,0
i6 s94,s94,s92
i37 s92,v51
i15 0
i46 s92,32
i28 s93,1,s93
i35 s96,7
i28 s92,s92,0
i6 s94,s94,s92
i5 s99,1
i47 s93,0
i22 L_v1gvk
i5 s99,2
s_lshr_b32 s98, s94, 5
s_and_b32 s20, s94, 31
i8 vmcnt(0) lgkmcnt(0)
s_barrier
i44 L_role
L_v1gvk:
s_lshr_b32 s3, s32, 1
i6 s3,s3,s30
i47 s3,1
i28 s3,s30,0
i47 s3,1
i22 L_hgve
i11 v40,0
i5 s94,0
i46 s21,0
i22 L_hgvb
i39 exec,1
L_hgv:
i55 v41,v40,s[100:101] offset:68 sc1
i6 s94,s94,1
i35 s94,400000
i22 L_end
i8 vmcnt(0)
v_cmp_gt_u32 vcc, 64, v41
i49 L_hgvz
i44 L_hgvk
L_hgvz:
s_sleep 12
i44 L_hgv
L_hgvk:
i39 exec,-1
L_hgvb:
s_barrier
L_hgve:
i23 v10,4,v0
i23 v11,5,v10
i31 v11,8,v11
i34 v12,v10,4,1
i24 v11,v12,10,v11
i18 v12,0xf0,v0
v_or_b32 v8, v11, v12
i32 s44,s30,3
s_lshr_b32 s45, s21, 1
i32 s45,s45,2
i6 s44,s44,s45
i32 s49,s44,18
i32 s44,s31,1
s_and_b32 s45, s21, 1
i6 s44,s44,s45
i32 s44,s44,13
i6 s49,s49,s44
i32 s44,s32,24
i6 s49,s49,s44
i47 s32,0
i28 s50,1040356334,1.0
i5 s51,s50
i15 7
i15 7
i6 s44,s49,0
i10 v16,a0
i10 v17,a1
i10 v18,a2
i10 v19,a3
i10 v20,a4
i10 v21,a5
i10 v22,a6
i10 v23,a7
i3 v24,v16,v17
i3 v25,v18,v19
i3 v26,v20,v21
i3 v27,v22,v23
i13 v[24:27],v8,s[8:11],s44 offen offset:0 sc1
i10 v28,a8
i10 v29,a9
i10 v30,a10
i10 v31,a11
i10 v32,a12
i10 v33,a13
i10 v34,a14
i10 v35,a15
i3 v36,v28,v29
i3 v37,v30,v31
i3 v38,v32,v33
i3 v39,v34,v35
i13 v[36:39],v8,s[8:11],s44 offen offset:512 sc1
i6 s44,s49,2048
i10 v40,a64
i10 v41,a65
i10 v42,a66
i10 v43,a67
i10 v44,a68
i10 v45,a69
i10 v46,a70
i10 v47,a71
i3 v48,v40,v41
i3 v49,v42,v43
i3 v50,v44,v45
i3 v51,v46,v47
i13 v[48:51],v8,s[8:11],s44 offen offset:0 sc1
i10 v52,a72
i10 v53,a73
i10 v54,a74
i10 v55,a75
i10 v56,a76
i10 v57,a77
i10 v58,a78
i10 v59,a79
i3 v60,v52,v53
i3 v61,v54,v55
i3 v62,v56,v57
i3 v63,v58,v59
i13 v[60:63],v8,s[8:11],s44 offen offset:512 sc1
i6 s44,s49,4096
i10 v16,a128
i10 v17,a129
i10 v18,a130
i10 v19,a131
i10 v20,a132
i10 v21,a133
i10 v22,a134
i10 v23,a135
i3 v24,v16,v17
i3 v25,v18,v19
i3 v26,v20,v21
i3 v27,v22,v23
i13 v[24:27],v8,s[8:11],s44 offen offset:0 sc1
i10 v28,a136
i10 v29,a137
i10 v30,a138
i10 v31,a139
i10 v32,a140
i10 v33,a141
i10 v34,a142
i10 v35,a143
i3 v36,v28,v29
i3 v37,v30,v31
i3 v38,v32,v33
i3 v39,v34,v35
i13 v[36:39],v8,s[8:11],s44 offen offset:512 sc1
i6 s44,s49,6144
i10 v40,a192
i10 v41,a193
i10 v42,a194
i10 v43,a195
i10 v44,a196
i10 v45,a197
i10 v46,a198
i10 v47,a199
i3 v48,v40,v41
i3 v49,v42,v43
i3 v50,v44,v45
i3 v51,v46,v47
i13 v[48:51],v8,s[8:11],s44 offen offset:0 sc1
i10 v52,a200
i10 v53,a201
i10 v54,a202
i10 v55,a203
i10 v56,a204
i10 v57,a205
i10 v58,a206
i10 v59,a207
i3 v60,v52,v53
i3 v61,v54,v55
i3 v62,v56,v57
i3 v63,v58,v59
i13 v[60:63],v8,s[8:11],s44 offen offset:512 sc1
i6 s44,s49,262144
i10 v16,a16
i10 v17,a17
i10 v18,a18
i10 v19,a19
i10 v20,a20
i10 v21,a21
i10 v22,a22
i10 v23,a23
i3 v24,v16,v17
i3 v25,v18,v19
i3 v26,v20,v21
i3 v27,v22,v23
i13 v[24:27],v8,s[8:11],s44 offen offset:0 sc1
i10 v28,a24
i10 v29,a25
i10 v30,a26
i10 v31,a27
i10 v32,a28
i10 v33,a29
i10 v34,a30
i10 v35,a31
i3 v36,v28,v29
i3 v37,v30,v31
i3 v38,v32,v33
i3 v39,v34,v35
i13 v[36:39],v8,s[8:11],s44 offen offset:512 sc1
i6 s44,s49,264192
i10 v40,a80
i10 v41,a81
i10 v42,a82
i10 v43,a83
i10 v44,a84
i10 v45,a85
i10 v46,a86
i10 v47,a87
i3 v48,v40,v41
i3 v49,v42,v43
i3 v50,v44,v45
i3 v51,v46,v47
i13 v[48:51],v8,s[8:11],s44 offen offset:0 sc1
i10 v52,a88
i10 v53,a89
i10 v54,a90
i10 v55,a91
i10 v56,a92
i10 v57,a93
i10 v58,a94
i10 v59,a95
i3 v60,v52,v53
i3 v61,v54,v55
i3 v62,v56,v57
i3 v63,v58,v59
i13 v[60:63],v8,s[8:11],s44 offen offset:512 sc1
i6 s44,s49,266240
i10 v16,a144
i10 v17,a145
i10 v18,a146
i10 v19,a147
i10 v20,a148
i10 v21,a149
i10 v22,a150
i10 v23,a151
i3 v24,v16,v17
i3 v25,v18,v19
i3 v26,v20,v21
i3 v27,v22,v23
i13 v[24:27],v8,s[8:11],s44 offen offset:0 sc1
i10 v28,a152
i10 v29,a153
i10 v30,a154
i10 v31,a155
i10 v32,a156
i10 v33,a157
i10 v34,a158
i10 v35,a159
i3 v36,v28,v29
i3 v37,v30,v31
i3 v38,v32,v33
i3 v39,v34,v35
i13 v[36:39],v8,s[8:11],s44 offen offset:512 sc1
i6 s44,s49,268288
i10 v40,a208
i10 v41,a209
i10 v42,a210
i10 v43,a211
i10 v44,a212
i10 v45,a213
i10 v46,a214
i10 v47,a215
i3 v48,v40,v41
i3 v49,v42,v43
i3 v50,v44,v45
i3 v51,v46,v47
i13 v[48:51],v8,s[8:11],s44 offen offset:0 sc1
i10 v52,a216
i10 v53,a217
i10 v54,a218
i10 v55,a219
i10 v56,a220
i10 v57,a221
i10 v58,a222
i10 v59,a223
i3 v60,v52,v53
i3 v61,v54,v55
i3 v62,v56,v57
i3 v63,v58,v59
i13 v[60:63],v8,s[8:11],s44 offen offset:512 sc1
i6 s44,s49,524288
i10 v16,a32
i10 v17,a33
i10 v18,a34
i10 v19,a35
i10 v20,a36
i10 v21,a37
i10 v22,a38
i10 v23,a39
i3 v24,v16,v17
i3 v25,v18,v19
i3 v26,v20,v21
i3 v27,v22,v23
i13 v[24:27],v8,s[8:11],s44 offen offset:0 sc1
i10 v28,a40
i10 v29,a41
i10 v30,a42
i10 v31,a43
i10 v32,a44
i10 v33,a45
i10 v34,a46
i10 v35,a47
i3 v36,v28,v29
i3 v37,v30,v31
i3 v38,v32,v33
i3 v39,v34,v35
i13 v[36:39],v8,s[8:11],s44 offen offset:512 sc1
i6 s44,s49,526336
i10 v40,a96
i10 v41,a97
i10 v42,a98
i10 v43,a99
i10 v44,a100
i10 v45,a101
i10 v46,a102
i10 v47,a103
i3 v48,v40,v41
i3 v49,v42,v43
i3 v50,v44,v45
i3 v51,v46,v47
i13 v[48:51],v8,s[8:11],s44 offen offset:0 sc1
i10 v52,a104
i10 v53,a105
i10 v54,a106
i10 v55,a107
i10 v56,a108
i10 v57,a109
i10 v58,a110
i10 v59,a111
i3 v60,v52,v53
i3 v61,v54,v55
i3 v62,v56,v57
i3 v63,v58,v59
i13 v[60:63],v8,s[8:11],s44 offen offset:512 sc1
i6 s44,s49,528384
i10 v16,a160
i10 v17,a161
i10 v18,a162
i10 v19,a163
i10 v20,a164
i10 v21,a165
i10 v22,a166
i10 v23,a167
i3 v24,v16,v17
i3 v25,v18,v19
i3 v26,v20,v21
i3 v27,v22,v23
i13 v[24:27],v8,s[8:11],s44 offen offset:0 sc1
i10 v28,a168
i10 v29,a169
i10 v30,a170
i10 v31,a171
i10 v32,a172
i10 v33,a173
i10 v34,a174
i10 v35,a175
i3 v36,v28,v29
i3 v37,v30,v31
i3 v38,v32,v33
i3 v39,v34,v35
i13 v[36:39],v8,s[8:11],s44 offen offset:512 sc1
i6 s44,s49,530432
i10 v40,a224
i10 v41,a225
i10 v42,a226
i10 v43,a227
i10 v44,a228
i10 v45,a229
i10 v46,a230
i10 v47,a231
i3 v48,v40,v41
i3 v49,v42,v43
i3 v50,v44,v45
i3 v51,v46,v47
i13 v[48:51],v8,s[8:11],s44 offen offset:0 sc1
i10 v52,a232
i10 v53,a233
i10 v54,a234
i10 v55,a235
i10 v56,a236
i10 v57,a237
i10 v58,a238
i10 v59,a239
i3 v60,v52,v53
i3 v61,v54,v55
i3 v62,v56,v57
i3 v63,v58,v59
i13 v[60:63],v8,s[8:11],s44 offen offset:512 sc1
i6 s44,s49,786432
i10 v16,a48
i10 v17,a49
i10 v18,a50
i10 v19,a51
i10 v20,a52
i10 v21,a53
i10 v22,a54
i10 v23,a55
i3 v24,v16,v17
i3 v25,v18,v19
i3 v26,v20,v21
i3 v27,v22,v23
i13 v[24:27],v8,s[8:11],s44 offen offset:0 sc1
i10 v28,a56
i10 v29,a57
i10 v30,a58
i10 v31,a59
i10 v32,a60
i10 v33,a61
i10 v34,a62
i10 v35,a63
i3 v36,v28,v29
i3 v37,v30,v31
i3 v38,v32,v33
i3 v39,v34,v35
i13 v[36:39],v8,s[8:11],s44 offen offset:512 sc1
i6 s44,s49,788480
i10 v40,a112
i10 v41,a113
i10 v42,a114
i10 v43,a115
i10 v44,a116
i10 v45,a117
i10 v46,a118
i10 v47,a119
i3 v48,v40,v41
i3 v49,v42,v43
i3 v50,v44,v45
i3 v51,v46,v47
i13 v[48:51],v8,s[8:11],s44 offen offset:0 sc1
i10 v52,a120
i10 v53,a121
i10 v54,a122
i10 v55,a123
i10 v56,a124
i10 v57,a125
i10 v58,a126
i10 v59,a127
i3 v60,v52,v53
i3 v61,v54,v55
i3 v62,v56,v57
i3 v63,v58,v59
i13 v[60:63],v8,s[8:11],s44 offen offset:512 sc1
i6 s44,s49,790528
i10 v16,a176
i10 v17,a177
i10 v18,a178
i10 v19,a179
i10 v20,a180
i10 v21,a181
i10 v22,a182
i10 v23,a183
i3 v24,v16,v17
i3 v25,v18,v19
i3 v26,v20,v21
i3 v27,v22,v23
i13 v[24:27],v8,s[8:11],s44 offen offset:0 sc1
i10 v28,a184
i10 v29,a185
i10 v30,a186
i10 v31,a187
i10 v32,a188
i10 v33,a189
i10 v34,a190
i10 v35,a191
i3 v36,v28,v29
i3 v37,v30,v31
i3 v38,v32,v33
i3 v39,v34,v35
i13 v[36:39],v8,s[8:11],s44 offen offset:512 sc1
i6 s44,s49,792576
i10 v40,a240
i10 v41,a241
i10 v42,a242
i10 v43,a243
i10 v44,a244
i10 v45,a245
i10 v46,a246
i10 v47,a247
i3 v48,v40,v41
i3 v49,v42,v43
i3 v50,v44,v45
i3 v51,v46,v47
i13 v[48:51],v8,s[8:11],s44 offen offset:0 sc1
i10 v52,a248
i10 v53,a249
i10 v54,a250
i10 v55,a251
i10 v56,a252
i10 v57,a253
i10 v58,a254
i10 v59,a255
i3 v60,v52,v53
i3 v61,v54,v55
i3 v62,v56,v57
i3 v63,v58,v59
i13 v[60:63],v8,s[8:11],s44 offen offset:512 sc1
Lg_end:
i8 vmcnt(0)
s_barrier
i47 s32,2
i28 s3,96,64
i32 s4,s30,2
i6 s3,s3,s4
i46 s21,0
i22 L_s1
i11 v40,s3
i11 v41,2
i39 exec,1
global_atomic_add v40, v41, s[100:101]
i39 exec,-1
L_s1:
i6 s95,s95,1
s_cmp_lt_u32 s98, 4
i22 L_x
s_sub_u32 s3, s98, 4
i32 s3,s3,5
i6 s22,s3,s20
i47 s95,1
s_cbranch_scc0 L_r2
i50 s[64:65],s[0:1],0
i50 s[66:67],s[0:1],8
i50 s[68:69],s[0:1],32
s_sub_u32 s3, s98, 4
i32 s3,s3,5
i6 s3,s3,s20
i32 s3,s3,2
i6 s3,s3,s21
i32 s3,s3,12
i6 s4,s3,2097152
i31 v101,2,v0
i5 s91,0x20000
i8 lgkmcnt(0)
i39 s[88:89],s[64:65]
i5 s90,2359296
i36 v100,v101,s[88:91],s3 offen
i36 v100,v101,s[88:91],s4 offen
i39 s[88:89],s[66:67]
i5 s90,663552
i36 v100,v101,s[88:91],s3 offen
i39 s[88:89],s[68:69]
i5 s90,663552
i36 v100,v101,s[88:91],s3 offen
s_cmp_lt_u32 s21, 2
i28 s24,16,24
i50 s[36:37],s[0:1],s24
s_and_b32 s27, s21, 1
s_mul_i32 s27, s27, 11264
s_lshr_b32 s31, s21, 1
s_mul_i32 s31, s31, 22528
i8 lgkmcnt(0)
i5 s38,20736
i5 s39,0x20000
i6 s30,s31,s27
i6 m0,s30,0
i6 s24,s27,0
i1 v0,s[36:39],s24 offen lds
i6 m0,s30,1024
i6 s24,s27,1024
i1 v0,s[36:39],s24 offen lds
i6 m0,s30,2048
i6 s24,s27,2048
i1 v0,s[36:39],s24 offen lds
i6 m0,s30,3072
i6 s24,s27,3072
i1 v0,s[36:39],s24 offen lds
i6 m0,s30,4096
i6 s24,s27,4096
i1 v0,s[36:39],s24 offen lds
i6 m0,s30,5120
i6 s24,s27,5120
i1 v0,s[36:39],s24 offen lds
i6 m0,s30,6144
i6 s24,s27,6144
i1 v0,s[36:39],s24 offen lds
i6 m0,s30,7168
i6 s24,s27,7168
i1 v0,s[36:39],s24 offen lds
i6 m0,s30,8192
i6 s24,s27,8192
i1 v0,s[36:39],s24 offen lds
i6 m0,s30,9216
i6 s24,s27,9216
i1 v0,s[36:39],s24 offen lds
i6 m0,s30,10240
i6 s24,s27,10240
i1 v0,s[36:39],s24 offen lds
i50 s[40:41],s[0:1],0
i23 v1,4,v0
i18 v4,15,v1
i23 v5,4,v1
i54 s25,1152
i31 v6,4,v5
i45 v6,v4,s25,v6
s_mul_i32 s26, s22, 18432
i39 s[32:33],0xffff
i8 lgkmcnt(0)
i5 s42,2359296
i5 s43,0x20000
i1 v[16:19],v6,s[40:43],s26 offen offset:0
i1 v[20:23],v6,s[40:43],s26 offen offset:64
i1 v[24:27],v6,s[40:43],s26 offen offset:128
i1 v[28:31],v6,s[40:43],s26 offen offset:192
i1 v[32:35],v6,s[40:43],s26 offen offset:256
i1 v[36:39],v6,s[40:43],s26 offen offset:320
i1 v[40:43],v6,s[40:43],s26 offen offset:384
i1 v[44:47],v6,s[40:43],s26 offen offset:448
i1 v[48:51],v6,s[40:43],s26 offen offset:512
i1 v[52:55],v6,s[40:43],s26 offen offset:576
i1 v[56:59],v6,s[40:43],s26 offen offset:640
i1 v[60:63],v6,s[40:43],s26 offen offset:704
i1 v[64:67],v6,s[40:43],s26 offen offset:768
i1 v[68:71],v6,s[40:43],s26 offen offset:832
i1 v[72:75],v6,s[40:43],s26 offen offset:896
i1 v[76:79],v6,s[40:43],s26 offen offset:960
i1 v[80:83],v6,s[40:43],s26 offen offset:1024
i1 v[84:87],v6,s[40:43],s26 offen offset:1088
s_and_b32 s24, s21, 1
i32 s24,s24,4
i20 v7,s24,v4
i43 v8,288,v5
v_min_u32 v9, 17, v7
i17 v8,v9,1,v8
i20 v8,s31,v8
v_cmp_gt_u32 vcc, 18, v7
i15 1
i26 v9,0,-1,vcc
i8 vmcnt(0)
s_barrier
i30 v88,v8 offset:0
i30 v89,v8 offset:36
i30 v90,v8 offset:72
i30 v91,v8 offset:108
i30 v92,v8 offset:144
i30 v93,v8 offset:180
i30 v94,v8 offset:216
i30 v95,v8 offset:252
i30 v96,v8 offset:1152
i30 v97,v8 offset:1188
i30 v98,v8 offset:1224
i30 v99,v8 offset:1260
i30 v100,v8 offset:1296
i30 v101,v8 offset:1332
i30 v102,v8 offset:1368
i30 v103,v8 offset:1404
i8 lgkmcnt(8)
i24 v160,v89,16,v88
i18 v160,v160,v9
i24 v161,v91,16,v90
i18 v161,v161,v9
i24 v162,v93,16,v92
i18 v162,v162,v9
i24 v163,v95,16,v94
i18 v163,v163,v9
i30 v88,v8 offset:2304
i30 v89,v8 offset:2340
i30 v90,v8 offset:2376
i30 v91,v8 offset:2412
i30 v92,v8 offset:2448
i30 v93,v8 offset:2484
i30 v94,v8 offset:2520
i30 v95,v8 offset:2556
i8 lgkmcnt(8)
i24 v164,v97,16,v96
i18 v164,v164,v9
i24 v165,v99,16,v98
i18 v165,v165,v9
i24 v166,v101,16,v100
i18 v166,v166,v9
i24 v167,v103,16,v102
i18 v167,v167,v9
i30 v96,v8 offset:3456
i30 v97,v8 offset:3492
i30 v98,v8 offset:3528
i30 v99,v8 offset:3564
i30 v100,v8 offset:3600
i30 v101,v8 offset:3636
i30 v102,v8 offset:3672
i30 v103,v8 offset:3708
i8 lgkmcnt(8)
i24 v168,v89,16,v88
i18 v168,v168,v9
i24 v169,v91,16,v90
i18 v169,v169,v9
i24 v170,v93,16,v92
i18 v170,v170,v9
i24 v171,v95,16,v94
i18 v171,v171,v9
i30 v88,v8 offset:4608
i30 v89,v8 offset:4644
i30 v90,v8 offset:4680
i30 v91,v8 offset:4716
i30 v92,v8 offset:4752
i30 v93,v8 offset:4788
i30 v94,v8 offset:4824
i30 v95,v8 offset:4860
i8 lgkmcnt(8)
i24 v172,v97,16,v96
i18 v172,v172,v9
i24 v173,v99,16,v98
i18 v173,v173,v9
i24 v174,v101,16,v100
i18 v174,v174,v9
i24 v175,v103,16,v102
i18 v175,v175,v9
i30 v96,v8 offset:5760
i30 v97,v8 offset:5796
i30 v98,v8 offset:5832
i30 v99,v8 offset:5868
i30 v100,v8 offset:5904
i30 v101,v8 offset:5940
i30 v102,v8 offset:5976
i30 v103,v8 offset:6012
i8 lgkmcnt(8)
i24 v176,v89,16,v88
i18 v176,v176,v9
i24 v177,v91,16,v90
i18 v177,v177,v9
i24 v178,v93,16,v92
i18 v178,v178,v9
i24 v179,v95,16,v94
i18 v179,v179,v9
i30 v88,v8 offset:6912
i30 v89,v8 offset:6948
i30 v90,v8 offset:6984
i30 v91,v8 offset:7020
i30 v92,v8 offset:7056
i30 v93,v8 offset:7092
i30 v94,v8 offset:7128
i30 v95,v8 offset:7164
i8 lgkmcnt(8)
i24 v180,v97,16,v96
i18 v180,v180,v9
i24 v181,v99,16,v98
i18 v181,v181,v9
i24 v182,v101,16,v100
i18 v182,v182,v9
i24 v183,v103,16,v102
i18 v183,v183,v9
i30 v96,v8 offset:8064
i30 v97,v8 offset:8100
i30 v98,v8 offset:8136
i30 v99,v8 offset:8172
i30 v100,v8 offset:8208
i30 v101,v8 offset:8244
i30 v102,v8 offset:8280
i30 v103,v8 offset:8316
i8 lgkmcnt(8)
i24 v184,v89,16,v88
i18 v184,v184,v9
i24 v185,v91,16,v90
i18 v185,v185,v9
i24 v186,v93,16,v92
i18 v186,v186,v9
i24 v187,v95,16,v94
i18 v187,v187,v9
i30 v88,v8 offset:9216
i30 v89,v8 offset:9252
i30 v90,v8 offset:9288
i30 v91,v8 offset:9324
i30 v92,v8 offset:9360
i30 v93,v8 offset:9396
i30 v94,v8 offset:9432
i30 v95,v8 offset:9468
i8 lgkmcnt(8)
i24 v188,v97,16,v96
i18 v188,v188,v9
i24 v189,v99,16,v98
i18 v189,v189,v9
i24 v190,v101,16,v100
i18 v190,v190,v9
i24 v191,v103,16,v102
i18 v191,v191,v9
i30 v96,v8 offset:10368
i30 v97,v8 offset:10404
i30 v98,v8 offset:10440
i30 v99,v8 offset:10476
i30 v100,v8 offset:10512
i30 v101,v8 offset:10548
i30 v102,v8 offset:10584
i30 v103,v8 offset:10620
i8 lgkmcnt(8)
i24 v192,v89,16,v88
i18 v192,v192,v9
i24 v193,v91,16,v90
i18 v193,v193,v9
i24 v194,v93,16,v92
i18 v194,v194,v9
i24 v195,v95,16,v94
i18 v195,v195,v9
i30 v88,v8 offset:11520
i30 v89,v8 offset:11556
i30 v90,v8 offset:11592
i30 v91,v8 offset:11628
i30 v92,v8 offset:11664
i30 v93,v8 offset:11700
i30 v94,v8 offset:11736
i30 v95,v8 offset:11772
i8 lgkmcnt(8)
i24 v196,v97,16,v96
i18 v196,v196,v9
i24 v197,v99,16,v98
i18 v197,v197,v9
i24 v198,v101,16,v100
i18 v198,v198,v9
i24 v199,v103,16,v102
i18 v199,v199,v9
i30 v96,v8 offset:12672
i30 v97,v8 offset:12708
i30 v98,v8 offset:12744
i30 v99,v8 offset:12780
i30 v100,v8 offset:12816
i30 v101,v8 offset:12852
i30 v102,v8 offset:12888
i30 v103,v8 offset:12924
i8 lgkmcnt(8)
i24 v200,v89,16,v88
i18 v200,v200,v9
i24 v201,v91,16,v90
i18 v201,v201,v9
i24 v202,v93,16,v92
i18 v202,v202,v9
i24 v203,v95,16,v94
i18 v203,v203,v9
i30 v88,v8 offset:13824
i30 v89,v8 offset:13860
i30 v90,v8 offset:13896
i30 v91,v8 offset:13932
i30 v92,v8 offset:13968
i30 v93,v8 offset:14004
i30 v94,v8 offset:14040
i30 v95,v8 offset:14076
i8 lgkmcnt(8)
i24 v204,v97,16,v96
i18 v204,v204,v9
i24 v205,v99,16,v98
i18 v205,v205,v9
i24 v206,v101,16,v100
i18 v206,v206,v9
i24 v207,v103,16,v102
i18 v207,v207,v9
i30 v96,v8 offset:14976
i30 v97,v8 offset:15012
i30 v98,v8 offset:15048
i30 v99,v8 offset:15084
i30 v100,v8 offset:15120
i30 v101,v8 offset:15156
i30 v102,v8 offset:15192
i30 v103,v8 offset:15228
i8 lgkmcnt(8)
i24 v208,v89,16,v88
i18 v208,v208,v9
i24 v209,v91,16,v90
i18 v209,v209,v9
i24 v210,v93,16,v92
i18 v210,v210,v9
i24 v211,v95,16,v94
i18 v211,v211,v9
i30 v88,v8 offset:16128
i30 v89,v8 offset:16164
i30 v90,v8 offset:16200
i30 v91,v8 offset:16236
i30 v92,v8 offset:16272
i30 v93,v8 offset:16308
i30 v94,v8 offset:16344
i30 v95,v8 offset:16380
i8 lgkmcnt(8)
i24 v212,v97,16,v96
i18 v212,v212,v9
i24 v213,v99,16,v98
i18 v213,v213,v9
i24 v214,v101,16,v100
i18 v214,v214,v9
i24 v215,v103,16,v102
i18 v215,v215,v9
i30 v96,v8 offset:17280
i30 v97,v8 offset:17316
i30 v98,v8 offset:17352
i30 v99,v8 offset:17388
i30 v100,v8 offset:17424
i30 v101,v8 offset:17460
i30 v102,v8 offset:17496
i30 v103,v8 offset:17532
i8 lgkmcnt(8)
i24 v216,v89,16,v88
i18 v216,v216,v9
i24 v217,v91,16,v90
i18 v217,v217,v9
i24 v218,v93,16,v92
i18 v218,v218,v9
i24 v219,v95,16,v94
i18 v219,v219,v9
i30 v88,v8 offset:18432
i30 v89,v8 offset:18468
i30 v90,v8 offset:18504
i30 v91,v8 offset:18540
i30 v92,v8 offset:18576
i30 v93,v8 offset:18612
i30 v94,v8 offset:18648
i30 v95,v8 offset:18684
i8 lgkmcnt(8)
i24 v220,v97,16,v96
i18 v220,v220,v9
i24 v221,v99,16,v98
i18 v221,v221,v9
i24 v222,v101,16,v100
i18 v222,v222,v9
i24 v223,v103,16,v102
i18 v223,v223,v9
i30 v96,v8 offset:19584
i30 v97,v8 offset:19620
i30 v98,v8 offset:19656
i30 v99,v8 offset:19692
i30 v100,v8 offset:19728
i30 v101,v8 offset:19764
i30 v102,v8 offset:19800
i30 v103,v8 offset:19836
i8 lgkmcnt(8)
i24 v224,v89,16,v88
i18 v224,v224,v9
i24 v225,v91,16,v90
i18 v225,v225,v9
i24 v226,v93,16,v92
i18 v226,v226,v9
i24 v227,v95,16,v94
i18 v227,v227,v9
i8 lgkmcnt(0)
i24 v228,v97,16,v96
i18 v228,v228,v9
i24 v229,v99,16,v98
i18 v229,v229,v9
i24 v230,v101,16,v100
i18 v230,v230,v9
i24 v231,v103,16,v102
i18 v231,v231,v9
s_cmp_ge_u32 s21, 2
i22 La_vp
i2 v[88:91],v[160:163],v[16:19],0
i2 v[88:91],v[164:167],v[20:23],v[88:91]
i2 v[88:91],v[168:171],v[24:27],v[88:91]
i2 v[88:91],v[172:175],v[28:31],v[88:91]
i2 v[88:91],v[176:179],v[32:35],v[88:91]
i2 v[88:91],v[180:183],v[36:39],v[88:91]
i2 v[88:91],v[184:187],v[40:43],v[88:91]
i2 v[88:91],v[188:191],v[44:47],v[88:91]
i2 v[88:91],v[192:195],v[48:51],v[88:91]
i2 v[88:91],v[196:199],v[52:55],v[88:91]
i2 v[88:91],v[200:203],v[56:59],v[88:91]
i2 v[88:91],v[204:207],v[60:63],v[88:91]
i2 v[88:91],v[208:211],v[64:67],v[88:91]
i2 v[88:91],v[212:215],v[68:71],v[88:91]
i2 v[88:91],v[216:219],v[72:75],v[88:91]
i2 v[88:91],v[220:223],v[76:79],v[88:91]
i2 v[88:91],v[224:227],v[80:83],v[88:91]
i2 v[88:91],v[228:231],v[84:87],v[88:91]
i47 s21,1
s_cselect_b64 vcc, s[32:33], 0
i15 5
i26 v90,v90,1.0,vcc
i32 s24,s22,10
i32 s25,s21,3
i6 s24,s24,s25
i6 s24,s24,92274688
i44 La_kvs
La_vp:
i2 v[88:91],v[16:19],v[160:163],0
i2 v[88:91],v[20:23],v[164:167],v[88:91]
i2 v[88:91],v[24:27],v[168:171],v[88:91]
i2 v[88:91],v[28:31],v[172:175],v[88:91]
i2 v[88:91],v[32:35],v[176:179],v[88:91]
i2 v[88:91],v[36:39],v[180:183],v[88:91]
i2 v[88:91],v[40:43],v[184:187],v[88:91]
i2 v[88:91],v[44:47],v[188:191],v[88:91]
i2 v[88:91],v[48:51],v[192:195],v[88:91]
i2 v[88:91],v[52:55],v[196:199],v[88:91]
i2 v[88:91],v[56:59],v[200:203],v[88:91]
i2 v[88:91],v[60:63],v[204:207],v[88:91]
i2 v[88:91],v[64:67],v[208:211],v[88:91]
i2 v[88:91],v[68:71],v[212:215],v[88:91]
i2 v[88:91],v[72:75],v[216:219],v[88:91]
i2 v[88:91],v[76:79],v[220:223],v[88:91]
i2 v[88:91],v[80:83],v[224:227],v[88:91]
i2 v[88:91],v[84:87],v[228:231],v[88:91]
i25 vcc,18,v7
i15 6
i26 v88,v88,1.0,vcc
i26 v89,v89,1.0,vcc
i26 v90,v90,1.0,vcc
i26 v91,v91,1.0,vcc
s_lshr_b32 s24, s22, 1
i32 s24,s24,11
s_and_b32 s25, s22, 1
i32 s25,s25,3
i6 s24,s24,s25
s_and_b32 s25, s21, 1
i32 s25,s25,10
i6 s24,s24,s25
i6 s24,s24,92405760
La_kvs:
i3 v88,v88,v89
i3 v89,v90,v91
i41 v[88:89],v0,s[8:11],s24 offen sc1
i8 vmcnt(0) lgkmcnt(0)
s_barrier
i46 s21,0
i22 La_nosig
i11 v9,0
i11 v10,1
i39 exec,1
global_atomic_add v9, v10, s[100:101] offset:52
i39 exec,-1
i8 vmcnt(0)
La_nosig:
i44 L_g1
L_r2:
i50 s[44:45],s[0:1],96
i5 s29,0
i50 s[40:41],s[0:1],0
i23 v1,4,v0
i18 v4,15,v1
i23 v5,4,v1
i54 s25,1152
i31 v6,4,v5
i45 v6,v4,s25,v6
s_mul_i32 s26, s22, 18432
i39 s[32:33],0xffff
i8 lgkmcnt(0)
i5 s42,2359296
i5 s43,0x20000
i1 v[16:19],v6,s[40:43],s26 offen offset:0
i1 v[20:23],v6,s[40:43],s26 offen offset:64
i1 v[24:27],v6,s[40:43],s26 offen offset:128
i1 v[28:31],v6,s[40:43],s26 offen offset:192
i1 v[32:35],v6,s[40:43],s26 offen offset:256
i1 v[36:39],v6,s[40:43],s26 offen offset:320
i1 v[40:43],v6,s[40:43],s26 offen offset:384
i1 v[44:47],v6,s[40:43],s26 offen offset:448
i1 v[48:51],v6,s[40:43],s26 offen offset:512
i1 v[52:55],v6,s[40:43],s26 offen offset:576
i1 v[56:59],v6,s[40:43],s26 offen offset:640
i1 v[60:63],v6,s[40:43],s26 offen offset:704
i1 v[64:67],v6,s[40:43],s26 offen offset:768
i1 v[68:71],v6,s[40:43],s26 offen offset:832
i1 v[72:75],v6,s[40:43],s26 offen offset:896
i1 v[76:79],v6,s[40:43],s26 offen offset:960
i1 v[80:83],v6,s[40:43],s26 offen offset:1024
i1 v[84:87],v6,s[40:43],s26 offen offset:1088
i5 s46,4718592
i5 s47,0x20000
i14 v[88:89],0
i14 v[90:91],0
i32 s24,s21,13
i6 s24,s24,110592
i20 v9,s24,v0
i21 v9,v[88:91] offset:0
i21 v9,v[88:91] offset:1024
i21 v9,v[88:91] offset:2048
i21 v9,v[88:91] offset:3072
i21 v9,v[88:91] offset:4096
i21 v9,v[88:91] offset:5120
i21 v9,v[88:91] offset:6144
i21 v9,v[88:91] offset:7168
i8 lgkmcnt(0)
i34 v7,v1,2,2
i17 v7,v5,3,v7
i54 s25,1152
i18 v8,3,v1
i31 v8,3,v8
i45 v2,v7,s25,v8
s_mul_i32 s24, s21, 288
i20 v2,s24,v2
i20 v3,65536,v2
i50 s[36:37],s[0:1],8
s_mul_i32 s31, s21, 9216
i8 lgkmcnt(0)
i5 s38,663552
i5 s39,0x20000
s_barrier
i6 m0,s31,0
i6 s24,s31,0
i1 v0,s[36:39],s24 offen lds
i6 m0,s31,1024
i6 s24,s31,1024
i1 v0,s[36:39],s24 offen lds
i6 m0,s31,2048
i6 s24,s31,2048
i1 v0,s[36:39],s24 offen lds
i6 m0,s31,3072
i6 s24,s31,3072
i1 v0,s[36:39],s24 offen lds
i6 m0,s31,4096
i6 s24,s31,4096
i1 v0,s[36:39],s24 offen lds
i6 m0,s31,5120
i6 s24,s31,5120
i1 v0,s[36:39],s24 offen lds
i6 m0,s31,6144
i6 s24,s31,6144
i1 v0,s[36:39],s24 offen lds
i6 m0,s31,7168
i6 s24,s31,7168
i1 v0,s[36:39],s24 offen lds
i6 m0,s31,8192
i6 s24,s31,8192
i1 v0,s[36:39],s24 offen lds
i6 m0,s31,36864
i6 s24,s31,36864
i1 v0,s[36:39],s24 offen lds
i6 m0,s31,37888
i6 s24,s31,37888
i1 v0,s[36:39],s24 offen lds
i6 m0,s31,38912
i6 s24,s31,38912
i1 v0,s[36:39],s24 offen lds
i6 m0,s31,39936
i6 s24,s31,39936
i1 v0,s[36:39],s24 offen lds
i6 m0,s31,40960
i6 s24,s31,40960
i1 v0,s[36:39],s24 offen lds
i6 m0,s31,41984
i6 s24,s31,41984
i1 v0,s[36:39],s24 offen lds
i6 m0,s31,43008
i6 s24,s31,43008
i1 v0,s[36:39],s24 offen lds
i6 m0,s31,44032
i6 s24,s31,44032
i1 v0,s[36:39],s24 offen lds
i6 m0,s31,45056
i6 s24,s31,45056
i1 v0,s[36:39],s24 offen lds
i8 vmcnt(9)
s_barrier
i0 v[124:125],v2 offset:0
i0 v[126:127],v2 offset:4608
i0 v[128:129],v2 offset:32
i0 v[130:131],v2 offset:4640
i0 v[132:133],v2 offset:64
i0 v[134:135],v2 offset:4672
i0 v[136:137],v2 offset:96
i0 v[138:139],v2 offset:4704
i6 m0,s31,73728
i6 s24,s31,73728
i1 v0,s[36:39],s24 offen lds
i0 v[140:141],v2 offset:128
i0 v[142:143],v2 offset:4736
i8 lgkmcnt(8)
i2 v[88:91],v[124:127],v[16:19],0
i6 m0,s31,74752
i6 s24,s31,74752
i1 v0,s[36:39],s24 offen lds
i0 v[144:145],v2 offset:160
i0 v[146:147],v2 offset:4768
i8 lgkmcnt(8)
i2 v[92:95],v[128:131],v[16:19],0
i6 m0,s31,75776
i6 s24,s31,75776
i1 v0,s[36:39],s24 offen lds
i0 v[148:149],v2 offset:192
i0 v[150:151],v2 offset:4800
i8 lgkmcnt(8)
i2 v[96:99],v[132:135],v[16:19],0
i6 m0,s31,76800
i6 s24,s31,76800
i1 v0,s[36:39],s24 offen lds
i0 v[152:153],v2 offset:224
i0 v[154:155],v2 offset:4832
i8 lgkmcnt(8)
i2 v[100:103],v[136:139],v[16:19],0
i6 m0,s31,77824
i6 s24,s31,77824
i1 v0,s[36:39],s24 offen lds
i0 v[156:157],v2 offset:256
i0 v[158:159],v2 offset:4864
i8 lgkmcnt(8)
i2 v[104:107],v[140:143],v[16:19],0
i6 m0,s31,78848
i6 s24,s31,78848
i1 v0,s[36:39],s24 offen lds
i8 lgkmcnt(6)
i2 v[108:111],v[144:147],v[16:19],0
i6 m0,s31,79872
i6 s24,s31,79872
i1 v0,s[36:39],s24 offen lds
i8 lgkmcnt(4)
i2 v[112:115],v[148:151],v[16:19],0
i6 m0,s31,80896
i6 s24,s31,80896
i1 v0,s[36:39],s24 offen lds
i8 lgkmcnt(2)
i2 v[116:119],v[152:155],v[16:19],0
i6 m0,s31,81920
i6 s24,s31,81920
i1 v0,s[36:39],s24 offen lds
i8 lgkmcnt(0)
i2 v[120:123],v[156:159],v[16:19],0
i8 vmcnt(9)
s_barrier
i0 v[124:125],v2 offset:36864
i0 v[126:127],v2 offset:41472
i0 v[128:129],v2 offset:36896
i0 v[130:131],v2 offset:41504
i0 v[132:133],v2 offset:36928
i0 v[134:135],v2 offset:41536
i0 v[136:137],v2 offset:36960
i0 v[138:139],v2 offset:41568
i6 m0,s31,0
i6 s24,s31,110592
i1 v0,s[36:39],s24 offen lds
i0 v[140:141],v2 offset:36992
i0 v[142:143],v2 offset:41600
i8 lgkmcnt(8)
i2 v[88:91],v[124:127],v[20:23],v[88:91]
i6 m0,s31,1024
i6 s24,s31,111616
i1 v0,s[36:39],s24 offen lds
i0 v[144:145],v2 offset:37024
i0 v[146:147],v2 offset:41632
i8 lgkmcnt(8)
i2 v[92:95],v[128:131],v[20:23],v[92:95]
i6 m0,s31,2048
i6 s24,s31,112640
i1 v0,s[36:39],s24 offen lds
i0 v[148:149],v2 offset:37056
i0 v[150:151],v2 offset:41664
i8 lgkmcnt(8)
i2 v[96:99],v[132:135],v[20:23],v[96:99]
i6 m0,s31,3072
i6 s24,s31,113664
i1 v0,s[36:39],s24 offen lds
i0 v[152:153],v2 offset:37088
i0 v[154:155],v2 offset:41696
i8 lgkmcnt(8)
i2 v[100:103],v[136:139],v[20:23],v[100:103]
i6 m0,s31,4096
i6 s24,s31,114688
i1 v0,s[36:39],s24 offen lds
i0 v[156:157],v2 offset:37120
i0 v[158:159],v2 offset:41728
i8 lgkmcnt(8)
i2 v[104:107],v[140:143],v[20:23],v[104:107]
i6 m0,s31,5120
i6 s24,s31,115712
i1 v0,s[36:39],s24 offen lds
i8 lgkmcnt(6)
i2 v[108:111],v[144:147],v[20:23],v[108:111]
i6 m0,s31,6144
i6 s24,s31,116736
i1 v0,s[36:39],s24 offen lds
i8 lgkmcnt(4)
i2 v[112:115],v[148:151],v[20:23],v[112:115]
i6 m0,s31,7168
i6 s24,s31,117760
i1 v0,s[36:39],s24 offen lds
i8 lgkmcnt(2)
i2 v[116:119],v[152:155],v[20:23],v[116:119]
i6 m0,s31,8192
i6 s24,s31,118784
i1 v0,s[36:39],s24 offen lds
i8 lgkmcnt(0)
i2 v[120:123],v[156:159],v[20:23],v[120:123]
i8 vmcnt(9)
s_barrier
i0 v[124:125],v3 offset:8192
i0 v[126:127],v3 offset:12800
i0 v[128:129],v3 offset:8224
i0 v[130:131],v3 offset:12832
i0 v[132:133],v3 offset:8256
i0 v[134:135],v3 offset:12864
i0 v[136:137],v3 offset:8288
i0 v[138:139],v3 offset:12896
i6 m0,s31,36864
i6 s24,s31,147456
i1 v0,s[36:39],s24 offen lds
i0 v[140:141],v3 offset:8320
i0 v[142:143],v3 offset:12928
i8 lgkmcnt(8)
i2 v[88:91],v[124:127],v[24:27],v[88:91]
i6 m0,s31,37888
i6 s24,s31,148480
i1 v0,s[36:39],s24 offen lds
i0 v[144:145],v3 offset:8352
i0 v[146:147],v3 offset:12960
i8 lgkmcnt(8)
i2 v[92:95],v[128:131],v[24:27],v[92:95]
i6 m0,s31,38912
i6 s24,s31,149504
i1 v0,s[36:39],s24 offen lds
i0 v[148:149],v3 offset:8384
i0 v[150:151],v3 offset:12992
i8 lgkmcnt(8)
i2 v[96:99],v[132:135],v[24:27],v[96:99]
i6 m0,s31,39936
i6 s24,s31,150528
i1 v0,s[36:39],s24 offen lds
i0 v[152:153],v3 offset:8416
i0 v[154:155],v3 offset:13024
i8 lgkmcnt(8)
i2 v[100:103],v[136:139],v[24:27],v[100:103]
i6 m0,s31,40960
i6 s24,s31,151552
i1 v0,s[36:39],s24 offen lds
i0 v[156:157],v3 offset:8448
i0 v[158:159],v3 offset:13056
i8 lgkmcnt(8)
i2 v[104:107],v[140:143],v[24:27],v[104:107]
i6 m0,s31,41984
i6 s24,s31,152576
i1 v0,s[36:39],s24 offen lds
i8 lgkmcnt(6)
i2 v[108:111],v[144:147],v[24:27],v[108:111]
i6 m0,s31,43008
i6 s24,s31,153600
i1 v0,s[36:39],s24 offen lds
i8 lgkmcnt(4)
i2 v[112:115],v[148:151],v[24:27],v[112:115]
i6 m0,s31,44032
i6 s24,s31,154624
i1 v0,s[36:39],s24 offen lds
i8 lgkmcnt(2)
i2 v[116:119],v[152:155],v[24:27],v[116:119]
i6 m0,s31,45056
i6 s24,s31,155648
i1 v0,s[36:39],s24 offen lds
i8 lgkmcnt(0)
i2 v[120:123],v[156:159],v[24:27],v[120:123]
i8 vmcnt(9)
s_barrier
i0 v[124:125],v2 offset:0
i0 v[126:127],v2 offset:4608
i0 v[128:129],v2 offset:32
i0 v[130:131],v2 offset:4640
i0 v[132:133],v2 offset:64
i0 v[134:135],v2 offset:4672
i0 v[136:137],v2 offset:96
i0 v[138:139],v2 offset:4704
i6 m0,s31,73728
i6 s24,s31,184320
i1 v0,s[36:39],s24 offen lds
i0 v[140:141],v2 offset:128
i0 v[142:143],v2 offset:4736
i8 lgkmcnt(8)
i2 v[88:91],v[124:127],v[28:31],v[88:91]
i6 m0,s31,74752
i6 s24,s31,185344
i1 v0,s[36:39],s24 offen lds
i0 v[144:145],v2 offset:160
i0 v[146:147],v2 offset:4768
i8 lgkmcnt(8)
i2 v[92:95],v[128:131],v[28:31],v[92:95]
i6 m0,s31,75776
i6 s24,s31,186368
i1 v0,s[36:39],s24 offen lds
i0 v[148:149],v2 offset:192
i0 v[150:151],v2 offset:4800
i8 lgkmcnt(8)
i2 v[96:99],v[132:135],v[28:31],v[96:99]
i6 m0,s31,76800
i6 s24,s31,187392
i1 v0,s[36:39],s24 offen lds
i0 v[152:153],v2 offset:224
i0 v[154:155],v2 offset:4832
i8 lgkmcnt(8)
i2 v[100:103],v[136:139],v[28:31],v[100:103]
i6 m0,s31,77824
i6 s24,s31,188416
i1 v0,s[36:39],s24 offen lds
i0 v[156:157],v2 offset:256
i0 v[158:159],v2 offset:4864
i8 lgkmcnt(8)
i2 v[104:107],v[140:143],v[28:31],v[104:107]
i6 m0,s31,78848
i6 s24,s31,189440
i1 v0,s[36:39],s24 offen lds
i8 lgkmcnt(6)
i2 v[108:111],v[144:147],v[28:31],v[108:111]
i6 m0,s31,79872
i6 s24,s31,190464
i1 v0,s[36:39],s24 offen lds
i8 lgkmcnt(4)
i2 v[112:115],v[148:151],v[28:31],v[112:115]
i6 m0,s31,80896
i6 s24,s31,191488
i1 v0,s[36:39],s24 offen lds
i8 lgkmcnt(2)
i2 v[116:119],v[152:155],v[28:31],v[116:119]
i6 m0,s31,81920
i6 s24,s31,192512
i1 v0,s[36:39],s24 offen lds
i8 lgkmcnt(0)
i2 v[120:123],v[156:159],v[28:31],v[120:123]
i8 vmcnt(9)
s_barrier
i0 v[124:125],v2 offset:36864
i0 v[126:127],v2 offset:41472
i0 v[128:129],v2 offset:36896
i0 v[130:131],v2 offset:41504
i0 v[132:133],v2 offset:36928
i0 v[134:135],v2 offset:41536
i0 v[136:137],v2 offset:36960
i0 v[138:139],v2 offset:41568
i6 m0,s31,0
i6 s24,s31,221184
i1 v0,s[36:39],s24 offen lds
i0 v[140:141],v2 offset:36992
i0 v[142:143],v2 offset:41600
i8 lgkmcnt(8)
i2 v[88:91],v[124:127],v[32:35],v[88:91]
i6 m0,s31,1024
i6 s24,s31,222208
i1 v0,s[36:39],s24 offen lds
i0 v[144:145],v2 offset:37024
i0 v[146:147],v2 offset:41632
i8 lgkmcnt(8)
i2 v[92:95],v[128:131],v[32:35],v[92:95]
i6 m0,s31,2048
i6 s24,s31,223232
i1 v0,s[36:39],s24 offen lds
i0 v[148:149],v2 offset:37056
i0 v[150:151],v2 offset:41664
i8 lgkmcnt(8)
i2 v[96:99],v[132:135],v[32:35],v[96:99]
i6 m0,s31,3072
i6 s24,s31,224256
i1 v0,s[36:39],s24 offen lds
i0 v[152:153],v2 offset:37088
i0 v[154:155],v2 offset:41696
i8 lgkmcnt(8)
i2 v[100:103],v[136:139],v[32:35],v[100:103]
i6 m0,s31,4096
i6 s24,s31,225280
i1 v0,s[36:39],s24 offen lds
i0 v[156:157],v2 offset:37120
i0 v[158:159],v2 offset:41728
i8 lgkmcnt(8)
i2 v[104:107],v[140:143],v[32:35],v[104:107]
i6 m0,s31,5120
i6 s24,s31,226304
i1 v0,s[36:39],s24 offen lds
i8 lgkmcnt(6)
i2 v[108:111],v[144:147],v[32:35],v[108:111]
i6 m0,s31,6144
i6 s24,s31,227328
i1 v0,s[36:39],s24 offen lds
i8 lgkmcnt(4)
i2 v[112:115],v[148:151],v[32:35],v[112:115]
i6 m0,s31,7168
i6 s24,s31,228352
i1 v0,s[36:39],s24 offen lds
i8 lgkmcnt(2)
i2 v[116:119],v[152:155],v[32:35],v[116:119]
i6 m0,s31,8192
i6 s24,s31,229376
i1 v0,s[36:39],s24 offen lds
i8 lgkmcnt(0)
i2 v[120:123],v[156:159],v[32:35],v[120:123]
i8 vmcnt(9)
s_barrier
i0 v[124:125],v3 offset:8192
i0 v[126:127],v3 offset:12800
i0 v[128:129],v3 offset:8224
i0 v[130:131],v3 offset:12832
i0 v[132:133],v3 offset:8256
i0 v[134:135],v3 offset:12864
i0 v[136:137],v3 offset:8288
i0 v[138:139],v3 offset:12896
i6 m0,s31,36864
i6 s24,s31,258048
i1 v0,s[36:39],s24 offen lds
i0 v[140:141],v3 offset:8320
i0 v[142:143],v3 offset:12928
i8 lgkmcnt(8)
i2 v[88:91],v[124:127],v[36:39],v[88:91]
i6 m0,s31,37888
i6 s24,s31,259072
i1 v0,s[36:39],s24 offen lds
i0 v[144:145],v3 offset:8352
i0 v[146:147],v3 offset:12960
i8 lgkmcnt(8)
i2 v[92:95],v[128:131],v[36:39],v[92:95]
i6 m0,s31,38912
i6 s24,s31,260096
i1 v0,s[36:39],s24 offen lds
i0 v[148:149],v3 offset:8384
i0 v[150:151],v3 offset:12992
i8 lgkmcnt(8)
i2 v[96:99],v[132:135],v[36:39],v[96:99]
i6 m0,s31,39936
i6 s24,s31,261120
i1 v0,s[36:39],s24 offen lds
i0 v[152:153],v3 offset:8416
i0 v[154:155],v3 offset:13024
i8 lgkmcnt(8)
i2 v[100:103],v[136:139],v[36:39],v[100:103]
i6 m0,s31,40960
i6 s24,s31,262144
i1 v0,s[36:39],s24 offen lds
i0 v[156:157],v3 offset:8448
i0 v[158:159],v3 offset:13056
i8 lgkmcnt(8)
i2 v[104:107],v[140:143],v[36:39],v[104:107]
i6 m0,s31,41984
i6 s24,s31,263168
i1 v0,s[36:39],s24 offen lds
i8 lgkmcnt(6)
i2 v[108:111],v[144:147],v[36:39],v[108:111]
i6 m0,s31,43008
i6 s24,s31,264192
i1 v0,s[36:39],s24 offen lds
i8 lgkmcnt(4)
i2 v[112:115],v[148:151],v[36:39],v[112:115]
i6 m0,s31,44032
i6 s24,s31,265216
i1 v0,s[36:39],s24 offen lds
i8 lgkmcnt(2)
i2 v[116:119],v[152:155],v[36:39],v[116:119]
i6 m0,s31,45056
i6 s24,s31,266240
i1 v0,s[36:39],s24 offen lds
i8 lgkmcnt(0)
i2 v[120:123],v[156:159],v[36:39],v[120:123]
i8 vmcnt(9)
s_barrier
i0 v[124:125],v2 offset:0
i0 v[126:127],v2 offset:4608
i0 v[128:129],v2 offset:32
i0 v[130:131],v2 offset:4640
i0 v[132:133],v2 offset:64
i0 v[134:135],v2 offset:4672
i0 v[136:137],v2 offset:96
i0 v[138:139],v2 offset:4704
i6 m0,s31,73728
i6 s24,s31,294912
i1 v0,s[36:39],s24 offen lds
i0 v[140:141],v2 offset:128
i0 v[142:143],v2 offset:4736
i8 lgkmcnt(8)
i2 v[88:91],v[124:127],v[40:43],v[88:91]
i6 m0,s31,74752
i6 s24,s31,295936
i1 v0,s[36:39],s24 offen lds
i0 v[144:145],v2 offset:160
i0 v[146:147],v2 offset:4768
i8 lgkmcnt(8)
i2 v[92:95],v[128:131],v[40:43],v[92:95]
i6 m0,s31,75776
i6 s24,s31,296960
i1 v0,s[36:39],s24 offen lds
i0 v[148:149],v2 offset:192
i0 v[150:151],v2 offset:4800
i8 lgkmcnt(8)
i2 v[96:99],v[132:135],v[40:43],v[96:99]
i6 m0,s31,76800
i6 s24,s31,297984
i1 v0,s[36:39],s24 offen lds
i0 v[152:153],v2 offset:224
i0 v[154:155],v2 offset:4832
i8 lgkmcnt(8)
i2 v[100:103],v[136:139],v[40:43],v[100:103]
i6 m0,s31,77824
i6 s24,s31,299008
i1 v0,s[36:39],s24 offen lds
i0 v[156:157],v2 offset:256
i0 v[158:159],v2 offset:4864
i8 lgkmcnt(8)
i2 v[104:107],v[140:143],v[40:43],v[104:107]
i6 m0,s31,78848
i6 s24,s31,300032
i1 v0,s[36:39],s24 offen lds
i8 lgkmcnt(6)
i2 v[108:111],v[144:147],v[40:43],v[108:111]
i6 m0,s31,79872
i6 s24,s31,301056
i1 v0,s[36:39],s24 offen lds
i8 lgkmcnt(4)
i2 v[112:115],v[148:151],v[40:43],v[112:115]
i6 m0,s31,80896
i6 s24,s31,302080
i1 v0,s[36:39],s24 offen lds
i8 lgkmcnt(2)
i2 v[116:119],v[152:155],v[40:43],v[116:119]
i6 m0,s31,81920
i6 s24,s31,303104
i1 v0,s[36:39],s24 offen lds
i8 lgkmcnt(0)
i2 v[120:123],v[156:159],v[40:43],v[120:123]
i8 vmcnt(9)
s_barrier
i0 v[124:125],v2 offset:36864
i0 v[126:127],v2 offset:41472
i0 v[128:129],v2 offset:36896
i0 v[130:131],v2 offset:41504
i0 v[132:133],v2 offset:36928
i0 v[134:135],v2 offset:41536
i0 v[136:137],v2 offset:36960
i0 v[138:139],v2 offset:41568
i6 m0,s31,0
i6 s24,s31,331776
i1 v0,s[36:39],s24 offen lds
i0 v[140:141],v2 offset:36992
i0 v[142:143],v2 offset:41600
i8 lgkmcnt(8)
i2 v[88:91],v[124:127],v[44:47],v[88:91]
i6 m0,s31,1024
i6 s24,s31,332800
i1 v0,s[36:39],s24 offen lds
i0 v[144:145],v2 offset:37024
i0 v[146:147],v2 offset:41632
i8 lgkmcnt(8)
i2 v[92:95],v[128:131],v[44:47],v[92:95]
i6 m0,s31,2048
i6 s24,s31,333824
i1 v0,s[36:39],s24 offen lds
i0 v[148:149],v2 offset:37056
i0 v[150:151],v2 offset:41664
i8 lgkmcnt(8)
i2 v[96:99],v[132:135],v[44:47],v[96:99]
i6 m0,s31,3072
i6 s24,s31,334848
i1 v0,s[36:39],s24 offen lds
i0 v[152:153],v2 offset:37088
i0 v[154:155],v2 offset:41696
i8 lgkmcnt(8)
i2 v[100:103],v[136:139],v[44:47],v[100:103]
i6 m0,s31,4096
i6 s24,s31,335872
i1 v0,s[36:39],s24 offen lds
i0 v[156:157],v2 offset:37120
i0 v[158:159],v2 offset:41728
i8 lgkmcnt(8)
i2 v[104:107],v[140:143],v[44:47],v[104:107]
i6 m0,s31,5120
i6 s24,s31,336896
i1 v0,s[36:39],s24 offen lds
i8 lgkmcnt(6)
i2 v[108:111],v[144:147],v[44:47],v[108:111]
i6 m0,s31,6144
i6 s24,s31,337920
i1 v0,s[36:39],s24 offen lds
i8 lgkmcnt(4)
i2 v[112:115],v[148:151],v[44:47],v[112:115]
i6 m0,s31,7168
i6 s24,s31,338944
i1 v0,s[36:39],s24 offen lds
i8 lgkmcnt(2)
i2 v[116:119],v[152:155],v[44:47],v[116:119]
i6 m0,s31,8192
i6 s24,s31,339968
i1 v0,s[36:39],s24 offen lds
i8 lgkmcnt(0)
i2 v[120:123],v[156:159],v[44:47],v[120:123]
i8 vmcnt(9)
s_barrier
i0 v[124:125],v3 offset:8192
i0 v[126:127],v3 offset:12800
i0 v[128:129],v3 offset:8224
i0 v[130:131],v3 offset:12832
i0 v[132:133],v3 offset:8256
i0 v[134:135],v3 offset:12864
i0 v[136:137],v3 offset:8288
i0 v[138:139],v3 offset:12896
i6 m0,s31,36864
i6 s24,s31,368640
i1 v0,s[36:39],s24 offen lds
i0 v[140:141],v3 offset:8320
i0 v[142:143],v3 offset:12928
i8 lgkmcnt(8)
i2 v[88:91],v[124:127],v[48:51],v[88:91]
i6 m0,s31,37888
i6 s24,s31,369664
i1 v0,s[36:39],s24 offen lds
i0 v[144:145],v3 offset:8352
i0 v[146:147],v3 offset:12960
i8 lgkmcnt(8)
i2 v[92:95],v[128:131],v[48:51],v[92:95]
i6 m0,s31,38912
i6 s24,s31,370688
i1 v0,s[36:39],s24 offen lds
i0 v[148:149],v3 offset:8384
i0 v[150:151],v3 offset:12992
i8 lgkmcnt(8)
i2 v[96:99],v[132:135],v[48:51],v[96:99]
i6 m0,s31,39936
i6 s24,s31,371712
i1 v0,s[36:39],s24 offen lds
i0 v[152:153],v3 offset:8416
i0 v[154:155],v3 offset:13024
i8 lgkmcnt(8)
i2 v[100:103],v[136:139],v[48:51],v[100:103]
i6 m0,s31,40960
i6 s24,s31,372736
i1 v0,s[36:39],s24 offen lds
i0 v[156:157],v3 offset:8448
i0 v[158:159],v3 offset:13056
i8 lgkmcnt(8)
i2 v[104:107],v[140:143],v[48:51],v[104:107]
i6 m0,s31,41984
i6 s24,s31,373760
i1 v0,s[36:39],s24 offen lds
i8 lgkmcnt(6)
i2 v[108:111],v[144:147],v[48:51],v[108:111]
i6 m0,s31,43008
i6 s24,s31,374784
i1 v0,s[36:39],s24 offen lds
i8 lgkmcnt(4)
i2 v[112:115],v[148:151],v[48:51],v[112:115]
i6 m0,s31,44032
i6 s24,s31,375808
i1 v0,s[36:39],s24 offen lds
i8 lgkmcnt(2)
i2 v[116:119],v[152:155],v[48:51],v[116:119]
i6 m0,s31,45056
i6 s24,s31,376832
i1 v0,s[36:39],s24 offen lds
i8 lgkmcnt(0)
i2 v[120:123],v[156:159],v[48:51],v[120:123]
i8 vmcnt(9)
s_barrier
i0 v[124:125],v2 offset:0
i0 v[126:127],v2 offset:4608
i0 v[128:129],v2 offset:32
i0 v[130:131],v2 offset:4640
i0 v[132:133],v2 offset:64
i0 v[134:135],v2 offset:4672
i0 v[136:137],v2 offset:96
i0 v[138:139],v2 offset:4704
i6 m0,s31,73728
i6 s24,s31,405504
i1 v0,s[36:39],s24 offen lds
i0 v[140:141],v2 offset:128
i0 v[142:143],v2 offset:4736
i8 lgkmcnt(8)
i2 v[88:91],v[124:127],v[52:55],v[88:91]
i6 m0,s31,74752
i6 s24,s31,406528
i1 v0,s[36:39],s24 offen lds
i0 v[144:145],v2 offset:160
i0 v[146:147],v2 offset:4768
i8 lgkmcnt(8)
i2 v[92:95],v[128:131],v[52:55],v[92:95]
i6 m0,s31,75776
i6 s24,s31,407552
i1 v0,s[36:39],s24 offen lds
i0 v[148:149],v2 offset:192
i0 v[150:151],v2 offset:4800
i8 lgkmcnt(8)
i2 v[96:99],v[132:135],v[52:55],v[96:99]
i6 m0,s31,76800
i6 s24,s31,408576
i1 v0,s[36:39],s24 offen lds
i0 v[152:153],v2 offset:224
i0 v[154:155],v2 offset:4832
i8 lgkmcnt(8)
i2 v[100:103],v[136:139],v[52:55],v[100:103]
i6 m0,s31,77824
i6 s24,s31,409600
i1 v0,s[36:39],s24 offen lds
i0 v[156:157],v2 offset:256
i0 v[158:159],v2 offset:4864
i8 lgkmcnt(8)
i2 v[104:107],v[140:143],v[52:55],v[104:107]
i6 m0,s31,78848
i6 s24,s31,410624
i1 v0,s[36:39],s24 offen lds
i8 lgkmcnt(6)
i2 v[108:111],v[144:147],v[52:55],v[108:111]
i6 m0,s31,79872
i6 s24,s31,411648
i1 v0,s[36:39],s24 offen lds
i8 lgkmcnt(4)
i2 v[112:115],v[148:151],v[52:55],v[112:115]
i6 m0,s31,80896
i6 s24,s31,412672
i1 v0,s[36:39],s24 offen lds
i8 lgkmcnt(2)
i2 v[116:119],v[152:155],v[52:55],v[116:119]
i6 m0,s31,81920
i6 s24,s31,413696
i1 v0,s[36:39],s24 offen lds
i8 lgkmcnt(0)
i2 v[120:123],v[156:159],v[52:55],v[120:123]
i8 vmcnt(9)
s_barrier
i0 v[124:125],v2 offset:36864
i0 v[126:127],v2 offset:41472
i0 v[128:129],v2 offset:36896
i0 v[130:131],v2 offset:41504
i0 v[132:133],v2 offset:36928
i0 v[134:135],v2 offset:41536
i0 v[136:137],v2 offset:36960
i0 v[138:139],v2 offset:41568
i6 m0,s31,0
i6 s24,s31,442368
i1 v0,s[36:39],s24 offen lds
i0 v[140:141],v2 offset:36992
i0 v[142:143],v2 offset:41600
i8 lgkmcnt(8)
i2 v[88:91],v[124:127],v[56:59],v[88:91]
i6 m0,s31,1024
i6 s24,s31,443392
i1 v0,s[36:39],s24 offen lds
i0 v[144:145],v2 offset:37024
i0 v[146:147],v2 offset:41632
i8 lgkmcnt(8)
i2 v[92:95],v[128:131],v[56:59],v[92:95]
i6 m0,s31,2048
i6 s24,s31,444416
i1 v0,s[36:39],s24 offen lds
i0 v[148:149],v2 offset:37056
i0 v[150:151],v2 offset:41664
i8 lgkmcnt(8)
i2 v[96:99],v[132:135],v[56:59],v[96:99]
i6 m0,s31,3072
i6 s24,s31,445440
i1 v0,s[36:39],s24 offen lds
i0 v[152:153],v2 offset:37088
i0 v[154:155],v2 offset:41696
i8 lgkmcnt(8)
i2 v[100:103],v[136:139],v[56:59],v[100:103]
i6 m0,s31,4096
i6 s24,s31,446464
i1 v0,s[36:39],s24 offen lds
i0 v[156:157],v2 offset:37120
i0 v[158:159],v2 offset:41728
i8 lgkmcnt(8)
i2 v[104:107],v[140:143],v[56:59],v[104:107]
i6 m0,s31,5120
i6 s24,s31,447488
i1 v0,s[36:39],s24 offen lds
i8 lgkmcnt(6)
i2 v[108:111],v[144:147],v[56:59],v[108:111]
i6 m0,s31,6144
i6 s24,s31,448512
i1 v0,s[36:39],s24 offen lds
i8 lgkmcnt(4)
i2 v[112:115],v[148:151],v[56:59],v[112:115]
i6 m0,s31,7168
i6 s24,s31,449536
i1 v0,s[36:39],s24 offen lds
i8 lgkmcnt(2)
i2 v[116:119],v[152:155],v[56:59],v[116:119]
i6 m0,s31,8192
i6 s24,s31,450560
i1 v0,s[36:39],s24 offen lds
i8 lgkmcnt(0)
i2 v[120:123],v[156:159],v[56:59],v[120:123]
i8 vmcnt(9)
s_barrier
i0 v[124:125],v3 offset:8192
i0 v[126:127],v3 offset:12800
i0 v[128:129],v3 offset:8224
i0 v[130:131],v3 offset:12832
i0 v[132:133],v3 offset:8256
i0 v[134:135],v3 offset:12864
i0 v[136:137],v3 offset:8288
i0 v[138:139],v3 offset:12896
i6 m0,s31,36864
i6 s24,s31,479232
i1 v0,s[36:39],s24 offen lds
i0 v[140:141],v3 offset:8320
i0 v[142:143],v3 offset:12928
i8 lgkmcnt(8)
i2 v[88:91],v[124:127],v[60:63],v[88:91]
i6 m0,s31,37888
i6 s24,s31,480256
i1 v0,s[36:39],s24 offen lds
i0 v[144:145],v3 offset:8352
i0 v[146:147],v3 offset:12960
i8 lgkmcnt(8)
i2 v[92:95],v[128:131],v[60:63],v[92:95]
i6 m0,s31,38912
i6 s24,s31,481280
i1 v0,s[36:39],s24 offen lds
i0 v[148:149],v3 offset:8384
i0 v[150:151],v3 offset:12992
i8 lgkmcnt(8)
i2 v[96:99],v[132:135],v[60:63],v[96:99]
i6 m0,s31,39936
i6 s24,s31,482304
i1 v0,s[36:39],s24 offen lds
i0 v[152:153],v3 offset:8416
i0 v[154:155],v3 offset:13024
i8 lgkmcnt(8)
i2 v[100:103],v[136:139],v[60:63],v[100:103]
i6 m0,s31,40960
i6 s24,s31,483328
i1 v0,s[36:39],s24 offen lds
i0 v[156:157],v3 offset:8448
i0 v[158:159],v3 offset:13056
i8 lgkmcnt(8)
i2 v[104:107],v[140:143],v[60:63],v[104:107]
i6 m0,s31,41984
i6 s24,s31,484352
i1 v0,s[36:39],s24 offen lds
i8 lgkmcnt(6)
i2 v[108:111],v[144:147],v[60:63],v[108:111]
i6 m0,s31,43008
i6 s24,s31,485376
i1 v0,s[36:39],s24 offen lds
i8 lgkmcnt(4)
i2 v[112:115],v[148:151],v[60:63],v[112:115]
i6 m0,s31,44032
i6 s24,s31,486400
i1 v0,s[36:39],s24 offen lds
i8 lgkmcnt(2)
i2 v[116:119],v[152:155],v[60:63],v[116:119]
i6 m0,s31,45056
i6 s24,s31,487424
i1 v0,s[36:39],s24 offen lds
i8 lgkmcnt(0)
i2 v[120:123],v[156:159],v[60:63],v[120:123]
i8 vmcnt(9)
s_barrier
i0 v[124:125],v2 offset:0
i0 v[126:127],v2 offset:4608
i0 v[128:129],v2 offset:32
i0 v[130:131],v2 offset:4640
i0 v[132:133],v2 offset:64
i0 v[134:135],v2 offset:4672
i0 v[136:137],v2 offset:96
i0 v[138:139],v2 offset:4704
i6 m0,s31,73728
i6 s24,s31,516096
i1 v0,s[36:39],s24 offen lds
i0 v[140:141],v2 offset:128
i0 v[142:143],v2 offset:4736
i8 lgkmcnt(8)
i2 v[88:91],v[124:127],v[64:67],v[88:91]
i6 m0,s31,74752
i6 s24,s31,517120
i1 v0,s[36:39],s24 offen lds
i0 v[144:145],v2 offset:160
i0 v[146:147],v2 offset:4768
i8 lgkmcnt(8)
i2 v[92:95],v[128:131],v[64:67],v[92:95]
i6 m0,s31,75776
i6 s24,s31,518144
i1 v0,s[36:39],s24 offen lds
i0 v[148:149],v2 offset:192
i0 v[150:151],v2 offset:4800
i8 lgkmcnt(8)
i2 v[96:99],v[132:135],v[64:67],v[96:99]
i6 m0,s31,76800
i6 s24,s31,519168
i1 v0,s[36:39],s24 offen lds
i0 v[152:153],v2 offset:224
i0 v[154:155],v2 offset:4832
i8 lgkmcnt(8)
i2 v[100:103],v[136:139],v[64:67],v[100:103]
i6 m0,s31,77824
i6 s24,s31,520192
i1 v0,s[36:39],s24 offen lds
i0 v[156:157],v2 offset:256
i0 v[158:159],v2 offset:4864
i8 lgkmcnt(8)
i2 v[104:107],v[140:143],v[64:67],v[104:107]
i6 m0,s31,78848
i6 s24,s31,521216
i1 v0,s[36:39],s24 offen lds
i8 lgkmcnt(6)
i2 v[108:111],v[144:147],v[64:67],v[108:111]
i6 m0,s31,79872
i6 s24,s31,522240
i1 v0,s[36:39],s24 offen lds
i8 lgkmcnt(4)
i2 v[112:115],v[148:151],v[64:67],v[112:115]
i6 m0,s31,80896
i6 s24,s31,523264
i1 v0,s[36:39],s24 offen lds
i8 lgkmcnt(2)
i2 v[116:119],v[152:155],v[64:67],v[116:119]
i6 m0,s31,81920
i6 s24,s31,524288
i1 v0,s[36:39],s24 offen lds
i8 lgkmcnt(0)
i2 v[120:123],v[156:159],v[64:67],v[120:123]
i8 vmcnt(9)
s_barrier
i0 v[124:125],v2 offset:36864
i0 v[126:127],v2 offset:41472
i0 v[128:129],v2 offset:36896
i0 v[130:131],v2 offset:41504
i0 v[132:133],v2 offset:36928
i0 v[134:135],v2 offset:41536
i0 v[136:137],v2 offset:36960
i0 v[138:139],v2 offset:41568
i6 m0,s31,0
i6 s24,s31,552960
i1 v0,s[36:39],s24 offen lds
i0 v[140:141],v2 offset:36992
i0 v[142:143],v2 offset:41600
i8 lgkmcnt(8)
i2 v[88:91],v[124:127],v[68:71],v[88:91]
i6 m0,s31,1024
i6 s24,s31,553984
i1 v0,s[36:39],s24 offen lds
i0 v[144:145],v2 offset:37024
i0 v[146:147],v2 offset:41632
i8 lgkmcnt(8)
i2 v[92:95],v[128:131],v[68:71],v[92:95]
i6 m0,s31,2048
i6 s24,s31,555008
i1 v0,s[36:39],s24 offen lds
i0 v[148:149],v2 offset:37056
i0 v[150:151],v2 offset:41664
i8 lgkmcnt(8)
i2 v[96:99],v[132:135],v[68:71],v[96:99]
i6 m0,s31,3072
i6 s24,s31,556032
i1 v0,s[36:39],s24 offen lds
i0 v[152:153],v2 offset:37088
i0 v[154:155],v2 offset:41696
i8 lgkmcnt(8)
i2 v[100:103],v[136:139],v[68:71],v[100:103]
i6 m0,s31,4096
i6 s24,s31,557056
i1 v0,s[36:39],s24 offen lds
i0 v[156:157],v2 offset:37120
i0 v[158:159],v2 offset:41728
i8 lgkmcnt(8)
i2 v[104:107],v[140:143],v[68:71],v[104:107]
i6 m0,s31,5120
i6 s24,s31,558080
i1 v0,s[36:39],s24 offen lds
i8 lgkmcnt(6)
i2 v[108:111],v[144:147],v[68:71],v[108:111]
i6 m0,s31,6144
i6 s24,s31,559104
i1 v0,s[36:39],s24 offen lds
i8 lgkmcnt(4)
i2 v[112:115],v[148:151],v[68:71],v[112:115]
i6 m0,s31,7168
i6 s24,s31,560128
i1 v0,s[36:39],s24 offen lds
i8 lgkmcnt(2)
i2 v[116:119],v[152:155],v[68:71],v[116:119]
i6 m0,s31,8192
i6 s24,s31,561152
i1 v0,s[36:39],s24 offen lds
i8 lgkmcnt(0)
i2 v[120:123],v[156:159],v[68:71],v[120:123]
i8 vmcnt(9)
s_barrier
i0 v[124:125],v3 offset:8192
i0 v[126:127],v3 offset:12800
i0 v[128:129],v3 offset:8224
i0 v[130:131],v3 offset:12832
i0 v[132:133],v3 offset:8256
i0 v[134:135],v3 offset:12864
i0 v[136:137],v3 offset:8288
i0 v[138:139],v3 offset:12896
i6 m0,s31,36864
i6 s24,s31,589824
i1 v0,s[36:39],s24 offen lds
i0 v[140:141],v3 offset:8320
i0 v[142:143],v3 offset:12928
i8 lgkmcnt(8)
i2 v[88:91],v[124:127],v[72:75],v[88:91]
i6 m0,s31,37888
i6 s24,s31,590848
i1 v0,s[36:39],s24 offen lds
i0 v[144:145],v3 offset:8352
i0 v[146:147],v3 offset:12960
i8 lgkmcnt(8)
i2 v[92:95],v[128:131],v[72:75],v[92:95]
i6 m0,s31,38912
i6 s24,s31,591872
i1 v0,s[36:39],s24 offen lds
i0 v[148:149],v3 offset:8384
i0 v[150:151],v3 offset:12992
i8 lgkmcnt(8)
i2 v[96:99],v[132:135],v[72:75],v[96:99]
i6 m0,s31,39936
i6 s24,s31,592896
i1 v0,s[36:39],s24 offen lds
i0 v[152:153],v3 offset:8416
i0 v[154:155],v3 offset:13024
i8 lgkmcnt(8)
i2 v[100:103],v[136:139],v[72:75],v[100:103]
i6 m0,s31,40960
i6 s24,s31,593920
i1 v0,s[36:39],s24 offen lds
i0 v[156:157],v3 offset:8448
i0 v[158:159],v3 offset:13056
i8 lgkmcnt(8)
i2 v[104:107],v[140:143],v[72:75],v[104:107]
i6 m0,s31,41984
i6 s24,s31,594944
i1 v0,s[36:39],s24 offen lds
i8 lgkmcnt(6)
i2 v[108:111],v[144:147],v[72:75],v[108:111]
i6 m0,s31,43008
i6 s24,s31,595968
i1 v0,s[36:39],s24 offen lds
i8 lgkmcnt(4)
i2 v[112:115],v[148:151],v[72:75],v[112:115]
i6 m0,s31,44032
i6 s24,s31,596992
i1 v0,s[36:39],s24 offen lds
i8 lgkmcnt(2)
i2 v[116:119],v[152:155],v[72:75],v[116:119]
i6 m0,s31,45056
i6 s24,s31,598016
i1 v0,s[36:39],s24 offen lds
i8 lgkmcnt(0)
i2 v[120:123],v[156:159],v[72:75],v[120:123]
i8 vmcnt(9)
s_barrier
i0 v[124:125],v2 offset:0
i0 v[126:127],v2 offset:4608
i0 v[128:129],v2 offset:32
i0 v[130:131],v2 offset:4640
i0 v[132:133],v2 offset:64
i0 v[134:135],v2 offset:4672
i0 v[136:137],v2 offset:96
i0 v[138:139],v2 offset:4704
i6 m0,s31,73728
i6 s24,s31,626688
i1 v0,s[36:39],s24 offen lds
i0 v[140:141],v2 offset:128
i0 v[142:143],v2 offset:4736
i8 lgkmcnt(8)
i2 v[88:91],v[124:127],v[76:79],v[88:91]
i6 m0,s31,74752
i6 s24,s31,627712
i1 v0,s[36:39],s24 offen lds
i0 v[144:145],v2 offset:160
i0 v[146:147],v2 offset:4768
i8 lgkmcnt(8)
i2 v[92:95],v[128:131],v[76:79],v[92:95]
i6 m0,s31,75776
i6 s24,s31,628736
i1 v0,s[36:39],s24 offen lds
i0 v[148:149],v2 offset:192
i0 v[150:151],v2 offset:4800
i8 lgkmcnt(8)
i2 v[96:99],v[132:135],v[76:79],v[96:99]
i6 m0,s31,76800
i6 s24,s31,629760
i1 v0,s[36:39],s24 offen lds
i0 v[152:153],v2 offset:224
i0 v[154:155],v2 offset:4832
i8 lgkmcnt(8)
i2 v[100:103],v[136:139],v[76:79],v[100:103]
i6 m0,s31,77824
i6 s24,s31,630784
i1 v0,s[36:39],s24 offen lds
i0 v[156:157],v2 offset:256
i0 v[158:159],v2 offset:4864
i8 lgkmcnt(8)
i2 v[104:107],v[140:143],v[76:79],v[104:107]
i6 m0,s31,78848
i6 s24,s31,631808
i1 v0,s[36:39],s24 offen lds
i8 lgkmcnt(6)
i2 v[108:111],v[144:147],v[76:79],v[108:111]
i6 m0,s31,79872
i6 s24,s31,632832
i1 v0,s[36:39],s24 offen lds
i8 lgkmcnt(4)
i2 v[112:115],v[148:151],v[76:79],v[112:115]
i6 m0,s31,80896
i6 s24,s31,633856
i1 v0,s[36:39],s24 offen lds
i8 lgkmcnt(2)
i2 v[116:119],v[152:155],v[76:79],v[116:119]
i6 m0,s31,81920
i6 s24,s31,634880
i1 v0,s[36:39],s24 offen lds
i8 lgkmcnt(0)
i2 v[120:123],v[156:159],v[76:79],v[120:123]
i8 vmcnt(9)
s_barrier
i0 v[124:125],v2 offset:36864
i0 v[126:127],v2 offset:41472
i0 v[128:129],v2 offset:36896
i0 v[130:131],v2 offset:41504
i0 v[132:133],v2 offset:36928
i0 v[134:135],v2 offset:41536
i0 v[136:137],v2 offset:36960
i0 v[138:139],v2 offset:41568
i0 v[140:141],v2 offset:36992
i0 v[142:143],v2 offset:41600
i8 lgkmcnt(8)
i2 v[88:91],v[124:127],v[80:83],v[88:91]
i0 v[144:145],v2 offset:37024
i0 v[146:147],v2 offset:41632
i8 lgkmcnt(8)
i2 v[92:95],v[128:131],v[80:83],v[92:95]
i0 v[148:149],v2 offset:37056
i0 v[150:151],v2 offset:41664
i8 lgkmcnt(8)
i2 v[96:99],v[132:135],v[80:83],v[96:99]
i0 v[152:153],v2 offset:37088
i0 v[154:155],v2 offset:41696
i8 lgkmcnt(8)
i2 v[100:103],v[136:139],v[80:83],v[100:103]
i0 v[156:157],v2 offset:37120
i0 v[158:159],v2 offset:41728
i8 lgkmcnt(8)
i2 v[104:107],v[140:143],v[80:83],v[104:107]
i8 lgkmcnt(6)
i2 v[108:111],v[144:147],v[80:83],v[108:111]
i8 lgkmcnt(4)
i2 v[112:115],v[148:151],v[80:83],v[112:115]
i8 lgkmcnt(2)
i2 v[116:119],v[152:155],v[80:83],v[116:119]
i8 lgkmcnt(0)
i2 v[120:123],v[156:159],v[80:83],v[120:123]
i8 vmcnt(0)
s_barrier
i0 v[124:125],v3 offset:8192
i0 v[126:127],v3 offset:12800
i0 v[128:129],v3 offset:8224
i0 v[130:131],v3 offset:12832
i0 v[132:133],v3 offset:8256
i0 v[134:135],v3 offset:12864
i0 v[136:137],v3 offset:8288
i0 v[138:139],v3 offset:12896
i0 v[140:141],v3 offset:8320
i0 v[142:143],v3 offset:12928
i8 lgkmcnt(8)
i2 v[88:91],v[124:127],v[84:87],v[88:91]
i0 v[144:145],v3 offset:8352
i0 v[146:147],v3 offset:12960
i8 lgkmcnt(8)
i2 v[92:95],v[128:131],v[84:87],v[92:95]
i0 v[148:149],v3 offset:8384
i0 v[150:151],v3 offset:12992
i8 lgkmcnt(8)
i2 v[96:99],v[132:135],v[84:87],v[96:99]
i0 v[152:153],v3 offset:8416
i0 v[154:155],v3 offset:13024
i8 lgkmcnt(8)
i2 v[100:103],v[136:139],v[84:87],v[100:103]
i0 v[156:157],v3 offset:8448
i0 v[158:159],v3 offset:13056
i8 lgkmcnt(8)
i2 v[104:107],v[140:143],v[84:87],v[104:107]
i8 lgkmcnt(6)
i2 v[108:111],v[144:147],v[84:87],v[108:111]
i8 lgkmcnt(4)
i2 v[112:115],v[148:151],v[84:87],v[112:115]
i8 lgkmcnt(2)
i2 v[116:119],v[152:155],v[84:87],v[116:119]
i8 lgkmcnt(0)
i2 v[120:123],v[156:159],v[84:87],v[120:123]
s_mul_i32 s24, s21, 144
i17 v6,v5,2,s24
i31 v7,4,v4
i20 v7,110592,v7
i5 s25,1051597459
i54 s26,3641
i20 v8,0,v6
i43 v9,s26,v8
i23 v9,16,v9
i43 v10,18,v9
v_sub_u32 v8, v8, v10
i17 v9,v9,10,v7
i34 v10,v8,2,2
i17 v9,v10,8,v9
i18 v10,3,v8
i17 v9,v10,1,v9
i23 v8,4,v8
i17 v9,v8,3,v9
i51 v88,s25,v88
i3 v88,v88,v88
ds_write_b16 v9, v88
i20 v8,1,v6
i43 v9,s26,v8
i23 v9,16,v9
i43 v10,18,v9
v_sub_u32 v8, v8, v10
i17 v9,v9,10,v7
i34 v10,v8,2,2
i17 v9,v10,8,v9
i18 v10,3,v8
i17 v9,v10,1,v9
i23 v8,4,v8
i17 v9,v8,3,v9
i51 v89,s25,v89
i3 v89,v89,v89
ds_write_b16 v9, v89
i20 v8,2,v6
i43 v9,s26,v8
i23 v9,16,v9
i43 v10,18,v9
v_sub_u32 v8, v8, v10
i17 v9,v9,10,v7
i34 v10,v8,2,2
i17 v9,v10,8,v9
i18 v10,3,v8
i17 v9,v10,1,v9
i23 v8,4,v8
i17 v9,v8,3,v9
i51 v90,s25,v90
i3 v90,v90,v90
ds_write_b16 v9, v90
i20 v8,3,v6
i43 v9,s26,v8
i23 v9,16,v9
i43 v10,18,v9
v_sub_u32 v8, v8, v10
i17 v9,v9,10,v7
i34 v10,v8,2,2
i17 v9,v10,8,v9
i18 v10,3,v8
i17 v9,v10,1,v9
i23 v8,4,v8
i17 v9,v8,3,v9
i51 v91,s25,v91
i3 v91,v91,v91
ds_write_b16 v9, v91
i20 v8,16,v6
i43 v9,s26,v8
i23 v9,16,v9
i43 v10,18,v9
v_sub_u32 v8, v8, v10
i17 v9,v9,10,v7
i34 v10,v8,2,2
i17 v9,v10,8,v9
i18 v10,3,v8
i17 v9,v10,1,v9
i23 v8,4,v8
i17 v9,v8,3,v9
i51 v92,s25,v92
i3 v92,v92,v92
ds_write_b16 v9, v92
i20 v8,17,v6
i43 v9,s26,v8
i23 v9,16,v9
i43 v10,18,v9
v_sub_u32 v8, v8, v10
i17 v9,v9,10,v7
i34 v10,v8,2,2
i17 v9,v10,8,v9
i18 v10,3,v8
i17 v9,v10,1,v9
i23 v8,4,v8
i17 v9,v8,3,v9
i51 v93,s25,v93
i3 v93,v93,v93
ds_write_b16 v9, v93
i20 v8,18,v6
i43 v9,s26,v8
i23 v9,16,v9
i43 v10,18,v9
v_sub_u32 v8, v8, v10
i17 v9,v9,10,v7
i34 v10,v8,2,2
i17 v9,v10,8,v9
i18 v10,3,v8
i17 v9,v10,1,v9
i23 v8,4,v8
i17 v9,v8,3,v9
i51 v94,s25,v94
i3 v94,v94,v94
ds_write_b16 v9, v94
i20 v8,19,v6
i43 v9,s26,v8
i23 v9,16,v9
i43 v10,18,v9
v_sub_u32 v8, v8, v10
i17 v9,v9,10,v7
i34 v10,v8,2,2
i17 v9,v10,8,v9
i18 v10,3,v8
i17 v9,v10,1,v9
i23 v8,4,v8
i17 v9,v8,3,v9
i51 v95,s25,v95
i3 v95,v95,v95
ds_write_b16 v9, v95
i20 v8,32,v6
i43 v9,s26,v8
i23 v9,16,v9
i43 v10,18,v9
v_sub_u32 v8, v8, v10
i17 v9,v9,10,v7
i34 v10,v8,2,2
i17 v9,v10,8,v9
i18 v10,3,v8
i17 v9,v10,1,v9
i23 v8,4,v8
i17 v9,v8,3,v9
i51 v96,s25,v96
i3 v96,v96,v96
ds_write_b16 v9, v96
i20 v8,33,v6
i43 v9,s26,v8
i23 v9,16,v9
i43 v10,18,v9
v_sub_u32 v8, v8, v10
i17 v9,v9,10,v7
i34 v10,v8,2,2
i17 v9,v10,8,v9
i18 v10,3,v8
i17 v9,v10,1,v9
i23 v8,4,v8
i17 v9,v8,3,v9
i51 v97,s25,v97
i3 v97,v97,v97
ds_write_b16 v9, v97
i20 v8,34,v6
i43 v9,s26,v8
i23 v9,16,v9
i43 v10,18,v9
v_sub_u32 v8, v8, v10
i17 v9,v9,10,v7
i34 v10,v8,2,2
i17 v9,v10,8,v9
i18 v10,3,v8
i17 v9,v10,1,v9
i23 v8,4,v8
i17 v9,v8,3,v9
i51 v98,s25,v98
i3 v98,v98,v98
ds_write_b16 v9, v98
i20 v8,35,v6
i43 v9,s26,v8
i23 v9,16,v9
i43 v10,18,v9
v_sub_u32 v8, v8, v10
i17 v9,v9,10,v7
i34 v10,v8,2,2
i17 v9,v10,8,v9
i18 v10,3,v8
i17 v9,v10,1,v9
i23 v8,4,v8
i17 v9,v8,3,v9
i51 v99,s25,v99
i3 v99,v99,v99
ds_write_b16 v9, v99
i20 v8,48,v6
i43 v9,s26,v8
i23 v9,16,v9
i43 v10,18,v9
v_sub_u32 v8, v8, v10
i17 v9,v9,10,v7
i34 v10,v8,2,2
i17 v9,v10,8,v9
i18 v10,3,v8
i17 v9,v10,1,v9
i23 v8,4,v8
i17 v9,v8,3,v9
i51 v100,s25,v100
i3 v100,v100,v100
ds_write_b16 v9, v100
i20 v8,49,v6
i43 v9,s26,v8
i23 v9,16,v9
i43 v10,18,v9
v_sub_u32 v8, v8, v10
i17 v9,v9,10,v7
i34 v10,v8,2,2
i17 v9,v10,8,v9
i18 v10,3,v8
i17 v9,v10,1,v9
i23 v8,4,v8
i17 v9,v8,3,v9
i51 v101,s25,v101
i3 v101,v101,v101
ds_write_b16 v9, v101
i20 v8,50,v6
i43 v9,s26,v8
i23 v9,16,v9
i43 v10,18,v9
v_sub_u32 v8, v8, v10
i17 v9,v9,10,v7
i34 v10,v8,2,2
i17 v9,v10,8,v9
i18 v10,3,v8
i17 v9,v10,1,v9
i23 v8,4,v8
i17 v9,v8,3,v9
i51 v102,s25,v102
i3 v102,v102,v102
ds_write_b16 v9, v102
i20 v8,51,v6
i43 v9,s26,v8
i23 v9,16,v9
i43 v10,18,v9
v_sub_u32 v8, v8, v10
i17 v9,v9,10,v7
i34 v10,v8,2,2
i17 v9,v10,8,v9
i18 v10,3,v8
i17 v9,v10,1,v9
i23 v8,4,v8
i17 v9,v8,3,v9
i51 v103,s25,v103
i3 v103,v103,v103
ds_write_b16 v9, v103
i20 v8,64,v6
i43 v9,s26,v8
i23 v9,16,v9
i43 v10,18,v9
v_sub_u32 v8, v8, v10
i17 v9,v9,10,v7
i34 v10,v8,2,2
i17 v9,v10,8,v9
i18 v10,3,v8
i17 v9,v10,1,v9
i23 v8,4,v8
i17 v9,v8,3,v9
i51 v104,s25,v104
i3 v104,v104,v104
ds_write_b16 v9, v104
i20 v8,65,v6
i43 v9,s26,v8
i23 v9,16,v9
i43 v10,18,v9
v_sub_u32 v8, v8, v10
i17 v9,v9,10,v7
i34 v10,v8,2,2
i17 v9,v10,8,v9
i18 v10,3,v8
i17 v9,v10,1,v9
i23 v8,4,v8
i17 v9,v8,3,v9
i51 v105,s25,v105
i3 v105,v105,v105
ds_write_b16 v9, v105
i20 v8,66,v6
i43 v9,s26,v8
i23 v9,16,v9
i43 v10,18,v9
v_sub_u32 v8, v8, v10
i17 v9,v9,10,v7
i34 v10,v8,2,2
i17 v9,v10,8,v9
i18 v10,3,v8
i17 v9,v10,1,v9
i23 v8,4,v8
i17 v9,v8,3,v9
i51 v106,s25,v106
i3 v106,v106,v106
ds_write_b16 v9, v106
i20 v8,67,v6
i43 v9,s26,v8
i23 v9,16,v9
i43 v10,18,v9
v_sub_u32 v8, v8, v10
i17 v9,v9,10,v7
i34 v10,v8,2,2
i17 v9,v10,8,v9
i18 v10,3,v8
i17 v9,v10,1,v9
i23 v8,4,v8
i17 v9,v8,3,v9
i51 v107,s25,v107
i3 v107,v107,v107
ds_write_b16 v9, v107
i20 v8,80,v6
i43 v9,s26,v8
i23 v9,16,v9
i43 v10,18,v9
v_sub_u32 v8, v8, v10
i17 v9,v9,10,v7
i34 v10,v8,2,2
i17 v9,v10,8,v9
i18 v10,3,v8
i17 v9,v10,1,v9
i23 v8,4,v8
i17 v9,v8,3,v9
i51 v108,s25,v108
i3 v108,v108,v108
ds_write_b16 v9, v108
i20 v8,81,v6
i43 v9,s26,v8
i23 v9,16,v9
i43 v10,18,v9
v_sub_u32 v8, v8, v10
i17 v9,v9,10,v7
i34 v10,v8,2,2
i17 v9,v10,8,v9
i18 v10,3,v8
i17 v9,v10,1,v9
i23 v8,4,v8
i17 v9,v8,3,v9
i51 v109,s25,v109
i3 v109,v109,v109
ds_write_b16 v9, v109
i20 v8,82,v6
i43 v9,s26,v8
i23 v9,16,v9
i43 v10,18,v9
v_sub_u32 v8, v8, v10
i17 v9,v9,10,v7
i34 v10,v8,2,2
i17 v9,v10,8,v9
i18 v10,3,v8
i17 v9,v10,1,v9
i23 v8,4,v8
i17 v9,v8,3,v9
i51 v110,s25,v110
i3 v110,v110,v110
ds_write_b16 v9, v110
i20 v8,83,v6
i43 v9,s26,v8
i23 v9,16,v9
i43 v10,18,v9
v_sub_u32 v8, v8, v10
i17 v9,v9,10,v7
i34 v10,v8,2,2
i17 v9,v10,8,v9
i18 v10,3,v8
i17 v9,v10,1,v9
i23 v8,4,v8
i17 v9,v8,3,v9
i51 v111,s25,v111
i3 v111,v111,v111
ds_write_b16 v9, v111
i20 v8,96,v6
i43 v9,s26,v8
i23 v9,16,v9
i43 v10,18,v9
v_sub_u32 v8, v8, v10
i17 v9,v9,10,v7
i34 v10,v8,2,2
i17 v9,v10,8,v9
i18 v10,3,v8
i17 v9,v10,1,v9
i23 v8,4,v8
i17 v9,v8,3,v9
i51 v112,s25,v112
i3 v112,v112,v112
ds_write_b16 v9, v112
i20 v8,97,v6
i43 v9,s26,v8
i23 v9,16,v9
i43 v10,18,v9
v_sub_u32 v8, v8, v10
i17 v9,v9,10,v7
i34 v10,v8,2,2
i17 v9,v10,8,v9
i18 v10,3,v8
i17 v9,v10,1,v9
i23 v8,4,v8
i17 v9,v8,3,v9
i51 v113,s25,v113
i3 v113,v113,v113
ds_write_b16 v9, v113
i20 v8,98,v6
i43 v9,s26,v8
i23 v9,16,v9
i43 v10,18,v9
v_sub_u32 v8, v8, v10
i17 v9,v9,10,v7
i34 v10,v8,2,2
i17 v9,v10,8,v9
i18 v10,3,v8
i17 v9,v10,1,v9
i23 v8,4,v8
i17 v9,v8,3,v9
i51 v114,s25,v114
i3 v114,v114,v114
ds_write_b16 v9, v114
i20 v8,99,v6
i43 v9,s26,v8
i23 v9,16,v9
i43 v10,18,v9
v_sub_u32 v8, v8, v10
i17 v9,v9,10,v7
i34 v10,v8,2,2
i17 v9,v10,8,v9
i18 v10,3,v8
i17 v9,v10,1,v9
i23 v8,4,v8
i17 v9,v8,3,v9
i51 v115,s25,v115
i3 v115,v115,v115
ds_write_b16 v9, v115
i20 v8,112,v6
i43 v9,s26,v8
i23 v9,16,v9
i43 v10,18,v9
v_sub_u32 v8, v8, v10
i17 v9,v9,10,v7
i34 v10,v8,2,2
i17 v9,v10,8,v9
i18 v10,3,v8
i17 v9,v10,1,v9
i23 v8,4,v8
i17 v9,v8,3,v9
i51 v116,s25,v116
i3 v116,v116,v116
ds_write_b16 v9, v116
i20 v8,113,v6
i43 v9,s26,v8
i23 v9,16,v9
i43 v10,18,v9
v_sub_u32 v8, v8, v10
i17 v9,v9,10,v7
i34 v10,v8,2,2
i17 v9,v10,8,v9
i18 v10,3,v8
i17 v9,v10,1,v9
i23 v8,4,v8
i17 v9,v8,3,v9
i51 v117,s25,v117
i3 v117,v117,v117
ds_write_b16 v9, v117
i20 v8,114,v6
i43 v9,s26,v8
i23 v9,16,v9
i43 v10,18,v9
v_sub_u32 v8, v8, v10
i17 v9,v9,10,v7
i34 v10,v8,2,2
i17 v9,v10,8,v9
i18 v10,3,v8
i17 v9,v10,1,v9
i23 v8,4,v8
i17 v9,v8,3,v9
i51 v118,s25,v118
i3 v118,v118,v118
ds_write_b16 v9, v118
i20 v8,115,v6
i43 v9,s26,v8
i23 v9,16,v9
i43 v10,18,v9
v_sub_u32 v8, v8, v10
i17 v9,v9,10,v7
i34 v10,v8,2,2
i17 v9,v10,8,v9
i18 v10,3,v8
i17 v9,v10,1,v9
i23 v8,4,v8
i17 v9,v8,3,v9
i51 v119,s25,v119
i3 v119,v119,v119
ds_write_b16 v9, v119
i20 v8,128,v6
i43 v9,s26,v8
i23 v9,16,v9
i43 v10,18,v9
v_sub_u32 v8, v8, v10
i17 v9,v9,10,v7
i34 v10,v8,2,2
i17 v9,v10,8,v9
i18 v10,3,v8
i17 v9,v10,1,v9
i23 v8,4,v8
i17 v9,v8,3,v9
i51 v120,s25,v120
i3 v120,v120,v120
ds_write_b16 v9, v120
i20 v8,129,v6
i43 v9,s26,v8
i23 v9,16,v9
i43 v10,18,v9
v_sub_u32 v8, v8, v10
i17 v9,v9,10,v7
i34 v10,v8,2,2
i17 v9,v10,8,v9
i18 v10,3,v8
i17 v9,v10,1,v9
i23 v8,4,v8
i17 v9,v8,3,v9
i51 v121,s25,v121
i3 v121,v121,v121
ds_write_b16 v9, v121
i20 v8,130,v6
i43 v9,s26,v8
i23 v9,16,v9
i43 v10,18,v9
v_sub_u32 v8, v8, v10
i17 v9,v9,10,v7
i34 v10,v8,2,2
i17 v9,v10,8,v9
i18 v10,3,v8
i17 v9,v10,1,v9
i23 v8,4,v8
i17 v9,v8,3,v9
i51 v122,s25,v122
i3 v122,v122,v122
ds_write_b16 v9, v122
i20 v8,131,v6
i43 v9,s26,v8
i23 v9,16,v9
i43 v10,18,v9
v_sub_u32 v8, v8, v10
i17 v9,v9,10,v7
i34 v10,v8,2,2
i17 v9,v10,8,v9
i18 v10,3,v8
i17 v9,v10,1,v9
i23 v8,4,v8
i17 v9,v8,3,v9
i51 v123,s25,v123
i3 v123,v123,v123
ds_write_b16 v9, v123
i11 v9,0
i46 s21,0
i22 La_kvb
i39 exec,1
La_kvw:
i55 v10,v9,s[100:101] offset:52 sc1
i6 s29,s29,1
i35 s29,400000
i22 L_end
i8 vmcnt(0)
v_cmp_gt_u32 vcc, 128, v10
s_cbranch_vccz La_kvk
s_sleep 16
i44 La_kvw
La_kvk:
i39 exec,-1
La_kvb:
s_barrier
i32 s24,s21,15
i6 s25,s24,92405760
i6 s24,s24,92274688
i1 a[0:3],v0,s[8:11],s24 offen offset:0 sc1
i1 a[4:7],v0,s[8:11],s24 offen offset:1024 sc1
i1 a[8:11],v0,s[8:11],s24 offen offset:2048 sc1
i1 a[12:15],v0,s[8:11],s24 offen offset:3072 sc1
i6 s24,s24,4096
i1 a[16:19],v0,s[8:11],s24 offen offset:0 sc1
i1 a[20:23],v0,s[8:11],s24 offen offset:1024 sc1
i1 a[24:27],v0,s[8:11],s24 offen offset:2048 sc1
i1 a[28:31],v0,s[8:11],s24 offen offset:3072 sc1
i6 s24,s24,4096
i1 a[32:35],v0,s[8:11],s24 offen offset:0 sc1
i1 a[36:39],v0,s[8:11],s24 offen offset:1024 sc1
i1 a[40:43],v0,s[8:11],s24 offen offset:2048 sc1
i1 a[44:47],v0,s[8:11],s24 offen offset:3072 sc1
i6 s24,s24,4096
i1 a[48:51],v0,s[8:11],s24 offen offset:0 sc1
i1 a[52:55],v0,s[8:11],s24 offen offset:1024 sc1
i1 a[56:59],v0,s[8:11],s24 offen offset:2048 sc1
i1 a[60:63],v0,s[8:11],s24 offen offset:3072 sc1
i6 s24,s24,4096
i1 a[64:67],v0,s[8:11],s24 offen offset:0 sc1
i1 a[68:71],v0,s[8:11],s24 offen offset:1024 sc1
i1 a[72:75],v0,s[8:11],s24 offen offset:2048 sc1
i1 a[76:79],v0,s[8:11],s24 offen offset:3072 sc1
i6 s24,s24,4096
i1 a[80:83],v0,s[8:11],s24 offen offset:0 sc1
i1 a[84:87],v0,s[8:11],s24 offen offset:1024 sc1
i1 a[88:91],v0,s[8:11],s24 offen offset:2048 sc1
i1 a[92:95],v0,s[8:11],s24 offen offset:3072 sc1
i6 s24,s24,4096
i1 a[96:99],v0,s[8:11],s24 offen offset:0 sc1
i1 a[100:103],v0,s[8:11],s24 offen offset:1024 sc1
i1 a[104:107],v0,s[8:11],s24 offen offset:2048 sc1
i1 a[108:111],v0,s[8:11],s24 offen offset:3072 sc1
i6 s24,s24,4096
i1 a[112:115],v0,s[8:11],s24 offen offset:0 sc1
i1 a[116:119],v0,s[8:11],s24 offen offset:1024 sc1
i1 a[120:123],v0,s[8:11],s24 offen offset:2048 sc1
i1 a[124:127],v0,s[8:11],s24 offen offset:3072 sc1
i6 s24,s24,4096
i8 vmcnt(16)
i1 a[128:131],v0,s[8:11],s25 offen offset:0 sc1
i1 a[132:135],v0,s[8:11],s25 offen offset:1024 sc1
i1 a[136:139],v0,s[8:11],s25 offen offset:2048 sc1
i1 a[140:143],v0,s[8:11],s25 offen offset:3072 sc1
i6 s25,s25,4096
i1 a[144:147],v0,s[8:11],s25 offen offset:0 sc1
i1 a[148:151],v0,s[8:11],s25 offen offset:1024 sc1
i1 a[152:155],v0,s[8:11],s25 offen offset:2048 sc1
i1 a[156:159],v0,s[8:11],s25 offen offset:3072 sc1
i6 s25,s25,4096
i1 a[160:163],v0,s[8:11],s25 offen offset:0 sc1
i1 a[164:167],v0,s[8:11],s25 offen offset:1024 sc1
i1 a[168:171],v0,s[8:11],s25 offen offset:2048 sc1
i1 a[172:175],v0,s[8:11],s25 offen offset:3072 sc1
i6 s25,s25,4096
i1 a[176:179],v0,s[8:11],s25 offen offset:0 sc1
i1 a[180:183],v0,s[8:11],s25 offen offset:1024 sc1
i1 a[184:187],v0,s[8:11],s25 offen offset:2048 sc1
i1 a[188:191],v0,s[8:11],s25 offen offset:3072 sc1
i6 s25,s25,4096
i1 a[192:195],v0,s[8:11],s25 offen offset:0 sc1
i1 a[196:199],v0,s[8:11],s25 offen offset:1024 sc1
i1 a[200:203],v0,s[8:11],s25 offen offset:2048 sc1
i1 a[204:207],v0,s[8:11],s25 offen offset:3072 sc1
i6 s25,s25,4096
i1 a[208:211],v0,s[8:11],s25 offen offset:0 sc1
i1 a[212:215],v0,s[8:11],s25 offen offset:1024 sc1
i1 a[216:219],v0,s[8:11],s25 offen offset:2048 sc1
i1 a[220:223],v0,s[8:11],s25 offen offset:3072 sc1
i6 s25,s25,4096
i1 a[224:227],v0,s[8:11],s25 offen offset:0 sc1
i1 a[228:231],v0,s[8:11],s25 offen offset:1024 sc1
i1 a[232:235],v0,s[8:11],s25 offen offset:2048 sc1
i1 a[236:239],v0,s[8:11],s25 offen offset:3072 sc1
i6 s25,s25,4096
i1 a[240:243],v0,s[8:11],s25 offen offset:0 sc1
i1 a[244:247],v0,s[8:11],s25 offen offset:1024 sc1
i1 a[248:251],v0,s[8:11],s25 offen offset:2048 sc1
i1 a[252:255],v0,s[8:11],s25 offen offset:3072 sc1
i6 s25,s25,4096
i20 v12,110592,v0
i32 s24,s21,11
i20 v13,s24,v0
i32 s24,s21,13
i20 v14,s24,v0
i54 s25,1168
i31 v6,3,v5
i45 v15,v4,s25,v6
s_mul_i32 s24, s21, 36
i6 s24,s24,143360
i20 v15,s24,v15
i5 s28,0
i5 s48,562036736
i5 s49,1568669696
i39 s[50:51],s[32:33]
i8 vmcnt(0) lgkmcnt(0)
s_barrier
La_grp:
i5 s27,0
La_head:
i9 v[16:19],v12
i20 v12,1024,v12
i8 lgkmcnt(0)
i11 v28,0
La_p2:
i2 v[40:43],a[0:3],v[16:19],0
i2 v[44:47],a[4:7],v[16:19],0
i2 v[48:51],a[8:11],v[16:19],0
i2 v[52:55],a[12:15],v[16:19],0
i2 v[56:59],a[16:19],v[16:19],0
i19 v40,v40
i19 v41,v41
i2 v[60:63],a[20:23],v[16:19],0
i19 v42,v42
i19 v43,v43
i3 v32,v40,v41
i19 v44,v44
i19 v45,v45
i3 v33,v42,v43
i19 v46,v46
i19 v47,v47
i3 v34,v44,v45
i3 v35,v46,v47
i2 v[64:67],a[24:27],v[16:19],0
i19 v48,v48
i19 v49,v49
i2 v[68:71],a[28:31],v[16:19],0
i19 v50,v50
i19 v51,v51
i3 v36,v48,v49
i2 v[20:23],a[128:131],v[32:35],0
i19 v52,v52
i19 v53,v53
i3 v37,v50,v51
i2 v[24:27],a[132:135],v[32:35],0
i19 v54,v54
i19 v55,v55
i3 v38,v52,v53
i3 v39,v54,v55
i2 v[40:43],a[32:35],v[16:19],0
i19 v56,v56
i19 v57,v57
i2 v[44:47],a[36:39],v[16:19],0
i19 v58,v58
i19 v59,v59
i3 v32,v56,v57
i2 v[20:23],a[136:139],v[36:39],v[20:23]
i19 v60,v60
i19 v61,v61
i3 v33,v58,v59
i2 v[24:27],a[140:143],v[36:39],v[24:27]
i19 v62,v62
i19 v63,v63
i3 v34,v60,v61
i3 v35,v62,v63
i2 v[48:51],a[40:43],v[16:19],0
i19 v64,v64
i19 v65,v65
i2 v[52:55],a[44:47],v[16:19],0
i19 v66,v66
i19 v67,v67
i3 v36,v64,v65
i2 v[20:23],a[144:147],v[32:35],v[20:23]
i19 v68,v68
i19 v69,v69
i3 v37,v66,v67
i2 v[24:27],a[148:151],v[32:35],v[24:27]
i19 v70,v70
i19 v71,v71
i3 v38,v68,v69
i3 v39,v70,v71
i2 v[56:59],a[48:51],v[16:19],0
i19 v40,v40
i19 v41,v41
i2 v[60:63],a[52:55],v[16:19],0
i19 v42,v42
i19 v43,v43
i3 v32,v40,v41
i2 v[20:23],a[152:155],v[36:39],v[20:23]
i19 v44,v44
i19 v45,v45
i3 v33,v42,v43
i2 v[24:27],a[156:159],v[36:39],v[24:27]
i19 v46,v46
i19 v47,v47
i3 v34,v44,v45
i3 v35,v46,v47
i2 v[64:67],a[56:59],v[16:19],0
i19 v48,v48
i19 v49,v49
i2 v[68:71],a[60:63],v[16:19],0
i19 v50,v50
i19 v51,v51
i3 v36,v48,v49
i2 v[20:23],a[160:163],v[32:35],v[20:23]
i19 v52,v52
i19 v53,v53
i3 v37,v50,v51
i2 v[24:27],a[164:167],v[32:35],v[24:27]
i19 v54,v54
i19 v55,v55
i3 v38,v52,v53
i3 v39,v54,v55
i2 v[40:43],a[64:67],v[16:19],0
i19 v56,v56
i19 v57,v57
i2 v[44:47],a[68:71],v[16:19],0
i19 v58,v58
i19 v59,v59
i3 v32,v56,v57
i2 v[20:23],a[168:171],v[36:39],v[20:23]
i19 v60,v60
i19 v61,v61
i3 v33,v58,v59
i2 v[24:27],a[172:175],v[36:39],v[24:27]
i19 v62,v62
i19 v63,v63
i3 v34,v60,v61
i3 v35,v62,v63
i2 v[48:51],a[72:75],v[16:19],0
i19 v64,v64
i19 v65,v65
i2 v[52:55],a[76:79],v[16:19],0
i19 v66,v66
i19 v67,v67
i3 v36,v64,v65
i2 v[20:23],a[176:179],v[32:35],v[20:23]
i19 v68,v68
i19 v69,v69
i3 v37,v66,v67
i2 v[24:27],a[180:183],v[32:35],v[24:27]
i19 v70,v70
i19 v71,v71
i3 v38,v68,v69
i3 v39,v70,v71
i2 v[56:59],a[80:83],v[16:19],0
i19 v40,v40
i19 v41,v41
i2 v[60:63],a[84:87],v[16:19],0
i19 v42,v42
i19 v43,v43
i3 v32,v40,v41
i2 v[20:23],a[184:187],v[36:39],v[20:23]
i19 v44,v44
i19 v45,v45
i3 v33,v42,v43
i2 v[24:27],a[188:191],v[36:39],v[24:27]
i19 v46,v46
i19 v47,v47
i3 v34,v44,v45
i3 v35,v46,v47
i2 v[64:67],a[88:91],v[16:19],0
i19 v48,v48
i19 v49,v49
i2 v[68:71],a[92:95],v[16:19],0
i19 v50,v50
i19 v51,v51
i3 v36,v48,v49
i2 v[20:23],a[192:195],v[32:35],v[20:23]
i19 v52,v52
i19 v53,v53
i3 v37,v50,v51
i2 v[24:27],a[196:199],v[32:35],v[24:27]
i19 v54,v54
i19 v55,v55
i3 v38,v52,v53
i3 v39,v54,v55
i2 v[40:43],a[96:99],v[16:19],0
i19 v56,v56
i19 v57,v57
i2 v[44:47],a[100:103],v[16:19],0
i19 v58,v58
i19 v59,v59
i3 v32,v56,v57
i2 v[20:23],a[200:203],v[36:39],v[20:23]
i19 v60,v60
i19 v61,v61
i3 v33,v58,v59
i2 v[24:27],a[204:207],v[36:39],v[24:27]
i19 v62,v62
i19 v63,v63
i3 v34,v60,v61
i3 v35,v62,v63
i2 v[48:51],a[104:107],v[16:19],0
i19 v64,v64
i19 v65,v65
i2 v[52:55],a[108:111],v[16:19],0
i19 v66,v66
i19 v67,v67
i3 v36,v64,v65
i2 v[20:23],a[208:211],v[32:35],v[20:23]
i19 v68,v68
i19 v69,v69
i3 v37,v66,v67
i2 v[24:27],a[212:215],v[32:35],v[24:27]
i19 v70,v70
i19 v71,v71
i3 v38,v68,v69
i3 v39,v70,v71
i2 v[56:59],a[112:115],v[16:19],0
i19 v40,v40
i19 v41,v41
i2 v[60:63],a[116:119],v[16:19],0
i19 v42,v42
i19 v43,v43
i3 v32,v40,v41
i2 v[20:23],a[216:219],v[36:39],v[20:23]
i19 v44,v44
i19 v45,v45
i3 v33,v42,v43
i2 v[24:27],a[220:223],v[36:39],v[24:27]
i19 v46,v46
i19 v47,v47
i3 v34,v44,v45
i3 v35,v46,v47
i2 v[64:67],a[120:123],v[16:19],0
i19 v48,v48
i19 v49,v49
i2 v[68:71],a[124:127],v[16:19],0
i19 v50,v50
i19 v51,v51
i3 v36,v48,v49
i2 v[20:23],a[224:227],v[32:35],v[20:23]
i19 v52,v52
i19 v53,v53
i3 v37,v50,v51
i2 v[24:27],a[228:231],v[32:35],v[24:27]
i19 v54,v54
i19 v55,v55
i3 v38,v52,v53
i3 v39,v54,v55
i15 1
i2 v[20:23],a[232:235],v[36:39],v[20:23]
i19 v56,v56
i19 v57,v57
i2 v[24:27],a[236:239],v[36:39],v[24:27]
i19 v58,v58
i19 v59,v59
i3 v32,v56,v57
i19 v60,v60
i19 v61,v61
i3 v33,v58,v59
i19 v62,v62
i19 v63,v63
i3 v34,v60,v61
i3 v35,v62,v63
i15 1
i2 v[20:23],a[240:243],v[32:35],v[20:23]
i19 v64,v64
i19 v65,v65
i2 v[24:27],a[244:247],v[32:35],v[24:27]
i19 v66,v66
i19 v67,v67
i3 v36,v64,v65
i19 v68,v68
i19 v69,v69
i3 v37,v66,v67
i19 v70,v70
i19 v71,v71
i3 v38,v68,v69
i3 v39,v70,v71
i15 1
i2 v[20:23],a[248:251],v[36:39],v[20:23]
i2 v[24:27],a[252:255],v[36:39],v[24:27]
i15 7
v_cmp_nlt_f32 vcc, s48, v26
v_cmp_ngt_f32 s[24:25], s49, v26
i11 v27,v28
i53 vcc,vcc,s[24:25]
s_and_b64 vcc, vcc, s[50:51]
i22 La_p1
i39 s[50:51],s[32:33]
i21 v13,v[20:23]
i21 v13,v[24:27] offset:1024
i20 v13,8192,v13
i6 s27,s27,1
s_cmp_lt_u32 s27, 4
i22 La_head
i8 lgkmcnt(0)
s_barrier
i18 v6,0xfffffcff,v14
i9 v[40:43],v14 offset:0
i9 v[56:59],v6 offset:1024
i9 v[44:47],v14 offset:2048
i9 v[60:63],v6 offset:3072
i9 v[48:51],v14 offset:4096
i9 v[64:67],v6 offset:5120
i9 v[52:55],v14 offset:6144
i9 v[68:71],v6 offset:7168
i8 lgkmcnt(0)
v_min3_f32 v28, v59, v63, v67
v_min_f32 v28, v28, v71
i33 v59,v28,v59
i19 v59,v59
i33 v63,v28,v63
i19 v63,v63
i33 v67,v28,v67
i19 v67,v67
i33 v71,v28,v71
i19 v71,v71
i51 v40,v40,v59
i51 v41,v41,v59
i51 v42,v42,v59
i51 v43,v43,v59
i51 v56,v56,v59
i51 v57,v57,v59
i51 v58,v58,v59
v_fmac_f32 v40, v44, v63
v_fmac_f32 v41, v45, v63
v_fmac_f32 v42, v46, v63
v_fmac_f32 v43, v47, v63
v_fmac_f32 v56, v60, v63
v_fmac_f32 v57, v61, v63
v_fmac_f32 v58, v62, v63
v_fmac_f32 v40, v48, v67
v_fmac_f32 v41, v49, v67
v_fmac_f32 v42, v50, v67
v_fmac_f32 v43, v51, v67
v_fmac_f32 v56, v64, v67
v_fmac_f32 v57, v65, v67
v_fmac_f32 v58, v66, v67
v_fmac_f32 v40, v52, v71
v_fmac_f32 v41, v53, v71
v_fmac_f32 v42, v54, v71
v_fmac_f32 v43, v55, v71
v_fmac_f32 v56, v68, v71
v_fmac_f32 v57, v69, v71
v_fmac_f32 v58, v70, v71
v_rcp_f32 v58, v58
i15 0
i51 v40,v40,v58
i51 v41,v41,v58
i51 v42,v42,v58
i51 v43,v43,v58
i51 v56,v56,v58
i51 v57,v57,v58
i3 v40,v40,v41
i3 v41,v42,v43
i3 v56,v56,v57
ds_write_b32 v15, v40
ds_write_b32 v15, v41 offset:4
i39 exec,s[32:33]
ds_write_b32 v15, v56 offset:32
i39 exec,-1
i20 v15,144,v15
v_xor_b32 v14, 32768, v14
i18 v13,65535,v13
i6 s28,s28,4
s_cmp_lt_u32 s28, 32
i22 La_grp
i8 lgkmcnt(0)
s_barrier
i54 s25,1168
i31 v6,4,v5
i45 v6,v4,s25,v6
i20 v6,143360,v6
i9 v[16:19],v6 offset:0
i9 v[20:23],v6 offset:64
i9 v[24:27],v6 offset:128
i9 v[28:31],v6 offset:192
i9 v[32:35],v6 offset:256
i9 v[36:39],v6 offset:320
i9 v[40:43],v6 offset:384
i9 v[44:47],v6 offset:448
i9 v[48:51],v6 offset:512
i9 v[52:55],v6 offset:576
i9 v[56:59],v6 offset:640
i9 v[60:63],v6 offset:704
i9 v[64:67],v6 offset:768
i9 v[68:71],v6 offset:832
i9 v[72:75],v6 offset:896
i9 v[76:79],v6 offset:960
i9 v[80:83],v6 offset:1024
i9 v[84:87],v6 offset:1088
i8 lgkmcnt(0)
i50 s[36:37],s[0:1],32
s_mul_i32 s31, s21, 9216
i8 lgkmcnt(0)
i5 s38,663552
i5 s39,0x20000
s_barrier
i6 m0,s31,0
i6 s24,s31,0
i1 v0,s[36:39],s24 offen lds
i6 m0,s31,1024
i6 s24,s31,1024
i1 v0,s[36:39],s24 offen lds
i6 m0,s31,2048
i6 s24,s31,2048
i1 v0,s[36:39],s24 offen lds
i6 m0,s31,3072
i6 s24,s31,3072
i1 v0,s[36:39],s24 offen lds
i6 m0,s31,4096
i6 s24,s31,4096
i1 v0,s[36:39],s24 offen lds
i6 m0,s31,5120
i6 s24,s31,5120
i1 v0,s[36:39],s24 offen lds
i6 m0,s31,6144
i6 s24,s31,6144
i1 v0,s[36:39],s24 offen lds
i6 m0,s31,7168
i6 s24,s31,7168
i1 v0,s[36:39],s24 offen lds
i6 m0,s31,8192
i6 s24,s31,8192
i1 v0,s[36:39],s24 offen lds
i6 m0,s31,36864
i6 s24,s31,36864
i1 v0,s[36:39],s24 offen lds
i6 m0,s31,37888
i6 s24,s31,37888
i1 v0,s[36:39],s24 offen lds
i6 m0,s31,38912
i6 s24,s31,38912
i1 v0,s[36:39],s24 offen lds
i6 m0,s31,39936
i6 s24,s31,39936
i1 v0,s[36:39],s24 offen lds
i6 m0,s31,40960
i6 s24,s31,40960
i1 v0,s[36:39],s24 offen lds
i6 m0,s31,41984
i6 s24,s31,41984
i1 v0,s[36:39],s24 offen lds
i6 m0,s31,43008
i6 s24,s31,43008
i1 v0,s[36:39],s24 offen lds
i6 m0,s31,44032
i6 s24,s31,44032
i1 v0,s[36:39],s24 offen lds
i6 m0,s31,45056
i6 s24,s31,45056
i1 v0,s[36:39],s24 offen lds
i8 vmcnt(9)
s_barrier
i0 v[124:125],v2 offset:0
i0 v[126:127],v2 offset:4608
i0 v[128:129],v2 offset:32
i0 v[130:131],v2 offset:4640
i0 v[132:133],v2 offset:64
i0 v[134:135],v2 offset:4672
i0 v[136:137],v2 offset:96
i0 v[138:139],v2 offset:4704
i6 m0,s31,73728
i6 s24,s31,73728
i1 v0,s[36:39],s24 offen lds
i0 v[140:141],v2 offset:128
i0 v[142:143],v2 offset:4736
i8 lgkmcnt(8)
i2 v[88:91],v[124:127],v[16:19],0
i6 m0,s31,74752
i6 s24,s31,74752
i1 v0,s[36:39],s24 offen lds
i0 v[144:145],v2 offset:160
i0 v[146:147],v2 offset:4768
i8 lgkmcnt(8)
i2 v[92:95],v[128:131],v[16:19],0
i6 m0,s31,75776
i6 s24,s31,75776
i1 v0,s[36:39],s24 offen lds
i0 v[148:149],v2 offset:192
i0 v[150:151],v2 offset:4800
i8 lgkmcnt(8)
i2 v[96:99],v[132:135],v[16:19],0
i6 m0,s31,76800
i6 s24,s31,76800
i1 v0,s[36:39],s24 offen lds
i0 v[152:153],v2 offset:224
i0 v[154:155],v2 offset:4832
i8 lgkmcnt(8)
i2 v[100:103],v[136:139],v[16:19],0
i6 m0,s31,77824
i6 s24,s31,77824
i1 v0,s[36:39],s24 offen lds
i0 v[156:157],v2 offset:256
i0 v[158:159],v2 offset:4864
i8 lgkmcnt(8)
i2 v[104:107],v[140:143],v[16:19],0
i6 m0,s31,78848
i6 s24,s31,78848
i1 v0,s[36:39],s24 offen lds
i8 lgkmcnt(6)
i2 v[108:111],v[144:147],v[16:19],0
i6 m0,s31,79872
i6 s24,s31,79872
i1 v0,s[36:39],s24 offen lds
i8 lgkmcnt(4)
i2 v[112:115],v[148:151],v[16:19],0
i6 m0,s31,80896
i6 s24,s31,80896
i1 v0,s[36:39],s24 offen lds
i8 lgkmcnt(2)
i2 v[116:119],v[152:155],v[16:19],0
i6 m0,s31,81920
i6 s24,s31,81920
i1 v0,s[36:39],s24 offen lds
i8 lgkmcnt(0)
i2 v[120:123],v[156:159],v[16:19],0
i8 vmcnt(9)
s_barrier
i0 v[124:125],v2 offset:36864
i0 v[126:127],v2 offset:41472
i0 v[128:129],v2 offset:36896
i0 v[130:131],v2 offset:41504
i0 v[132:133],v2 offset:36928
i0 v[134:135],v2 offset:41536
i0 v[136:137],v2 offset:36960
i0 v[138:139],v2 offset:41568
i6 m0,s31,0
i6 s24,s31,110592
i1 v0,s[36:39],s24 offen lds
i0 v[140:141],v2 offset:36992
i0 v[142:143],v2 offset:41600
i8 lgkmcnt(8)
i2 v[88:91],v[124:127],v[20:23],v[88:91]
i6 m0,s31,1024
i6 s24,s31,111616
i1 v0,s[36:39],s24 offen lds
i0 v[144:145],v2 offset:37024
i0 v[146:147],v2 offset:41632
i8 lgkmcnt(8)
i2 v[92:95],v[128:131],v[20:23],v[92:95]
i6 m0,s31,2048
i6 s24,s31,112640
i1 v0,s[36:39],s24 offen lds
i0 v[148:149],v2 offset:37056
i0 v[150:151],v2 offset:41664
i8 lgkmcnt(8)
i2 v[96:99],v[132:135],v[20:23],v[96:99]
i6 m0,s31,3072
i6 s24,s31,113664
i1 v0,s[36:39],s24 offen lds
i0 v[152:153],v2 offset:37088
i0 v[154:155],v2 offset:41696
i8 lgkmcnt(8)
i2 v[100:103],v[136:139],v[20:23],v[100:103]
i6 m0,s31,4096
i6 s24,s31,114688
i1 v0,s[36:39],s24 offen lds
i0 v[156:157],v2 offset:37120
i0 v[158:159],v2 offset:41728
i8 lgkmcnt(8)
i2 v[104:107],v[140:143],v[20:23],v[104:107]
i6 m0,s31,5120
i6 s24,s31,115712
i1 v0,s[36:39],s24 offen lds
i8 lgkmcnt(6)
i2 v[108:111],v[144:147],v[20:23],v[108:111]
i6 m0,s31,6144
i6 s24,s31,116736
i1 v0,s[36:39],s24 offen lds
i8 lgkmcnt(4)
i2 v[112:115],v[148:151],v[20:23],v[112:115]
i6 m0,s31,7168
i6 s24,s31,117760
i1 v0,s[36:39],s24 offen lds
i8 lgkmcnt(2)
i2 v[116:119],v[152:155],v[20:23],v[116:119]
i6 m0,s31,8192
i6 s24,s31,118784
i1 v0,s[36:39],s24 offen lds
i8 lgkmcnt(0)
i2 v[120:123],v[156:159],v[20:23],v[120:123]
i8 vmcnt(9)
s_barrier
i0 v[124:125],v3 offset:8192
i0 v[126:127],v3 offset:12800
i0 v[128:129],v3 offset:8224
i0 v[130:131],v3 offset:12832
i0 v[132:133],v3 offset:8256
i0 v[134:135],v3 offset:12864
i0 v[136:137],v3 offset:8288
i0 v[138:139],v3 offset:12896
i6 m0,s31,36864
i6 s24,s31,147456
i1 v0,s[36:39],s24 offen lds
i0 v[140:141],v3 offset:8320
i0 v[142:143],v3 offset:12928
i8 lgkmcnt(8)
i2 v[88:91],v[124:127],v[24:27],v[88:91]
i6 m0,s31,37888
i6 s24,s31,148480
i1 v0,s[36:39],s24 offen lds
i0 v[144:145],v3 offset:8352
i0 v[146:147],v3 offset:12960
i8 lgkmcnt(8)
i2 v[92:95],v[128:131],v[24:27],v[92:95]
i6 m0,s31,38912
i6 s24,s31,149504
i1 v0,s[36:39],s24 offen lds
i0 v[148:149],v3 offset:8384
i0 v[150:151],v3 offset:12992
i8 lgkmcnt(8)
i2 v[96:99],v[132:135],v[24:27],v[96:99]
i6 m0,s31,39936
i6 s24,s31,150528
i1 v0,s[36:39],s24 offen lds
i0 v[152:153],v3 offset:8416
i0 v[154:155],v3 offset:13024
i8 lgkmcnt(8)
i2 v[100:103],v[136:139],v[24:27],v[100:103]
i6 m0,s31,40960
i6 s24,s31,151552
i1 v0,s[36:39],s24 offen lds
i0 v[156:157],v3 offset:8448
i0 v[158:159],v3 offset:13056
i8 lgkmcnt(8)
i2 v[104:107],v[140:143],v[24:27],v[104:107]
i6 m0,s31,41984
i6 s24,s31,152576
i1 v0,s[36:39],s24 offen lds
i8 lgkmcnt(6)
i2 v[108:111],v[144:147],v[24:27],v[108:111]
i6 m0,s31,43008
i6 s24,s31,153600
i1 v0,s[36:39],s24 offen lds
i8 lgkmcnt(4)
i2 v[112:115],v[148:151],v[24:27],v[112:115]
i6 m0,s31,44032
i6 s24,s31,154624
i1 v0,s[36:39],s24 offen lds
i8 lgkmcnt(2)
i2 v[116:119],v[152:155],v[24:27],v[116:119]
i6 m0,s31,45056
i6 s24,s31,155648
i1 v0,s[36:39],s24 offen lds
i8 lgkmcnt(0)
i2 v[120:123],v[156:159],v[24:27],v[120:123]
i8 vmcnt(9)
s_barrier
i0 v[124:125],v2 offset:0
i0 v[126:127],v2 offset:4608
i0 v[128:129],v2 offset:32
i0 v[130:131],v2 offset:4640
i0 v[132:133],v2 offset:64
i0 v[134:135],v2 offset:4672
i0 v[136:137],v2 offset:96
i0 v[138:139],v2 offset:4704
i6 m0,s31,73728
i6 s24,s31,184320
i1 v0,s[36:39],s24 offen lds
i0 v[140:141],v2 offset:128
i0 v[142:143],v2 offset:4736
i8 lgkmcnt(8)
i2 v[88:91],v[124:127],v[28:31],v[88:91]
i6 m0,s31,74752
i6 s24,s31,185344
i1 v0,s[36:39],s24 offen lds
i0 v[144:145],v2 offset:160
i0 v[146:147],v2 offset:4768
i8 lgkmcnt(8)
i2 v[92:95],v[128:131],v[28:31],v[92:95]
i6 m0,s31,75776
i6 s24,s31,186368
i1 v0,s[36:39],s24 offen lds
i0 v[148:149],v2 offset:192
i0 v[150:151],v2 offset:4800
i8 lgkmcnt(8)
i2 v[96:99],v[132:135],v[28:31],v[96:99]
i6 m0,s31,76800
i6 s24,s31,187392
i1 v0,s[36:39],s24 offen lds
i0 v[152:153],v2 offset:224
i0 v[154:155],v2 offset:4832
i8 lgkmcnt(8)
i2 v[100:103],v[136:139],v[28:31],v[100:103]
i6 m0,s31,77824
i6 s24,s31,188416
i1 v0,s[36:39],s24 offen lds
i0 v[156:157],v2 offset:256
i0 v[158:159],v2 offset:4864
i8 lgkmcnt(8)
i2 v[104:107],v[140:143],v[28:31],v[104:107]
i6 m0,s31,78848
i6 s24,s31,189440
i1 v0,s[36:39],s24 offen lds
i8 lgkmcnt(6)
i2 v[108:111],v[144:147],v[28:31],v[108:111]
i6 m0,s31,79872
i6 s24,s31,190464
i1 v0,s[36:39],s24 offen lds
i8 lgkmcnt(4)
i2 v[112:115],v[148:151],v[28:31],v[112:115]
i6 m0,s31,80896
i6 s24,s31,191488
i1 v0,s[36:39],s24 offen lds
i8 lgkmcnt(2)
i2 v[116:119],v[152:155],v[28:31],v[116:119]
i6 m0,s31,81920
i6 s24,s31,192512
i1 v0,s[36:39],s24 offen lds
i8 lgkmcnt(0)
i2 v[120:123],v[156:159],v[28:31],v[120:123]
i8 vmcnt(9)
s_barrier
i0 v[124:125],v2 offset:36864
i0 v[126:127],v2 offset:41472
i0 v[128:129],v2 offset:36896
i0 v[130:131],v2 offset:41504
i0 v[132:133],v2 offset:36928
i0 v[134:135],v2 offset:41536
i0 v[136:137],v2 offset:36960
i0 v[138:139],v2 offset:41568
i6 m0,s31,0
i6 s24,s31,221184
i1 v0,s[36:39],s24 offen lds
i0 v[140:141],v2 offset:36992
i0 v[142:143],v2 offset:41600
i8 lgkmcnt(8)
i2 v[88:91],v[124:127],v[32:35],v[88:91]
i6 m0,s31,1024
i6 s24,s31,222208
i1 v0,s[36:39],s24 offen lds
i0 v[144:145],v2 offset:37024
i0 v[146:147],v2 offset:41632
i8 lgkmcnt(8)
i2 v[92:95],v[128:131],v[32:35],v[92:95]
i6 m0,s31,2048
i6 s24,s31,223232
i1 v0,s[36:39],s24 offen lds
i0 v[148:149],v2 offset:37056
i0 v[150:151],v2 offset:41664
i8 lgkmcnt(8)
i2 v[96:99],v[132:135],v[32:35],v[96:99]
i6 m0,s31,3072
i6 s24,s31,224256
i1 v0,s[36:39],s24 offen lds
i0 v[152:153],v2 offset:37088
i0 v[154:155],v2 offset:41696
i8 lgkmcnt(8)
i2 v[100:103],v[136:139],v[32:35],v[100:103]
i6 m0,s31,4096
i6 s24,s31,225280
i1 v0,s[36:39],s24 offen lds
i0 v[156:157],v2 offset:37120
i0 v[158:159],v2 offset:41728
i8 lgkmcnt(8)
i2 v[104:107],v[140:143],v[32:35],v[104:107]
i6 m0,s31,5120
i6 s24,s31,226304
i1 v0,s[36:39],s24 offen lds
i8 lgkmcnt(6)
i2 v[108:111],v[144:147],v[32:35],v[108:111]
i6 m0,s31,6144
i6 s24,s31,227328
i1 v0,s[36:39],s24 offen lds
i8 lgkmcnt(4)
i2 v[112:115],v[148:151],v[32:35],v[112:115]
i6 m0,s31,7168
i6 s24,s31,228352
i1 v0,s[36:39],s24 offen lds
i8 lgkmcnt(2)
i2 v[116:119],v[152:155],v[32:35],v[116:119]
i6 m0,s31,8192
i6 s24,s31,229376
i1 v0,s[36:39],s24 offen lds
i8 lgkmcnt(0)
i2 v[120:123],v[156:159],v[32:35],v[120:123]
i8 vmcnt(9)
s_barrier
i0 v[124:125],v3 offset:8192
i0 v[126:127],v3 offset:12800
i0 v[128:129],v3 offset:8224
i0 v[130:131],v3 offset:12832
i0 v[132:133],v3 offset:8256
i0 v[134:135],v3 offset:12864
i0 v[136:137],v3 offset:8288
i0 v[138:139],v3 offset:12896
i6 m0,s31,36864
i6 s24,s31,258048
i1 v0,s[36:39],s24 offen lds
i0 v[140:141],v3 offset:8320
i0 v[142:143],v3 offset:12928
i8 lgkmcnt(8)
i2 v[88:91],v[124:127],v[36:39],v[88:91]
i6 m0,s31,37888
i6 s24,s31,259072
i1 v0,s[36:39],s24 offen lds
i0 v[144:145],v3 offset:8352
i0 v[146:147],v3 offset:12960
i8 lgkmcnt(8)
i2 v[92:95],v[128:131],v[36:39],v[92:95]
i6 m0,s31,38912
i6 s24,s31,260096
i1 v0,s[36:39],s24 offen lds
i0 v[148:149],v3 offset:8384
i0 v[150:151],v3 offset:12992
i8 lgkmcnt(8)
i2 v[96:99],v[132:135],v[36:39],v[96:99]
i6 m0,s31,39936
i6 s24,s31,261120
i1 v0,s[36:39],s24 offen lds
i0 v[152:153],v3 offset:8416
i0 v[154:155],v3 offset:13024
i8 lgkmcnt(8)
i2 v[100:103],v[136:139],v[36:39],v[100:103]
i6 m0,s31,40960
i6 s24,s31,262144
i1 v0,s[36:39],s24 offen lds
i0 v[156:157],v3 offset:8448
i0 v[158:159],v3 offset:13056
i8 lgkmcnt(8)
i2 v[104:107],v[140:143],v[36:39],v[104:107]
i6 m0,s31,41984
i6 s24,s31,263168
i1 v0,s[36:39],s24 offen lds
i8 lgkmcnt(6)
i2 v[108:111],v[144:147],v[36:39],v[108:111]
i6 m0,s31,43008
i6 s24,s31,264192
i1 v0,s[36:39],s24 offen lds
i8 lgkmcnt(4)
i2 v[112:115],v[148:151],v[36:39],v[112:115]
i6 m0,s31,44032
i6 s24,s31,265216
i1 v0,s[36:39],s24 offen lds
i8 lgkmcnt(2)
i2 v[116:119],v[152:155],v[36:39],v[116:119]
i6 m0,s31,45056
i6 s24,s31,266240
i1 v0,s[36:39],s24 offen lds
i8 lgkmcnt(0)
i2 v[120:123],v[156:159],v[36:39],v[120:123]
i8 vmcnt(9)
s_barrier
i0 v[124:125],v2 offset:0
i0 v[126:127],v2 offset:4608
i0 v[128:129],v2 offset:32
i0 v[130:131],v2 offset:4640
i0 v[132:133],v2 offset:64
i0 v[134:135],v2 offset:4672
i0 v[136:137],v2 offset:96
i0 v[138:139],v2 offset:4704
i6 m0,s31,73728
i6 s24,s31,294912
i1 v0,s[36:39],s24 offen lds
i0 v[140:141],v2 offset:128
i0 v[142:143],v2 offset:4736
i8 lgkmcnt(8)
i2 v[88:91],v[124:127],v[40:43],v[88:91]
i6 m0,s31,74752
i6 s24,s31,295936
i1 v0,s[36:39],s24 offen lds
i0 v[144:145],v2 offset:160
i0 v[146:147],v2 offset:4768
i8 lgkmcnt(8)
i2 v[92:95],v[128:131],v[40:43],v[92:95]
i6 m0,s31,75776
i6 s24,s31,296960
i1 v0,s[36:39],s24 offen lds
i0 v[148:149],v2 offset:192
i0 v[150:151],v2 offset:4800
i8 lgkmcnt(8)
i2 v[96:99],v[132:135],v[40:43],v[96:99]
i6 m0,s31,76800
i6 s24,s31,297984
i1 v0,s[36:39],s24 offen lds
i0 v[152:153],v2 offset:224
i0 v[154:155],v2 offset:4832
i8 lgkmcnt(8)
i2 v[100:103],v[136:139],v[40:43],v[100:103]
i6 m0,s31,77824
i6 s24,s31,299008
i1 v0,s[36:39],s24 offen lds
i0 v[156:157],v2 offset:256
i0 v[158:159],v2 offset:4864
i8 lgkmcnt(8)
i2 v[104:107],v[140:143],v[40:43],v[104:107]
i6 m0,s31,78848
i6 s24,s31,300032
i1 v0,s[36:39],s24 offen lds
i8 lgkmcnt(6)
i2 v[108:111],v[144:147],v[40:43],v[108:111]
i6 m0,s31,79872
i6 s24,s31,301056
i1 v0,s[36:39],s24 offen lds
i8 lgkmcnt(4)
i2 v[112:115],v[148:151],v[40:43],v[112:115]
i6 m0,s31,80896
i6 s24,s31,302080
i1 v0,s[36:39],s24 offen lds
i8 lgkmcnt(2)
i2 v[116:119],v[152:155],v[40:43],v[116:119]
i6 m0,s31,81920
i6 s24,s31,303104
i1 v0,s[36:39],s24 offen lds
i8 lgkmcnt(0)
i2 v[120:123],v[156:159],v[40:43],v[120:123]
i8 vmcnt(9)
s_barrier
i0 v[124:125],v2 offset:36864
i0 v[126:127],v2 offset:41472
i0 v[128:129],v2 offset:36896
i0 v[130:131],v2 offset:41504
i0 v[132:133],v2 offset:36928
i0 v[134:135],v2 offset:41536
i0 v[136:137],v2 offset:36960
i0 v[138:139],v2 offset:41568
i6 m0,s31,0
i6 s24,s31,331776
i1 v0,s[36:39],s24 offen lds
i0 v[140:141],v2 offset:36992
i0 v[142:143],v2 offset:41600
i8 lgkmcnt(8)
i2 v[88:91],v[124:127],v[44:47],v[88:91]
i6 m0,s31,1024
i6 s24,s31,332800
i1 v0,s[36:39],s24 offen lds
i0 v[144:145],v2 offset:37024
i0 v[146:147],v2 offset:41632
i8 lgkmcnt(8)
i2 v[92:95],v[128:131],v[44:47],v[92:95]
i6 m0,s31,2048
i6 s24,s31,333824
i1 v0,s[36:39],s24 offen lds
i0 v[148:149],v2 offset:37056
i0 v[150:151],v2 offset:41664
i8 lgkmcnt(8)
i2 v[96:99],v[132:135],v[44:47],v[96:99]
i6 m0,s31,3072
i6 s24,s31,334848
i1 v0,s[36:39],s24 offen lds
i0 v[152:153],v2 offset:37088
i0 v[154:155],v2 offset:41696
i8 lgkmcnt(8)
i2 v[100:103],v[136:139],v[44:47],v[100:103]
i6 m0,s31,4096
i6 s24,s31,335872
i1 v0,s[36:39],s24 offen lds
i0 v[156:157],v2 offset:37120
i0 v[158:159],v2 offset:41728
i8 lgkmcnt(8)
i2 v[104:107],v[140:143],v[44:47],v[104:107]
i6 m0,s31,5120
i6 s24,s31,336896
i1 v0,s[36:39],s24 offen lds
i8 lgkmcnt(6)
i2 v[108:111],v[144:147],v[44:47],v[108:111]
i6 m0,s31,6144
i6 s24,s31,337920
i1 v0,s[36:39],s24 offen lds
i8 lgkmcnt(4)
i2 v[112:115],v[148:151],v[44:47],v[112:115]
i6 m0,s31,7168
i6 s24,s31,338944
i1 v0,s[36:39],s24 offen lds
i8 lgkmcnt(2)
i2 v[116:119],v[152:155],v[44:47],v[116:119]
i6 m0,s31,8192
i6 s24,s31,339968
i1 v0,s[36:39],s24 offen lds
i8 lgkmcnt(0)
i2 v[120:123],v[156:159],v[44:47],v[120:123]
i8 vmcnt(9)
s_barrier
i0 v[124:125],v3 offset:8192
i0 v[126:127],v3 offset:12800
i0 v[128:129],v3 offset:8224
i0 v[130:131],v3 offset:12832
i0 v[132:133],v3 offset:8256
i0 v[134:135],v3 offset:12864
i0 v[136:137],v3 offset:8288
i0 v[138:139],v3 offset:12896
i6 m0,s31,36864
i6 s24,s31,368640
i1 v0,s[36:39],s24 offen lds
i0 v[140:141],v3 offset:8320
i0 v[142:143],v3 offset:12928
i8 lgkmcnt(8)
i2 v[88:91],v[124:127],v[48:51],v[88:91]
i6 m0,s31,37888
i6 s24,s31,369664
i1 v0,s[36:39],s24 offen lds
i0 v[144:145],v3 offset:8352
i0 v[146:147],v3 offset:12960
i8 lgkmcnt(8)
i2 v[92:95],v[128:131],v[48:51],v[92:95]
i6 m0,s31,38912
i6 s24,s31,370688
i1 v0,s[36:39],s24 offen lds
i0 v[148:149],v3 offset:8384
i0 v[150:151],v3 offset:12992
i8 lgkmcnt(8)
i2 v[96:99],v[132:135],v[48:51],v[96:99]
i6 m0,s31,39936
i6 s24,s31,371712
i1 v0,s[36:39],s24 offen lds
i0 v[152:153],v3 offset:8416
i0 v[154:155],v3 offset:13024
i8 lgkmcnt(8)
i2 v[100:103],v[136:139],v[48:51],v[100:103]
i6 m0,s31,40960
i6 s24,s31,372736
i1 v0,s[36:39],s24 offen lds
i0 v[156:157],v3 offset:8448
i0 v[158:159],v3 offset:13056
i8 lgkmcnt(8)
i2 v[104:107],v[140:143],v[48:51],v[104:107]
i6 m0,s31,41984
i6 s24,s31,373760
i1 v0,s[36:39],s24 offen lds
i8 lgkmcnt(6)
i2 v[108:111],v[144:147],v[48:51],v[108:111]
i6 m0,s31,43008
i6 s24,s31,374784
i1 v0,s[36:39],s24 offen lds
i8 lgkmcnt(4)
i2 v[112:115],v[148:151],v[48:51],v[112:115]
i6 m0,s31,44032
i6 s24,s31,375808
i1 v0,s[36:39],s24 offen lds
i8 lgkmcnt(2)
i2 v[116:119],v[152:155],v[48:51],v[116:119]
i6 m0,s31,45056
i6 s24,s31,376832
i1 v0,s[36:39],s24 offen lds
i8 lgkmcnt(0)
i2 v[120:123],v[156:159],v[48:51],v[120:123]
i8 vmcnt(9)
s_barrier
i0 v[124:125],v2 offset:0
i0 v[126:127],v2 offset:4608
i0 v[128:129],v2 offset:32
i0 v[130:131],v2 offset:4640
i0 v[132:133],v2 offset:64
i0 v[134:135],v2 offset:4672
i0 v[136:137],v2 offset:96
i0 v[138:139],v2 offset:4704
i6 m0,s31,73728
i6 s24,s31,405504
i1 v0,s[36:39],s24 offen lds
i0 v[140:141],v2 offset:128
i0 v[142:143],v2 offset:4736
i8 lgkmcnt(8)
i2 v[88:91],v[124:127],v[52:55],v[88:91]
i6 m0,s31,74752
i6 s24,s31,406528
i1 v0,s[36:39],s24 offen lds
i0 v[144:145],v2 offset:160
i0 v[146:147],v2 offset:4768
i8 lgkmcnt(8)
i2 v[92:95],v[128:131],v[52:55],v[92:95]
i6 m0,s31,75776
i6 s24,s31,407552
i1 v0,s[36:39],s24 offen lds
i0 v[148:149],v2 offset:192
i0 v[150:151],v2 offset:4800
i8 lgkmcnt(8)
i2 v[96:99],v[132:135],v[52:55],v[96:99]
i6 m0,s31,76800
i6 s24,s31,408576
i1 v0,s[36:39],s24 offen lds
i0 v[152:153],v2 offset:224
i0 v[154:155],v2 offset:4832
i8 lgkmcnt(8)
i2 v[100:103],v[136:139],v[52:55],v[100:103]
i6 m0,s31,77824
i6 s24,s31,409600
i1 v0,s[36:39],s24 offen lds
i0 v[156:157],v2 offset:256
i0 v[158:159],v2 offset:4864
i8 lgkmcnt(8)
i2 v[104:107],v[140:143],v[52:55],v[104:107]
i6 m0,s31,78848
i6 s24,s31,410624
i1 v0,s[36:39],s24 offen lds
i8 lgkmcnt(6)
i2 v[108:111],v[144:147],v[52:55],v[108:111]
i6 m0,s31,79872
i6 s24,s31,411648
i1 v0,s[36:39],s24 offen lds
i8 lgkmcnt(4)
i2 v[112:115],v[148:151],v[52:55],v[112:115]
i6 m0,s31,80896
i6 s24,s31,412672
i1 v0,s[36:39],s24 offen lds
i8 lgkmcnt(2)
i2 v[116:119],v[152:155],v[52:55],v[116:119]
i6 m0,s31,81920
i6 s24,s31,413696
i1 v0,s[36:39],s24 offen lds
i8 lgkmcnt(0)
i2 v[120:123],v[156:159],v[52:55],v[120:123]
i8 vmcnt(9)
s_barrier
i0 v[124:125],v2 offset:36864
i0 v[126:127],v2 offset:41472
i0 v[128:129],v2 offset:36896
i0 v[130:131],v2 offset:41504
i0 v[132:133],v2 offset:36928
i0 v[134:135],v2 offset:41536
i0 v[136:137],v2 offset:36960
i0 v[138:139],v2 offset:41568
i6 m0,s31,0
i6 s24,s31,442368
i1 v0,s[36:39],s24 offen lds
i0 v[140:141],v2 offset:36992
i0 v[142:143],v2 offset:41600
i8 lgkmcnt(8)
i2 v[88:91],v[124:127],v[56:59],v[88:91]
i6 m0,s31,1024
i6 s24,s31,443392
i1 v0,s[36:39],s24 offen lds
i0 v[144:145],v2 offset:37024
i0 v[146:147],v2 offset:41632
i8 lgkmcnt(8)
i2 v[92:95],v[128:131],v[56:59],v[92:95]
i6 m0,s31,2048
i6 s24,s31,444416
i1 v0,s[36:39],s24 offen lds
i0 v[148:149],v2 offset:37056
i0 v[150:151],v2 offset:41664
i8 lgkmcnt(8)
i2 v[96:99],v[132:135],v[56:59],v[96:99]
i6 m0,s31,3072
i6 s24,s31,445440
i1 v0,s[36:39],s24 offen lds
i0 v[152:153],v2 offset:37088
i0 v[154:155],v2 offset:41696
i8 lgkmcnt(8)
i2 v[100:103],v[136:139],v[56:59],v[100:103]
i6 m0,s31,4096
i6 s24,s31,446464
i1 v0,s[36:39],s24 offen lds
i0 v[156:157],v2 offset:37120
i0 v[158:159],v2 offset:41728
i8 lgkmcnt(8)
i2 v[104:107],v[140:143],v[56:59],v[104:107]
i6 m0,s31,5120
i6 s24,s31,447488
i1 v0,s[36:39],s24 offen lds
i8 lgkmcnt(6)
i2 v[108:111],v[144:147],v[56:59],v[108:111]
i6 m0,s31,6144
i6 s24,s31,448512
i1 v0,s[36:39],s24 offen lds
i8 lgkmcnt(4)
i2 v[112:115],v[148:151],v[56:59],v[112:115]
i6 m0,s31,7168
i6 s24,s31,449536
i1 v0,s[36:39],s24 offen lds
i8 lgkmcnt(2)
i2 v[116:119],v[152:155],v[56:59],v[116:119]
i6 m0,s31,8192
i6 s24,s31,450560
i1 v0,s[36:39],s24 offen lds
i8 lgkmcnt(0)
i2 v[120:123],v[156:159],v[56:59],v[120:123]
i8 vmcnt(9)
s_barrier
i0 v[124:125],v3 offset:8192
i0 v[126:127],v3 offset:12800
i0 v[128:129],v3 offset:8224
i0 v[130:131],v3 offset:12832
i0 v[132:133],v3 offset:8256
i0 v[134:135],v3 offset:12864
i0 v[136:137],v3 offset:8288
i0 v[138:139],v3 offset:12896
i6 m0,s31,36864
i6 s24,s31,479232
i1 v0,s[36:39],s24 offen lds
i0 v[140:141],v3 offset:8320
i0 v[142:143],v3 offset:12928
i8 lgkmcnt(8)
i2 v[88:91],v[124:127],v[60:63],v[88:91]
i6 m0,s31,37888
i6 s24,s31,480256
i1 v0,s[36:39],s24 offen lds
i0 v[144:145],v3 offset:8352
i0 v[146:147],v3 offset:12960
i8 lgkmcnt(8)
i2 v[92:95],v[128:131],v[60:63],v[92:95]
i6 m0,s31,38912
i6 s24,s31,481280
i1 v0,s[36:39],s24 offen lds
i0 v[148:149],v3 offset:8384
i0 v[150:151],v3 offset:12992
i8 lgkmcnt(8)
i2 v[96:99],v[132:135],v[60:63],v[96:99]
i6 m0,s31,39936
i6 s24,s31,482304
i1 v0,s[36:39],s24 offen lds
i0 v[152:153],v3 offset:8416
i0 v[154:155],v3 offset:13024
i8 lgkmcnt(8)
i2 v[100:103],v[136:139],v[60:63],v[100:103]
i6 m0,s31,40960
i6 s24,s31,483328
i1 v0,s[36:39],s24 offen lds
i0 v[156:157],v3 offset:8448
i0 v[158:159],v3 offset:13056
i8 lgkmcnt(8)
i2 v[104:107],v[140:143],v[60:63],v[104:107]
i6 m0,s31,41984
i6 s24,s31,484352
i1 v0,s[36:39],s24 offen lds
i8 lgkmcnt(6)
i2 v[108:111],v[144:147],v[60:63],v[108:111]
i6 m0,s31,43008
i6 s24,s31,485376
i1 v0,s[36:39],s24 offen lds
i8 lgkmcnt(4)
i2 v[112:115],v[148:151],v[60:63],v[112:115]
i6 m0,s31,44032
i6 s24,s31,486400
i1 v0,s[36:39],s24 offen lds
i8 lgkmcnt(2)
i2 v[116:119],v[152:155],v[60:63],v[116:119]
i6 m0,s31,45056
i6 s24,s31,487424
i1 v0,s[36:39],s24 offen lds
i8 lgkmcnt(0)
i2 v[120:123],v[156:159],v[60:63],v[120:123]
i8 vmcnt(9)
s_barrier
i0 v[124:125],v2 offset:0
i0 v[126:127],v2 offset:4608
i0 v[128:129],v2 offset:32
i0 v[130:131],v2 offset:4640
i0 v[132:133],v2 offset:64
i0 v[134:135],v2 offset:4672
i0 v[136:137],v2 offset:96
i0 v[138:139],v2 offset:4704
i6 m0,s31,73728
i6 s24,s31,516096
i1 v0,s[36:39],s24 offen lds
i0 v[140:141],v2 offset:128
i0 v[142:143],v2 offset:4736
i8 lgkmcnt(8)
i2 v[88:91],v[124:127],v[64:67],v[88:91]
i6 m0,s31,74752
i6 s24,s31,517120
i1 v0,s[36:39],s24 offen lds
i0 v[144:145],v2 offset:160
i0 v[146:147],v2 offset:4768
i8 lgkmcnt(8)
i2 v[92:95],v[128:131],v[64:67],v[92:95]
i6 m0,s31,75776
i6 s24,s31,518144
i1 v0,s[36:39],s24 offen lds
i0 v[148:149],v2 offset:192
i0 v[150:151],v2 offset:4800
i8 lgkmcnt(8)
i2 v[96:99],v[132:135],v[64:67],v[96:99]
i6 m0,s31,76800
i6 s24,s31,519168
i1 v0,s[36:39],s24 offen lds
i0 v[152:153],v2 offset:224
i0 v[154:155],v2 offset:4832
i8 lgkmcnt(8)
i2 v[100:103],v[136:139],v[64:67],v[100:103]
i6 m0,s31,77824
i6 s24,s31,520192
i1 v0,s[36:39],s24 offen lds
i0 v[156:157],v2 offset:256
i0 v[158:159],v2 offset:4864
i8 lgkmcnt(8)
i2 v[104:107],v[140:143],v[64:67],v[104:107]
i6 m0,s31,78848
i6 s24,s31,521216
i1 v0,s[36:39],s24 offen lds
i8 lgkmcnt(6)
i2 v[108:111],v[144:147],v[64:67],v[108:111]
i6 m0,s31,79872
i6 s24,s31,522240
i1 v0,s[36:39],s24 offen lds
i8 lgkmcnt(4)
i2 v[112:115],v[148:151],v[64:67],v[112:115]
i6 m0,s31,80896
i6 s24,s31,523264
i1 v0,s[36:39],s24 offen lds
i8 lgkmcnt(2)
i2 v[116:119],v[152:155],v[64:67],v[116:119]
i6 m0,s31,81920
i6 s24,s31,524288
i1 v0,s[36:39],s24 offen lds
i8 lgkmcnt(0)
i2 v[120:123],v[156:159],v[64:67],v[120:123]
i8 vmcnt(9)
s_barrier
i0 v[124:125],v2 offset:36864
i0 v[126:127],v2 offset:41472
i0 v[128:129],v2 offset:36896
i0 v[130:131],v2 offset:41504
i0 v[132:133],v2 offset:36928
i0 v[134:135],v2 offset:41536
i0 v[136:137],v2 offset:36960
i0 v[138:139],v2 offset:41568
i6 m0,s31,0
i6 s24,s31,552960
i1 v0,s[36:39],s24 offen lds
i0 v[140:141],v2 offset:36992
i0 v[142:143],v2 offset:41600
i8 lgkmcnt(8)
i2 v[88:91],v[124:127],v[68:71],v[88:91]
i6 m0,s31,1024
i6 s24,s31,553984
i1 v0,s[36:39],s24 offen lds
i0 v[144:145],v2 offset:37024
i0 v[146:147],v2 offset:41632
i8 lgkmcnt(8)
i2 v[92:95],v[128:131],v[68:71],v[92:95]
i6 m0,s31,2048
i6 s24,s31,555008
i1 v0,s[36:39],s24 offen lds
i0 v[148:149],v2 offset:37056
i0 v[150:151],v2 offset:41664
i8 lgkmcnt(8)
i2 v[96:99],v[132:135],v[68:71],v[96:99]
i6 m0,s31,3072
i6 s24,s31,556032
i1 v0,s[36:39],s24 offen lds
i0 v[152:153],v2 offset:37088
i0 v[154:155],v2 offset:41696
i8 lgkmcnt(8)
i2 v[100:103],v[136:139],v[68:71],v[100:103]
i6 m0,s31,4096
i6 s24,s31,557056
i1 v0,s[36:39],s24 offen lds
i0 v[156:157],v2 offset:37120
i0 v[158:159],v2 offset:41728
i8 lgkmcnt(8)
i2 v[104:107],v[140:143],v[68:71],v[104:107]
i6 m0,s31,5120
i6 s24,s31,558080
i1 v0,s[36:39],s24 offen lds
i8 lgkmcnt(6)
i2 v[108:111],v[144:147],v[68:71],v[108:111]
i6 m0,s31,6144
i6 s24,s31,559104
i1 v0,s[36:39],s24 offen lds
i8 lgkmcnt(4)
i2 v[112:115],v[148:151],v[68:71],v[112:115]
i6 m0,s31,7168
i6 s24,s31,560128
i1 v0,s[36:39],s24 offen lds
i8 lgkmcnt(2)
i2 v[116:119],v[152:155],v[68:71],v[116:119]
i6 m0,s31,8192
i6 s24,s31,561152
i1 v0,s[36:39],s24 offen lds
i8 lgkmcnt(0)
i2 v[120:123],v[156:159],v[68:71],v[120:123]
i8 vmcnt(9)
s_barrier
i0 v[124:125],v3 offset:8192
i0 v[126:127],v3 offset:12800
i0 v[128:129],v3 offset:8224
i0 v[130:131],v3 offset:12832
i0 v[132:133],v3 offset:8256
i0 v[134:135],v3 offset:12864
i0 v[136:137],v3 offset:8288
i0 v[138:139],v3 offset:12896
i6 m0,s31,36864
i6 s24,s31,589824
i1 v0,s[36:39],s24 offen lds
i0 v[140:141],v3 offset:8320
i0 v[142:143],v3 offset:12928
i8 lgkmcnt(8)
i2 v[88:91],v[124:127],v[72:75],v[88:91]
i6 m0,s31,37888
i6 s24,s31,590848
i1 v0,s[36:39],s24 offen lds
i0 v[144:145],v3 offset:8352
i0 v[146:147],v3 offset:12960
i8 lgkmcnt(8)
i2 v[92:95],v[128:131],v[72:75],v[92:95]
i6 m0,s31,38912
i6 s24,s31,591872
i1 v0,s[36:39],s24 offen lds
i0 v[148:149],v3 offset:8384
i0 v[150:151],v3 offset:12992
i8 lgkmcnt(8)
i2 v[96:99],v[132:135],v[72:75],v[96:99]
i6 m0,s31,39936
i6 s24,s31,592896
i1 v0,s[36:39],s24 offen lds
i0 v[152:153],v3 offset:8416
i0 v[154:155],v3 offset:13024
i8 lgkmcnt(8)
i2 v[100:103],v[136:139],v[72:75],v[100:103]
i6 m0,s31,40960
i6 s24,s31,593920
i1 v0,s[36:39],s24 offen lds
i0 v[156:157],v3 offset:8448
i0 v[158:159],v3 offset:13056
i8 lgkmcnt(8)
i2 v[104:107],v[140:143],v[72:75],v[104:107]
i6 m0,s31,41984
i6 s24,s31,594944
i1 v0,s[36:39],s24 offen lds
i8 lgkmcnt(6)
i2 v[108:111],v[144:147],v[72:75],v[108:111]
i6 m0,s31,43008
i6 s24,s31,595968
i1 v0,s[36:39],s24 offen lds
i8 lgkmcnt(4)
i2 v[112:115],v[148:151],v[72:75],v[112:115]
i6 m0,s31,44032
i6 s24,s31,596992
i1 v0,s[36:39],s24 offen lds
i8 lgkmcnt(2)
i2 v[116:119],v[152:155],v[72:75],v[116:119]
i6 m0,s31,45056
i6 s24,s31,598016
i1 v0,s[36:39],s24 offen lds
i8 lgkmcnt(0)
i2 v[120:123],v[156:159],v[72:75],v[120:123]
i8 vmcnt(9)
s_barrier
i0 v[124:125],v2 offset:0
i0 v[126:127],v2 offset:4608
i0 v[128:129],v2 offset:32
i0 v[130:131],v2 offset:4640
i0 v[132:133],v2 offset:64
i0 v[134:135],v2 offset:4672
i0 v[136:137],v2 offset:96
i0 v[138:139],v2 offset:4704
i6 m0,s31,73728
i6 s24,s31,626688
i1 v0,s[36:39],s24 offen lds
i0 v[140:141],v2 offset:128
i0 v[142:143],v2 offset:4736
i8 lgkmcnt(8)
i2 v[88:91],v[124:127],v[76:79],v[88:91]
i6 m0,s31,74752
i6 s24,s31,627712
i1 v0,s[36:39],s24 offen lds
i0 v[144:145],v2 offset:160
i0 v[146:147],v2 offset:4768
i8 lgkmcnt(8)
i2 v[92:95],v[128:131],v[76:79],v[92:95]
i6 m0,s31,75776
i6 s24,s31,628736
i1 v0,s[36:39],s24 offen lds
i0 v[148:149],v2 offset:192
i0 v[150:151],v2 offset:4800
i8 lgkmcnt(8)
i2 v[96:99],v[132:135],v[76:79],v[96:99]
i6 m0,s31,76800
i6 s24,s31,629760
i1 v0,s[36:39],s24 offen lds
i0 v[152:153],v2 offset:224
i0 v[154:155],v2 offset:4832
i8 lgkmcnt(8)
i2 v[100:103],v[136:139],v[76:79],v[100:103]
i6 m0,s31,77824
i6 s24,s31,630784
i1 v0,s[36:39],s24 offen lds
i0 v[156:157],v2 offset:256
i0 v[158:159],v2 offset:4864
i8 lgkmcnt(8)
i2 v[104:107],v[140:143],v[76:79],v[104:107]
i6 m0,s31,78848
i6 s24,s31,631808
i1 v0,s[36:39],s24 offen lds
i8 lgkmcnt(6)
i2 v[108:111],v[144:147],v[76:79],v[108:111]
i6 m0,s31,79872
i6 s24,s31,632832
i1 v0,s[36:39],s24 offen lds
i8 lgkmcnt(4)
i2 v[112:115],v[148:151],v[76:79],v[112:115]
i6 m0,s31,80896
i6 s24,s31,633856
i1 v0,s[36:39],s24 offen lds
i8 lgkmcnt(2)
i2 v[116:119],v[152:155],v[76:79],v[116:119]
i6 m0,s31,81920
i6 s24,s31,634880
i1 v0,s[36:39],s24 offen lds
i8 lgkmcnt(0)
i2 v[120:123],v[156:159],v[76:79],v[120:123]
i8 vmcnt(9)
s_barrier
i0 v[124:125],v2 offset:36864
i0 v[126:127],v2 offset:41472
i0 v[128:129],v2 offset:36896
i0 v[130:131],v2 offset:41504
i0 v[132:133],v2 offset:36928
i0 v[134:135],v2 offset:41536
i0 v[136:137],v2 offset:36960
i0 v[138:139],v2 offset:41568
i0 v[140:141],v2 offset:36992
i0 v[142:143],v2 offset:41600
i8 lgkmcnt(8)
i2 v[88:91],v[124:127],v[80:83],v[88:91]
i0 v[144:145],v2 offset:37024
i0 v[146:147],v2 offset:41632
i8 lgkmcnt(8)
i2 v[92:95],v[128:131],v[80:83],v[92:95]
i0 v[148:149],v2 offset:37056
i0 v[150:151],v2 offset:41664
i8 lgkmcnt(8)
i2 v[96:99],v[132:135],v[80:83],v[96:99]
i0 v[152:153],v2 offset:37088
i0 v[154:155],v2 offset:41696
i8 lgkmcnt(8)
i2 v[100:103],v[136:139],v[80:83],v[100:103]
i0 v[156:157],v2 offset:37120
i0 v[158:159],v2 offset:41728
i8 lgkmcnt(8)
i2 v[104:107],v[140:143],v[80:83],v[104:107]
i8 lgkmcnt(6)
i2 v[108:111],v[144:147],v[80:83],v[108:111]
i8 lgkmcnt(4)
i2 v[112:115],v[148:151],v[80:83],v[112:115]
i8 lgkmcnt(2)
i2 v[116:119],v[152:155],v[80:83],v[116:119]
i8 lgkmcnt(0)
i2 v[120:123],v[156:159],v[80:83],v[120:123]
i8 vmcnt(0)
s_barrier
i0 v[124:125],v3 offset:8192
i0 v[126:127],v3 offset:12800
i0 v[128:129],v3 offset:8224
i0 v[130:131],v3 offset:12832
i0 v[132:133],v3 offset:8256
i0 v[134:135],v3 offset:12864
i0 v[136:137],v3 offset:8288
i0 v[138:139],v3 offset:12896
i0 v[140:141],v3 offset:8320
i0 v[142:143],v3 offset:12928
i8 lgkmcnt(8)
i2 v[88:91],v[124:127],v[84:87],v[88:91]
i0 v[144:145],v3 offset:8352
i0 v[146:147],v3 offset:12960
i8 lgkmcnt(8)
i2 v[92:95],v[128:131],v[84:87],v[92:95]
i0 v[148:149],v3 offset:8384
i0 v[150:151],v3 offset:12992
i8 lgkmcnt(8)
i2 v[96:99],v[132:135],v[84:87],v[96:99]
i0 v[152:153],v3 offset:8416
i0 v[154:155],v3 offset:13024
i8 lgkmcnt(8)
i2 v[100:103],v[136:139],v[84:87],v[100:103]
i0 v[156:157],v3 offset:8448
i0 v[158:159],v3 offset:13056
i8 lgkmcnt(8)
i2 v[104:107],v[140:143],v[84:87],v[104:107]
i8 lgkmcnt(6)
i2 v[108:111],v[144:147],v[84:87],v[108:111]
i8 lgkmcnt(4)
i2 v[112:115],v[148:151],v[84:87],v[112:115]
i8 lgkmcnt(2)
i2 v[116:119],v[152:155],v[84:87],v[116:119]
i8 lgkmcnt(0)
i2 v[120:123],v[156:159],v[84:87],v[120:123]
i54 s25,2304
i31 v6,3,v5
i45 v6,v4,s25,v6
s_mul_i32 s24, s22, 36864
s_mul_i32 s25, s21, 288
i6 s24,s24,s25
i3 v88,v88,v89
i3 v89,v90,v91
i41 v[88:89],v6,s[44:47],s24 offen offset:0
i3 v92,v92,v93
i3 v93,v94,v95
i41 v[92:93],v6,s[44:47],s24 offen offset:32
i3 v96,v96,v97
i3 v97,v98,v99
i41 v[96:97],v6,s[44:47],s24 offen offset:64
i3 v100,v100,v101
i3 v101,v102,v103
i41 v[100:101],v6,s[44:47],s24 offen offset:96
i3 v104,v104,v105
i3 v105,v106,v107
i41 v[104:105],v6,s[44:47],s24 offen offset:128
i3 v108,v108,v109
i3 v109,v110,v111
i41 v[108:109],v6,s[44:47],s24 offen offset:160
i3 v112,v112,v113
i3 v113,v114,v115
i41 v[112:113],v6,s[44:47],s24 offen offset:192
i3 v116,v116,v117
i3 v117,v118,v119
i41 v[116:117],v6,s[44:47],s24 offen offset:224
i3 v120,v120,v121
i3 v121,v122,v123
i41 v[120:121],v6,s[44:47],s24 offen offset:256
i8 vmcnt(0)
i44 La_fin
La_p1:
i39 s[50:51],0
i2 v[40:43],a[0:3],v[16:19],0
i2 v[44:47],a[4:7],v[16:19],0
i2 v[48:51],a[8:11],v[16:19],0
i2 v[52:55],a[12:15],v[16:19],0
i38 v28,v40,v41,v42
v_max_f32 v28, v28, v43
i2 v[56:59],a[16:19],v[16:19],0
i38 v29,v44,v45,v46
v_max_f32 v29, v29, v47
i2 v[60:63],a[20:23],v[16:19],0
i38 v28,v28,v48,v49
i38 v28,v28,v50,v51
i2 v[64:67],a[24:27],v[16:19],0
i38 v29,v29,v52,v53
i38 v29,v29,v54,v55
i2 v[68:71],a[28:31],v[16:19],0
i38 v28,v28,v56,v57
i38 v28,v28,v58,v59
i2 v[40:43],a[32:35],v[16:19],0
i38 v29,v29,v60,v61
i38 v29,v29,v62,v63
i2 v[44:47],a[36:39],v[16:19],0
i38 v28,v28,v64,v65
i38 v28,v28,v66,v67
i2 v[48:51],a[40:43],v[16:19],0
i38 v29,v29,v68,v69
i38 v29,v29,v70,v71
i2 v[52:55],a[44:47],v[16:19],0
i38 v28,v28,v40,v41
i38 v28,v28,v42,v43
i2 v[56:59],a[48:51],v[16:19],0
i38 v29,v29,v44,v45
i38 v29,v29,v46,v47
i2 v[60:63],a[52:55],v[16:19],0
i38 v28,v28,v48,v49
i38 v28,v28,v50,v51
i2 v[64:67],a[56:59],v[16:19],0
i38 v29,v29,v52,v53
i38 v29,v29,v54,v55
i2 v[68:71],a[60:63],v[16:19],0
i38 v28,v28,v56,v57
i38 v28,v28,v58,v59
i2 v[40:43],a[64:67],v[16:19],0
i38 v29,v29,v60,v61
i38 v29,v29,v62,v63
i2 v[44:47],a[68:71],v[16:19],0
i38 v28,v28,v64,v65
i38 v28,v28,v66,v67
i2 v[48:51],a[72:75],v[16:19],0
i38 v29,v29,v68,v69
i38 v29,v29,v70,v71
i2 v[52:55],a[76:79],v[16:19],0
i38 v28,v28,v40,v41
i38 v28,v28,v42,v43
i2 v[56:59],a[80:83],v[16:19],0
i38 v29,v29,v44,v45
i38 v29,v29,v46,v47
i2 v[60:63],a[84:87],v[16:19],0
i38 v28,v28,v48,v49
i38 v28,v28,v50,v51
i2 v[64:67],a[88:91],v[16:19],0
i38 v29,v29,v52,v53
i38 v29,v29,v54,v55
i2 v[68:71],a[92:95],v[16:19],0
i38 v28,v28,v56,v57
i38 v28,v28,v58,v59
i2 v[40:43],a[96:99],v[16:19],0
i38 v29,v29,v60,v61
i38 v29,v29,v62,v63
i2 v[44:47],a[100:103],v[16:19],0
i38 v28,v28,v64,v65
i38 v28,v28,v66,v67
i2 v[48:51],a[104:107],v[16:19],0
i38 v29,v29,v68,v69
i38 v29,v29,v70,v71
i2 v[52:55],a[108:111],v[16:19],0
i38 v28,v28,v40,v41
i38 v28,v28,v42,v43
i2 v[56:59],a[112:115],v[16:19],0
i38 v29,v29,v44,v45
i38 v29,v29,v46,v47
i2 v[60:63],a[116:119],v[16:19],0
i38 v28,v28,v48,v49
i38 v28,v28,v50,v51
i2 v[64:67],a[120:123],v[16:19],0
i38 v29,v29,v52,v53
i38 v29,v29,v54,v55
i2 v[68:71],a[124:127],v[16:19],0
i38 v28,v28,v56,v57
i38 v28,v28,v58,v59
i38 v29,v29,v60,v61
i38 v29,v29,v62,v63
i38 v28,v28,v64,v65
i38 v28,v28,v66,v67
i15 1
i38 v29,v29,v68,v69
i38 v29,v29,v70,v71
v_max_f32 v28, v28, v29
i11 v29,v28
i15 1
v_permlane16_swap_b32 v28, v29
v_max_f32 v28, v28, v29
i11 v29,v28
i15 1
i40 v28,v29
v_max_f32 v28, v28, v29
i3 v28,-v28,0
i26 v19,0,v28,s[32:33]
i31 v28,16,v28
i44 La_p2
La_fin:
L_end:
s_endpgm
L_x:
s_sub_u32 s19, s98, 1
i47 s21,0
i22 L_xw0
i47 s21,1
i22 L_xw1
i47 s21,2
i22 L_xw2
L_xw3:
i23 v79,4,v0
i23 v20,2,v79
i18 v21,3,v79
i31 v21,4,v21
i17 v78,v20,13,v21
i32 s24,s20,8
i6 s24,s24,192
i20 v78,s24,v78
i54 s25,1152
s_mul_i32 s24, s20, 147456
i23 v20,1,v79
i18 v21,1,v79
i31 v21,4,v21
i45 v77,v20,s25,v21
i20 v77,s24,v77
i23 v22,4,v79
i34 v23,v79,2,2
i18 v24,3,v79
i17 v20,v22,3,v23
i31 v20,6,v20
i20 v20,114688,v20
i17 v75,v24,3,v20
i23 v21,1,v24
i17 v20,v21,5,v20
i18 v21,1,v24
i17 v76,v21,3,v20
i17 v20,v22,2,v23
i31 v20,5,v20
i17 v74,v24,3,v20
i20 v74,114688,v74
i50 s[64:65],s[0:1],64
i50 s[68:69],s[0:1],72
i50 s[72:73],s[0:1],80
i50 s[56:57],s[0:1],96
i8 lgkmcnt(0)
i5 s58,4718592
i5 s59,0x20000
i5 s66,4718592
i5 s67,0x20000
i5 s70,4718592
i5 s71,0x20000
i5 s74,4718592
i5 s75,0x20000
i5 m0,114688
i5 s24,0
i1 v78,s[64:67],s24 offen lds
i5 m0,115712
i5 s24,131072
i1 v78,s[64:67],s24 offen lds
i5 m0,116736
i5 s24,262144
i1 v78,s[64:67],s24 offen lds
i5 m0,117760
i5 s24,393216
i1 v78,s[64:67],s24 offen lds
i5 m0,118784
i5 s24,524288
i1 v78,s[64:67],s24 offen lds
i5 m0,119808
i5 s24,655360
i1 v78,s[64:67],s24 offen lds
i5 m0,120832
i5 s24,786432
i1 v78,s[64:67],s24 offen lds
i5 m0,121856
i5 s24,917504
i1 v78,s[64:67],s24 offen lds
i5 m0,122880
i5 s24,1048576
i1 v78,s[64:67],s24 offen lds
i5 m0,123904
i5 s24,1179648
i1 v78,s[64:67],s24 offen lds
i5 m0,124928
i5 s24,1310720
i1 v78,s[64:67],s24 offen lds
i5 m0,125952
i5 s24,1441792
i1 v78,s[64:67],s24 offen lds
i5 m0,126976
i5 s24,1572864
i1 v78,s[64:67],s24 offen lds
i5 m0,128000
i5 s24,1703936
i1 v78,s[64:67],s24 offen lds
i5 m0,129024
i5 s24,1835008
i1 v78,s[64:67],s24 offen lds
i5 m0,130048
i5 s24,1966080
i1 v78,s[64:67],s24 offen lds
i5 m0,131072
i5 s24,2097152
i1 v78,s[64:67],s24 offen lds
i5 m0,132096
i5 s24,2228224
i1 v78,s[64:67],s24 offen lds
i5 m0,133120
i5 s24,2359296
i1 v78,s[64:67],s24 offen lds
i5 m0,134144
i5 s24,2490368
i1 v78,s[64:67],s24 offen lds
i5 m0,135168
i5 s24,2621440
i1 v78,s[64:67],s24 offen lds
i5 m0,136192
i5 s24,2752512
i1 v78,s[64:67],s24 offen lds
i5 m0,137216
i5 s24,2883584
i1 v78,s[64:67],s24 offen lds
i5 m0,138240
i5 s24,3014656
i1 v78,s[64:67],s24 offen lds
i5 m0,139264
i5 s24,3145728
i1 v78,s[64:67],s24 offen lds
i5 m0,140288
i5 s24,3276800
i1 v78,s[64:67],s24 offen lds
i5 m0,141312
i5 s24,3407872
i1 v78,s[64:67],s24 offen lds
i5 m0,142336
i5 s24,3538944
i1 v78,s[64:67],s24 offen lds
i5 m0,143360
i5 s24,3670016
i1 v78,s[64:67],s24 offen lds
i5 m0,144384
i5 s24,3801088
i1 v78,s[64:67],s24 offen lds
i5 m0,145408
i5 s24,3932160
i1 v78,s[64:67],s24 offen lds
i5 m0,146432
i5 s24,4063232
i1 v78,s[64:67],s24 offen lds
i8 vmcnt(28)
i0 v[80:81],v76 offset:0
i0 v[82:83],v76 offset:256
i0 v[84:85],v76 offset:2048
i0 v[86:87],v76 offset:2304
i0 v[88:89],v76 offset:16
i0 v[90:91],v76 offset:272
i0 v[92:93],v76 offset:2064
i0 v[94:95],v76 offset:2320
i8 lgkmcnt(0)
i5 m0,114688
i5 s24,4194304
i1 v78,s[64:67],s24 offen lds
i5 m0,115712
i5 s24,4325376
i1 v78,s[64:67],s24 offen lds
i5 m0,116736
i5 s24,4456448
i1 v78,s[64:67],s24 offen lds
i5 m0,117760
i5 s24,4587520
i1 v78,s[64:67],s24 offen lds
i8 vmcnt(28)
i0 v[96:97],v76 offset:4096
i0 v[98:99],v76 offset:4352
i0 v[100:101],v76 offset:6144
i0 v[102:103],v76 offset:6400
i0 v[104:105],v76 offset:4112
i0 v[106:107],v76 offset:4368
i0 v[108:109],v76 offset:6160
i0 v[110:111],v76 offset:6416
i8 lgkmcnt(0)
i5 m0,118784
i5 s24,0
i1 v78,s[68:71],s24 offen lds
i5 m0,119808
i5 s24,131072
i1 v78,s[68:71],s24 offen lds
i5 m0,120832
i5 s24,262144
i1 v78,s[68:71],s24 offen lds
i5 m0,121856
i5 s24,393216
i1 v78,s[68:71],s24 offen lds
i8 vmcnt(28)
i0 v[112:113],v76 offset:8192
i0 v[114:115],v76 offset:8448
i0 v[116:117],v76 offset:10240
i0 v[118:119],v76 offset:10496
i0 v[120:121],v76 offset:8208
i0 v[122:123],v76 offset:8464
i0 v[124:125],v76 offset:10256
i0 v[126:127],v76 offset:10512
i8 lgkmcnt(0)
i5 m0,122880
i5 s24,524288
i1 v78,s[68:71],s24 offen lds
i5 m0,123904
i5 s24,655360
i1 v78,s[68:71],s24 offen lds
i5 m0,124928
i5 s24,786432
i1 v78,s[68:71],s24 offen lds
i5 m0,125952
i5 s24,917504
i1 v78,s[68:71],s24 offen lds
i8 vmcnt(28)
i0 v[128:129],v76 offset:12288
i0 v[130:131],v76 offset:12544
i0 v[132:133],v76 offset:14336
i0 v[134:135],v76 offset:14592
i0 v[136:137],v76 offset:12304
i0 v[138:139],v76 offset:12560
i0 v[140:141],v76 offset:14352
i0 v[142:143],v76 offset:14608
i8 lgkmcnt(0)
i5 m0,126976
i5 s24,1048576
i1 v78,s[68:71],s24 offen lds
i5 m0,128000
i5 s24,1179648
i1 v78,s[68:71],s24 offen lds
i5 m0,129024
i5 s24,1310720
i1 v78,s[68:71],s24 offen lds
i5 m0,130048
i5 s24,1441792
i1 v78,s[68:71],s24 offen lds
i8 vmcnt(28)
i0 v[144:145],v76 offset:16384
i0 v[146:147],v76 offset:16640
i0 v[148:149],v76 offset:18432
i0 v[150:151],v76 offset:18688
i0 v[152:153],v76 offset:16400
i0 v[154:155],v76 offset:16656
i0 v[156:157],v76 offset:18448
i0 v[158:159],v76 offset:18704
i8 lgkmcnt(0)
i5 m0,131072
i5 s24,1572864
i1 v78,s[68:71],s24 offen lds
i5 m0,132096
i5 s24,1703936
i1 v78,s[68:71],s24 offen lds
i5 m0,133120
i5 s24,1835008
i1 v78,s[68:71],s24 offen lds
i5 m0,134144
i5 s24,1966080
i1 v78,s[68:71],s24 offen lds
i8 vmcnt(28)
i0 v[160:161],v76 offset:20480
i0 v[162:163],v76 offset:20736
i0 v[164:165],v76 offset:22528
i0 v[166:167],v76 offset:22784
i0 v[168:169],v76 offset:20496
i0 v[170:171],v76 offset:20752
i0 v[172:173],v76 offset:22544
i0 v[174:175],v76 offset:22800
i8 lgkmcnt(0)
i5 m0,135168
i5 s24,2097152
i1 v78,s[68:71],s24 offen lds
i5 m0,136192
i5 s24,2228224
i1 v78,s[68:71],s24 offen lds
i5 m0,137216
i5 s24,2359296
i1 v78,s[68:71],s24 offen lds
i5 m0,138240
i5 s24,2490368
i1 v78,s[68:71],s24 offen lds
i8 vmcnt(28)
i0 v[176:177],v76 offset:24576
i0 v[178:179],v76 offset:24832
i0 v[180:181],v76 offset:26624
i0 v[182:183],v76 offset:26880
i0 v[184:185],v76 offset:24592
i0 v[186:187],v76 offset:24848
i0 v[188:189],v76 offset:26640
i0 v[190:191],v76 offset:26896
i8 lgkmcnt(0)
i5 m0,139264
i5 s24,2621440
i1 v78,s[68:71],s24 offen lds
i5 m0,140288
i5 s24,2752512
i1 v78,s[68:71],s24 offen lds
i5 m0,141312
i5 s24,2883584
i1 v78,s[68:71],s24 offen lds
i5 m0,142336
i5 s24,3014656
i1 v78,s[68:71],s24 offen lds
i8 vmcnt(28)
i0 v[192:193],v76 offset:28672
i0 v[194:195],v76 offset:28928
i0 v[196:197],v76 offset:30720
i0 v[198:199],v76 offset:30976
i0 v[200:201],v76 offset:28688
i0 v[202:203],v76 offset:28944
i0 v[204:205],v76 offset:30736
i0 v[206:207],v76 offset:30992
i8 lgkmcnt(0)
i5 m0,143360
i5 s24,3145728
i1 v78,s[68:71],s24 offen lds
i5 m0,144384
i5 s24,3276800
i1 v78,s[68:71],s24 offen lds
i5 m0,145408
i5 s24,3407872
i1 v78,s[68:71],s24 offen lds
i5 m0,146432
i5 s24,3538944
i1 v78,s[68:71],s24 offen lds
i8 vmcnt(28)
i0 v[208:209],v76 offset:0
i0 v[210:211],v76 offset:256
i0 v[212:213],v76 offset:2048
i0 v[214:215],v76 offset:2304
i0 v[216:217],v76 offset:16
i0 v[218:219],v76 offset:272
i0 v[220:221],v76 offset:2064
i0 v[222:223],v76 offset:2320
i8 lgkmcnt(0)
i5 m0,114688
i5 s24,3670016
i1 v78,s[68:71],s24 offen lds
i5 m0,115712
i5 s24,3801088
i1 v78,s[68:71],s24 offen lds
i5 m0,116736
i5 s24,3932160
i1 v78,s[68:71],s24 offen lds
i5 m0,117760
i5 s24,4063232
i1 v78,s[68:71],s24 offen lds
i8 vmcnt(28)
i0 v[224:225],v75 offset:4096
i0 v[226:227],v75 offset:4352
i0 v[228:229],v75 offset:6144
i0 v[230:231],v75 offset:6400
i0 v[232:233],v75 offset:4128
i0 v[234:235],v75 offset:4384
i0 v[236:237],v75 offset:6176
i0 v[238:239],v75 offset:6432
i8 lgkmcnt(0)
i5 m0,118784
i5 s24,4194304
i1 v78,s[68:71],s24 offen lds
i5 m0,119808
i5 s24,4325376
i1 v78,s[68:71],s24 offen lds
i5 m0,120832
i5 s24,4456448
i1 v78,s[68:71],s24 offen lds
i5 m0,121856
i5 s24,4587520
i1 v78,s[68:71],s24 offen lds
i8 vmcnt(28)
i0 v[240:241],v75 offset:8192
i0 v[242:243],v75 offset:8448
i0 v[244:245],v75 offset:10240
i0 v[246:247],v75 offset:10496
i0 v[248:249],v75 offset:8224
i0 v[250:251],v75 offset:8480
i0 v[252:253],v75 offset:10272
i0 v[254:255],v75 offset:10528
i8 lgkmcnt(0)
i5 m0,122880
i5 s24,864
i1 v77,s[72:75],s24 offen lds
i5 m0,123904
i5 s24,37728
i1 v77,s[72:75],s24 offen lds
i5 m0,124928
i5 s24,74592
i1 v77,s[72:75],s24 offen lds
i5 m0,125952
i5 s24,111456
i1 v77,s[72:75],s24 offen lds
i8 vmcnt(28)
i0 a[0:1],v75 offset:12288
i0 a[2:3],v75 offset:12544
i0 a[4:5],v75 offset:14336
i0 a[6:7],v75 offset:14592
i0 a[8:9],v75 offset:12320
i0 a[10:11],v75 offset:12576
i0 a[12:13],v75 offset:14368
i0 a[14:15],v75 offset:14624
i8 lgkmcnt(0)
i5 m0,126976
i5 s24,896
i1 v77,s[72:75],s24 offen lds
i5 m0,128000
i5 s24,37760
i1 v77,s[72:75],s24 offen lds
i5 m0,129024
i5 s24,74624
i1 v77,s[72:75],s24 offen lds
i5 m0,130048
i5 s24,111488
i1 v77,s[72:75],s24 offen lds
i8 vmcnt(28)
i0 a[16:17],v75 offset:16384
i0 a[18:19],v75 offset:16640
i0 a[20:21],v75 offset:18432
i0 a[22:23],v75 offset:18688
i0 a[24:25],v75 offset:16416
i0 a[26:27],v75 offset:16672
i0 a[28:29],v75 offset:18464
i0 a[30:31],v75 offset:18720
i8 lgkmcnt(0)
i5 m0,131072
i5 s24,928
i1 v77,s[72:75],s24 offen lds
i5 m0,132096
i5 s24,37792
i1 v77,s[72:75],s24 offen lds
i5 m0,133120
i5 s24,74656
i1 v77,s[72:75],s24 offen lds
i5 m0,134144
i5 s24,111520
i1 v77,s[72:75],s24 offen lds
i8 vmcnt(28)
i0 a[32:33],v75 offset:20480
i0 a[34:35],v75 offset:20736
i0 a[36:37],v75 offset:22528
i0 a[38:39],v75 offset:22784
i0 a[40:41],v75 offset:20512
i0 a[42:43],v75 offset:20768
i0 a[44:45],v75 offset:22560
i0 a[46:47],v75 offset:22816
i8 lgkmcnt(0)
i5 m0,135168
i5 s24,960
i1 v77,s[72:75],s24 offen lds
i5 m0,136192
i5 s24,37824
i1 v77,s[72:75],s24 offen lds
i5 m0,137216
i5 s24,74688
i1 v77,s[72:75],s24 offen lds
i5 m0,138240
i5 s24,111552
i1 v77,s[72:75],s24 offen lds
i8 vmcnt(28)
i0 a[48:49],v75 offset:24576
i0 a[50:51],v75 offset:24832
i0 a[52:53],v75 offset:26624
i0 a[54:55],v75 offset:26880
i0 a[56:57],v75 offset:24608
i0 a[58:59],v75 offset:24864
i0 a[60:61],v75 offset:26656
i0 a[62:63],v75 offset:26912
i8 lgkmcnt(0)
i5 m0,139264
i5 s24,992
i1 v77,s[72:75],s24 offen lds
i5 m0,140288
i5 s24,37856
i1 v77,s[72:75],s24 offen lds
i5 m0,141312
i5 s24,74720
i1 v77,s[72:75],s24 offen lds
i5 m0,142336
i5 s24,111584
i1 v77,s[72:75],s24 offen lds
i8 vmcnt(28)
i0 a[64:65],v75 offset:28672
i0 a[66:67],v75 offset:28928
i0 a[68:69],v75 offset:30720
i0 a[70:71],v75 offset:30976
i0 a[72:73],v75 offset:28704
i0 a[74:75],v75 offset:28960
i0 a[76:77],v75 offset:30752
i0 a[78:79],v75 offset:31008
i8 lgkmcnt(0)
i5 m0,143360
i5 s24,1024
i1 v77,s[72:75],s24 offen lds
i5 m0,144384
i5 s24,37888
i1 v77,s[72:75],s24 offen lds
i5 m0,145408
i5 s24,74752
i1 v77,s[72:75],s24 offen lds
i5 m0,146432
i5 s24,111616
i1 v77,s[72:75],s24 offen lds
i8 vmcnt(28)
i0 a[80:81],v75 offset:0
i0 a[82:83],v75 offset:256
i0 a[84:85],v75 offset:2048
i0 a[86:87],v75 offset:2304
i0 a[88:89],v75 offset:32
i0 a[90:91],v75 offset:288
i0 a[92:93],v75 offset:2080
i0 a[94:95],v75 offset:2336
i8 lgkmcnt(0)
i5 m0,114688
i5 s24,1056
i1 v77,s[72:75],s24 offen lds
i5 m0,115712
i5 s24,37920
i1 v77,s[72:75],s24 offen lds
i5 m0,116736
i5 s24,74784
i1 v77,s[72:75],s24 offen lds
i5 m0,117760
i5 s24,111648
i1 v77,s[72:75],s24 offen lds
i8 vmcnt(28)
i0 a[96:97],v75 offset:4096
i0 a[98:99],v75 offset:4352
i0 a[100:101],v75 offset:6144
i0 a[102:103],v75 offset:6400
i0 a[104:105],v75 offset:4128
i0 a[106:107],v75 offset:4384
i0 a[108:109],v75 offset:6176
i0 a[110:111],v75 offset:6432
i8 lgkmcnt(0)
i5 m0,118784
i5 s24,1088
i1 v77,s[72:75],s24 offen lds
i5 m0,119808
i5 s24,37952
i1 v77,s[72:75],s24 offen lds
i5 m0,120832
i5 s24,74816
i1 v77,s[72:75],s24 offen lds
i5 m0,121856
i5 s24,111680
i1 v77,s[72:75],s24 offen lds
i8 vmcnt(28)
i0 a[112:113],v74 offset:8192
i0 a[114:115],v74 offset:8704
i0 a[116:117],v74 offset:9216
i0 a[118:119],v74 offset:9728
i0 a[120:121],v74 offset:10240
i0 a[122:123],v74 offset:10752
i0 a[124:125],v74 offset:11264
i0 a[126:127],v74 offset:11776
i8 lgkmcnt(0)
i5 m0,122880
i5 s24,1120
i1 v77,s[72:75],s24 offen lds
i5 m0,123904
i5 s24,37984
i1 v77,s[72:75],s24 offen lds
i5 m0,124928
i5 s24,74848
i1 v77,s[72:75],s24 offen lds
i5 m0,125952
i5 s24,111712
i1 v77,s[72:75],s24 offen lds
i8 vmcnt(28)
i0 a[128:129],v74 offset:12288
i0 a[130:131],v74 offset:12800
i0 a[132:133],v74 offset:13312
i0 a[134:135],v74 offset:13824
i0 a[136:137],v74 offset:14336
i0 a[138:139],v74 offset:14848
i0 a[140:141],v74 offset:15360
i0 a[142:143],v74 offset:15872
i8 lgkmcnt(0)
i8 vmcnt(24)
i0 a[144:145],v74 offset:16384
i0 a[146:147],v74 offset:16896
i0 a[148:149],v74 offset:17408
i0 a[150:151],v74 offset:17920
i0 a[152:153],v74 offset:18432
i0 a[154:155],v74 offset:18944
i0 a[156:157],v74 offset:19456
i0 a[158:159],v74 offset:19968
i8 lgkmcnt(0)
i8 vmcnt(20)
i0 a[160:161],v74 offset:20480
i0 a[162:163],v74 offset:20992
i0 a[164:165],v74 offset:21504
i0 a[166:167],v74 offset:22016
i0 a[168:169],v74 offset:22528
i0 a[170:171],v74 offset:23040
i0 a[172:173],v74 offset:23552
i0 a[174:175],v74 offset:24064
i8 lgkmcnt(0)
i8 vmcnt(16)
i0 a[176:177],v74 offset:24576
i0 a[178:179],v74 offset:25088
i0 a[180:181],v74 offset:25600
i0 a[182:183],v74 offset:26112
i0 a[184:185],v74 offset:26624
i0 a[186:187],v74 offset:27136
i0 a[188:189],v74 offset:27648
i0 a[190:191],v74 offset:28160
i8 lgkmcnt(0)
i8 vmcnt(12)
i0 a[192:193],v74 offset:28672
i0 a[194:195],v74 offset:29184
i0 a[196:197],v74 offset:29696
i0 a[198:199],v74 offset:30208
i0 a[200:201],v74 offset:30720
i0 a[202:203],v74 offset:31232
i0 a[204:205],v74 offset:31744
i0 a[206:207],v74 offset:32256
i8 lgkmcnt(0)
i8 vmcnt(8)
i0 a[208:209],v74 offset:0
i0 a[210:211],v74 offset:512
i0 a[212:213],v74 offset:1024
i0 a[214:215],v74 offset:1536
i0 a[216:217],v74 offset:2048
i0 a[218:219],v74 offset:2560
i0 a[220:221],v74 offset:3072
i0 a[222:223],v74 offset:3584
i8 lgkmcnt(0)
i8 vmcnt(4)
i0 a[224:225],v74 offset:4096
i0 a[226:227],v74 offset:4608
i0 a[228:229],v74 offset:5120
i0 a[230:231],v74 offset:5632
i0 a[232:233],v74 offset:6144
i0 a[234:235],v74 offset:6656
i0 a[236:237],v74 offset:7168
i0 a[238:239],v74 offset:7680
i8 lgkmcnt(0)
i8 vmcnt(0)
i0 a[240:241],v74 offset:8192
i0 a[242:243],v74 offset:8704
i0 a[244:245],v74 offset:9216
i0 a[246:247],v74 offset:9728
i0 a[248:249],v74 offset:10240
i0 a[250:251],v74 offset:10752
i0 a[252:253],v74 offset:11264
i0 a[254:255],v74 offset:11776
i8 lgkmcnt(0)
i34 v21,v79,3,1
i25 vcc,1,v21
i11 v1,0x8888
i11 v20,0xdddd
i26 v1,v1,v20,vcc
i18 v20,7,v79
i34 v21,v79,4,1
i31 v21,2,v21
v_sub_u32 v20, v20, v21
i18 v21,1,v20
i31 v21,4,v21
i11 v22,0x3f80
i31 v22,v21,v22
v_ashrrev_i32 v20, 1, v20
i25 vcc,0,v20
i15 1
i26 v2,0,v22,vcc
i25 vcc,1,v20
i15 1
i26 v3,0,v22,vcc
i18 v4,0x33f,v0
i34 v20,v0,7,1
i24 v4,v20,6,v4
i34 v20,v0,6,1
i24 v4,v20,7,v4
i18 v20,16,v0
i11 v22,0x3f80
i31 v22,v20,v22
i34 v20,v0,5,3
i25 vcc,0,v20
i15 1
i26 v12,0,v22,vcc
i25 vcc,1,v20
i15 1
i26 v13,0,v22,vcc
i25 vcc,2,v20
i15 1
i26 v14,0,v22,vcc
i25 vcc,3,v20
i15 1
i26 v15,0,v22,vcc
i25 vcc,4,v20
i15 1
i26 v16,0,v22,vcc
i25 vcc,5,v20
i15 1
i26 v17,0,v22,vcc
i25 vcc,6,v20
i15 1
i26 v18,0,v22,vcc
i25 vcc,7,v20
i15 1
i26 v19,0,v22,vcc
i34 v20,v79,3,1
i18 v21,7,v79
i17 v20,v20,4,v21
i23 v21,5,v79
i34 v22,v79,4,1
i31 v22,2,v22
i17 v21,v21,4,v22
v_sub_u32 v21, v20, v21
i20 v21,8,v21
v_cmp_le_i32 s[36:37], 0, v21
v_cmp_le_i32 s[38:39], 1, v21
v_cmp_le_i32 s[40:41], 2, v21
v_cmp_le_i32 s[42:43], 3, v21
v_cmp_le_i32 s[44:45], 8, v21
v_cmp_le_i32 s[46:47], 9, v21
v_cmp_le_i32 s[48:49], 10, v21
v_cmp_le_i32 s[50:51], 11, v21
i23 v21,4,v79
i5 s25,36864
i18 v22,0xf0,v0
i45 v8,v21,s25,v22
i34 v22,v79,4,1
i17 v20,v22,3,v20
i54 s25,2304
i43 v9,s25,v20
i32 s24,s20,2
i6 s24,s24,3
i32 s24,s24,3
i6 s24,s24,1152
i32 s25,s20,3
i6 s25,s25,2176
s_cmp_lt_u32 s20, 16
i28 s62,0,0
i47 s62,1
i28 s25,s25,0x80000000
i11 v21,s24
i11 v22,s25
v_cmp_lt_u32 vcc, 31, v79
i15 1
i26 v21,v21,v22,vcc
i20 v9,v9,v21
i5 s52,0x3f803f80
i5 s53,0x3f803f80
i5 s54,0x3f003f00
i5 s55,0x3f003f00
i5 s31,0
i5 s63,0
i5 s34,0x80000000
i5 s18,2147516416
i5 s22,s19
i5 s32,1
i32 s33,s19,7
i6 s33,s33,74448896
s_mul_i32 s29, s19, 4194304
i6 s29,s29,75497472
i20 v20,159744,v0
i21 v20,v[2:5]
i21 v20,v[8:11] offset:1024
i21 v20,v[12:15] offset:2048
i21 v20,v[16:19] offset:3072
i8 lgkmcnt(0)
s_barrier
i11 v40,0
i5 s94,0
i46 s21,0
i22 L_xb3b
i39 exec,1
L_xb3:
i55 v41,v40,s[100:101] offset:48 sc1
i6 s94,s94,1
i35 s94,400000
i22 L_endx
i8 vmcnt(0)
v_cmp_gt_u32 vcc, 32, v41
i49 L_xb3z
i44 L_xb3k
L_xb3z:
s_sleep 4
i44 L_xb3
L_xb3k:
i39 exec,-1
L_xb3b:
s_barrier
i47 s99,2
i22 L_xs3
Lx3f_top:
i32 s27,s22,18
i32 s24,s20,13
i6 s27,s27,s24
i32 s28,s22,14
i6 s28,s28,72351744
s_mul_i32 s30, s22, 73728
s_and_b32 s24, s22, 7
s_cmp_ge_u32 s24, 3
i22 Lx3f_rdyk
s_barrier
Lx3f_rdyk:
s_bitcmp1_b32 s18, 31
s_cbranch_scc0 Lx3f_pre
s_bitset0_b32 s18, 31
i6 m0,s18,6144
i6 s25,s27,33560576
i1 v0,s[8:11],s25 offen sc1 lds
i6 m0,s18,7168
i6 s25,s27,33561600
i1 v0,s[8:11],s25 offen sc1 lds
i6 m0,s18,14336
i6 s25,s27,6144
i1 v0,s[8:11],s25 offen sc1 lds
i6 m0,s18,15360
i6 s25,s27,7168
i1 v0,s[8:11],s25 offen sc1 lds
i6 m0,s18,22528
i6 s25,s27,16783360
i1 v0,s[8:11],s25 offen sc1 lds
i6 m0,s18,23552
i6 s25,s27,16784384
i1 v0,s[8:11],s25 offen sc1 lds
Lx3f_pre:
i20 v6,s18,v0
i8 vmcnt(0)
s_barrier
i9 v[8:11],v6 offset:1024
i9 v[48:51],v6 offset:8192
i9 v[12:15],v6 offset:3072
i9 v[52:55],v6 offset:10240
i9 v[16:19],v6 offset:5120
i9 v[56:59],v6 offset:12288
i9 v[20:23],v6 offset:7168
i9 v[60:63],v6 offset:14336
i9 v[24:27],v6 offset:9216
i9 v[28:31],v6 offset:11264
i9 v[32:35],v6 offset:13312
i9 v[36:39],v6 offset:15360
i8 lgkmcnt(10)
i2 v[40:43],v[48:51],v[8:11],0
i8 lgkmcnt(8)
i2 v[40:43],v[52:55],v[12:15],v[40:43]
i8 lgkmcnt(6)
i2 v[40:43],v[56:59],v[16:19],v[40:43]
i8 lgkmcnt(4)
i2 v[40:43],v[60:63],v[20:23],v[40:43]
i8 lgkmcnt(3)
i2 v[44:47],v[24:27],v[8:11],0
i8 lgkmcnt(2)
i2 v[44:47],v[28:31],v[12:15],v[44:47]
i8 lgkmcnt(1)
i2 v[44:47],v[32:35],v[16:19],v[44:47]
i8 lgkmcnt(0)
i2 v[44:47],v[36:39],v[20:23],v[44:47]
i9 v[24:27],v6 offset:20480
i9 v[28:31],v6 offset:21504
i9 v[32:35],v6 offset:22528
i9 v[36:39],v6 offset:23552
i11 v5,0xff800000
i26 v40,v5,v40,s[36:37]
i26 v41,v5,v41,s[38:39]
i26 v42,v5,v42,s[40:41]
i26 v43,v5,v43,s[42:43]
i26 v44,v5,v44,s[44:45]
i26 v45,v5,v45,s[46:47]
i26 v46,v5,v46,s[48:49]
i26 v47,v5,v47,s[50:51]
Lx3f_h:
i6 s24,s28,3072
i1 v[64:67],v4,s[8:11],s24 offen sc1
i6 s24,s28,7168
i1 v[68:71],v4,s[8:11],s24 offen sc1
i6 s24,s28,8192
i1 v[72:75],v4,s[8:11],s24 offen sc1
i23 v76,2,v0
i18 v76,0x7c,v76
i36 v77,v76,s[8:11],s33 offen sc1
i6 s31,s31,1
i35 s31,400000
i22 L_endx
i8 vmcnt(0)
i48 v5,v64,v65,v66
i48 v5,v5,v67,v68
i48 v5,v5,v69,v70
i48 v5,v5,v71,v72
i48 v5,v5,v73,v74
v_max_u32 v5, v5, v75
i25 vcc,-1,v5
s_cbranch_vccz Lx3f_hk
s_cmp_ge_u32 s22, 60
i22 Lx3f_h
i11 v6,3072
i39 exec,1
Lx3f_hl:
s_sleep 12
i36 v5,v6,s[8:11],s28 offen sc1
i6 s31,s31,1
i35 s31,400000
i22 L_endx
i8 vmcnt(0)
i25 vcc,-1,v5
i49 Lx3f_hl
i39 exec,-1
i44 Lx3f_h
Lx3f_hk:
i21 v0,v[64:67] offset:3072
i21 v0,v[68:71] offset:7168
i21 v0,v[72:75] offset:8192
i47 s63,0
i22 Lx3f_nq
Lx3f_fl0:
i8 vmcnt(0)
v_cmp_gt_u32 vcc, s32, v77
s_cbranch_vccz Lx3f_fl0k
i36 v77,v76,s[8:11],s33 offen sc1
i6 s31,s31,1
i35 s31,400000
i22 L_endx
i44 Lx3f_fl0
Lx3f_fl0k:
Lx3f_nq:
i20 v78,159744,v0
ds_read_b32 v78, v78 offset:1024
i32 s14,s20,10
i6 s14,s14,768
i6 s14,s14,s34
s_xor_b32 s16, s18, 24576
i6 s24,s22,3
s_xor_b32 s24, s24, s22
s_cmp_ge_u32 s24, 8
i28 s24,0x80000000,0
s_or_b32 s18, s16, s24
i6 s26,s27,786432
s_or_b32 s26, s26, s24
i14 v[48:49],0
i14 v[50:51],0
i14 v[52:53],0
i14 v[54:55],0
i14 v[56:57],0
i14 v[58:59],0
i14 v[60:61],0
i14 v[62:63],0
i8 lgkmcnt(0)
s_barrier
i9 v[64:67],v0 offset:0
i9 v[68:71],v0 offset:1024
i9 v[72:75],v0 offset:2048
i8 lgkmcnt(2)
i4 v[48:51],v[64:67],v[80:87],v1
i5 m0,106496
i6 s25,s14,0
i1 v78,s[8:11],s25 offen sc1 lds
i4 v[52:55],v[64:67],v[88:95],v1
i4 v[56:59],v[64:67],v[224:231],v1
i5 m0,107520
i6 s25,s14,147456
i1 v78,s[8:11],s25 offen sc1 lds
i4 v[60:63],v[64:67],v[232:239],v1
i9 v[64:67],v0 offset:3072
i8 lgkmcnt(2)
i4 v[48:51],v[68:71],v[96:103],v1
i5 m0,108544
i6 s25,s14,294912
i1 v78,s[8:11],s25 offen sc1 lds
i4 v[52:55],v[68:71],v[104:111],v1
i4 v[56:59],v[68:71],v[240:247],v1
i5 m0,109568
i6 s25,s14,442368
i1 v78,s[8:11],s25 offen sc1 lds
i4 v[60:63],v[68:71],v[248:255],v1
i9 v[68:71],v0 offset:4096
i8 lgkmcnt(2)
i4 v[48:51],v[72:75],v[112:119],v1
i5 m0,110592
i6 s25,s14,589824
i1 v78,s[8:11],s25 offen sc1 lds
i4 v[52:55],v[72:75],v[120:127],v1
i4 v[56:59],v[72:75],a[0:7],v1
i5 m0,111616
i6 s25,s14,737280
i1 v78,s[8:11],s25 offen sc1 lds
i4 v[60:63],v[72:75],a[8:15],v1
i9 v[72:75],v0 offset:5120
i8 lgkmcnt(2)
i4 v[48:51],v[64:67],v[128:135],v1
i5 m0,112640
i6 s25,s14,884736
i1 v78,s[8:11],s25 offen sc1 lds
i4 v[52:55],v[64:67],v[136:143],v1
i4 v[56:59],v[64:67],a[16:23],v1
i5 m0,113664
i6 s25,s14,1032192
i1 v78,s[8:11],s25 offen sc1 lds
i4 v[60:63],v[64:67],a[24:31],v1
i9 v[64:67],v0 offset:6144
i8 lgkmcnt(2)
i4 v[48:51],v[68:71],v[144:151],v1
i6 m0,s16,6144
i6 s25,s26,33560576
i1 v0,s[8:11],s25 offen sc1 lds
i4 v[52:55],v[68:71],v[152:159],v1
i4 v[56:59],v[68:71],a[32:39],v1
i6 m0,s16,7168
i6 s25,s26,33561600
i1 v0,s[8:11],s25 offen sc1 lds
i4 v[60:63],v[68:71],a[40:47],v1
i9 v[68:71],v0 offset:7168
i8 lgkmcnt(2)
i4 v[48:51],v[72:75],v[160:167],v1
i6 m0,s16,14336
i6 s25,s26,6144
i1 v0,s[8:11],s25 offen sc1 lds
i4 v[52:55],v[72:75],v[168:175],v1
i4 v[56:59],v[72:75],a[48:55],v1
i6 m0,s16,15360
i6 s25,s26,7168
i1 v0,s[8:11],s25 offen sc1 lds
i4 v[60:63],v[72:75],a[56:63],v1
i9 v[72:75],v0 offset:8192
i8 lgkmcnt(2)
i4 v[48:51],v[64:67],v[176:183],v1
i6 m0,s16,22528
i6 s25,s26,16783360
i1 v0,s[8:11],s25 offen sc1 lds
i4 v[52:55],v[64:67],v[184:191],v1
i4 v[56:59],v[64:67],a[64:71],v1
i6 m0,s16,23552
i6 s25,s26,16784384
i1 v0,s[8:11],s25 offen sc1 lds
i4 v[60:63],v[64:67],a[72:79],v1
i8 lgkmcnt(1)
i4 v[48:51],v[68:71],v[192:199],v1
i4 v[52:55],v[68:71],v[200:207],v1
i4 v[56:59],v[68:71],a[80:87],v1
i4 v[60:63],v[68:71],a[88:95],v1
i8 lgkmcnt(0)
i4 v[48:51],v[72:75],v[208:215],v1
i4 v[52:55],v[72:75],v[216:223],v1
i4 v[56:59],v[72:75],a[96:103],v1
i4 v[60:63],v[72:75],a[104:111],v1
i3 v48,v48,v49
i3 v49,v50,v51
i3 v50,v52,v53
i3 v51,v54,v55
i27 v[52:55],v[48:49],v[2:3],0
i15 0
i27 v[76:79],v[50:51],v[2:3],0
i3 v56,v56,v57
i3 v57,v58,v59
i3 v58,v60,v61
i3 v59,v62,v63
i21 v0,v[56:59] offset:16384
i3 v48,v52,v53
i3 v49,v54,v55
i15 0
i3 v50,v76,v77
i3 v51,v78,v79
i21 v0,v[48:51] offset:12288
i8 lgkmcnt(0)
s_barrier
i9 v[64:67],v0 offset:9216
i9 v[68:71],v0 offset:10240
i9 v[72:75],v0 offset:11264
i9 v[76:79],v0 offset:12288
i9 v[48:51],v0 offset:15360
i9 v[52:55],v0 offset:16384
i38 v5,v40,v41,v42
i38 v6,v43,v44,v45
i38 v5,v5,v46,v47
i8 lgkmcnt(5)
i2 v[60:63],v[64:67],v[8:11],0
i8 lgkmcnt(4)
i2 v[60:63],v[68:71],v[12:15],v[60:63]
i8 lgkmcnt(3)
i2 v[60:63],v[72:75],v[16:19],v[60:63]
i8 lgkmcnt(2)
i2 v[60:63],v[76:79],v[20:23],v[60:63]
i15 7
i51 v60,0x3e0293ee,v60
i51 v61,0x3e0293ee,v61
i51 v62,0x3e0293ee,v62
i51 v63,0x3e0293ee,v63
i38 v5,v5,v6,v60
i38 v5,v5,v61,v62
v_max_f32 v5, v5, v63
i11 v6,v5
i15 1
v_permlane16_swap_b32 v5, v6
v_max_f32 v5, v5, v6
i11 v6,v5
i15 1
i40 v5,v6
v_max_f32 v5, v5, v6
i33 v40,v40,v5
i33 v41,v41,v5
i33 v42,v42,v5
i33 v43,v43,v5
i33 v44,v44,v5
i33 v45,v45,v5
i33 v46,v46,v5
i33 v47,v47,v5
i33 v60,v60,v5
i33 v61,v61,v5
i33 v62,v62,v5
i33 v63,v63,v5
i19 v40,v40
i19 v41,v41
i19 v42,v42
i19 v43,v43
i19 v44,v44
i19 v45,v45
i19 v46,v46
i19 v47,v47
i19 v60,v60
i19 v61,v61
i19 v62,v62
i19 v63,v63
i14 v[12:13],s[52:53]
i14 v[14:15],s[52:53]
i14 v[16:17],s[54:55]
i3 v20,v40,v41
i3 v21,v42,v43
i3 v22,v44,v45
i3 v23,v46,v47
i3 v18,v60,v61
i3 v19,v62,v63
i8 lgkmcnt(0)
i2 v[8:11],v[12:15],v[20:23],0
i2 v[64:67],v[24:27],v[20:23],0
i2 v[68:71],v[28:31],v[20:23],0
i2 v[72:75],v[32:35],v[20:23],0
i2 v[76:79],v[36:39],v[20:23],0
i27 v[8:11],v[16:17],v[18:19],v[8:11]
i27 v[64:67],v[48:49],v[18:19],v[64:67]
i27 v[68:71],v[50:51],v[18:19],v[68:71]
i27 v[72:75],v[52:53],v[18:19],v[72:75]
i27 v[76:79],v[54:55],v[18:19],v[76:79]
v_rcp_f32 v6, v8
i15 0
i16 v[64:65],v[64:65],v[6:7] op_sel_hi:[1,0]
i16 v[66:67],v[66:67],v[6:7] op_sel_hi:[1,0]
i16 v[68:69],v[68:69],v[6:7] op_sel_hi:[1,0]
i16 v[70:71],v[70:71],v[6:7] op_sel_hi:[1,0]
i16 v[72:73],v[72:73],v[6:7] op_sel_hi:[1,0]
i16 v[74:75],v[74:75],v[6:7] op_sel_hi:[1,0]
i16 v[76:77],v[76:77],v[6:7] op_sel_hi:[1,0]
i16 v[78:79],v[78:79],v[6:7] op_sel_hi:[1,0]
i3 v64,v64,v65
i3 v65,v66,v67
i3 v66,v68,v69
i3 v67,v70,v71
i21 v0,v[64:67] offset:23552
i3 v72,v72,v73
i3 v73,v74,v75
i3 v74,v76,v77
i3 v75,v78,v79
i21 v0,v[72:75] offset:24576
i8 lgkmcnt(0)
s_barrier
i47 s63,0
i22 Lx3f_nr
i20 v40,159744,v0
i20 v41,106496,v0
ds_read_b32 v42, v40 offset:1028
i9 v[72:75],v40 offset:2048
i9 v[76:79],v40 offset:3072
i8 vmcnt(0)
i9 v[8:11],v41 offset:0
i9 v[12:15],v41 offset:1024
i9 v[16:19],v41 offset:2048
i9 v[20:23],v41 offset:3072
i9 v[24:27],v41 offset:4096
i9 v[28:31],v41 offset:5120
i9 v[32:35],v41 offset:6144
i9 v[36:39],v41 offset:7168
i8 lgkmcnt(7)
i2 v[44:47],v[72:75],v[8:11],0
i8 lgkmcnt(6)
i2 v[44:47],v[72:75],v[12:15],v[44:47]
i8 lgkmcnt(5)
i2 v[44:47],v[72:75],v[16:19],v[44:47]
i8 lgkmcnt(4)
i2 v[44:47],v[72:75],v[20:23],v[44:47]
i8 lgkmcnt(3)
i2 v[44:47],v[72:75],v[24:27],v[44:47]
i8 lgkmcnt(2)
i2 v[44:47],v[72:75],v[28:31],v[44:47]
i8 lgkmcnt(1)
i2 v[44:47],v[72:75],v[32:35],v[44:47]
i8 lgkmcnt(0)
i2 v[44:47],v[72:75],v[36:39],v[44:47]
i15 7
i3 v44,v44,v45
i3 v45,v46,v47
i41 v[44:45],v42,s[56:59],s35 offen
i6 s32,s32,1
Lx3f_nr:
i9 v[8:11],v0 offset:17408
i9 v[12:15],v0 offset:18432
i9 v[16:19],v0 offset:19456
i9 v[20:23],v0 offset:20480
i9 v[24:27],v0 offset:21504
i9 v[28:31],v0 offset:22528
i9 v[32:35],v0 offset:23552
i9 v[36:39],v0 offset:24576
s_mul_i32 s24, s20, 36864
i6 s24,s24,s29
i6 s24,s24,27648
i6 s25,s24,4096
i6 s26,s24,8192
i8 lgkmcnt(7)
i2 v[40:43],a[112:115],v[8:11],0
i8 lgkmcnt(6)
i2 v[40:43],a[116:119],v[12:15],v[40:43]
i8 lgkmcnt(5)
i2 v[40:43],a[120:123],v[16:19],v[40:43]
i8 lgkmcnt(4)
i2 v[40:43],a[124:127],v[20:23],v[40:43]
i8 lgkmcnt(3)
i2 v[44:47],a[112:115],v[24:27],0
i8 lgkmcnt(2)
i2 v[44:47],a[116:119],v[28:31],v[44:47]
i8 lgkmcnt(1)
i2 v[44:47],a[120:123],v[32:35],v[44:47]
i8 lgkmcnt(0)
i2 v[44:47],a[124:127],v[36:39],v[44:47]
i2 v[48:51],a[128:131],v[8:11],0
i2 v[48:51],a[132:135],v[12:15],v[48:51]
i2 v[48:51],a[136:139],v[16:19],v[48:51]
i2 v[48:51],a[140:143],v[20:23],v[48:51]
i3 v40,v40,v41
i3 v41,v42,v43
i3 v42,v44,v45
i3 v43,v46,v47
i13 v[40:43],v0,s[8:11],s24 offen offset:0
i2 v[52:55],a[128:131],v[24:27],0
i2 v[52:55],a[132:135],v[28:31],v[52:55]
i2 v[52:55],a[136:139],v[32:35],v[52:55]
i2 v[52:55],a[140:143],v[36:39],v[52:55]
i2 v[56:59],a[144:147],v[8:11],0
i2 v[56:59],a[148:151],v[12:15],v[56:59]
i2 v[56:59],a[152:155],v[16:19],v[56:59]
i2 v[56:59],a[156:159],v[20:23],v[56:59]
i3 v48,v48,v49
i3 v49,v50,v51
i3 v50,v52,v53
i3 v51,v54,v55
i13 v[48:51],v0,s[8:11],s24 offen offset:1024
i2 v[60:63],a[144:147],v[24:27],0
i2 v[60:63],a[148:151],v[28:31],v[60:63]
i2 v[60:63],a[152:155],v[32:35],v[60:63]
i2 v[60:63],a[156:159],v[36:39],v[60:63]
i2 v[64:67],a[160:163],v[8:11],0
i2 v[64:67],a[164:167],v[12:15],v[64:67]
i2 v[64:67],a[168:171],v[16:19],v[64:67]
i2 v[64:67],a[172:175],v[20:23],v[64:67]
i3 v56,v56,v57
i3 v57,v58,v59
i3 v58,v60,v61
i3 v59,v62,v63
i13 v[56:59],v0,s[8:11],s24 offen offset:2048
i2 v[68:71],a[160:163],v[24:27],0
i2 v[68:71],a[164:167],v[28:31],v[68:71]
i2 v[68:71],a[168:171],v[32:35],v[68:71]
i2 v[68:71],a[172:175],v[36:39],v[68:71]
i2 v[72:75],a[176:179],v[8:11],0
i2 v[72:75],a[180:183],v[12:15],v[72:75]
i2 v[72:75],a[184:187],v[16:19],v[72:75]
i2 v[72:75],a[188:191],v[20:23],v[72:75]
i3 v64,v64,v65
i3 v65,v66,v67
i3 v66,v68,v69
i3 v67,v70,v71
i13 v[64:67],v0,s[8:11],s24 offen offset:3072
i2 v[76:79],a[176:179],v[24:27],0
i2 v[76:79],a[180:183],v[28:31],v[76:79]
i2 v[76:79],a[184:187],v[32:35],v[76:79]
i2 v[76:79],a[188:191],v[36:39],v[76:79]
i2 v[40:43],a[192:195],v[8:11],0
i2 v[40:43],a[196:199],v[12:15],v[40:43]
i2 v[40:43],a[200:203],v[16:19],v[40:43]
i2 v[40:43],a[204:207],v[20:23],v[40:43]
i3 v72,v72,v73
i3 v73,v74,v75
i3 v74,v76,v77
i3 v75,v78,v79
i13 v[72:75],v0,s[8:11],s25 offen offset:0
i2 v[44:47],a[192:195],v[24:27],0
i2 v[44:47],a[196:199],v[28:31],v[44:47]
i2 v[44:47],a[200:203],v[32:35],v[44:47]
i2 v[44:47],a[204:207],v[36:39],v[44:47]
i2 v[48:51],a[208:211],v[8:11],0
i2 v[48:51],a[212:215],v[12:15],v[48:51]
i2 v[48:51],a[216:219],v[16:19],v[48:51]
i2 v[48:51],a[220:223],v[20:23],v[48:51]
i3 v40,v40,v41
i3 v41,v42,v43
i3 v42,v44,v45
i3 v43,v46,v47
i13 v[40:43],v0,s[8:11],s25 offen offset:1024
i2 v[52:55],a[208:211],v[24:27],0
i2 v[52:55],a[212:215],v[28:31],v[52:55]
i2 v[52:55],a[216:219],v[32:35],v[52:55]
i2 v[52:55],a[220:223],v[36:39],v[52:55]
i2 v[56:59],a[224:227],v[8:11],0
i2 v[56:59],a[228:231],v[12:15],v[56:59]
i2 v[56:59],a[232:235],v[16:19],v[56:59]
i2 v[56:59],a[236:239],v[20:23],v[56:59]
i3 v48,v48,v49
i3 v49,v50,v51
i3 v50,v52,v53
i3 v51,v54,v55
i13 v[48:51],v0,s[8:11],s25 offen offset:2048
i2 v[60:63],a[224:227],v[24:27],0
i2 v[60:63],a[228:231],v[28:31],v[60:63]
i2 v[60:63],a[232:235],v[32:35],v[60:63]
i2 v[60:63],a[236:239],v[36:39],v[60:63]
i2 v[64:67],a[240:243],v[8:11],0
i2 v[64:67],a[244:247],v[12:15],v[64:67]
i2 v[64:67],a[248:251],v[16:19],v[64:67]
i2 v[64:67],a[252:255],v[20:23],v[64:67]
i3 v56,v56,v57
i3 v57,v58,v59
i3 v58,v60,v61
i3 v59,v62,v63
i13 v[56:59],v0,s[8:11],s25 offen offset:3072
i2 v[68:71],a[240:243],v[24:27],0
i2 v[68:71],a[244:247],v[28:31],v[68:71]
i2 v[68:71],a[248:251],v[32:35],v[68:71]
i2 v[68:71],a[252:255],v[36:39],v[68:71]
i3 v64,v64,v65
i3 v65,v66,v67
i15 5
i3 v66,v68,v69
i3 v67,v70,v71
i13 v[64:67],v0,s[8:11],s26 offen offset:0
i5 s63,1
i5 s34,s29
i5 s35,s30
s_xor_b32 s29, s29, 2097152
i6 s22,s22,3
s_cmp_lt_u32 s22, 64
i22 Lx3f_top
i8 vmcnt(0)
s_barrier
i23 v76,2,v0
i18 v76,0x7c,v76
i36 v77,v76,s[8:11],s33 offen sc1
Lx3f_fl1:
i8 vmcnt(0)
v_cmp_gt_u32 vcc, s32, v77
s_cbranch_vccz Lx3f_fl1k
i36 v77,v76,s[8:11],s33 offen sc1
i6 s31,s31,1
i35 s31,400000
i22 L_endx
i44 Lx3f_fl1
Lx3f_fl1k:
i20 v78,159744,v0
ds_read_b32 v78, v78 offset:1024
i32 s14,s20,10
i6 s14,s14,768
i6 s14,s14,s34
i8 lgkmcnt(0)
i5 m0,106496
i6 s25,s14,0
i1 v78,s[8:11],s25 offen sc1 lds
i5 m0,107520
i6 s25,s14,147456
i1 v78,s[8:11],s25 offen sc1 lds
i5 m0,108544
i6 s25,s14,294912
i1 v78,s[8:11],s25 offen sc1 lds
i5 m0,109568
i6 s25,s14,442368
i1 v78,s[8:11],s25 offen sc1 lds
i5 m0,110592
i6 s25,s14,589824
i1 v78,s[8:11],s25 offen sc1 lds
i5 m0,111616
i6 s25,s14,737280
i1 v78,s[8:11],s25 offen sc1 lds
i5 m0,112640
i6 s25,s14,884736
i1 v78,s[8:11],s25 offen sc1 lds
i5 m0,113664
i6 s25,s14,1032192
i1 v78,s[8:11],s25 offen sc1 lds
i20 v40,159744,v0
i20 v41,106496,v0
ds_read_b32 v42, v40 offset:1028
i9 v[72:75],v40 offset:2048
i9 v[76:79],v40 offset:3072
i8 vmcnt(0)
i9 v[8:11],v41 offset:0
i9 v[12:15],v41 offset:1024
i9 v[16:19],v41 offset:2048
i9 v[20:23],v41 offset:3072
i9 v[24:27],v41 offset:4096
i9 v[28:31],v41 offset:5120
i9 v[32:35],v41 offset:6144
i9 v[36:39],v41 offset:7168
i8 lgkmcnt(7)
i2 v[44:47],v[72:75],v[8:11],0
i8 lgkmcnt(6)
i2 v[44:47],v[72:75],v[12:15],v[44:47]
i8 lgkmcnt(5)
i2 v[44:47],v[72:75],v[16:19],v[44:47]
i8 lgkmcnt(4)
i2 v[44:47],v[72:75],v[20:23],v[44:47]
i8 lgkmcnt(3)
i2 v[44:47],v[72:75],v[24:27],v[44:47]
i8 lgkmcnt(2)
i2 v[44:47],v[72:75],v[28:31],v[44:47]
i8 lgkmcnt(1)
i2 v[44:47],v[72:75],v[32:35],v[44:47]
i8 lgkmcnt(0)
i2 v[44:47],v[72:75],v[36:39],v[44:47]
i15 7
i3 v44,v44,v45
i3 v45,v46,v47
i41 v[44:45],v42,s[56:59],s35 offen
i8 vmcnt(0)
i44 L_endx
L_xs3:
Lx3s_top:
i32 s27,s22,18
i32 s24,s20,13
i6 s27,s27,s24
i32 s28,s22,14
i6 s28,s28,72351744
s_mul_i32 s30, s22, 73728
s_and_b32 s24, s22, 7
s_cmp_ge_u32 s24, 3
i22 Lx3s_rdyk
s_barrier
Lx3s_rdyk:
s_bitcmp1_b32 s18, 31
s_cbranch_scc0 Lx3s_pre
s_bitset0_b32 s18, 31
i6 m0,s18,6144
i6 s25,s27,33560576
i1 v0,s[8:11],s25 offen sc1 lds
i6 m0,s18,7168
i6 s25,s27,33561600
i1 v0,s[8:11],s25 offen sc1 lds
i6 m0,s18,14336
i6 s25,s27,6144
i1 v0,s[8:11],s25 offen sc1 lds
i6 m0,s18,15360
i6 s25,s27,7168
i1 v0,s[8:11],s25 offen sc1 lds
i6 m0,s18,22528
i6 s25,s27,16783360
i1 v0,s[8:11],s25 offen sc1 lds
i6 m0,s18,23552
i6 s25,s27,16784384
i1 v0,s[8:11],s25 offen sc1 lds
Lx3s_pre:
i20 v6,s18,v0
i8 vmcnt(0)
s_barrier
i9 v[8:11],v6 offset:1024
i9 v[48:51],v6 offset:8192
i9 v[12:15],v6 offset:3072
i9 v[52:55],v6 offset:10240
i9 v[16:19],v6 offset:5120
i9 v[56:59],v6 offset:12288
i9 v[20:23],v6 offset:7168
i9 v[60:63],v6 offset:14336
i9 v[24:27],v6 offset:9216
i9 v[28:31],v6 offset:11264
i9 v[32:35],v6 offset:13312
i9 v[36:39],v6 offset:15360
i8 lgkmcnt(10)
i2 v[40:43],v[48:51],v[8:11],0
i8 lgkmcnt(8)
i2 v[40:43],v[52:55],v[12:15],v[40:43]
i8 lgkmcnt(6)
i2 v[40:43],v[56:59],v[16:19],v[40:43]
i8 lgkmcnt(4)
i2 v[40:43],v[60:63],v[20:23],v[40:43]
i8 lgkmcnt(3)
i2 v[44:47],v[24:27],v[8:11],0
i8 lgkmcnt(2)
i2 v[44:47],v[28:31],v[12:15],v[44:47]
i8 lgkmcnt(1)
i2 v[44:47],v[32:35],v[16:19],v[44:47]
i8 lgkmcnt(0)
i2 v[44:47],v[36:39],v[20:23],v[44:47]
i9 v[24:27],v6 offset:20480
i9 v[28:31],v6 offset:21504
i9 v[32:35],v6 offset:22528
i9 v[36:39],v6 offset:23552
i11 v5,0xff800000
i26 v40,v5,v40,s[36:37]
i26 v41,v5,v41,s[38:39]
i26 v42,v5,v42,s[40:41]
i26 v43,v5,v43,s[42:43]
i26 v44,v5,v44,s[44:45]
i26 v45,v5,v45,s[46:47]
i26 v46,v5,v46,s[48:49]
i26 v47,v5,v47,s[50:51]
Lx3s_h:
i6 s24,s28,3072
i1 v[64:67],v4,s[8:11],s24 offen sc1
i6 s24,s28,7168
i1 v[68:71],v4,s[8:11],s24 offen sc1
i6 s24,s28,8192
i1 v[72:75],v4,s[8:11],s24 offen sc1
i23 v76,2,v0
i18 v76,0x7c,v76
i36 v77,v76,s[8:11],s33 offen sc1
i6 s31,s31,1
i35 s31,400000
i22 L_endx
i8 vmcnt(0)
i48 v5,v64,v65,v66
i48 v5,v5,v67,v68
i48 v5,v5,v69,v70
i48 v5,v5,v71,v72
i48 v5,v5,v73,v74
v_max_u32 v5, v5, v75
i25 vcc,-1,v5
s_cbranch_vccz Lx3s_hk
s_cmp_ge_u32 s22, 60
i22 Lx3s_h
i11 v6,3072
i39 exec,1
Lx3s_hl:
s_sleep 12
i36 v5,v6,s[8:11],s28 offen sc1
i6 s31,s31,1
i35 s31,400000
i22 L_endx
i8 vmcnt(0)
i25 vcc,-1,v5
i49 Lx3s_hl
i39 exec,-1
i44 Lx3s_h
Lx3s_hk:
i21 v0,v[64:67] offset:3072
i21 v0,v[68:71] offset:7168
i21 v0,v[72:75] offset:8192
i47 s63,0
i22 Lx3s_nq
Lx3s_fl0:
i8 vmcnt(0)
v_cmp_gt_u32 vcc, s32, v77
s_cbranch_vccz Lx3s_fl0k
i36 v77,v76,s[8:11],s33 offen sc1
i6 s31,s31,1
i35 s31,400000
i22 L_endx
i44 Lx3s_fl0
Lx3s_fl0k:
Lx3s_nq:
i20 v78,159744,v0
ds_read_b32 v78, v78 offset:1024
i32 s14,s20,10
i6 s14,s14,768
i6 s14,s14,s34
s_xor_b32 s16, s18, 24576
i6 s24,s22,3
s_xor_b32 s24, s24, s22
s_cmp_ge_u32 s24, 8
i28 s24,0x80000000,0
s_or_b32 s18, s16, s24
i6 s26,s27,786432
s_or_b32 s26, s26, s24
i14 v[48:49],0
i14 v[50:51],0
i14 v[52:53],0
i14 v[54:55],0
i14 v[56:57],0
i14 v[58:59],0
i14 v[60:61],0
i14 v[62:63],0
i8 lgkmcnt(0)
s_barrier
i9 v[64:67],v0 offset:0
i9 v[68:71],v0 offset:1024
i9 v[72:75],v0 offset:2048
i8 lgkmcnt(2)
i4 v[48:51],v[64:67],v[80:87],v1
i5 m0,106496
i6 s25,s14,0
i1 v78,s[8:11],s25 offen sc1 lds
i4 v[52:55],v[64:67],v[88:95],v1
i4 v[56:59],v[64:67],v[224:231],v1
i5 m0,107520
i6 s25,s14,147456
i1 v78,s[8:11],s25 offen sc1 lds
i4 v[60:63],v[64:67],v[232:239],v1
i9 v[64:67],v0 offset:3072
i8 lgkmcnt(2)
i4 v[48:51],v[68:71],v[96:103],v1
i5 m0,108544
i6 s25,s14,294912
i1 v78,s[8:11],s25 offen sc1 lds
i4 v[52:55],v[68:71],v[104:111],v1
i4 v[56:59],v[68:71],v[240:247],v1
i5 m0,109568
i6 s25,s14,442368
i1 v78,s[8:11],s25 offen sc1 lds
i4 v[60:63],v[68:71],v[248:255],v1
i9 v[68:71],v0 offset:4096
i8 lgkmcnt(2)
i4 v[48:51],v[72:75],v[112:119],v1
i5 m0,110592
i6 s25,s14,589824
i1 v78,s[8:11],s25 offen sc1 lds
i4 v[52:55],v[72:75],v[120:127],v1
i4 v[56:59],v[72:75],a[0:7],v1
i5 m0,111616
i6 s25,s14,737280
i1 v78,s[8:11],s25 offen sc1 lds
i4 v[60:63],v[72:75],a[8:15],v1
i9 v[72:75],v0 offset:5120
i8 lgkmcnt(2)
i4 v[48:51],v[64:67],v[128:135],v1
i5 m0,112640
i6 s25,s14,884736
i1 v78,s[8:11],s25 offen sc1 lds
i4 v[52:55],v[64:67],v[136:143],v1
i4 v[56:59],v[64:67],a[16:23],v1
i5 m0,113664
i6 s25,s14,1032192
i1 v78,s[8:11],s25 offen sc1 lds
i4 v[60:63],v[64:67],a[24:31],v1
i9 v[64:67],v0 offset:6144
i8 lgkmcnt(2)
i4 v[48:51],v[68:71],v[144:151],v1
i6 m0,s16,6144
i6 s25,s26,33560576
i1 v0,s[8:11],s25 offen sc1 lds
i4 v[52:55],v[68:71],v[152:159],v1
i4 v[56:59],v[68:71],a[32:39],v1
i6 m0,s16,7168
i6 s25,s26,33561600
i1 v0,s[8:11],s25 offen sc1 lds
i4 v[60:63],v[68:71],a[40:47],v1
i9 v[68:71],v0 offset:7168
i8 lgkmcnt(2)
i4 v[48:51],v[72:75],v[160:167],v1
i6 m0,s16,14336
i6 s25,s26,6144
i1 v0,s[8:11],s25 offen sc1 lds
i4 v[52:55],v[72:75],v[168:175],v1
i4 v[56:59],v[72:75],a[48:55],v1
i6 m0,s16,15360
i6 s25,s26,7168
i1 v0,s[8:11],s25 offen sc1 lds
i4 v[60:63],v[72:75],a[56:63],v1
i9 v[72:75],v0 offset:8192
i8 lgkmcnt(2)
i4 v[48:51],v[64:67],v[176:183],v1
i6 m0,s16,22528
i6 s25,s26,16783360
i1 v0,s[8:11],s25 offen sc1 lds
i4 v[52:55],v[64:67],v[184:191],v1
i4 v[56:59],v[64:67],a[64:71],v1
i6 m0,s16,23552
i6 s25,s26,16784384
i1 v0,s[8:11],s25 offen sc1 lds
i4 v[60:63],v[64:67],a[72:79],v1
i8 lgkmcnt(1)
i4 v[48:51],v[68:71],v[192:199],v1
i4 v[52:55],v[68:71],v[200:207],v1
i4 v[56:59],v[68:71],a[80:87],v1
i4 v[60:63],v[68:71],a[88:95],v1
i8 lgkmcnt(0)
i4 v[48:51],v[72:75],v[208:215],v1
i4 v[52:55],v[72:75],v[216:223],v1
i4 v[56:59],v[72:75],a[96:103],v1
i4 v[60:63],v[72:75],a[104:111],v1
i3 v48,v48,v49
i3 v49,v50,v51
i3 v50,v52,v53
i3 v51,v54,v55
i27 v[52:55],v[48:49],v[2:3],0
i15 0
i27 v[76:79],v[50:51],v[2:3],0
i3 v56,v56,v57
i3 v57,v58,v59
i3 v58,v60,v61
i3 v59,v62,v63
i21 v0,v[56:59] offset:16384
i3 v48,v52,v53
i3 v49,v54,v55
i15 0
i3 v50,v76,v77
i3 v51,v78,v79
i21 v0,v[48:51] offset:12288
i8 lgkmcnt(0)
s_barrier
i9 v[64:67],v0 offset:9216
i9 v[68:71],v0 offset:10240
i9 v[72:75],v0 offset:11264
i9 v[76:79],v0 offset:12288
i9 v[48:51],v0 offset:15360
i9 v[52:55],v0 offset:16384
i38 v5,v40,v41,v42
i38 v6,v43,v44,v45
i38 v5,v5,v46,v47
i8 lgkmcnt(5)
i2 v[60:63],v[64:67],v[8:11],0
i8 lgkmcnt(4)
i2 v[60:63],v[68:71],v[12:15],v[60:63]
i8 lgkmcnt(3)
i2 v[60:63],v[72:75],v[16:19],v[60:63]
i8 lgkmcnt(2)
i2 v[60:63],v[76:79],v[20:23],v[60:63]
i15 7
i51 v60,0x3e0293ee,v60
i51 v61,0x3e0293ee,v61
i51 v62,0x3e0293ee,v62
i51 v63,0x3e0293ee,v63
i38 v5,v5,v6,v60
i38 v5,v5,v61,v62
v_max_f32 v5, v5, v63
i11 v6,v5
i15 1
v_permlane16_swap_b32 v5, v6
v_max_f32 v5, v5, v6
i11 v6,v5
i15 1
i40 v5,v6
v_max_f32 v5, v5, v6
i33 v40,v40,v5
i33 v41,v41,v5
i33 v42,v42,v5
i33 v43,v43,v5
i33 v44,v44,v5
i33 v45,v45,v5
i33 v46,v46,v5
i33 v47,v47,v5
i33 v60,v60,v5
i33 v61,v61,v5
i33 v62,v62,v5
i33 v63,v63,v5
i19 v40,v40
i19 v41,v41
i19 v42,v42
i19 v43,v43
i19 v44,v44
i19 v45,v45
i19 v46,v46
i19 v47,v47
i19 v60,v60
i19 v61,v61
i19 v62,v62
i19 v63,v63
i14 v[12:13],s[52:53]
i14 v[14:15],s[52:53]
i14 v[16:17],s[54:55]
i3 v20,v40,v41
i3 v21,v42,v43
i3 v22,v44,v45
i3 v23,v46,v47
i3 v18,v60,v61
i3 v19,v62,v63
i8 lgkmcnt(0)
i2 v[8:11],v[12:15],v[20:23],0
i2 v[64:67],v[24:27],v[20:23],0
i2 v[68:71],v[28:31],v[20:23],0
i2 v[72:75],v[32:35],v[20:23],0
i2 v[76:79],v[36:39],v[20:23],0
i27 v[8:11],v[16:17],v[18:19],v[8:11]
i27 v[64:67],v[48:49],v[18:19],v[64:67]
i27 v[68:71],v[50:51],v[18:19],v[68:71]
i27 v[72:75],v[52:53],v[18:19],v[72:75]
i27 v[76:79],v[54:55],v[18:19],v[76:79]
v_rcp_f32 v6, v8
i15 0
i16 v[64:65],v[64:65],v[6:7] op_sel_hi:[1,0]
i16 v[66:67],v[66:67],v[6:7] op_sel_hi:[1,0]
i16 v[68:69],v[68:69],v[6:7] op_sel_hi:[1,0]
i16 v[70:71],v[70:71],v[6:7] op_sel_hi:[1,0]
i16 v[72:73],v[72:73],v[6:7] op_sel_hi:[1,0]
i16 v[74:75],v[74:75],v[6:7] op_sel_hi:[1,0]
i16 v[76:77],v[76:77],v[6:7] op_sel_hi:[1,0]
i16 v[78:79],v[78:79],v[6:7] op_sel_hi:[1,0]
i3 v64,v64,v65
i3 v65,v66,v67
i3 v66,v68,v69
i3 v67,v70,v71
i21 v0,v[64:67] offset:23552
i3 v72,v72,v73
i3 v73,v74,v75
i3 v74,v76,v77
i3 v75,v78,v79
i21 v0,v[72:75] offset:24576
i8 lgkmcnt(0)
s_barrier
i47 s63,0
i22 Lx3s_nr
i20 v40,159744,v0
i20 v41,106496,v0
ds_read_b32 v42, v40 offset:1028
i9 v[72:75],v40 offset:2048
i9 v[76:79],v40 offset:3072
i8 vmcnt(0)
i9 v[8:11],v41 offset:0
i9 v[12:15],v41 offset:1024
i9 v[16:19],v41 offset:2048
i9 v[20:23],v41 offset:3072
i9 v[24:27],v41 offset:4096
i9 v[28:31],v41 offset:5120
i9 v[32:35],v41 offset:6144
i9 v[36:39],v41 offset:7168
i8 lgkmcnt(7)
i2 v[44:47],v[72:75],v[8:11],0
i8 lgkmcnt(6)
i2 v[44:47],v[72:75],v[12:15],v[44:47]
i8 lgkmcnt(5)
i2 v[44:47],v[72:75],v[16:19],v[44:47]
i8 lgkmcnt(4)
i2 v[44:47],v[72:75],v[20:23],v[44:47]
i8 lgkmcnt(3)
i2 v[44:47],v[72:75],v[24:27],v[44:47]
i8 lgkmcnt(2)
i2 v[44:47],v[72:75],v[28:31],v[44:47]
i8 lgkmcnt(1)
i2 v[44:47],v[72:75],v[32:35],v[44:47]
i8 lgkmcnt(0)
i2 v[44:47],v[72:75],v[36:39],v[44:47]
i15 7
i3 v44,v44,v45
i3 v45,v46,v47
i41 v[44:45],v42,s[56:59],s35 offen
i6 s32,s32,1
Lx3s_nr:
i9 v[8:11],v0 offset:17408
i9 v[12:15],v0 offset:18432
i9 v[16:19],v0 offset:19456
i9 v[20:23],v0 offset:20480
i9 v[24:27],v0 offset:21504
i9 v[28:31],v0 offset:22528
i9 v[32:35],v0 offset:23552
i9 v[36:39],v0 offset:24576
s_mul_i32 s24, s20, 36864
i6 s24,s24,s29
i6 s24,s24,27648
i6 s25,s24,4096
i6 s26,s24,8192
i8 lgkmcnt(7)
i2 v[40:43],a[112:115],v[8:11],0
i8 lgkmcnt(6)
i2 v[40:43],a[116:119],v[12:15],v[40:43]
i8 lgkmcnt(5)
i2 v[40:43],a[120:123],v[16:19],v[40:43]
i8 lgkmcnt(4)
i2 v[40:43],a[124:127],v[20:23],v[40:43]
i8 lgkmcnt(3)
i2 v[44:47],a[112:115],v[24:27],0
i8 lgkmcnt(2)
i2 v[44:47],a[116:119],v[28:31],v[44:47]
i8 lgkmcnt(1)
i2 v[44:47],a[120:123],v[32:35],v[44:47]
i8 lgkmcnt(0)
i2 v[44:47],a[124:127],v[36:39],v[44:47]
i2 v[48:51],a[128:131],v[8:11],0
i2 v[48:51],a[132:135],v[12:15],v[48:51]
i2 v[48:51],a[136:139],v[16:19],v[48:51]
i2 v[48:51],a[140:143],v[20:23],v[48:51]
i3 v40,v40,v41
i3 v41,v42,v43
i3 v42,v44,v45
i3 v43,v46,v47
i13 v[40:43],v0,s[8:11],s24 offen offset:0 sc1
i2 v[52:55],a[128:131],v[24:27],0
i2 v[52:55],a[132:135],v[28:31],v[52:55]
i2 v[52:55],a[136:139],v[32:35],v[52:55]
i2 v[52:55],a[140:143],v[36:39],v[52:55]
i2 v[56:59],a[144:147],v[8:11],0
i2 v[56:59],a[148:151],v[12:15],v[56:59]
i2 v[56:59],a[152:155],v[16:19],v[56:59]
i2 v[56:59],a[156:159],v[20:23],v[56:59]
i3 v48,v48,v49
i3 v49,v50,v51
i3 v50,v52,v53
i3 v51,v54,v55
i13 v[48:51],v0,s[8:11],s24 offen offset:1024 sc1
i2 v[60:63],a[144:147],v[24:27],0
i2 v[60:63],a[148:151],v[28:31],v[60:63]
i2 v[60:63],a[152:155],v[32:35],v[60:63]
i2 v[60:63],a[156:159],v[36:39],v[60:63]
i2 v[64:67],a[160:163],v[8:11],0
i2 v[64:67],a[164:167],v[12:15],v[64:67]
i2 v[64:67],a[168:171],v[16:19],v[64:67]
i2 v[64:67],a[172:175],v[20:23],v[64:67]
i3 v56,v56,v57
i3 v57,v58,v59
i3 v58,v60,v61
i3 v59,v62,v63
i13 v[56:59],v0,s[8:11],s24 offen offset:2048 sc1
i2 v[68:71],a[160:163],v[24:27],0
i2 v[68:71],a[164:167],v[28:31],v[68:71]
i2 v[68:71],a[168:171],v[32:35],v[68:71]
i2 v[68:71],a[172:175],v[36:39],v[68:71]
i2 v[72:75],a[176:179],v[8:11],0
i2 v[72:75],a[180:183],v[12:15],v[72:75]
i2 v[72:75],a[184:187],v[16:19],v[72:75]
i2 v[72:75],a[188:191],v[20:23],v[72:75]
i3 v64,v64,v65
i3 v65,v66,v67
i3 v66,v68,v69
i3 v67,v70,v71
i13 v[64:67],v0,s[8:11],s24 offen offset:3072 sc1
i2 v[76:79],a[176:179],v[24:27],0
i2 v[76:79],a[180:183],v[28:31],v[76:79]
i2 v[76:79],a[184:187],v[32:35],v[76:79]
i2 v[76:79],a[188:191],v[36:39],v[76:79]
i2 v[40:43],a[192:195],v[8:11],0
i2 v[40:43],a[196:199],v[12:15],v[40:43]
i2 v[40:43],a[200:203],v[16:19],v[40:43]
i2 v[40:43],a[204:207],v[20:23],v[40:43]
i3 v72,v72,v73
i3 v73,v74,v75
i3 v74,v76,v77
i3 v75,v78,v79
i13 v[72:75],v0,s[8:11],s25 offen offset:0 sc1
i2 v[44:47],a[192:195],v[24:27],0
i2 v[44:47],a[196:199],v[28:31],v[44:47]
i2 v[44:47],a[200:203],v[32:35],v[44:47]
i2 v[44:47],a[204:207],v[36:39],v[44:47]
i2 v[48:51],a[208:211],v[8:11],0
i2 v[48:51],a[212:215],v[12:15],v[48:51]
i2 v[48:51],a[216:219],v[16:19],v[48:51]
i2 v[48:51],a[220:223],v[20:23],v[48:51]
i3 v40,v40,v41
i3 v41,v42,v43
i3 v42,v44,v45
i3 v43,v46,v47
i13 v[40:43],v0,s[8:11],s25 offen offset:1024 sc1
i2 v[52:55],a[208:211],v[24:27],0
i2 v[52:55],a[212:215],v[28:31],v[52:55]
i2 v[52:55],a[216:219],v[32:35],v[52:55]
i2 v[52:55],a[220:223],v[36:39],v[52:55]
i2 v[56:59],a[224:227],v[8:11],0
i2 v[56:59],a[228:231],v[12:15],v[56:59]
i2 v[56:59],a[232:235],v[16:19],v[56:59]
i2 v[56:59],a[236:239],v[20:23],v[56:59]
i3 v48,v48,v49
i3 v49,v50,v51
i3 v50,v52,v53
i3 v51,v54,v55
i13 v[48:51],v0,s[8:11],s25 offen offset:2048 sc1
i2 v[60:63],a[224:227],v[24:27],0
i2 v[60:63],a[228:231],v[28:31],v[60:63]
i2 v[60:63],a[232:235],v[32:35],v[60:63]
i2 v[60:63],a[236:239],v[36:39],v[60:63]
i2 v[64:67],a[240:243],v[8:11],0
i2 v[64:67],a[244:247],v[12:15],v[64:67]
i2 v[64:67],a[248:251],v[16:19],v[64:67]
i2 v[64:67],a[252:255],v[20:23],v[64:67]
i3 v56,v56,v57
i3 v57,v58,v59
i3 v58,v60,v61
i3 v59,v62,v63
i13 v[56:59],v0,s[8:11],s25 offen offset:3072 sc1
i2 v[68:71],a[240:243],v[24:27],0
i2 v[68:71],a[244:247],v[28:31],v[68:71]
i2 v[68:71],a[248:251],v[32:35],v[68:71]
i2 v[68:71],a[252:255],v[36:39],v[68:71]
i3 v64,v64,v65
i3 v65,v66,v67
i15 5
i3 v66,v68,v69
i3 v67,v70,v71
i13 v[64:67],v0,s[8:11],s26 offen offset:0 sc1
i5 s63,1
i5 s34,s29
i5 s35,s30
s_xor_b32 s29, s29, 2097152
i6 s22,s22,3
s_cmp_lt_u32 s22, 64
i22 Lx3s_top
i8 vmcnt(0)
s_barrier
i23 v76,2,v0
i18 v76,0x7c,v76
i36 v77,v76,s[8:11],s33 offen sc1
Lx3s_fl1:
i8 vmcnt(0)
v_cmp_gt_u32 vcc, s32, v77
s_cbranch_vccz Lx3s_fl1k
i36 v77,v76,s[8:11],s33 offen sc1
i6 s31,s31,1
i35 s31,400000
i22 L_endx
i44 Lx3s_fl1
Lx3s_fl1k:
i20 v78,159744,v0
ds_read_b32 v78, v78 offset:1024
i32 s14,s20,10
i6 s14,s14,768
i6 s14,s14,s34
i8 lgkmcnt(0)
i5 m0,106496
i6 s25,s14,0
i1 v78,s[8:11],s25 offen sc1 lds
i5 m0,107520
i6 s25,s14,147456
i1 v78,s[8:11],s25 offen sc1 lds
i5 m0,108544
i6 s25,s14,294912
i1 v78,s[8:11],s25 offen sc1 lds
i5 m0,109568
i6 s25,s14,442368
i1 v78,s[8:11],s25 offen sc1 lds
i5 m0,110592
i6 s25,s14,589824
i1 v78,s[8:11],s25 offen sc1 lds
i5 m0,111616
i6 s25,s14,737280
i1 v78,s[8:11],s25 offen sc1 lds
i5 m0,112640
i6 s25,s14,884736
i1 v78,s[8:11],s25 offen sc1 lds
i5 m0,113664
i6 s25,s14,1032192
i1 v78,s[8:11],s25 offen sc1 lds
i20 v40,159744,v0
i20 v41,106496,v0
ds_read_b32 v42, v40 offset:1028
i9 v[72:75],v40 offset:2048
i9 v[76:79],v40 offset:3072
i8 vmcnt(0)
i9 v[8:11],v41 offset:0
i9 v[12:15],v41 offset:1024
i9 v[16:19],v41 offset:2048
i9 v[20:23],v41 offset:3072
i9 v[24:27],v41 offset:4096
i9 v[28:31],v41 offset:5120
i9 v[32:35],v41 offset:6144
i9 v[36:39],v41 offset:7168
i8 lgkmcnt(7)
i2 v[44:47],v[72:75],v[8:11],0
i8 lgkmcnt(6)
i2 v[44:47],v[72:75],v[12:15],v[44:47]
i8 lgkmcnt(5)
i2 v[44:47],v[72:75],v[16:19],v[44:47]
i8 lgkmcnt(4)
i2 v[44:47],v[72:75],v[20:23],v[44:47]
i8 lgkmcnt(3)
i2 v[44:47],v[72:75],v[24:27],v[44:47]
i8 lgkmcnt(2)
i2 v[44:47],v[72:75],v[28:31],v[44:47]
i8 lgkmcnt(1)
i2 v[44:47],v[72:75],v[32:35],v[44:47]
i8 lgkmcnt(0)
i2 v[44:47],v[72:75],v[36:39],v[44:47]
i15 7
i3 v44,v44,v45
i3 v45,v46,v47
i41 v[44:45],v42,s[56:59],s35 offen
i8 vmcnt(0)
i44 L_endx
L_xw0:
i23 v79,4,v0
i23 v20,2,v79
i18 v21,3,v79
i31 v21,4,v21
i17 v78,v20,13,v21
i32 s24,s20,8
i6 s24,s24,0
i20 v78,s24,v78
i54 s25,1152
s_mul_i32 s24, s20, 147456
i23 v20,1,v79
i18 v21,1,v79
i31 v21,4,v21
i45 v77,v20,s25,v21
i20 v77,s24,v77
i23 v22,4,v79
i34 v23,v79,2,2
i18 v24,3,v79
i17 v20,v22,3,v23
i31 v20,6,v20
i20 v20,16384,v20
i17 v75,v24,3,v20
i23 v21,1,v24
i17 v20,v21,5,v20
i18 v21,1,v24
i17 v76,v21,3,v20
i17 v20,v22,2,v23
i31 v20,5,v20
i17 v74,v24,3,v20
i20 v74,16384,v74
i50 s[64:65],s[0:1],64
i50 s[68:69],s[0:1],72
i50 s[72:73],s[0:1],80
i50 s[56:57],s[0:1],96
i8 lgkmcnt(0)
i5 s58,4718592
i5 s59,0x20000
i5 s66,4718592
i5 s67,0x20000
i5 s70,4718592
i5 s71,0x20000
i5 s74,4718592
i5 s75,0x20000
i5 m0,16384
i5 s24,0
i1 v78,s[64:67],s24 offen lds
i5 m0,17408
i5 s24,131072
i1 v78,s[64:67],s24 offen lds
i5 m0,18432
i5 s24,262144
i1 v78,s[64:67],s24 offen lds
i5 m0,19456
i5 s24,393216
i1 v78,s[64:67],s24 offen lds
i5 m0,20480
i5 s24,524288
i1 v78,s[64:67],s24 offen lds
i5 m0,21504
i5 s24,655360
i1 v78,s[64:67],s24 offen lds
i5 m0,22528
i5 s24,786432
i1 v78,s[64:67],s24 offen lds
i5 m0,23552
i5 s24,917504
i1 v78,s[64:67],s24 offen lds
i5 m0,24576
i5 s24,1048576
i1 v78,s[64:67],s24 offen lds
i5 m0,25600
i5 s24,1179648
i1 v78,s[64:67],s24 offen lds
i5 m0,26624
i5 s24,1310720
i1 v78,s[64:67],s24 offen lds
i5 m0,27648
i5 s24,1441792
i1 v78,s[64:67],s24 offen lds
i5 m0,28672
i5 s24,1572864
i1 v78,s[64:67],s24 offen lds
i5 m0,29696
i5 s24,1703936
i1 v78,s[64:67],s24 offen lds
i5 m0,30720
i5 s24,1835008
i1 v78,s[64:67],s24 offen lds
i5 m0,31744
i5 s24,1966080
i1 v78,s[64:67],s24 offen lds
i5 m0,32768
i5 s24,2097152
i1 v78,s[64:67],s24 offen lds
i5 m0,33792
i5 s24,2228224
i1 v78,s[64:67],s24 offen lds
i5 m0,34816
i5 s24,2359296
i1 v78,s[64:67],s24 offen lds
i5 m0,35840
i5 s24,2490368
i1 v78,s[64:67],s24 offen lds
i5 m0,36864
i5 s24,2621440
i1 v78,s[64:67],s24 offen lds
i5 m0,37888
i5 s24,2752512
i1 v78,s[64:67],s24 offen lds
i5 m0,38912
i5 s24,2883584
i1 v78,s[64:67],s24 offen lds
i5 m0,39936
i5 s24,3014656
i1 v78,s[64:67],s24 offen lds
i5 m0,40960
i5 s24,3145728
i1 v78,s[64:67],s24 offen lds
i5 m0,41984
i5 s24,3276800
i1 v78,s[64:67],s24 offen lds
i5 m0,43008
i5 s24,3407872
i1 v78,s[64:67],s24 offen lds
i5 m0,44032
i5 s24,3538944
i1 v78,s[64:67],s24 offen lds
i5 m0,45056
i5 s24,3670016
i1 v78,s[64:67],s24 offen lds
i5 m0,46080
i5 s24,3801088
i1 v78,s[64:67],s24 offen lds
i5 m0,47104
i5 s24,3932160
i1 v78,s[64:67],s24 offen lds
i5 m0,48128
i5 s24,4063232
i1 v78,s[64:67],s24 offen lds
i8 vmcnt(28)
i0 v[80:81],v76 offset:0
i0 v[82:83],v76 offset:256
i0 v[84:85],v76 offset:2048
i0 v[86:87],v76 offset:2304
i0 v[88:89],v76 offset:16
i0 v[90:91],v76 offset:272
i0 v[92:93],v76 offset:2064
i0 v[94:95],v76 offset:2320
i8 lgkmcnt(0)
i5 m0,16384
i5 s24,4194304
i1 v78,s[64:67],s24 offen lds
i5 m0,17408
i5 s24,4325376
i1 v78,s[64:67],s24 offen lds
i5 m0,18432
i5 s24,4456448
i1 v78,s[64:67],s24 offen lds
i5 m0,19456
i5 s24,4587520
i1 v78,s[64:67],s24 offen lds
i8 vmcnt(28)
i0 v[96:97],v76 offset:4096
i0 v[98:99],v76 offset:4352
i0 v[100:101],v76 offset:6144
i0 v[102:103],v76 offset:6400
i0 v[104:105],v76 offset:4112
i0 v[106:107],v76 offset:4368
i0 v[108:109],v76 offset:6160
i0 v[110:111],v76 offset:6416
i8 lgkmcnt(0)
i5 m0,20480
i5 s24,0
i1 v78,s[68:71],s24 offen lds
i5 m0,21504
i5 s24,131072
i1 v78,s[68:71],s24 offen lds
i5 m0,22528
i5 s24,262144
i1 v78,s[68:71],s24 offen lds
i5 m0,23552
i5 s24,393216
i1 v78,s[68:71],s24 offen lds
i8 vmcnt(28)
i0 v[112:113],v76 offset:8192
i0 v[114:115],v76 offset:8448
i0 v[116:117],v76 offset:10240
i0 v[118:119],v76 offset:10496
i0 v[120:121],v76 offset:8208
i0 v[122:123],v76 offset:8464
i0 v[124:125],v76 offset:10256
i0 v[126:127],v76 offset:10512
i8 lgkmcnt(0)
i5 m0,24576
i5 s24,524288
i1 v78,s[68:71],s24 offen lds
i5 m0,25600
i5 s24,655360
i1 v78,s[68:71],s24 offen lds
i5 m0,26624
i5 s24,786432
i1 v78,s[68:71],s24 offen lds
i5 m0,27648
i5 s24,917504
i1 v78,s[68:71],s24 offen lds
i8 vmcnt(28)
i0 v[128:129],v76 offset:12288
i0 v[130:131],v76 offset:12544
i0 v[132:133],v76 offset:14336
i0 v[134:135],v76 offset:14592
i0 v[136:137],v76 offset:12304
i0 v[138:139],v76 offset:12560
i0 v[140:141],v76 offset:14352
i0 v[142:143],v76 offset:14608
i8 lgkmcnt(0)
i5 m0,28672
i5 s24,1048576
i1 v78,s[68:71],s24 offen lds
i5 m0,29696
i5 s24,1179648
i1 v78,s[68:71],s24 offen lds
i5 m0,30720
i5 s24,1310720
i1 v78,s[68:71],s24 offen lds
i5 m0,31744
i5 s24,1441792
i1 v78,s[68:71],s24 offen lds
i8 vmcnt(28)
i0 v[144:145],v76 offset:16384
i0 v[146:147],v76 offset:16640
i0 v[148:149],v76 offset:18432
i0 v[150:151],v76 offset:18688
i0 v[152:153],v76 offset:16400
i0 v[154:155],v76 offset:16656
i0 v[156:157],v76 offset:18448
i0 v[158:159],v76 offset:18704
i8 lgkmcnt(0)
i5 m0,32768
i5 s24,1572864
i1 v78,s[68:71],s24 offen lds
i5 m0,33792
i5 s24,1703936
i1 v78,s[68:71],s24 offen lds
i5 m0,34816
i5 s24,1835008
i1 v78,s[68:71],s24 offen lds
i5 m0,35840
i5 s24,1966080
i1 v78,s[68:71],s24 offen lds
i8 vmcnt(28)
i0 v[160:161],v76 offset:20480
i0 v[162:163],v76 offset:20736
i0 v[164:165],v76 offset:22528
i0 v[166:167],v76 offset:22784
i0 v[168:169],v76 offset:20496
i0 v[170:171],v76 offset:20752
i0 v[172:173],v76 offset:22544
i0 v[174:175],v76 offset:22800
i8 lgkmcnt(0)
i5 m0,36864
i5 s24,2097152
i1 v78,s[68:71],s24 offen lds
i5 m0,37888
i5 s24,2228224
i1 v78,s[68:71],s24 offen lds
i5 m0,38912
i5 s24,2359296
i1 v78,s[68:71],s24 offen lds
i5 m0,39936
i5 s24,2490368
i1 v78,s[68:71],s24 offen lds
i8 vmcnt(28)
i0 v[176:177],v76 offset:24576
i0 v[178:179],v76 offset:24832
i0 v[180:181],v76 offset:26624
i0 v[182:183],v76 offset:26880
i0 v[184:185],v76 offset:24592
i0 v[186:187],v76 offset:24848
i0 v[188:189],v76 offset:26640
i0 v[190:191],v76 offset:26896
i8 lgkmcnt(0)
i5 m0,40960
i5 s24,2621440
i1 v78,s[68:71],s24 offen lds
i5 m0,41984
i5 s24,2752512
i1 v78,s[68:71],s24 offen lds
i5 m0,43008
i5 s24,2883584
i1 v78,s[68:71],s24 offen lds
i5 m0,44032
i5 s24,3014656
i1 v78,s[68:71],s24 offen lds
i8 vmcnt(28)
i0 v[192:193],v76 offset:28672
i0 v[194:195],v76 offset:28928
i0 v[196:197],v76 offset:30720
i0 v[198:199],v76 offset:30976
i0 v[200:201],v76 offset:28688
i0 v[202:203],v76 offset:28944
i0 v[204:205],v76 offset:30736
i0 v[206:207],v76 offset:30992
i8 lgkmcnt(0)
i5 m0,45056
i5 s24,3145728
i1 v78,s[68:71],s24 offen lds
i5 m0,46080
i5 s24,3276800
i1 v78,s[68:71],s24 offen lds
i5 m0,47104
i5 s24,3407872
i1 v78,s[68:71],s24 offen lds
i5 m0,48128
i5 s24,3538944
i1 v78,s[68:71],s24 offen lds
i8 vmcnt(28)
i0 v[208:209],v76 offset:0
i0 v[210:211],v76 offset:256
i0 v[212:213],v76 offset:2048
i0 v[214:215],v76 offset:2304
i0 v[216:217],v76 offset:16
i0 v[218:219],v76 offset:272
i0 v[220:221],v76 offset:2064
i0 v[222:223],v76 offset:2320
i8 lgkmcnt(0)
i5 m0,16384
i5 s24,3670016
i1 v78,s[68:71],s24 offen lds
i5 m0,17408
i5 s24,3801088
i1 v78,s[68:71],s24 offen lds
i5 m0,18432
i5 s24,3932160
i1 v78,s[68:71],s24 offen lds
i5 m0,19456
i5 s24,4063232
i1 v78,s[68:71],s24 offen lds
i8 vmcnt(28)
i0 v[224:225],v75 offset:4096
i0 v[226:227],v75 offset:4352
i0 v[228:229],v75 offset:6144
i0 v[230:231],v75 offset:6400
i0 v[232:233],v75 offset:4128
i0 v[234:235],v75 offset:4384
i0 v[236:237],v75 offset:6176
i0 v[238:239],v75 offset:6432
i8 lgkmcnt(0)
i5 m0,20480
i5 s24,4194304
i1 v78,s[68:71],s24 offen lds
i5 m0,21504
i5 s24,4325376
i1 v78,s[68:71],s24 offen lds
i5 m0,22528
i5 s24,4456448
i1 v78,s[68:71],s24 offen lds
i5 m0,23552
i5 s24,4587520
i1 v78,s[68:71],s24 offen lds
i8 vmcnt(28)
i0 v[240:241],v75 offset:8192
i0 v[242:243],v75 offset:8448
i0 v[244:245],v75 offset:10240
i0 v[246:247],v75 offset:10496
i0 v[248:249],v75 offset:8224
i0 v[250:251],v75 offset:8480
i0 v[252:253],v75 offset:10272
i0 v[254:255],v75 offset:10528
i8 lgkmcnt(0)
i5 m0,24576
i5 s24,0
i1 v77,s[72:75],s24 offen lds
i5 m0,25600
i5 s24,36864
i1 v77,s[72:75],s24 offen lds
i5 m0,26624
i5 s24,73728
i1 v77,s[72:75],s24 offen lds
i5 m0,27648
i5 s24,110592
i1 v77,s[72:75],s24 offen lds
i8 vmcnt(28)
i0 a[0:1],v75 offset:12288
i0 a[2:3],v75 offset:12544
i0 a[4:5],v75 offset:14336
i0 a[6:7],v75 offset:14592
i0 a[8:9],v75 offset:12320
i0 a[10:11],v75 offset:12576
i0 a[12:13],v75 offset:14368
i0 a[14:15],v75 offset:14624
i8 lgkmcnt(0)
i5 m0,28672
i5 s24,32
i1 v77,s[72:75],s24 offen lds
i5 m0,29696
i5 s24,36896
i1 v77,s[72:75],s24 offen lds
i5 m0,30720
i5 s24,73760
i1 v77,s[72:75],s24 offen lds
i5 m0,31744
i5 s24,110624
i1 v77,s[72:75],s24 offen lds
i8 vmcnt(28)
i0 a[16:17],v75 offset:16384
i0 a[18:19],v75 offset:16640
i0 a[20:21],v75 offset:18432
i0 a[22:23],v75 offset:18688
i0 a[24:25],v75 offset:16416
i0 a[26:27],v75 offset:16672
i0 a[28:29],v75 offset:18464
i0 a[30:31],v75 offset:18720
i8 lgkmcnt(0)
i5 m0,32768
i5 s24,64
i1 v77,s[72:75],s24 offen lds
i5 m0,33792
i5 s24,36928
i1 v77,s[72:75],s24 offen lds
i5 m0,34816
i5 s24,73792
i1 v77,s[72:75],s24 offen lds
i5 m0,35840
i5 s24,110656
i1 v77,s[72:75],s24 offen lds
i8 vmcnt(28)
i0 a[32:33],v75 offset:20480
i0 a[34:35],v75 offset:20736
i0 a[36:37],v75 offset:22528
i0 a[38:39],v75 offset:22784
i0 a[40:41],v75 offset:20512
i0 a[42:43],v75 offset:20768
i0 a[44:45],v75 offset:22560
i0 a[46:47],v75 offset:22816
i8 lgkmcnt(0)
i5 m0,36864
i5 s24,96
i1 v77,s[72:75],s24 offen lds
i5 m0,37888
i5 s24,36960
i1 v77,s[72:75],s24 offen lds
i5 m0,38912
i5 s24,73824
i1 v77,s[72:75],s24 offen lds
i5 m0,39936
i5 s24,110688
i1 v77,s[72:75],s24 offen lds
i8 vmcnt(28)
i0 a[48:49],v75 offset:24576
i0 a[50:51],v75 offset:24832
i0 a[52:53],v75 offset:26624
i0 a[54:55],v75 offset:26880
i0 a[56:57],v75 offset:24608
i0 a[58:59],v75 offset:24864
i0 a[60:61],v75 offset:26656
i0 a[62:63],v75 offset:26912
i8 lgkmcnt(0)
i5 m0,40960
i5 s24,128
i1 v77,s[72:75],s24 offen lds
i5 m0,41984
i5 s24,36992
i1 v77,s[72:75],s24 offen lds
i5 m0,43008
i5 s24,73856
i1 v77,s[72:75],s24 offen lds
i5 m0,44032
i5 s24,110720
i1 v77,s[72:75],s24 offen lds
i8 vmcnt(28)
i0 a[64:65],v75 offset:28672
i0 a[66:67],v75 offset:28928
i0 a[68:69],v75 offset:30720
i0 a[70:71],v75 offset:30976
i0 a[72:73],v75 offset:28704
i0 a[74:75],v75 offset:28960
i0 a[76:77],v75 offset:30752
i0 a[78:79],v75 offset:31008
i8 lgkmcnt(0)
i5 m0,45056
i5 s24,160
i1 v77,s[72:75],s24 offen lds
i5 m0,46080
i5 s24,37024
i1 v77,s[72:75],s24 offen lds
i5 m0,47104
i5 s24,73888
i1 v77,s[72:75],s24 offen lds
i5 m0,48128
i5 s24,110752
i1 v77,s[72:75],s24 offen lds
i8 vmcnt(28)
i0 a[80:81],v75 offset:0
i0 a[82:83],v75 offset:256
i0 a[84:85],v75 offset:2048
i0 a[86:87],v75 offset:2304
i0 a[88:89],v75 offset:32
i0 a[90:91],v75 offset:288
i0 a[92:93],v75 offset:2080
i0 a[94:95],v75 offset:2336
i8 lgkmcnt(0)
i5 m0,16384
i5 s24,192
i1 v77,s[72:75],s24 offen lds
i5 m0,17408
i5 s24,37056
i1 v77,s[72:75],s24 offen lds
i5 m0,18432
i5 s24,73920
i1 v77,s[72:75],s24 offen lds
i5 m0,19456
i5 s24,110784
i1 v77,s[72:75],s24 offen lds
i8 vmcnt(28)
i0 a[96:97],v75 offset:4096
i0 a[98:99],v75 offset:4352
i0 a[100:101],v75 offset:6144
i0 a[102:103],v75 offset:6400
i0 a[104:105],v75 offset:4128
i0 a[106:107],v75 offset:4384
i0 a[108:109],v75 offset:6176
i0 a[110:111],v75 offset:6432
i8 lgkmcnt(0)
i5 m0,20480
i5 s24,224
i1 v77,s[72:75],s24 offen lds
i5 m0,21504
i5 s24,37088
i1 v77,s[72:75],s24 offen lds
i5 m0,22528
i5 s24,73952
i1 v77,s[72:75],s24 offen lds
i5 m0,23552
i5 s24,110816
i1 v77,s[72:75],s24 offen lds
i8 vmcnt(28)
i0 a[112:113],v74 offset:8192
i0 a[114:115],v74 offset:8704
i0 a[116:117],v74 offset:9216
i0 a[118:119],v74 offset:9728
i0 a[120:121],v74 offset:10240
i0 a[122:123],v74 offset:10752
i0 a[124:125],v74 offset:11264
i0 a[126:127],v74 offset:11776
i8 lgkmcnt(0)
i5 m0,24576
i5 s24,256
i1 v77,s[72:75],s24 offen lds
i5 m0,25600
i5 s24,37120
i1 v77,s[72:75],s24 offen lds
i5 m0,26624
i5 s24,73984
i1 v77,s[72:75],s24 offen lds
i5 m0,27648
i5 s24,110848
i1 v77,s[72:75],s24 offen lds
i8 vmcnt(28)
i0 a[128:129],v74 offset:12288
i0 a[130:131],v74 offset:12800
i0 a[132:133],v74 offset:13312
i0 a[134:135],v74 offset:13824
i0 a[136:137],v74 offset:14336
i0 a[138:139],v74 offset:14848
i0 a[140:141],v74 offset:15360
i0 a[142:143],v74 offset:15872
i8 lgkmcnt(0)
i8 vmcnt(24)
i0 a[144:145],v74 offset:16384
i0 a[146:147],v74 offset:16896
i0 a[148:149],v74 offset:17408
i0 a[150:151],v74 offset:17920
i0 a[152:153],v74 offset:18432
i0 a[154:155],v74 offset:18944
i0 a[156:157],v74 offset:19456
i0 a[158:159],v74 offset:19968
i8 lgkmcnt(0)
i8 vmcnt(20)
i0 a[160:161],v74 offset:20480
i0 a[162:163],v74 offset:20992
i0 a[164:165],v74 offset:21504
i0 a[166:167],v74 offset:22016
i0 a[168:169],v74 offset:22528
i0 a[170:171],v74 offset:23040
i0 a[172:173],v74 offset:23552
i0 a[174:175],v74 offset:24064
i8 lgkmcnt(0)
i8 vmcnt(16)
i0 a[176:177],v74 offset:24576
i0 a[178:179],v74 offset:25088
i0 a[180:181],v74 offset:25600
i0 a[182:183],v74 offset:26112
i0 a[184:185],v74 offset:26624
i0 a[186:187],v74 offset:27136
i0 a[188:189],v74 offset:27648
i0 a[190:191],v74 offset:28160
i8 lgkmcnt(0)
i8 vmcnt(12)
i0 a[192:193],v74 offset:28672
i0 a[194:195],v74 offset:29184
i0 a[196:197],v74 offset:29696
i0 a[198:199],v74 offset:30208
i0 a[200:201],v74 offset:30720
i0 a[202:203],v74 offset:31232
i0 a[204:205],v74 offset:31744
i0 a[206:207],v74 offset:32256
i8 lgkmcnt(0)
i8 vmcnt(8)
i0 a[208:209],v74 offset:0
i0 a[210:211],v74 offset:512
i0 a[212:213],v74 offset:1024
i0 a[214:215],v74 offset:1536
i0 a[216:217],v74 offset:2048
i0 a[218:219],v74 offset:2560
i0 a[220:221],v74 offset:3072
i0 a[222:223],v74 offset:3584
i8 lgkmcnt(0)
i8 vmcnt(4)
i0 a[224:225],v74 offset:4096
i0 a[226:227],v74 offset:4608
i0 a[228:229],v74 offset:5120
i0 a[230:231],v74 offset:5632
i0 a[232:233],v74 offset:6144
i0 a[234:235],v74 offset:6656
i0 a[236:237],v74 offset:7168
i0 a[238:239],v74 offset:7680
i8 lgkmcnt(0)
i8 vmcnt(0)
i0 a[240:241],v74 offset:8192
i0 a[242:243],v74 offset:8704
i0 a[244:245],v74 offset:9216
i0 a[246:247],v74 offset:9728
i0 a[248:249],v74 offset:10240
i0 a[250:251],v74 offset:10752
i0 a[252:253],v74 offset:11264
i0 a[254:255],v74 offset:11776
i8 lgkmcnt(0)
i34 v21,v79,3,1
i25 vcc,1,v21
i11 v1,0x8888
i11 v20,0xdddd
i26 v1,v1,v20,vcc
i18 v20,7,v79
i34 v21,v79,4,1
i31 v21,2,v21
v_sub_u32 v20, v20, v21
i18 v21,1,v20
i31 v21,4,v21
i11 v22,0x3f80
i31 v22,v21,v22
v_ashrrev_i32 v20, 1, v20
i25 vcc,0,v20
i15 1
i26 v2,0,v22,vcc
i25 vcc,1,v20
i15 1
i26 v3,0,v22,vcc
i18 v4,0x33f,v0
i34 v20,v0,7,1
i24 v4,v20,6,v4
i34 v20,v0,6,1
i24 v4,v20,7,v4
i18 v20,16,v0
i11 v22,0x3f80
i31 v22,v20,v22
i34 v20,v0,5,3
i25 vcc,0,v20
i15 1
i26 v12,0,v22,vcc
i25 vcc,1,v20
i15 1
i26 v13,0,v22,vcc
i25 vcc,2,v20
i15 1
i26 v14,0,v22,vcc
i25 vcc,3,v20
i15 1
i26 v15,0,v22,vcc
i25 vcc,4,v20
i15 1
i26 v16,0,v22,vcc
i25 vcc,5,v20
i15 1
i26 v17,0,v22,vcc
i25 vcc,6,v20
i15 1
i26 v18,0,v22,vcc
i25 vcc,7,v20
i15 1
i26 v19,0,v22,vcc
i34 v20,v79,3,1
i18 v21,7,v79
i17 v20,v20,4,v21
i23 v21,5,v79
i34 v22,v79,4,1
i31 v22,2,v22
i17 v21,v21,4,v22
v_sub_u32 v21, v20, v21
i20 v21,0,v21
v_cmp_le_i32 s[36:37], 0, v21
v_cmp_le_i32 s[38:39], 1, v21
v_cmp_le_i32 s[40:41], 2, v21
v_cmp_le_i32 s[42:43], 3, v21
v_cmp_le_i32 s[44:45], 8, v21
v_cmp_le_i32 s[46:47], 9, v21
v_cmp_le_i32 s[48:49], 10, v21
v_cmp_le_i32 s[50:51], 11, v21
i23 v21,4,v79
i5 s25,36864
i18 v22,0xf0,v0
i45 v8,v21,s25,v22
i34 v22,v79,4,1
i17 v20,v22,3,v20
i54 s25,2304
i43 v9,s25,v20
i32 s24,s20,2
i6 s24,s24,0
i32 s24,s24,3
i6 s24,s24,1152
i32 s25,s20,3
i6 s25,s25,2176
s_cmp_lt_u32 s20, 16
i28 s62,1,0
i47 s62,1
i28 s25,s25,0x80000000
i11 v21,s24
i11 v22,s25
v_cmp_lt_u32 vcc, 31, v79
i15 1
i26 v21,v21,v22,vcc
i20 v9,v9,v21
i5 s52,0x3f803f80
i5 s53,0x3f803f80
i5 s54,0x3f003f00
i5 s55,0x3f003f00
i5 s31,0
i5 s63,0
i5 s34,0x80000000
i5 s18,2147516416
i5 s22,s19
i5 s32,1
i32 s33,s19,7
i6 s33,s33,74448896
s_mul_i32 s29, s19, 4194304
i6 s29,s29,75497472
i20 v20,147456,v0
i21 v20,v[2:5]
i21 v20,v[8:11] offset:1024
i21 v20,v[12:15] offset:2048
i21 v20,v[16:19] offset:3072
i8 lgkmcnt(0)
s_barrier
i11 v40,0
i5 s94,0
i46 s21,0
i22 L_xb0b
i39 exec,1
L_xb0:
i55 v41,v40,s[100:101] offset:48 sc1
i6 s94,s94,1
i35 s94,400000
i22 L_endx
i8 vmcnt(0)
v_cmp_gt_u32 vcc, 32, v41
i49 L_xb0z
i44 L_xb0k
L_xb0z:
s_sleep 4
i44 L_xb0
L_xb0k:
i39 exec,-1
L_xb0b:
s_barrier
i47 s99,2
i22 L_xs0
Lx0f_top:
i32 s27,s22,18
i32 s24,s20,13
i6 s27,s27,s24
i32 s28,s22,14
i6 s28,s28,72351744
s_mul_i32 s30, s22, 73728
s_and_b32 s24, s22, 7
s_cmp_ge_u32 s24, 3
i22 Lx0f_rdyk
s_lshr_b32 s24, s22, 3
i32 s24,s24,2
i11 v5,s24
i39 exec,1
Lx0f_rdy:
i55 v6,v5,s[100:101] offset:64 sc1
i55 v7,v5,s[100:101] offset:96 sc1
i6 s31,s31,1
i35 s31,400000
i22 L_endx
i8 vmcnt(0)
i17 v6,v7,1,v6
v_cmp_ne_u32 vcc, 0x80, v6
s_cbranch_vccz Lx0f_rdyj
s_sleep 16
i44 Lx0f_rdy
Lx0f_rdyj:
i39 exec,-1
s_barrier
Lx0f_rdyk:
s_bitcmp1_b32 s18, 31
s_cbranch_scc0 Lx0f_pre
s_bitset0_b32 s18, 31
i6 m0,s18,0
i6 s25,s27,33554432
i1 v0,s[8:11],s25 offen sc1 lds
i6 m0,s18,1024
i6 s25,s27,33555456
i1 v0,s[8:11],s25 offen sc1 lds
i6 m0,s18,8192
i6 s25,s27,0
i1 v0,s[8:11],s25 offen sc1 lds
i6 m0,s18,9216
i6 s25,s27,1024
i1 v0,s[8:11],s25 offen sc1 lds
i6 m0,s18,16384
i6 s25,s27,16777216
i1 v0,s[8:11],s25 offen sc1 lds
i6 m0,s18,17408
i6 s25,s27,16778240
i1 v0,s[8:11],s25 offen sc1 lds
Lx0f_pre:
i20 v6,s18,v0
i8 vmcnt(0)
s_barrier
i47 s63,0
i22 Lx0f_nf
i32 s24,s20,2
i6 s24,s24,s33
i11 v76,s32
i11 v77,0
i39 exec,1
i52 v76,v77,s[8:11],s24 offen
i39 exec,-1
Lx0f_nf:
i9 v[8:11],v6 offset:0
i9 v[48:51],v6 offset:8192
i9 v[12:15],v6 offset:2048
i9 v[52:55],v6 offset:10240
i9 v[16:19],v6 offset:4096
i9 v[56:59],v6 offset:12288
i9 v[20:23],v6 offset:6144
i9 v[60:63],v6 offset:14336
i9 v[24:27],v6 offset:9216
i9 v[28:31],v6 offset:11264
i9 v[32:35],v6 offset:13312
i9 v[36:39],v6 offset:15360
i8 lgkmcnt(10)
i2 v[40:43],v[48:51],v[8:11],0
i8 lgkmcnt(8)
i2 v[40:43],v[52:55],v[12:15],v[40:43]
i8 lgkmcnt(6)
i2 v[40:43],v[56:59],v[16:19],v[40:43]
i8 lgkmcnt(4)
i2 v[40:43],v[60:63],v[20:23],v[40:43]
i8 lgkmcnt(3)
i2 v[44:47],v[24:27],v[8:11],0
i8 lgkmcnt(2)
i2 v[44:47],v[28:31],v[12:15],v[44:47]
i8 lgkmcnt(1)
i2 v[44:47],v[32:35],v[16:19],v[44:47]
i8 lgkmcnt(0)
i2 v[44:47],v[36:39],v[20:23],v[44:47]
i9 v[24:27],v6 offset:16384
i9 v[28:31],v6 offset:17408
i9 v[32:35],v6 offset:18432
i9 v[36:39],v6 offset:19456
i11 v5,0xff800000
i26 v40,v5,v40,s[36:37]
i26 v41,v5,v41,s[38:39]
i26 v42,v5,v42,s[40:41]
i26 v43,v5,v43,s[42:43]
i26 v44,v5,v44,s[44:45]
i26 v45,v5,v45,s[46:47]
i26 v46,v5,v46,s[48:49]
i26 v47,v5,v47,s[50:51]
Lx0f_h:
i6 s24,s28,0
i1 v[64:67],v4,s[8:11],s24 offen sc1
i6 s24,s28,4096
i1 v[68:71],v4,s[8:11],s24 offen sc1
i23 v76,2,v0
i18 v76,0x7c,v76
i36 v77,v76,s[8:11],s33 offen sc1
i6 s31,s31,1
i35 s31,400000
i22 L_endx
i8 vmcnt(0)
i48 v5,v64,v65,v66
i48 v5,v5,v67,v68
i48 v5,v5,v69,v70
v_max_u32 v5, v5, v71
i25 vcc,-1,v5
s_cbranch_vccz Lx0f_hk
s_cmp_ge_u32 s22, 60
i22 Lx0f_h
i11 v6,0
i39 exec,1
Lx0f_hl:
s_sleep 12
i36 v5,v6,s[8:11],s28 offen sc1
i6 s31,s31,1
i35 s31,400000
i22 L_endx
i8 vmcnt(0)
i25 vcc,-1,v5
i49 Lx0f_hl
i39 exec,-1
i44 Lx0f_h
Lx0f_hk:
i21 v0,v[64:67] offset:0
i21 v0,v[68:71] offset:4096
i47 s63,0
i22 Lx0f_nq
Lx0f_fl0:
i8 vmcnt(0)
v_cmp_gt_u32 vcc, s32, v77
s_cbranch_vccz Lx0f_fl0k
i36 v77,v76,s[8:11],s33 offen sc1
i6 s31,s31,1
i35 s31,400000
i22 L_endx
i44 Lx0f_fl0
Lx0f_fl0k:
Lx0f_nq:
i20 v78,147456,v0
ds_read_b32 v78, v78 offset:1024
i32 s14,s20,10
i6 s14,s14,0
i6 s14,s14,s34
i32 s15,s20,8
i6 s15,s15,32768
i6 s15,s15,s34
i47 s62,0
i28 s15,0x80000000,s15
s_xor_b32 s16, s18, 24576
i6 s24,s22,3
s_xor_b32 s24, s24, s22
s_cmp_ge_u32 s24, 8
i28 s24,0x80000000,0
s_or_b32 s18, s16, s24
i6 s26,s27,786432
s_or_b32 s26, s26, s24
i14 v[48:49],0
i14 v[50:51],0
i14 v[52:53],0
i14 v[54:55],0
i14 v[56:57],0
i14 v[58:59],0
i14 v[60:61],0
i14 v[62:63],0
i8 lgkmcnt(0)
s_barrier
i9 v[64:67],v0 offset:0
i9 v[68:71],v0 offset:1024
i9 v[72:75],v0 offset:2048
i8 lgkmcnt(2)
i4 v[48:51],v[64:67],v[80:87],v1
i5 m0,81920
i6 s25,s14,0
i1 v78,s[8:11],s25 offen sc1 lds
i4 v[52:55],v[64:67],v[88:95],v1
i4 v[56:59],v[64:67],v[224:231],v1
i5 m0,82944
i6 s25,s14,147456
i1 v78,s[8:11],s25 offen sc1 lds
i4 v[60:63],v[64:67],v[232:239],v1
i9 v[64:67],v0 offset:3072
i8 lgkmcnt(2)
i4 v[48:51],v[68:71],v[96:103],v1
i5 m0,83968
i6 s25,s14,294912
i1 v78,s[8:11],s25 offen sc1 lds
i4 v[52:55],v[68:71],v[104:111],v1
i4 v[56:59],v[68:71],v[240:247],v1
i5 m0,84992
i6 s25,s14,442368
i1 v78,s[8:11],s25 offen sc1 lds
i4 v[60:63],v[68:71],v[248:255],v1
i9 v[68:71],v0 offset:4096
i8 lgkmcnt(2)
i4 v[48:51],v[72:75],v[112:119],v1
i5 m0,86016
i6 s25,s14,589824
i1 v78,s[8:11],s25 offen sc1 lds
i4 v[52:55],v[72:75],v[120:127],v1
i4 v[56:59],v[72:75],a[0:7],v1
i5 m0,87040
i6 s25,s14,737280
i1 v78,s[8:11],s25 offen sc1 lds
i4 v[60:63],v[72:75],a[8:15],v1
i9 v[72:75],v0 offset:5120
i8 lgkmcnt(2)
i4 v[48:51],v[64:67],v[128:135],v1
i5 m0,88064
i6 s25,s14,884736
i1 v78,s[8:11],s25 offen sc1 lds
i4 v[52:55],v[64:67],v[136:143],v1
i4 v[56:59],v[64:67],a[16:23],v1
i5 m0,89088
i6 s25,s14,1032192
i1 v78,s[8:11],s25 offen sc1 lds
i4 v[60:63],v[64:67],a[24:31],v1
i9 v[64:67],v0 offset:6144
i8 lgkmcnt(2)
i4 v[48:51],v[68:71],v[144:151],v1
i5 m0,114688
i6 s25,s15,0
i1 v78,s[8:11],s25 offen sc1 lds
i4 v[52:55],v[68:71],v[152:159],v1
i4 v[56:59],v[68:71],a[32:39],v1
i5 m0,115712
i6 s25,s15,147456
i1 v78,s[8:11],s25 offen sc1 lds
i4 v[60:63],v[68:71],a[40:47],v1
i9 v[68:71],v0 offset:7168
i8 lgkmcnt(2)
i4 v[48:51],v[72:75],v[160:167],v1
i5 m0,116736
i6 s25,s15,294912
i1 v78,s[8:11],s25 offen sc1 lds
i4 v[52:55],v[72:75],v[168:175],v1
i4 v[56:59],v[72:75],a[48:55],v1
i5 m0,117760
i6 s25,s15,442368
i1 v78,s[8:11],s25 offen sc1 lds
i4 v[60:63],v[72:75],a[56:63],v1
i9 v[72:75],v0 offset:8192
i8 lgkmcnt(2)
i4 v[48:51],v[64:67],v[176:183],v1
i5 m0,118784
i6 s25,s15,589824
i1 v78,s[8:11],s25 offen sc1 lds
i4 v[52:55],v[64:67],v[184:191],v1
i4 v[56:59],v[64:67],a[64:71],v1
i5 m0,119808
i6 s25,s15,737280
i1 v78,s[8:11],s25 offen sc1 lds
i4 v[60:63],v[64:67],a[72:79],v1
i8 lgkmcnt(1)
i4 v[48:51],v[68:71],v[192:199],v1
i5 m0,120832
i6 s25,s15,884736
i1 v78,s[8:11],s25 offen sc1 lds
i4 v[52:55],v[68:71],v[200:207],v1
i4 v[56:59],v[68:71],a[80:87],v1
i5 m0,121856
i6 s25,s15,1032192
i1 v78,s[8:11],s25 offen sc1 lds
i4 v[60:63],v[68:71],a[88:95],v1
i8 lgkmcnt(0)
i4 v[48:51],v[72:75],v[208:215],v1
i6 m0,s16,0
i6 s25,s26,33554432
i1 v0,s[8:11],s25 offen sc1 lds
i4 v[52:55],v[72:75],v[216:223],v1
i4 v[56:59],v[72:75],a[96:103],v1
i6 m0,s16,1024
i6 s25,s26,33555456
i1 v0,s[8:11],s25 offen sc1 lds
i4 v[60:63],v[72:75],a[104:111],v1
i6 m0,s16,8192
i6 s25,s26,0
i1 v0,s[8:11],s25 offen sc1 lds
i6 m0,s16,9216
i6 s25,s26,1024
i1 v0,s[8:11],s25 offen sc1 lds
i6 m0,s16,16384
i6 s25,s26,16777216
i1 v0,s[8:11],s25 offen sc1 lds
i6 m0,s16,17408
i6 s25,s26,16778240
i1 v0,s[8:11],s25 offen sc1 lds
i3 v48,v48,v49
i3 v49,v50,v51
i3 v50,v52,v53
i3 v51,v54,v55
i27 v[52:55],v[48:49],v[2:3],0
i15 0
i27 v[76:79],v[50:51],v[2:3],0
i3 v56,v56,v57
i3 v57,v58,v59
i3 v58,v60,v61
i3 v59,v62,v63
i21 v0,v[56:59] offset:13312
i3 v48,v52,v53
i3 v49,v54,v55
i15 0
i3 v50,v76,v77
i3 v51,v78,v79
i21 v0,v[48:51] offset:9216
i8 lgkmcnt(0)
s_barrier
i9 v[64:67],v0 offset:9216
i9 v[68:71],v0 offset:10240
i9 v[72:75],v0 offset:11264
i9 v[76:79],v0 offset:12288
i9 v[48:51],v0 offset:13312
i9 v[52:55],v0 offset:14336
i38 v5,v40,v41,v42
i38 v6,v43,v44,v45
i38 v5,v5,v46,v47
i8 lgkmcnt(5)
i2 v[60:63],v[64:67],v[8:11],0
i8 lgkmcnt(4)
i2 v[60:63],v[68:71],v[12:15],v[60:63]
i8 lgkmcnt(3)
i2 v[60:63],v[72:75],v[16:19],v[60:63]
i8 lgkmcnt(2)
i2 v[60:63],v[76:79],v[20:23],v[60:63]
i15 7
i51 v60,0x3e0293ee,v60
i51 v61,0x3e0293ee,v61
i51 v62,0x3e0293ee,v62
i51 v63,0x3e0293ee,v63
i38 v5,v5,v6,v60
i38 v5,v5,v61,v62
v_max_f32 v5, v5, v63
i11 v6,v5
i15 1
v_permlane16_swap_b32 v5, v6
v_max_f32 v5, v5, v6
i11 v6,v5
i15 1
i40 v5,v6
v_max_f32 v5, v5, v6
i33 v40,v40,v5
i33 v41,v41,v5
i33 v42,v42,v5
i33 v43,v43,v5
i33 v44,v44,v5
i33 v45,v45,v5
i33 v46,v46,v5
i33 v47,v47,v5
i33 v60,v60,v5
i33 v61,v61,v5
i33 v62,v62,v5
i33 v63,v63,v5
i19 v40,v40
i19 v41,v41
i19 v42,v42
i19 v43,v43
i19 v44,v44
i19 v45,v45
i19 v46,v46
i19 v47,v47
i19 v60,v60
i19 v61,v61
i19 v62,v62
i19 v63,v63
i14 v[12:13],s[52:53]
i14 v[14:15],s[52:53]
i14 v[16:17],s[54:55]
i3 v20,v40,v41
i3 v21,v42,v43
i3 v22,v44,v45
i3 v23,v46,v47
i3 v18,v60,v61
i3 v19,v62,v63
i8 lgkmcnt(0)
i2 v[8:11],v[12:15],v[20:23],0
i2 v[64:67],v[24:27],v[20:23],0
i2 v[68:71],v[28:31],v[20:23],0
i2 v[72:75],v[32:35],v[20:23],0
i2 v[76:79],v[36:39],v[20:23],0
i27 v[8:11],v[16:17],v[18:19],v[8:11]
i27 v[64:67],v[48:49],v[18:19],v[64:67]
i27 v[68:71],v[50:51],v[18:19],v[68:71]
i27 v[72:75],v[52:53],v[18:19],v[72:75]
i27 v[76:79],v[54:55],v[18:19],v[76:79]
v_rcp_f32 v6, v8
i15 0
i16 v[64:65],v[64:65],v[6:7] op_sel_hi:[1,0]
i16 v[66:67],v[66:67],v[6:7] op_sel_hi:[1,0]
i16 v[68:69],v[68:69],v[6:7] op_sel_hi:[1,0]
i16 v[70:71],v[70:71],v[6:7] op_sel_hi:[1,0]
i16 v[72:73],v[72:73],v[6:7] op_sel_hi:[1,0]
i16 v[74:75],v[74:75],v[6:7] op_sel_hi:[1,0]
i16 v[76:77],v[76:77],v[6:7] op_sel_hi:[1,0]
i16 v[78:79],v[78:79],v[6:7] op_sel_hi:[1,0]
i3 v64,v64,v65
i3 v65,v66,v67
i3 v66,v68,v69
i3 v67,v70,v71
i21 v0,v[64:67] offset:17408
i3 v72,v72,v73
i3 v73,v74,v75
i3 v74,v76,v77
i3 v75,v78,v79
i21 v0,v[72:75] offset:18432
i8 lgkmcnt(0)
s_barrier
i47 s63,0
i22 Lx0f_nr
i20 v40,147456,v0
i20 v41,81920,v0
ds_read_b32 v42, v40 offset:1028
i9 v[72:75],v40 offset:2048
i9 v[76:79],v40 offset:3072
i8 vmcnt(0)
i9 v[8:11],v41 offset:0
i9 v[12:15],v41 offset:1024
i9 v[16:19],v41 offset:2048
i9 v[20:23],v41 offset:3072
i9 v[24:27],v41 offset:4096
i9 v[28:31],v41 offset:5120
i9 v[32:35],v41 offset:6144
i9 v[36:39],v41 offset:7168
i8 lgkmcnt(7)
i2 v[44:47],v[72:75],v[8:11],0
i8 lgkmcnt(6)
i2 v[44:47],v[72:75],v[12:15],v[44:47]
i8 lgkmcnt(5)
i2 v[44:47],v[72:75],v[16:19],v[44:47]
i8 lgkmcnt(4)
i2 v[44:47],v[72:75],v[20:23],v[44:47]
i8 lgkmcnt(3)
i2 v[44:47],v[72:75],v[24:27],v[44:47]
i8 lgkmcnt(2)
i2 v[44:47],v[72:75],v[28:31],v[44:47]
i8 lgkmcnt(1)
i2 v[44:47],v[72:75],v[32:35],v[44:47]
i8 lgkmcnt(0)
i2 v[44:47],v[72:75],v[36:39],v[44:47]
i47 s62,0
i22 Lx0f_two0
i9 v[8:11],v41 offset:32768
i9 v[12:15],v41 offset:33792
i9 v[16:19],v41 offset:34816
i9 v[20:23],v41 offset:35840
i9 v[24:27],v41 offset:36864
i9 v[28:31],v41 offset:37888
i9 v[32:35],v41 offset:38912
i9 v[36:39],v41 offset:39936
i8 lgkmcnt(7)
i2 v[44:47],v[76:79],v[8:11],v[44:47]
i8 lgkmcnt(6)
i2 v[44:47],v[76:79],v[12:15],v[44:47]
i8 lgkmcnt(5)
i2 v[44:47],v[76:79],v[16:19],v[44:47]
i8 lgkmcnt(4)
i2 v[44:47],v[76:79],v[20:23],v[44:47]
i8 lgkmcnt(3)
i2 v[44:47],v[76:79],v[24:27],v[44:47]
i8 lgkmcnt(2)
i2 v[44:47],v[76:79],v[28:31],v[44:47]
i8 lgkmcnt(1)
i2 v[44:47],v[76:79],v[32:35],v[44:47]
i8 lgkmcnt(0)
i2 v[44:47],v[76:79],v[36:39],v[44:47]
Lx0f_two0:
i15 7
i3 v44,v44,v45
i3 v45,v46,v47
i41 v[44:45],v42,s[56:59],s35 offen
i6 s32,s32,1
Lx0f_nr:
i9 v[8:11],v0 offset:17408
i9 v[12:15],v0 offset:18432
i9 v[16:19],v0 offset:19456
i9 v[20:23],v0 offset:20480
i9 v[24:27],v0 offset:21504
i9 v[28:31],v0 offset:22528
i9 v[32:35],v0 offset:23552
i9 v[36:39],v0 offset:24576
s_mul_i32 s24, s20, 36864
i6 s24,s24,s29
i6 s24,s24,0
i6 s25,s24,4096
i6 s26,s24,8192
i8 lgkmcnt(7)
i2 v[40:43],a[112:115],v[8:11],0
i8 lgkmcnt(6)
i2 v[40:43],a[116:119],v[12:15],v[40:43]
i8 lgkmcnt(5)
i2 v[40:43],a[120:123],v[16:19],v[40:43]
i8 lgkmcnt(4)
i2 v[40:43],a[124:127],v[20:23],v[40:43]
i8 lgkmcnt(3)
i2 v[44:47],a[112:115],v[24:27],0
i8 lgkmcnt(2)
i2 v[44:47],a[116:119],v[28:31],v[44:47]
i8 lgkmcnt(1)
i2 v[44:47],a[120:123],v[32:35],v[44:47]
i8 lgkmcnt(0)
i2 v[44:47],a[124:127],v[36:39],v[44:47]
i2 v[48:51],a[128:131],v[8:11],0
i2 v[48:51],a[132:135],v[12:15],v[48:51]
i2 v[48:51],a[136:139],v[16:19],v[48:51]
i2 v[48:51],a[140:143],v[20:23],v[48:51]
i3 v40,v40,v41
i3 v41,v42,v43
i3 v42,v44,v45
i3 v43,v46,v47
i13 v[40:43],v0,s[8:11],s24 offen offset:0
i2 v[52:55],a[128:131],v[24:27],0
i2 v[52:55],a[132:135],v[28:31],v[52:55]
i2 v[52:55],a[136:139],v[32:35],v[52:55]
i2 v[52:55],a[140:143],v[36:39],v[52:55]
i2 v[56:59],a[144:147],v[8:11],0
i2 v[56:59],a[148:151],v[12:15],v[56:59]
i2 v[56:59],a[152:155],v[16:19],v[56:59]
i2 v[56:59],a[156:159],v[20:23],v[56:59]
i3 v48,v48,v49
i3 v49,v50,v51
i3 v50,v52,v53
i3 v51,v54,v55
i13 v[48:51],v0,s[8:11],s24 offen offset:1024
i2 v[60:63],a[144:147],v[24:27],0
i2 v[60:63],a[148:151],v[28:31],v[60:63]
i2 v[60:63],a[152:155],v[32:35],v[60:63]
i2 v[60:63],a[156:159],v[36:39],v[60:63]
i2 v[64:67],a[160:163],v[8:11],0
i2 v[64:67],a[164:167],v[12:15],v[64:67]
i2 v[64:67],a[168:171],v[16:19],v[64:67]
i2 v[64:67],a[172:175],v[20:23],v[64:67]
i3 v56,v56,v57
i3 v57,v58,v59
i3 v58,v60,v61
i3 v59,v62,v63
i13 v[56:59],v0,s[8:11],s24 offen offset:2048
i2 v[68:71],a[160:163],v[24:27],0
i2 v[68:71],a[164:167],v[28:31],v[68:71]
i2 v[68:71],a[168:171],v[32:35],v[68:71]
i2 v[68:71],a[172:175],v[36:39],v[68:71]
i2 v[72:75],a[176:179],v[8:11],0
i2 v[72:75],a[180:183],v[12:15],v[72:75]
i2 v[72:75],a[184:187],v[16:19],v[72:75]
i2 v[72:75],a[188:191],v[20:23],v[72:75]
i3 v64,v64,v65
i3 v65,v66,v67
i3 v66,v68,v69
i3 v67,v70,v71
i13 v[64:67],v0,s[8:11],s24 offen offset:3072
i2 v[76:79],a[176:179],v[24:27],0
i2 v[76:79],a[180:183],v[28:31],v[76:79]
i2 v[76:79],a[184:187],v[32:35],v[76:79]
i2 v[76:79],a[188:191],v[36:39],v[76:79]
i2 v[40:43],a[192:195],v[8:11],0
i2 v[40:43],a[196:199],v[12:15],v[40:43]
i2 v[40:43],a[200:203],v[16:19],v[40:43]
i2 v[40:43],a[204:207],v[20:23],v[40:43]
i3 v72,v72,v73
i3 v73,v74,v75
i3 v74,v76,v77
i3 v75,v78,v79
i13 v[72:75],v0,s[8:11],s25 offen offset:0
i2 v[44:47],a[192:195],v[24:27],0
i2 v[44:47],a[196:199],v[28:31],v[44:47]
i2 v[44:47],a[200:203],v[32:35],v[44:47]
i2 v[44:47],a[204:207],v[36:39],v[44:47]
i2 v[48:51],a[208:211],v[8:11],0
i2 v[48:51],a[212:215],v[12:15],v[48:51]
i2 v[48:51],a[216:219],v[16:19],v[48:51]
i2 v[48:51],a[220:223],v[20:23],v[48:51]
i3 v40,v40,v41
i3 v41,v42,v43
i3 v42,v44,v45
i3 v43,v46,v47
i13 v[40:43],v0,s[8:11],s25 offen offset:1024
i2 v[52:55],a[208:211],v[24:27],0
i2 v[52:55],a[212:215],v[28:31],v[52:55]
i2 v[52:55],a[216:219],v[32:35],v[52:55]
i2 v[52:55],a[220:223],v[36:39],v[52:55]
i2 v[56:59],a[224:227],v[8:11],0
i2 v[56:59],a[228:231],v[12:15],v[56:59]
i2 v[56:59],a[232:235],v[16:19],v[56:59]
i2 v[56:59],a[236:239],v[20:23],v[56:59]
i3 v48,v48,v49
i3 v49,v50,v51
i3 v50,v52,v53
i3 v51,v54,v55
i13 v[48:51],v0,s[8:11],s25 offen offset:2048
i2 v[60:63],a[224:227],v[24:27],0
i2 v[60:63],a[228:231],v[28:31],v[60:63]
i2 v[60:63],a[232:235],v[32:35],v[60:63]
i2 v[60:63],a[236:239],v[36:39],v[60:63]
i2 v[64:67],a[240:243],v[8:11],0
i2 v[64:67],a[244:247],v[12:15],v[64:67]
i2 v[64:67],a[248:251],v[16:19],v[64:67]
i2 v[64:67],a[252:255],v[20:23],v[64:67]
i3 v56,v56,v57
i3 v57,v58,v59
i3 v58,v60,v61
i3 v59,v62,v63
i13 v[56:59],v0,s[8:11],s25 offen offset:3072
i2 v[68:71],a[240:243],v[24:27],0
i2 v[68:71],a[244:247],v[28:31],v[68:71]
i2 v[68:71],a[248:251],v[32:35],v[68:71]
i2 v[68:71],a[252:255],v[36:39],v[68:71]
i3 v64,v64,v65
i3 v65,v66,v67
i15 5
i3 v66,v68,v69
i3 v67,v70,v71
i13 v[64:67],v0,s[8:11],s26 offen offset:0
i5 s63,1
i5 s34,s29
i5 s35,s30
s_xor_b32 s29, s29, 2097152
i6 s22,s22,3
s_cmp_lt_u32 s22, 64
i22 Lx0f_top
i8 vmcnt(0)
s_barrier
i32 s24,s20,2
i6 s24,s24,s33
i11 v76,s32
i11 v77,0
i39 exec,1
i52 v76,v77,s[8:11],s24 offen
i39 exec,-1
i23 v76,2,v0
i18 v76,0x7c,v76
i36 v77,v76,s[8:11],s33 offen sc1
Lx0f_fl1:
i8 vmcnt(0)
v_cmp_gt_u32 vcc, s32, v77
s_cbranch_vccz Lx0f_fl1k
i36 v77,v76,s[8:11],s33 offen sc1
i6 s31,s31,1
i35 s31,400000
i22 L_endx
i44 Lx0f_fl1
Lx0f_fl1k:
i20 v78,147456,v0
ds_read_b32 v78, v78 offset:1024
i32 s14,s20,10
i6 s14,s14,0
i6 s14,s14,s34
i32 s15,s20,8
i6 s15,s15,32768
i6 s15,s15,s34
i47 s62,0
i28 s15,0x80000000,s15
i8 lgkmcnt(0)
i5 m0,81920
i6 s25,s14,0
i1 v78,s[8:11],s25 offen sc1 lds
i5 m0,82944
i6 s25,s14,147456
i1 v78,s[8:11],s25 offen sc1 lds
i5 m0,83968
i6 s25,s14,294912
i1 v78,s[8:11],s25 offen sc1 lds
i5 m0,84992
i6 s25,s14,442368
i1 v78,s[8:11],s25 offen sc1 lds
i5 m0,86016
i6 s25,s14,589824
i1 v78,s[8:11],s25 offen sc1 lds
i5 m0,87040
i6 s25,s14,737280
i1 v78,s[8:11],s25 offen sc1 lds
i5 m0,88064
i6 s25,s14,884736
i1 v78,s[8:11],s25 offen sc1 lds
i5 m0,89088
i6 s25,s14,1032192
i1 v78,s[8:11],s25 offen sc1 lds
i5 m0,114688
i6 s25,s15,0
i1 v78,s[8:11],s25 offen sc1 lds
i5 m0,115712
i6 s25,s15,147456
i1 v78,s[8:11],s25 offen sc1 lds
i5 m0,116736
i6 s25,s15,294912
i1 v78,s[8:11],s25 offen sc1 lds
i5 m0,117760
i6 s25,s15,442368
i1 v78,s[8:11],s25 offen sc1 lds
i5 m0,118784
i6 s25,s15,589824
i1 v78,s[8:11],s25 offen sc1 lds
i5 m0,119808
i6 s25,s15,737280
i1 v78,s[8:11],s25 offen sc1 lds
i5 m0,120832
i6 s25,s15,884736
i1 v78,s[8:11],s25 offen sc1 lds
i5 m0,121856
i6 s25,s15,1032192
i1 v78,s[8:11],s25 offen sc1 lds
i20 v40,147456,v0
i20 v41,81920,v0
ds_read_b32 v42, v40 offset:1028
i9 v[72:75],v40 offset:2048
i9 v[76:79],v40 offset:3072
i8 vmcnt(0)
i9 v[8:11],v41 offset:0
i9 v[12:15],v41 offset:1024
i9 v[16:19],v41 offset:2048
i9 v[20:23],v41 offset:3072
i9 v[24:27],v41 offset:4096
i9 v[28:31],v41 offset:5120
i9 v[32:35],v41 offset:6144
i9 v[36:39],v41 offset:7168
i8 lgkmcnt(7)
i2 v[44:47],v[72:75],v[8:11],0
i8 lgkmcnt(6)
i2 v[44:47],v[72:75],v[12:15],v[44:47]
i8 lgkmcnt(5)
i2 v[44:47],v[72:75],v[16:19],v[44:47]
i8 lgkmcnt(4)
i2 v[44:47],v[72:75],v[20:23],v[44:47]
i8 lgkmcnt(3)
i2 v[44:47],v[72:75],v[24:27],v[44:47]
i8 lgkmcnt(2)
i2 v[44:47],v[72:75],v[28:31],v[44:47]
i8 lgkmcnt(1)
i2 v[44:47],v[72:75],v[32:35],v[44:47]
i8 lgkmcnt(0)
i2 v[44:47],v[72:75],v[36:39],v[44:47]
i47 s62,0
i22 Lx0f_two1
i9 v[8:11],v41 offset:32768
i9 v[12:15],v41 offset:33792
i9 v[16:19],v41 offset:34816
i9 v[20:23],v41 offset:35840
i9 v[24:27],v41 offset:36864
i9 v[28:31],v41 offset:37888
i9 v[32:35],v41 offset:38912
i9 v[36:39],v41 offset:39936
i8 lgkmcnt(7)
i2 v[44:47],v[76:79],v[8:11],v[44:47]
i8 lgkmcnt(6)
i2 v[44:47],v[76:79],v[12:15],v[44:47]
i8 lgkmcnt(5)
i2 v[44:47],v[76:79],v[16:19],v[44:47]
i8 lgkmcnt(4)
i2 v[44:47],v[76:79],v[20:23],v[44:47]
i8 lgkmcnt(3)
i2 v[44:47],v[76:79],v[24:27],v[44:47]
i8 lgkmcnt(2)
i2 v[44:47],v[76:79],v[28:31],v[44:47]
i8 lgkmcnt(1)
i2 v[44:47],v[76:79],v[32:35],v[44:47]
i8 lgkmcnt(0)
i2 v[44:47],v[76:79],v[36:39],v[44:47]
Lx0f_two1:
i15 7
i3 v44,v44,v45
i3 v45,v46,v47
i41 v[44:45],v42,s[56:59],s35 offen
i8 vmcnt(0)
i44 L_endx
L_xs0:
Lx0s_top:
i32 s27,s22,18
i32 s24,s20,13
i6 s27,s27,s24
i32 s28,s22,14
i6 s28,s28,72351744
s_mul_i32 s30, s22, 73728
s_and_b32 s24, s22, 7
s_cmp_ge_u32 s24, 3
i22 Lx0s_rdyk
s_lshr_b32 s24, s22, 3
i32 s24,s24,2
i11 v5,s24
i39 exec,1
Lx0s_rdy:
i55 v6,v5,s[100:101] offset:64 sc1
i55 v7,v5,s[100:101] offset:96 sc1
i6 s31,s31,1
i35 s31,400000
i22 L_endx
i8 vmcnt(0)
i17 v6,v7,1,v6
v_cmp_ne_u32 vcc, 0x80, v6
s_cbranch_vccz Lx0s_rdyj
s_sleep 16
i44 Lx0s_rdy
Lx0s_rdyj:
i39 exec,-1
s_barrier
Lx0s_rdyk:
s_bitcmp1_b32 s18, 31
s_cbranch_scc0 Lx0s_pre
s_bitset0_b32 s18, 31
i6 m0,s18,0
i6 s25,s27,33554432
i1 v0,s[8:11],s25 offen sc1 lds
i6 m0,s18,1024
i6 s25,s27,33555456
i1 v0,s[8:11],s25 offen sc1 lds
i6 m0,s18,8192
i6 s25,s27,0
i1 v0,s[8:11],s25 offen sc1 lds
i6 m0,s18,9216
i6 s25,s27,1024
i1 v0,s[8:11],s25 offen sc1 lds
i6 m0,s18,16384
i6 s25,s27,16777216
i1 v0,s[8:11],s25 offen sc1 lds
i6 m0,s18,17408
i6 s25,s27,16778240
i1 v0,s[8:11],s25 offen sc1 lds
Lx0s_pre:
i20 v6,s18,v0
i8 vmcnt(0)
s_barrier
i47 s63,0
i22 Lx0s_nf
i32 s24,s20,2
i6 s24,s24,s33
i11 v76,s32
i11 v77,0
i39 exec,1
i52 v76,v77,s[8:11],s24 offen sc1
i39 exec,-1
Lx0s_nf:
i9 v[8:11],v6 offset:0
i9 v[48:51],v6 offset:8192
i9 v[12:15],v6 offset:2048
i9 v[52:55],v6 offset:10240
i9 v[16:19],v6 offset:4096
i9 v[56:59],v6 offset:12288
i9 v[20:23],v6 offset:6144
i9 v[60:63],v6 offset:14336
i9 v[24:27],v6 offset:9216
i9 v[28:31],v6 offset:11264
i9 v[32:35],v6 offset:13312
i9 v[36:39],v6 offset:15360
i8 lgkmcnt(10)
i2 v[40:43],v[48:51],v[8:11],0
i8 lgkmcnt(8)
i2 v[40:43],v[52:55],v[12:15],v[40:43]
i8 lgkmcnt(6)
i2 v[40:43],v[56:59],v[16:19],v[40:43]
i8 lgkmcnt(4)
i2 v[40:43],v[60:63],v[20:23],v[40:43]
i8 lgkmcnt(3)
i2 v[44:47],v[24:27],v[8:11],0
i8 lgkmcnt(2)
i2 v[44:47],v[28:31],v[12:15],v[44:47]
i8 lgkmcnt(1)
i2 v[44:47],v[32:35],v[16:19],v[44:47]
i8 lgkmcnt(0)
i2 v[44:47],v[36:39],v[20:23],v[44:47]
i9 v[24:27],v6 offset:16384
i9 v[28:31],v6 offset:17408
i9 v[32:35],v6 offset:18432
i9 v[36:39],v6 offset:19456
i11 v5,0xff800000
i26 v40,v5,v40,s[36:37]
i26 v41,v5,v41,s[38:39]
i26 v42,v5,v42,s[40:41]
i26 v43,v5,v43,s[42:43]
i26 v44,v5,v44,s[44:45]
i26 v45,v5,v45,s[46:47]
i26 v46,v5,v46,s[48:49]
i26 v47,v5,v47,s[50:51]
Lx0s_h:
i6 s24,s28,0
i1 v[64:67],v4,s[8:11],s24 offen sc1
i6 s24,s28,4096
i1 v[68:71],v4,s[8:11],s24 offen sc1
i23 v76,2,v0
i18 v76,0x7c,v76
i36 v77,v76,s[8:11],s33 offen sc1
i6 s31,s31,1
i35 s31,400000
i22 L_endx
i8 vmcnt(0)
i48 v5,v64,v65,v66
i48 v5,v5,v67,v68
i48 v5,v5,v69,v70
v_max_u32 v5, v5, v71
i25 vcc,-1,v5
s_cbranch_vccz Lx0s_hk
s_cmp_ge_u32 s22, 60
i22 Lx0s_h
i11 v6,0
i39 exec,1
Lx0s_hl:
s_sleep 12
i36 v5,v6,s[8:11],s28 offen sc1
i6 s31,s31,1
i35 s31,400000
i22 L_endx
i8 vmcnt(0)
i25 vcc,-1,v5
i49 Lx0s_hl
i39 exec,-1
i44 Lx0s_h
Lx0s_hk:
i21 v0,v[64:67] offset:0
i21 v0,v[68:71] offset:4096
i47 s63,0
i22 Lx0s_nq
Lx0s_fl0:
i8 vmcnt(0)
v_cmp_gt_u32 vcc, s32, v77
s_cbranch_vccz Lx0s_fl0k
i36 v77,v76,s[8:11],s33 offen sc1
i6 s31,s31,1
i35 s31,400000
i22 L_endx
i44 Lx0s_fl0
Lx0s_fl0k:
Lx0s_nq:
i20 v78,147456,v0
ds_read_b32 v78, v78 offset:1024
i32 s14,s20,10
i6 s14,s14,0
i6 s14,s14,s34
i32 s15,s20,8
i6 s15,s15,32768
i6 s15,s15,s34
i47 s62,0
i28 s15,0x80000000,s15
s_xor_b32 s16, s18, 24576
i6 s24,s22,3
s_xor_b32 s24, s24, s22
s_cmp_ge_u32 s24, 8
i28 s24,0x80000000,0
s_or_b32 s18, s16, s24
i6 s26,s27,786432
s_or_b32 s26, s26, s24
i14 v[48:49],0
i14 v[50:51],0
i14 v[52:53],0
i14 v[54:55],0
i14 v[56:57],0
i14 v[58:59],0
i14 v[60:61],0
i14 v[62:63],0
i8 lgkmcnt(0)
s_barrier
i9 v[64:67],v0 offset:0
i9 v[68:71],v0 offset:1024
i9 v[72:75],v0 offset:2048
i8 lgkmcnt(2)
i4 v[48:51],v[64:67],v[80:87],v1
i5 m0,81920
i6 s25,s14,0
i1 v78,s[8:11],s25 offen sc1 lds
i4 v[52:55],v[64:67],v[88:95],v1
i4 v[56:59],v[64:67],v[224:231],v1
i5 m0,82944
i6 s25,s14,147456
i1 v78,s[8:11],s25 offen sc1 lds
i4 v[60:63],v[64:67],v[232:239],v1
i9 v[64:67],v0 offset:3072
i8 lgkmcnt(2)
i4 v[48:51],v[68:71],v[96:103],v1
i5 m0,83968
i6 s25,s14,294912
i1 v78,s[8:11],s25 offen sc1 lds
i4 v[52:55],v[68:71],v[104:111],v1
i4 v[56:59],v[68:71],v[240:247],v1
i5 m0,84992
i6 s25,s14,442368
i1 v78,s[8:11],s25 offen sc1 lds
i4 v[60:63],v[68:71],v[248:255],v1
i9 v[68:71],v0 offset:4096
i8 lgkmcnt(2)
i4 v[48:51],v[72:75],v[112:119],v1
i5 m0,86016
i6 s25,s14,589824
i1 v78,s[8:11],s25 offen sc1 lds
i4 v[52:55],v[72:75],v[120:127],v1
i4 v[56:59],v[72:75],a[0:7],v1
i5 m0,87040
i6 s25,s14,737280
i1 v78,s[8:11],s25 offen sc1 lds
i4 v[60:63],v[72:75],a[8:15],v1
i9 v[72:75],v0 offset:5120
i8 lgkmcnt(2)
i4 v[48:51],v[64:67],v[128:135],v1
i5 m0,88064
i6 s25,s14,884736
i1 v78,s[8:11],s25 offen sc1 lds
i4 v[52:55],v[64:67],v[136:143],v1
i4 v[56:59],v[64:67],a[16:23],v1
i5 m0,89088
i6 s25,s14,1032192
i1 v78,s[8:11],s25 offen sc1 lds
i4 v[60:63],v[64:67],a[24:31],v1
i9 v[64:67],v0 offset:6144
i8 lgkmcnt(2)
i4 v[48:51],v[68:71],v[144:151],v1
i5 m0,114688
i6 s25,s15,0
i1 v78,s[8:11],s25 offen sc1 lds
i4 v[52:55],v[68:71],v[152:159],v1
i4 v[56:59],v[68:71],a[32:39],v1
i5 m0,115712
i6 s25,s15,147456
i1 v78,s[8:11],s25 offen sc1 lds
i4 v[60:63],v[68:71],a[40:47],v1
i9 v[68:71],v0 offset:7168
i8 lgkmcnt(2)
i4 v[48:51],v[72:75],v[160:167],v1
i5 m0,116736
i6 s25,s15,294912
i1 v78,s[8:11],s25 offen sc1 lds
i4 v[52:55],v[72:75],v[168:175],v1
i4 v[56:59],v[72:75],a[48:55],v1
i5 m0,117760
i6 s25,s15,442368
i1 v78,s[8:11],s25 offen sc1 lds
i4 v[60:63],v[72:75],a[56:63],v1
i9 v[72:75],v0 offset:8192
i8 lgkmcnt(2)
i4 v[48:51],v[64:67],v[176:183],v1
i5 m0,118784
i6 s25,s15,589824
i1 v78,s[8:11],s25 offen sc1 lds
i4 v[52:55],v[64:67],v[184:191],v1
i4 v[56:59],v[64:67],a[64:71],v1
i5 m0,119808
i6 s25,s15,737280
i1 v78,s[8:11],s25 offen sc1 lds
i4 v[60:63],v[64:67],a[72:79],v1
i8 lgkmcnt(1)
i4 v[48:51],v[68:71],v[192:199],v1
i5 m0,120832
i6 s25,s15,884736
i1 v78,s[8:11],s25 offen sc1 lds
i4 v[52:55],v[68:71],v[200:207],v1
i4 v[56:59],v[68:71],a[80:87],v1
i5 m0,121856
i6 s25,s15,1032192
i1 v78,s[8:11],s25 offen sc1 lds
i4 v[60:63],v[68:71],a[88:95],v1
i8 lgkmcnt(0)
i4 v[48:51],v[72:75],v[208:215],v1
i6 m0,s16,0
i6 s25,s26,33554432
i1 v0,s[8:11],s25 offen sc1 lds
i4 v[52:55],v[72:75],v[216:223],v1
i4 v[56:59],v[72:75],a[96:103],v1
i6 m0,s16,1024
i6 s25,s26,33555456
i1 v0,s[8:11],s25 offen sc1 lds
i4 v[60:63],v[72:75],a[104:111],v1
i6 m0,s16,8192
i6 s25,s26,0
i1 v0,s[8:11],s25 offen sc1 lds
i6 m0,s16,9216
i6 s25,s26,1024
i1 v0,s[8:11],s25 offen sc1 lds
i6 m0,s16,16384
i6 s25,s26,16777216
i1 v0,s[8:11],s25 offen sc1 lds
i6 m0,s16,17408
i6 s25,s26,16778240
i1 v0,s[8:11],s25 offen sc1 lds
i3 v48,v48,v49
i3 v49,v50,v51
i3 v50,v52,v53
i3 v51,v54,v55
i27 v[52:55],v[48:49],v[2:3],0
i15 0
i27 v[76:79],v[50:51],v[2:3],0
i3 v56,v56,v57
i3 v57,v58,v59
i3 v58,v60,v61
i3 v59,v62,v63
i21 v0,v[56:59] offset:13312
i3 v48,v52,v53
i3 v49,v54,v55
i15 0
i3 v50,v76,v77
i3 v51,v78,v79
i21 v0,v[48:51] offset:9216
i8 lgkmcnt(0)
s_barrier
i9 v[64:67],v0 offset:9216
i9 v[68:71],v0 offset:10240
i9 v[72:75],v0 offset:11264
i9 v[76:79],v0 offset:12288
i9 v[48:51],v0 offset:13312
i9 v[52:55],v0 offset:14336
i38 v5,v40,v41,v42
i38 v6,v43,v44,v45
i38 v5,v5,v46,v47
i8 lgkmcnt(5)
i2 v[60:63],v[64:67],v[8:11],0
i8 lgkmcnt(4)
i2 v[60:63],v[68:71],v[12:15],v[60:63]
i8 lgkmcnt(3)
i2 v[60:63],v[72:75],v[16:19],v[60:63]
i8 lgkmcnt(2)
i2 v[60:63],v[76:79],v[20:23],v[60:63]
i15 7
i51 v60,0x3e0293ee,v60
i51 v61,0x3e0293ee,v61
i51 v62,0x3e0293ee,v62
i51 v63,0x3e0293ee,v63
i38 v5,v5,v6,v60
i38 v5,v5,v61,v62
v_max_f32 v5, v5, v63
i11 v6,v5
i15 1
v_permlane16_swap_b32 v5, v6
v_max_f32 v5, v5, v6
i11 v6,v5
i15 1
i40 v5,v6
v_max_f32 v5, v5, v6
i33 v40,v40,v5
i33 v41,v41,v5
i33 v42,v42,v5
i33 v43,v43,v5
i33 v44,v44,v5
i33 v45,v45,v5
i33 v46,v46,v5
i33 v47,v47,v5
i33 v60,v60,v5
i33 v61,v61,v5
i33 v62,v62,v5
i33 v63,v63,v5
i19 v40,v40
i19 v41,v41
i19 v42,v42
i19 v43,v43
i19 v44,v44
i19 v45,v45
i19 v46,v46
i19 v47,v47
i19 v60,v60
i19 v61,v61
i19 v62,v62
i19 v63,v63
i14 v[12:13],s[52:53]
i14 v[14:15],s[52:53]
i14 v[16:17],s[54:55]
i3 v20,v40,v41
i3 v21,v42,v43
i3 v22,v44,v45
i3 v23,v46,v47
i3 v18,v60,v61
i3 v19,v62,v63
i8 lgkmcnt(0)
i2 v[8:11],v[12:15],v[20:23],0
i2 v[64:67],v[24:27],v[20:23],0
i2 v[68:71],v[28:31],v[20:23],0
i2 v[72:75],v[32:35],v[20:23],0
i2 v[76:79],v[36:39],v[20:23],0
i27 v[8:11],v[16:17],v[18:19],v[8:11]
i27 v[64:67],v[48:49],v[18:19],v[64:67]
i27 v[68:71],v[50:51],v[18:19],v[68:71]
i27 v[72:75],v[52:53],v[18:19],v[72:75]
i27 v[76:79],v[54:55],v[18:19],v[76:79]
v_rcp_f32 v6, v8
i15 0
i16 v[64:65],v[64:65],v[6:7] op_sel_hi:[1,0]
i16 v[66:67],v[66:67],v[6:7] op_sel_hi:[1,0]
i16 v[68:69],v[68:69],v[6:7] op_sel_hi:[1,0]
i16 v[70:71],v[70:71],v[6:7] op_sel_hi:[1,0]
i16 v[72:73],v[72:73],v[6:7] op_sel_hi:[1,0]
i16 v[74:75],v[74:75],v[6:7] op_sel_hi:[1,0]
i16 v[76:77],v[76:77],v[6:7] op_sel_hi:[1,0]
i16 v[78:79],v[78:79],v[6:7] op_sel_hi:[1,0]
i3 v64,v64,v65
i3 v65,v66,v67
i3 v66,v68,v69
i3 v67,v70,v71
i21 v0,v[64:67] offset:17408
i3 v72,v72,v73
i3 v73,v74,v75
i3 v74,v76,v77
i3 v75,v78,v79
i21 v0,v[72:75] offset:18432
i8 lgkmcnt(0)
s_barrier
i47 s63,0
i22 Lx0s_nr
i20 v40,147456,v0
i20 v41,81920,v0
ds_read_b32 v42, v40 offset:1028
i9 v[72:75],v40 offset:2048
i9 v[76:79],v40 offset:3072
i8 vmcnt(0)
i9 v[8:11],v41 offset:0
i9 v[12:15],v41 offset:1024
i9 v[16:19],v41 offset:2048
i9 v[20:23],v41 offset:3072
i9 v[24:27],v41 offset:4096
i9 v[28:31],v41 offset:5120
i9 v[32:35],v41 offset:6144
i9 v[36:39],v41 offset:7168
i8 lgkmcnt(7)
i2 v[44:47],v[72:75],v[8:11],0
i8 lgkmcnt(6)
i2 v[44:47],v[72:75],v[12:15],v[44:47]
i8 lgkmcnt(5)
i2 v[44:47],v[72:75],v[16:19],v[44:47]
i8 lgkmcnt(4)
i2 v[44:47],v[72:75],v[20:23],v[44:47]
i8 lgkmcnt(3)
i2 v[44:47],v[72:75],v[24:27],v[44:47]
i8 lgkmcnt(2)
i2 v[44:47],v[72:75],v[28:31],v[44:47]
i8 lgkmcnt(1)
i2 v[44:47],v[72:75],v[32:35],v[44:47]
i8 lgkmcnt(0)
i2 v[44:47],v[72:75],v[36:39],v[44:47]
i47 s62,0
i22 Lx0s_two0
i9 v[8:11],v41 offset:32768
i9 v[12:15],v41 offset:33792
i9 v[16:19],v41 offset:34816
i9 v[20:23],v41 offset:35840
i9 v[24:27],v41 offset:36864
i9 v[28:31],v41 offset:37888
i9 v[32:35],v41 offset:38912
i9 v[36:39],v41 offset:39936
i8 lgkmcnt(7)
i2 v[44:47],v[76:79],v[8:11],v[44:47]
i8 lgkmcnt(6)
i2 v[44:47],v[76:79],v[12:15],v[44:47]
i8 lgkmcnt(5)
i2 v[44:47],v[76:79],v[16:19],v[44:47]
i8 lgkmcnt(4)
i2 v[44:47],v[76:79],v[20:23],v[44:47]
i8 lgkmcnt(3)
i2 v[44:47],v[76:79],v[24:27],v[44:47]
i8 lgkmcnt(2)
i2 v[44:47],v[76:79],v[28:31],v[44:47]
i8 lgkmcnt(1)
i2 v[44:47],v[76:79],v[32:35],v[44:47]
i8 lgkmcnt(0)
i2 v[44:47],v[76:79],v[36:39],v[44:47]
Lx0s_two0:
i15 7
i3 v44,v44,v45
i3 v45,v46,v47
i41 v[44:45],v42,s[56:59],s35 offen
i6 s32,s32,1
Lx0s_nr:
i9 v[8:11],v0 offset:17408
i9 v[12:15],v0 offset:18432
i9 v[16:19],v0 offset:19456
i9 v[20:23],v0 offset:20480
i9 v[24:27],v0 offset:21504
i9 v[28:31],v0 offset:22528
i9 v[32:35],v0 offset:23552
i9 v[36:39],v0 offset:24576
s_mul_i32 s24, s20, 36864
i6 s24,s24,s29
i6 s24,s24,0
i6 s25,s24,4096
i6 s26,s24,8192
i8 lgkmcnt(7)
i2 v[40:43],a[112:115],v[8:11],0
i8 lgkmcnt(6)
i2 v[40:43],a[116:119],v[12:15],v[40:43]
i8 lgkmcnt(5)
i2 v[40:43],a[120:123],v[16:19],v[40:43]
i8 lgkmcnt(4)
i2 v[40:43],a[124:127],v[20:23],v[40:43]
i8 lgkmcnt(3)
i2 v[44:47],a[112:115],v[24:27],0
i8 lgkmcnt(2)
i2 v[44:47],a[116:119],v[28:31],v[44:47]
i8 lgkmcnt(1)
i2 v[44:47],a[120:123],v[32:35],v[44:47]
i8 lgkmcnt(0)
i2 v[44:47],a[124:127],v[36:39],v[44:47]
i2 v[48:51],a[128:131],v[8:11],0
i2 v[48:51],a[132:135],v[12:15],v[48:51]
i2 v[48:51],a[136:139],v[16:19],v[48:51]
i2 v[48:51],a[140:143],v[20:23],v[48:51]
i3 v40,v40,v41
i3 v41,v42,v43
i3 v42,v44,v45
i3 v43,v46,v47
i13 v[40:43],v0,s[8:11],s24 offen offset:0 sc1
i2 v[52:55],a[128:131],v[24:27],0
i2 v[52:55],a[132:135],v[28:31],v[52:55]
i2 v[52:55],a[136:139],v[32:35],v[52:55]
i2 v[52:55],a[140:143],v[36:39],v[52:55]
i2 v[56:59],a[144:147],v[8:11],0
i2 v[56:59],a[148:151],v[12:15],v[56:59]
i2 v[56:59],a[152:155],v[16:19],v[56:59]
i2 v[56:59],a[156:159],v[20:23],v[56:59]
i3 v48,v48,v49
i3 v49,v50,v51
i3 v50,v52,v53
i3 v51,v54,v55
i13 v[48:51],v0,s[8:11],s24 offen offset:1024 sc1
i2 v[60:63],a[144:147],v[24:27],0
i2 v[60:63],a[148:151],v[28:31],v[60:63]
i2 v[60:63],a[152:155],v[32:35],v[60:63]
i2 v[60:63],a[156:159],v[36:39],v[60:63]
i2 v[64:67],a[160:163],v[8:11],0
i2 v[64:67],a[164:167],v[12:15],v[64:67]
i2 v[64:67],a[168:171],v[16:19],v[64:67]
i2 v[64:67],a[172:175],v[20:23],v[64:67]
i3 v56,v56,v57
i3 v57,v58,v59
i3 v58,v60,v61
i3 v59,v62,v63
i13 v[56:59],v0,s[8:11],s24 offen offset:2048 sc1
i2 v[68:71],a[160:163],v[24:27],0
i2 v[68:71],a[164:167],v[28:31],v[68:71]
i2 v[68:71],a[168:171],v[32:35],v[68:71]
i2 v[68:71],a[172:175],v[36:39],v[68:71]
i2 v[72:75],a[176:179],v[8:11],0
i2 v[72:75],a[180:183],v[12:15],v[72:75]
i2 v[72:75],a[184:187],v[16:19],v[72:75]
i2 v[72:75],a[188:191],v[20:23],v[72:75]
i3 v64,v64,v65
i3 v65,v66,v67
i3 v66,v68,v69
i3 v67,v70,v71
i13 v[64:67],v0,s[8:11],s24 offen offset:3072 sc1
i2 v[76:79],a[176:179],v[24:27],0
i2 v[76:79],a[180:183],v[28:31],v[76:79]
i2 v[76:79],a[184:187],v[32:35],v[76:79]
i2 v[76:79],a[188:191],v[36:39],v[76:79]
i2 v[40:43],a[192:195],v[8:11],0
i2 v[40:43],a[196:199],v[12:15],v[40:43]
i2 v[40:43],a[200:203],v[16:19],v[40:43]
i2 v[40:43],a[204:207],v[20:23],v[40:43]
i3 v72,v72,v73
i3 v73,v74,v75
i3 v74,v76,v77
i3 v75,v78,v79
i13 v[72:75],v0,s[8:11],s25 offen offset:0 sc1
i2 v[44:47],a[192:195],v[24:27],0
i2 v[44:47],a[196:199],v[28:31],v[44:47]
i2 v[44:47],a[200:203],v[32:35],v[44:47]
i2 v[44:47],a[204:207],v[36:39],v[44:47]
i2 v[48:51],a[208:211],v[8:11],0
i2 v[48:51],a[212:215],v[12:15],v[48:51]
i2 v[48:51],a[216:219],v[16:19],v[48:51]
i2 v[48:51],a[220:223],v[20:23],v[48:51]
i3 v40,v40,v41
i3 v41,v42,v43
i3 v42,v44,v45
i3 v43,v46,v47
i13 v[40:43],v0,s[8:11],s25 offen offset:1024 sc1
i2 v[52:55],a[208:211],v[24:27],0
i2 v[52:55],a[212:215],v[28:31],v[52:55]
i2 v[52:55],a[216:219],v[32:35],v[52:55]
i2 v[52:55],a[220:223],v[36:39],v[52:55]
i2 v[56:59],a[224:227],v[8:11],0
i2 v[56:59],a[228:231],v[12:15],v[56:59]
i2 v[56:59],a[232:235],v[16:19],v[56:59]
i2 v[56:59],a[236:239],v[20:23],v[56:59]
i3 v48,v48,v49
i3 v49,v50,v51
i3 v50,v52,v53
i3 v51,v54,v55
i13 v[48:51],v0,s[8:11],s25 offen offset:2048 sc1
i2 v[60:63],a[224:227],v[24:27],0
i2 v[60:63],a[228:231],v[28:31],v[60:63]
i2 v[60:63],a[232:235],v[32:35],v[60:63]
i2 v[60:63],a[236:239],v[36:39],v[60:63]
i2 v[64:67],a[240:243],v[8:11],0
i2 v[64:67],a[244:247],v[12:15],v[64:67]
i2 v[64:67],a[248:251],v[16:19],v[64:67]
i2 v[64:67],a[252:255],v[20:23],v[64:67]
i3 v56,v56,v57
i3 v57,v58,v59
i3 v58,v60,v61
i3 v59,v62,v63
i13 v[56:59],v0,s[8:11],s25 offen offset:3072 sc1
i2 v[68:71],a[240:243],v[24:27],0
i2 v[68:71],a[244:247],v[28:31],v[68:71]
i2 v[68:71],a[248:251],v[32:35],v[68:71]
i2 v[68:71],a[252:255],v[36:39],v[68:71]
i3 v64,v64,v65
i3 v65,v66,v67
i15 5
i3 v66,v68,v69
i3 v67,v70,v71
i13 v[64:67],v0,s[8:11],s26 offen offset:0 sc1
i5 s63,1
i5 s34,s29
i5 s35,s30
s_xor_b32 s29, s29, 2097152
i6 s22,s22,3
s_cmp_lt_u32 s22, 64
i22 Lx0s_top
i8 vmcnt(0)
s_barrier
i32 s24,s20,2
i6 s24,s24,s33
i11 v76,s32
i11 v77,0
i39 exec,1
i52 v76,v77,s[8:11],s24 offen sc1
i39 exec,-1
i23 v76,2,v0
i18 v76,0x7c,v76
i36 v77,v76,s[8:11],s33 offen sc1
Lx0s_fl1:
i8 vmcnt(0)
v_cmp_gt_u32 vcc, s32, v77
s_cbranch_vccz Lx0s_fl1k
i36 v77,v76,s[8:11],s33 offen sc1
i6 s31,s31,1
i35 s31,400000
i22 L_endx
i44 Lx0s_fl1
Lx0s_fl1k:
i20 v78,147456,v0
ds_read_b32 v78, v78 offset:1024
i32 s14,s20,10
i6 s14,s14,0
i6 s14,s14,s34
i32 s15,s20,8
i6 s15,s15,32768
i6 s15,s15,s34
i47 s62,0
i28 s15,0x80000000,s15
i8 lgkmcnt(0)
i5 m0,81920
i6 s25,s14,0
i1 v78,s[8:11],s25 offen sc1 lds
i5 m0,82944
i6 s25,s14,147456
i1 v78,s[8:11],s25 offen sc1 lds
i5 m0,83968
i6 s25,s14,294912
i1 v78,s[8:11],s25 offen sc1 lds
i5 m0,84992
i6 s25,s14,442368
i1 v78,s[8:11],s25 offen sc1 lds
i5 m0,86016
i6 s25,s14,589824
i1 v78,s[8:11],s25 offen sc1 lds
i5 m0,87040
i6 s25,s14,737280
i1 v78,s[8:11],s25 offen sc1 lds
i5 m0,88064
i6 s25,s14,884736
i1 v78,s[8:11],s25 offen sc1 lds
i5 m0,89088
i6 s25,s14,1032192
i1 v78,s[8:11],s25 offen sc1 lds
i5 m0,114688
i6 s25,s15,0
i1 v78,s[8:11],s25 offen sc1 lds
i5 m0,115712
i6 s25,s15,147456
i1 v78,s[8:11],s25 offen sc1 lds
i5 m0,116736
i6 s25,s15,294912
i1 v78,s[8:11],s25 offen sc1 lds
i5 m0,117760
i6 s25,s15,442368
i1 v78,s[8:11],s25 offen sc1 lds
i5 m0,118784
i6 s25,s15,589824
i1 v78,s[8:11],s25 offen sc1 lds
i5 m0,119808
i6 s25,s15,737280
i1 v78,s[8:11],s25 offen sc1 lds
i5 m0,120832
i6 s25,s15,884736
i1 v78,s[8:11],s25 offen sc1 lds
i5 m0,121856
i6 s25,s15,1032192
i1 v78,s[8:11],s25 offen sc1 lds
i20 v40,147456,v0
i20 v41,81920,v0
ds_read_b32 v42, v40 offset:1028
i9 v[72:75],v40 offset:2048
i9 v[76:79],v40 offset:3072
i8 vmcnt(0)
i9 v[8:11],v41 offset:0
i9 v[12:15],v41 offset:1024
i9 v[16:19],v41 offset:2048
i9 v[20:23],v41 offset:3072
i9 v[24:27],v41 offset:4096
i9 v[28:31],v41 offset:5120
i9 v[32:35],v41 offset:6144
i9 v[36:39],v41 offset:7168
i8 lgkmcnt(7)
i2 v[44:47],v[72:75],v[8:11],0
i8 lgkmcnt(6)
i2 v[44:47],v[72:75],v[12:15],v[44:47]
i8 lgkmcnt(5)
i2 v[44:47],v[72:75],v[16:19],v[44:47]
i8 lgkmcnt(4)
i2 v[44:47],v[72:75],v[20:23],v[44:47]
i8 lgkmcnt(3)
i2 v[44:47],v[72:75],v[24:27],v[44:47]
i8 lgkmcnt(2)
i2 v[44:47],v[72:75],v[28:31],v[44:47]
i8 lgkmcnt(1)
i2 v[44:47],v[72:75],v[32:35],v[44:47]
i8 lgkmcnt(0)
i2 v[44:47],v[72:75],v[36:39],v[44:47]
i47 s62,0
i22 Lx0s_two1
i9 v[8:11],v41 offset:32768
i9 v[12:15],v41 offset:33792
i9 v[16:19],v41 offset:34816
i9 v[20:23],v41 offset:35840
i9 v[24:27],v41 offset:36864
i9 v[28:31],v41 offset:37888
i9 v[32:35],v41 offset:38912
i9 v[36:39],v41 offset:39936
i8 lgkmcnt(7)
i2 v[44:47],v[76:79],v[8:11],v[44:47]
i8 lgkmcnt(6)
i2 v[44:47],v[76:79],v[12:15],v[44:47]
i8 lgkmcnt(5)
i2 v[44:47],v[76:79],v[16:19],v[44:47]
i8 lgkmcnt(4)
i2 v[44:47],v[76:79],v[20:23],v[44:47]
i8 lgkmcnt(3)
i2 v[44:47],v[76:79],v[24:27],v[44:47]
i8 lgkmcnt(2)
i2 v[44:47],v[76:79],v[28:31],v[44:47]
i8 lgkmcnt(1)
i2 v[44:47],v[76:79],v[32:35],v[44:47]
i8 lgkmcnt(0)
i2 v[44:47],v[76:79],v[36:39],v[44:47]
Lx0s_two1:
i15 7
i3 v44,v44,v45
i3 v45,v46,v47
i41 v[44:45],v42,s[56:59],s35 offen
i8 vmcnt(0)
i44 L_endx
L_xw1:
i23 v79,4,v0
i23 v20,2,v79
i18 v21,3,v79
i31 v21,4,v21
i17 v78,v20,13,v21
i32 s24,s20,8
i6 s24,s24,64
i20 v78,s24,v78
i54 s25,1152
s_mul_i32 s24, s20, 147456
i23 v20,1,v79
i18 v21,1,v79
i31 v21,4,v21
i45 v77,v20,s25,v21
i20 v77,s24,v77
i23 v22,4,v79
i34 v23,v79,2,2
i18 v24,3,v79
i17 v20,v22,3,v23
i31 v20,6,v20
i20 v20,49152,v20
i17 v75,v24,3,v20
i23 v21,1,v24
i17 v20,v21,5,v20
i18 v21,1,v24
i17 v76,v21,3,v20
i17 v20,v22,2,v23
i31 v20,5,v20
i17 v74,v24,3,v20
i20 v74,49152,v74
i50 s[64:65],s[0:1],64
i50 s[68:69],s[0:1],72
i50 s[72:73],s[0:1],80
i50 s[56:57],s[0:1],96
i8 lgkmcnt(0)
i5 s58,4718592
i5 s59,0x20000
i5 s66,4718592
i5 s67,0x20000
i5 s70,4718592
i5 s71,0x20000
i5 s74,4718592
i5 s75,0x20000
i5 m0,49152
i5 s24,0
i1 v78,s[64:67],s24 offen lds
i5 m0,50176
i5 s24,131072
i1 v78,s[64:67],s24 offen lds
i5 m0,51200
i5 s24,262144
i1 v78,s[64:67],s24 offen lds
i5 m0,52224
i5 s24,393216
i1 v78,s[64:67],s24 offen lds
i5 m0,53248
i5 s24,524288
i1 v78,s[64:67],s24 offen lds
i5 m0,54272
i5 s24,655360
i1 v78,s[64:67],s24 offen lds
i5 m0,55296
i5 s24,786432
i1 v78,s[64:67],s24 offen lds
i5 m0,56320
i5 s24,917504
i1 v78,s[64:67],s24 offen lds
i5 m0,57344
i5 s24,1048576
i1 v78,s[64:67],s24 offen lds
i5 m0,58368
i5 s24,1179648
i1 v78,s[64:67],s24 offen lds
i5 m0,59392
i5 s24,1310720
i1 v78,s[64:67],s24 offen lds
i5 m0,60416
i5 s24,1441792
i1 v78,s[64:67],s24 offen lds
i5 m0,61440
i5 s24,1572864
i1 v78,s[64:67],s24 offen lds
i5 m0,62464
i5 s24,1703936
i1 v78,s[64:67],s24 offen lds
i5 m0,63488
i5 s24,1835008
i1 v78,s[64:67],s24 offen lds
i5 m0,64512
i5 s24,1966080
i1 v78,s[64:67],s24 offen lds
i5 m0,65536
i5 s24,2097152
i1 v78,s[64:67],s24 offen lds
i5 m0,66560
i5 s24,2228224
i1 v78,s[64:67],s24 offen lds
i5 m0,67584
i5 s24,2359296
i1 v78,s[64:67],s24 offen lds
i5 m0,68608
i5 s24,2490368
i1 v78,s[64:67],s24 offen lds
i5 m0,69632
i5 s24,2621440
i1 v78,s[64:67],s24 offen lds
i5 m0,70656
i5 s24,2752512
i1 v78,s[64:67],s24 offen lds
i5 m0,71680
i5 s24,2883584
i1 v78,s[64:67],s24 offen lds
i5 m0,72704
i5 s24,3014656
i1 v78,s[64:67],s24 offen lds
i5 m0,73728
i5 s24,3145728
i1 v78,s[64:67],s24 offen lds
i5 m0,74752
i5 s24,3276800
i1 v78,s[64:67],s24 offen lds
i5 m0,75776
i5 s24,3407872
i1 v78,s[64:67],s24 offen lds
i5 m0,76800
i5 s24,3538944
i1 v78,s[64:67],s24 offen lds
i5 m0,77824
i5 s24,3670016
i1 v78,s[64:67],s24 offen lds
i5 m0,78848
i5 s24,3801088
i1 v78,s[64:67],s24 offen lds
i5 m0,79872
i5 s24,3932160
i1 v78,s[64:67],s24 offen lds
i5 m0,80896
i5 s24,4063232
i1 v78,s[64:67],s24 offen lds
i8 vmcnt(28)
i0 v[80:81],v76 offset:0
i0 v[82:83],v76 offset:256
i0 v[84:85],v76 offset:2048
i0 v[86:87],v76 offset:2304
i0 v[88:89],v76 offset:16
i0 v[90:91],v76 offset:272
i0 v[92:93],v76 offset:2064
i0 v[94:95],v76 offset:2320
i8 lgkmcnt(0)
i5 m0,49152
i5 s24,4194304
i1 v78,s[64:67],s24 offen lds
i5 m0,50176
i5 s24,4325376
i1 v78,s[64:67],s24 offen lds
i5 m0,51200
i5 s24,4456448
i1 v78,s[64:67],s24 offen lds
i5 m0,52224
i5 s24,4587520
i1 v78,s[64:67],s24 offen lds
i8 vmcnt(28)
i0 v[96:97],v76 offset:4096
i0 v[98:99],v76 offset:4352
i0 v[100:101],v76 offset:6144
i0 v[102:103],v76 offset:6400
i0 v[104:105],v76 offset:4112
i0 v[106:107],v76 offset:4368
i0 v[108:109],v76 offset:6160
i0 v[110:111],v76 offset:6416
i8 lgkmcnt(0)
i5 m0,53248
i5 s24,0
i1 v78,s[68:71],s24 offen lds
i5 m0,54272
i5 s24,131072
i1 v78,s[68:71],s24 offen lds
i5 m0,55296
i5 s24,262144
i1 v78,s[68:71],s24 offen lds
i5 m0,56320
i5 s24,393216
i1 v78,s[68:71],s24 offen lds
i8 vmcnt(28)
i0 v[112:113],v76 offset:8192
i0 v[114:115],v76 offset:8448
i0 v[116:117],v76 offset:10240
i0 v[118:119],v76 offset:10496
i0 v[120:121],v76 offset:8208
i0 v[122:123],v76 offset:8464
i0 v[124:125],v76 offset:10256
i0 v[126:127],v76 offset:10512
i8 lgkmcnt(0)
i5 m0,57344
i5 s24,524288
i1 v78,s[68:71],s24 offen lds
i5 m0,58368
i5 s24,655360
i1 v78,s[68:71],s24 offen lds
i5 m0,59392
i5 s24,786432
i1 v78,s[68:71],s24 offen lds
i5 m0,60416
i5 s24,917504
i1 v78,s[68:71],s24 offen lds
i8 vmcnt(28)
i0 v[128:129],v76 offset:12288
i0 v[130:131],v76 offset:12544
i0 v[132:133],v76 offset:14336
i0 v[134:135],v76 offset:14592
i0 v[136:137],v76 offset:12304
i0 v[138:139],v76 offset:12560
i0 v[140:141],v76 offset:14352
i0 v[142:143],v76 offset:14608
i8 lgkmcnt(0)
i5 m0,61440
i5 s24,1048576
i1 v78,s[68:71],s24 offen lds
i5 m0,62464
i5 s24,1179648
i1 v78,s[68:71],s24 offen lds
i5 m0,63488
i5 s24,1310720
i1 v78,s[68:71],s24 offen lds
i5 m0,64512
i5 s24,1441792
i1 v78,s[68:71],s24 offen lds
i8 vmcnt(28)
i0 v[144:145],v76 offset:16384
i0 v[146:147],v76 offset:16640
i0 v[148:149],v76 offset:18432
i0 v[150:151],v76 offset:18688
i0 v[152:153],v76 offset:16400
i0 v[154:155],v76 offset:16656
i0 v[156:157],v76 offset:18448
i0 v[158:159],v76 offset:18704
i8 lgkmcnt(0)
i5 m0,65536
i5 s24,1572864
i1 v78,s[68:71],s24 offen lds
i5 m0,66560
i5 s24,1703936
i1 v78,s[68:71],s24 offen lds
i5 m0,67584
i5 s24,1835008
i1 v78,s[68:71],s24 offen lds
i5 m0,68608
i5 s24,1966080
i1 v78,s[68:71],s24 offen lds
i8 vmcnt(28)
i0 v[160:161],v76 offset:20480
i0 v[162:163],v76 offset:20736
i0 v[164:165],v76 offset:22528
i0 v[166:167],v76 offset:22784
i0 v[168:169],v76 offset:20496
i0 v[170:171],v76 offset:20752
i0 v[172:173],v76 offset:22544
i0 v[174:175],v76 offset:22800
i8 lgkmcnt(0)
i5 m0,69632
i5 s24,2097152
i1 v78,s[68:71],s24 offen lds
i5 m0,70656
i5 s24,2228224
i1 v78,s[68:71],s24 offen lds
i5 m0,71680
i5 s24,2359296
i1 v78,s[68:71],s24 offen lds
i5 m0,72704
i5 s24,2490368
i1 v78,s[68:71],s24 offen lds
i8 vmcnt(28)
i0 v[176:177],v76 offset:24576
i0 v[178:179],v76 offset:24832
i0 v[180:181],v76 offset:26624
i0 v[182:183],v76 offset:26880
i0 v[184:185],v76 offset:24592
i0 v[186:187],v76 offset:24848
i0 v[188:189],v76 offset:26640
i0 v[190:191],v76 offset:26896
i8 lgkmcnt(0)
i5 m0,73728
i5 s24,2621440
i1 v78,s[68:71],s24 offen lds
i5 m0,74752
i5 s24,2752512
i1 v78,s[68:71],s24 offen lds
i5 m0,75776
i5 s24,2883584
i1 v78,s[68:71],s24 offen lds
i5 m0,76800
i5 s24,3014656
i1 v78,s[68:71],s24 offen lds
i8 vmcnt(28)
i0 v[192:193],v76 offset:28672
i0 v[194:195],v76 offset:28928
i0 v[196:197],v76 offset:30720
i0 v[198:199],v76 offset:30976
i0 v[200:201],v76 offset:28688
i0 v[202:203],v76 offset:28944
i0 v[204:205],v76 offset:30736
i0 v[206:207],v76 offset:30992
i8 lgkmcnt(0)
i5 m0,77824
i5 s24,3145728
i1 v78,s[68:71],s24 offen lds
i5 m0,78848
i5 s24,3276800
i1 v78,s[68:71],s24 offen lds
i5 m0,79872
i5 s24,3407872
i1 v78,s[68:71],s24 offen lds
i5 m0,80896
i5 s24,3538944
i1 v78,s[68:71],s24 offen lds
i8 vmcnt(28)
i0 v[208:209],v76 offset:0
i0 v[210:211],v76 offset:256
i0 v[212:213],v76 offset:2048
i0 v[214:215],v76 offset:2304
i0 v[216:217],v76 offset:16
i0 v[218:219],v76 offset:272
i0 v[220:221],v76 offset:2064
i0 v[222:223],v76 offset:2320
i8 lgkmcnt(0)
i5 m0,49152
i5 s24,3670016
i1 v78,s[68:71],s24 offen lds
i5 m0,50176
i5 s24,3801088
i1 v78,s[68:71],s24 offen lds
i5 m0,51200
i5 s24,3932160
i1 v78,s[68:71],s24 offen lds
i5 m0,52224
i5 s24,4063232
i1 v78,s[68:71],s24 offen lds
i8 vmcnt(28)
i0 v[224:225],v75 offset:4096
i0 v[226:227],v75 offset:4352
i0 v[228:229],v75 offset:6144
i0 v[230:231],v75 offset:6400
i0 v[232:233],v75 offset:4128
i0 v[234:235],v75 offset:4384
i0 v[236:237],v75 offset:6176
i0 v[238:239],v75 offset:6432
i8 lgkmcnt(0)
i5 m0,53248
i5 s24,4194304
i1 v78,s[68:71],s24 offen lds
i5 m0,54272
i5 s24,4325376
i1 v78,s[68:71],s24 offen lds
i5 m0,55296
i5 s24,4456448
i1 v78,s[68:71],s24 offen lds
i5 m0,56320
i5 s24,4587520
i1 v78,s[68:71],s24 offen lds
i8 vmcnt(28)
i0 v[240:241],v75 offset:8192
i0 v[242:243],v75 offset:8448
i0 v[244:245],v75 offset:10240
i0 v[246:247],v75 offset:10496
i0 v[248:249],v75 offset:8224
i0 v[250:251],v75 offset:8480
i0 v[252:253],v75 offset:10272
i0 v[254:255],v75 offset:10528
i8 lgkmcnt(0)
i5 m0,57344
i5 s24,288
i1 v77,s[72:75],s24 offen lds
i5 m0,58368
i5 s24,37152
i1 v77,s[72:75],s24 offen lds
i5 m0,59392
i5 s24,74016
i1 v77,s[72:75],s24 offen lds
i5 m0,60416
i5 s24,110880
i1 v77,s[72:75],s24 offen lds
i8 vmcnt(28)
i0 a[0:1],v75 offset:12288
i0 a[2:3],v75 offset:12544
i0 a[4:5],v75 offset:14336
i0 a[6:7],v75 offset:14592
i0 a[8:9],v75 offset:12320
i0 a[10:11],v75 offset:12576
i0 a[12:13],v75 offset:14368
i0 a[14:15],v75 offset:14624
i8 lgkmcnt(0)
i5 m0,61440
i5 s24,320
i1 v77,s[72:75],s24 offen lds
i5 m0,62464
i5 s24,37184
i1 v77,s[72:75],s24 offen lds
i5 m0,63488
i5 s24,74048
i1 v77,s[72:75],s24 offen lds
i5 m0,64512
i5 s24,110912
i1 v77,s[72:75],s24 offen lds
i8 vmcnt(28)
i0 a[16:17],v75 offset:16384
i0 a[18:19],v75 offset:16640
i0 a[20:21],v75 offset:18432
i0 a[22:23],v75 offset:18688
i0 a[24:25],v75 offset:16416
i0 a[26:27],v75 offset:16672
i0 a[28:29],v75 offset:18464
i0 a[30:31],v75 offset:18720
i8 lgkmcnt(0)
i5 m0,65536
i5 s24,352
i1 v77,s[72:75],s24 offen lds
i5 m0,66560
i5 s24,37216
i1 v77,s[72:75],s24 offen lds
i5 m0,67584
i5 s24,74080
i1 v77,s[72:75],s24 offen lds
i5 m0,68608
i5 s24,110944
i1 v77,s[72:75],s24 offen lds
i8 vmcnt(28)
i0 a[32:33],v75 offset:20480
i0 a[34:35],v75 offset:20736
i0 a[36:37],v75 offset:22528
i0 a[38:39],v75 offset:22784
i0 a[40:41],v75 offset:20512
i0 a[42:43],v75 offset:20768
i0 a[44:45],v75 offset:22560
i0 a[46:47],v75 offset:22816
i8 lgkmcnt(0)
i5 m0,69632
i5 s24,384
i1 v77,s[72:75],s24 offen lds
i5 m0,70656
i5 s24,37248
i1 v77,s[72:75],s24 offen lds
i5 m0,71680
i5 s24,74112
i1 v77,s[72:75],s24 offen lds
i5 m0,72704
i5 s24,110976
i1 v77,s[72:75],s24 offen lds
i8 vmcnt(28)
i0 a[48:49],v75 offset:24576
i0 a[50:51],v75 offset:24832
i0 a[52:53],v75 offset:26624
i0 a[54:55],v75 offset:26880
i0 a[56:57],v75 offset:24608
i0 a[58:59],v75 offset:24864
i0 a[60:61],v75 offset:26656
i0 a[62:63],v75 offset:26912
i8 lgkmcnt(0)
i5 m0,73728
i5 s24,416
i1 v77,s[72:75],s24 offen lds
i5 m0,74752
i5 s24,37280
i1 v77,s[72:75],s24 offen lds
i5 m0,75776
i5 s24,74144
i1 v77,s[72:75],s24 offen lds
i5 m0,76800
i5 s24,111008
i1 v77,s[72:75],s24 offen lds
i8 vmcnt(28)
i0 a[64:65],v75 offset:28672
i0 a[66:67],v75 offset:28928
i0 a[68:69],v75 offset:30720
i0 a[70:71],v75 offset:30976
i0 a[72:73],v75 offset:28704
i0 a[74:75],v75 offset:28960
i0 a[76:77],v75 offset:30752
i0 a[78:79],v75 offset:31008
i8 lgkmcnt(0)
i5 m0,77824
i5 s24,448
i1 v77,s[72:75],s24 offen lds
i5 m0,78848
i5 s24,37312
i1 v77,s[72:75],s24 offen lds
i5 m0,79872
i5 s24,74176
i1 v77,s[72:75],s24 offen lds
i5 m0,80896
i5 s24,111040
i1 v77,s[72:75],s24 offen lds
i8 vmcnt(28)
i0 a[80:81],v75 offset:0
i0 a[82:83],v75 offset:256
i0 a[84:85],v75 offset:2048
i0 a[86:87],v75 offset:2304
i0 a[88:89],v75 offset:32
i0 a[90:91],v75 offset:288
i0 a[92:93],v75 offset:2080
i0 a[94:95],v75 offset:2336
i8 lgkmcnt(0)
i5 m0,49152
i5 s24,480
i1 v77,s[72:75],s24 offen lds
i5 m0,50176
i5 s24,37344
i1 v77,s[72:75],s24 offen lds
i5 m0,51200
i5 s24,74208
i1 v77,s[72:75],s24 offen lds
i5 m0,52224
i5 s24,111072
i1 v77,s[72:75],s24 offen lds
i8 vmcnt(28)
i0 a[96:97],v75 offset:4096
i0 a[98:99],v75 offset:4352
i0 a[100:101],v75 offset:6144
i0 a[102:103],v75 offset:6400
i0 a[104:105],v75 offset:4128
i0 a[106:107],v75 offset:4384
i0 a[108:109],v75 offset:6176
i0 a[110:111],v75 offset:6432
i8 lgkmcnt(0)
i5 m0,53248
i5 s24,512
i1 v77,s[72:75],s24 offen lds
i5 m0,54272
i5 s24,37376
i1 v77,s[72:75],s24 offen lds
i5 m0,55296
i5 s24,74240
i1 v77,s[72:75],s24 offen lds
i5 m0,56320
i5 s24,111104
i1 v77,s[72:75],s24 offen lds
i8 vmcnt(28)
i0 a[112:113],v74 offset:8192
i0 a[114:115],v74 offset:8704
i0 a[116:117],v74 offset:9216
i0 a[118:119],v74 offset:9728
i0 a[120:121],v74 offset:10240
i0 a[122:123],v74 offset:10752
i0 a[124:125],v74 offset:11264
i0 a[126:127],v74 offset:11776
i8 lgkmcnt(0)
i5 m0,57344
i5 s24,544
i1 v77,s[72:75],s24 offen lds
i5 m0,58368
i5 s24,37408
i1 v77,s[72:75],s24 offen lds
i5 m0,59392
i5 s24,74272
i1 v77,s[72:75],s24 offen lds
i5 m0,60416
i5 s24,111136
i1 v77,s[72:75],s24 offen lds
i8 vmcnt(28)
i0 a[128:129],v74 offset:12288
i0 a[130:131],v74 offset:12800
i0 a[132:133],v74 offset:13312
i0 a[134:135],v74 offset:13824
i0 a[136:137],v74 offset:14336
i0 a[138:139],v74 offset:14848
i0 a[140:141],v74 offset:15360
i0 a[142:143],v74 offset:15872
i8 lgkmcnt(0)
i8 vmcnt(24)
i0 a[144:145],v74 offset:16384
i0 a[146:147],v74 offset:16896
i0 a[148:149],v74 offset:17408
i0 a[150:151],v74 offset:17920
i0 a[152:153],v74 offset:18432
i0 a[154:155],v74 offset:18944
i0 a[156:157],v74 offset:19456
i0 a[158:159],v74 offset:19968
i8 lgkmcnt(0)
i8 vmcnt(20)
i0 a[160:161],v74 offset:20480
i0 a[162:163],v74 offset:20992
i0 a[164:165],v74 offset:21504
i0 a[166:167],v74 offset:22016
i0 a[168:169],v74 offset:22528
i0 a[170:171],v74 offset:23040
i0 a[172:173],v74 offset:23552
i0 a[174:175],v74 offset:24064
i8 lgkmcnt(0)
i8 vmcnt(16)
i0 a[176:177],v74 offset:24576
i0 a[178:179],v74 offset:25088
i0 a[180:181],v74 offset:25600
i0 a[182:183],v74 offset:26112
i0 a[184:185],v74 offset:26624
i0 a[186:187],v74 offset:27136
i0 a[188:189],v74 offset:27648
i0 a[190:191],v74 offset:28160
i8 lgkmcnt(0)
i8 vmcnt(12)
i0 a[192:193],v74 offset:28672
i0 a[194:195],v74 offset:29184
i0 a[196:197],v74 offset:29696
i0 a[198:199],v74 offset:30208
i0 a[200:201],v74 offset:30720
i0 a[202:203],v74 offset:31232
i0 a[204:205],v74 offset:31744
i0 a[206:207],v74 offset:32256
i8 lgkmcnt(0)
i8 vmcnt(8)
i0 a[208:209],v74 offset:0
i0 a[210:211],v74 offset:512
i0 a[212:213],v74 offset:1024
i0 a[214:215],v74 offset:1536
i0 a[216:217],v74 offset:2048
i0 a[218:219],v74 offset:2560
i0 a[220:221],v74 offset:3072
i0 a[222:223],v74 offset:3584
i8 lgkmcnt(0)
i8 vmcnt(4)
i0 a[224:225],v74 offset:4096
i0 a[226:227],v74 offset:4608
i0 a[228:229],v74 offset:5120
i0 a[230:231],v74 offset:5632
i0 a[232:233],v74 offset:6144
i0 a[234:235],v74 offset:6656
i0 a[236:237],v74 offset:7168
i0 a[238:239],v74 offset:7680
i8 lgkmcnt(0)
i8 vmcnt(0)
i0 a[240:241],v74 offset:8192
i0 a[242:243],v74 offset:8704
i0 a[244:245],v74 offset:9216
i0 a[246:247],v74 offset:9728
i0 a[248:249],v74 offset:10240
i0 a[250:251],v74 offset:10752
i0 a[252:253],v74 offset:11264
i0 a[254:255],v74 offset:11776
i8 lgkmcnt(0)
i34 v21,v79,3,1
i25 vcc,1,v21
i11 v1,0x8888
i11 v20,0xdddd
i26 v1,v1,v20,vcc
i18 v20,7,v79
i34 v21,v79,4,1
i31 v21,2,v21
v_sub_u32 v20, v20, v21
i18 v21,1,v20
i31 v21,4,v21
i11 v22,0x3f80
i31 v22,v21,v22
v_ashrrev_i32 v20, 1, v20
i25 vcc,0,v20
i15 1
i26 v2,0,v22,vcc
i25 vcc,1,v20
i15 1
i26 v3,0,v22,vcc
i18 v4,0x33f,v0
i34 v20,v0,7,1
i24 v4,v20,6,v4
i34 v20,v0,6,1
i24 v4,v20,7,v4
i18 v20,16,v0
i11 v22,0x3f80
i31 v22,v20,v22
i34 v20,v0,5,3
i25 vcc,0,v20
i15 1
i26 v12,0,v22,vcc
i25 vcc,1,v20
i15 1
i26 v13,0,v22,vcc
i25 vcc,2,v20
i15 1
i26 v14,0,v22,vcc
i25 vcc,3,v20
i15 1
i26 v15,0,v22,vcc
i25 vcc,4,v20
i15 1
i26 v16,0,v22,vcc
i25 vcc,5,v20
i15 1
i26 v17,0,v22,vcc
i25 vcc,6,v20
i15 1
i26 v18,0,v22,vcc
i25 vcc,7,v20
i15 1
i26 v19,0,v22,vcc
i34 v20,v79,3,1
i18 v21,7,v79
i17 v20,v20,4,v21
i23 v21,5,v79
i34 v22,v79,4,1
i31 v22,2,v22
i17 v21,v21,4,v22
v_sub_u32 v21, v20, v21
i20 v21,8,v21
v_cmp_le_i32 s[36:37], 0, v21
v_cmp_le_i32 s[38:39], 1, v21
v_cmp_le_i32 s[40:41], 2, v21
v_cmp_le_i32 s[42:43], 3, v21
v_cmp_le_i32 s[44:45], 8, v21
v_cmp_le_i32 s[46:47], 9, v21
v_cmp_le_i32 s[48:49], 10, v21
v_cmp_le_i32 s[50:51], 11, v21
i23 v21,4,v79
i5 s25,36864
i18 v22,0xf0,v0
i45 v8,v21,s25,v22
i34 v22,v79,4,1
i17 v20,v22,3,v20
i54 s25,2304
i43 v9,s25,v20
i32 s24,s20,2
i6 s24,s24,1
i32 s24,s24,3
i6 s24,s24,1152
i32 s25,s20,3
i6 s25,s25,2176
s_cmp_lt_u32 s20, 16
i28 s62,0,0
i47 s62,1
i28 s25,s25,0x80000000
i11 v21,s24
i11 v22,s25
v_cmp_lt_u32 vcc, 31, v79
i15 1
i26 v21,v21,v22,vcc
i20 v9,v9,v21
i5 s52,0x3f803f80
i5 s53,0x3f803f80
i5 s54,0x3f003f00
i5 s55,0x3f003f00
i5 s31,0
i5 s63,0
i5 s34,0x80000000
i5 s18,2147516416
i5 s22,s19
i5 s32,1
i32 s33,s19,7
i6 s33,s33,74448896
s_mul_i32 s29, s19, 4194304
i6 s29,s29,75497472
i20 v20,151552,v0
i21 v20,v[2:5]
i21 v20,v[8:11] offset:1024
i21 v20,v[12:15] offset:2048
i21 v20,v[16:19] offset:3072
i8 lgkmcnt(0)
s_barrier
i11 v40,0
i5 s94,0
i46 s21,0
i22 L_xb1b
i39 exec,1
L_xb1:
i55 v41,v40,s[100:101] offset:48 sc1
i6 s94,s94,1
i35 s94,400000
i22 L_endx
i8 vmcnt(0)
v_cmp_gt_u32 vcc, 32, v41
i49 L_xb1z
i44 L_xb1k
L_xb1z:
s_sleep 4
i44 L_xb1
L_xb1k:
i39 exec,-1
L_xb1b:
s_barrier
i47 s99,2
i22 L_xs1
Lx1f_top:
i32 s27,s22,18
i32 s24,s20,13
i6 s27,s27,s24
i32 s28,s22,14
i6 s28,s28,72351744
s_mul_i32 s30, s22, 73728
s_and_b32 s24, s22, 7
s_cmp_ge_u32 s24, 3
i22 Lx1f_rdyk
s_barrier
Lx1f_rdyk:
s_bitcmp1_b32 s18, 31
s_cbranch_scc0 Lx1f_pre
s_bitset0_b32 s18, 31
i6 m0,s18,2048
i6 s25,s27,33556480
i1 v0,s[8:11],s25 offen sc1 lds
i6 m0,s18,3072
i6 s25,s27,33557504
i1 v0,s[8:11],s25 offen sc1 lds
i6 m0,s18,10240
i6 s25,s27,2048
i1 v0,s[8:11],s25 offen sc1 lds
i6 m0,s18,11264
i6 s25,s27,3072
i1 v0,s[8:11],s25 offen sc1 lds
i6 m0,s18,18432
i6 s25,s27,16779264
i1 v0,s[8:11],s25 offen sc1 lds
i6 m0,s18,19456
i6 s25,s27,16780288
i1 v0,s[8:11],s25 offen sc1 lds
Lx1f_pre:
i20 v6,s18,v0
i8 vmcnt(0)
s_barrier
i9 v[8:11],v6 offset:1024
i9 v[48:51],v6 offset:8192
i9 v[12:15],v6 offset:3072
i9 v[52:55],v6 offset:10240
i9 v[16:19],v6 offset:5120
i9 v[56:59],v6 offset:12288
i9 v[20:23],v6 offset:7168
i9 v[60:63],v6 offset:14336
i9 v[24:27],v6 offset:9216
i9 v[28:31],v6 offset:11264
i9 v[32:35],v6 offset:13312
i9 v[36:39],v6 offset:15360
i8 lgkmcnt(10)
i2 v[40:43],v[48:51],v[8:11],0
i8 lgkmcnt(8)
i2 v[40:43],v[52:55],v[12:15],v[40:43]
i8 lgkmcnt(6)
i2 v[40:43],v[56:59],v[16:19],v[40:43]
i8 lgkmcnt(4)
i2 v[40:43],v[60:63],v[20:23],v[40:43]
i8 lgkmcnt(3)
i2 v[44:47],v[24:27],v[8:11],0
i8 lgkmcnt(2)
i2 v[44:47],v[28:31],v[12:15],v[44:47]
i8 lgkmcnt(1)
i2 v[44:47],v[32:35],v[16:19],v[44:47]
i8 lgkmcnt(0)
i2 v[44:47],v[36:39],v[20:23],v[44:47]
i9 v[24:27],v6 offset:16384
i9 v[28:31],v6 offset:17408
i9 v[32:35],v6 offset:18432
i9 v[36:39],v6 offset:19456
i11 v5,0xff800000
i26 v40,v5,v40,s[36:37]
i26 v41,v5,v41,s[38:39]
i26 v42,v5,v42,s[40:41]
i26 v43,v5,v43,s[42:43]
i26 v44,v5,v44,s[44:45]
i26 v45,v5,v45,s[46:47]
i26 v46,v5,v46,s[48:49]
i26 v47,v5,v47,s[50:51]
Lx1f_h:
i6 s24,s28,1024
i1 v[64:67],v4,s[8:11],s24 offen sc1
i6 s24,s28,5120
i1 v[68:71],v4,s[8:11],s24 offen sc1
i23 v76,2,v0
i18 v76,0x7c,v76
i36 v77,v76,s[8:11],s33 offen sc1
i6 s31,s31,1
i35 s31,400000
i22 L_endx
i8 vmcnt(0)
i48 v5,v64,v65,v66
i48 v5,v5,v67,v68
i48 v5,v5,v69,v70
v_max_u32 v5, v5, v71
i25 vcc,-1,v5
s_cbranch_vccz Lx1f_hk
s_cmp_ge_u32 s22, 60
i22 Lx1f_h
i11 v6,1024
i39 exec,1
Lx1f_hl:
s_sleep 12
i36 v5,v6,s[8:11],s28 offen sc1
i6 s31,s31,1
i35 s31,400000
i22 L_endx
i8 vmcnt(0)
i25 vcc,-1,v5
i49 Lx1f_hl
i39 exec,-1
i44 Lx1f_h
Lx1f_hk:
i21 v0,v[64:67] offset:1024
i21 v0,v[68:71] offset:5120
i47 s63,0
i22 Lx1f_nq
Lx1f_fl0:
i8 vmcnt(0)
v_cmp_gt_u32 vcc, s32, v77
s_cbranch_vccz Lx1f_fl0k
i36 v77,v76,s[8:11],s33 offen sc1
i6 s31,s31,1
i35 s31,400000
i22 L_endx
i44 Lx1f_fl0
Lx1f_fl0k:
Lx1f_nq:
i20 v78,151552,v0
ds_read_b32 v78, v78 offset:1024
i32 s14,s20,10
i6 s14,s14,256
i6 s14,s14,s34
s_xor_b32 s16, s18, 24576
i6 s24,s22,3
s_xor_b32 s24, s24, s22
s_cmp_ge_u32 s24, 8
i28 s24,0x80000000,0
s_or_b32 s18, s16, s24
i6 s26,s27,786432
s_or_b32 s26, s26, s24
i14 v[48:49],0
i14 v[50:51],0
i14 v[52:53],0
i14 v[54:55],0
i14 v[56:57],0
i14 v[58:59],0
i14 v[60:61],0
i14 v[62:63],0
i8 lgkmcnt(0)
s_barrier
i9 v[64:67],v0 offset:0
i9 v[68:71],v0 offset:1024
i9 v[72:75],v0 offset:2048
i8 lgkmcnt(2)
i4 v[48:51],v[64:67],v[80:87],v1
i5 m0,90112
i6 s25,s14,0
i1 v78,s[8:11],s25 offen sc1 lds
i4 v[52:55],v[64:67],v[88:95],v1
i4 v[56:59],v[64:67],v[224:231],v1
i5 m0,91136
i6 s25,s14,147456
i1 v78,s[8:11],s25 offen sc1 lds
i4 v[60:63],v[64:67],v[232:239],v1
i9 v[64:67],v0 offset:3072
i8 lgkmcnt(2)
i4 v[48:51],v[68:71],v[96:103],v1
i5 m0,92160
i6 s25,s14,294912
i1 v78,s[8:11],s25 offen sc1 lds
i4 v[52:55],v[68:71],v[104:111],v1
i4 v[56:59],v[68:71],v[240:247],v1
i5 m0,93184
i6 s25,s14,442368
i1 v78,s[8:11],s25 offen sc1 lds
i4 v[60:63],v[68:71],v[248:255],v1
i9 v[68:71],v0 offset:4096
i8 lgkmcnt(2)
i4 v[48:51],v[72:75],v[112:119],v1
i5 m0,94208
i6 s25,s14,589824
i1 v78,s[8:11],s25 offen sc1 lds
i4 v[52:55],v[72:75],v[120:127],v1
i4 v[56:59],v[72:75],a[0:7],v1
i5 m0,95232
i6 s25,s14,737280
i1 v78,s[8:11],s25 offen sc1 lds
i4 v[60:63],v[72:75],a[8:15],v1
i9 v[72:75],v0 offset:5120
i8 lgkmcnt(2)
i4 v[48:51],v[64:67],v[128:135],v1
i5 m0,96256
i6 s25,s14,884736
i1 v78,s[8:11],s25 offen sc1 lds
i4 v[52:55],v[64:67],v[136:143],v1
i4 v[56:59],v[64:67],a[16:23],v1
i5 m0,97280
i6 s25,s14,1032192
i1 v78,s[8:11],s25 offen sc1 lds
i4 v[60:63],v[64:67],a[24:31],v1
i9 v[64:67],v0 offset:6144
i8 lgkmcnt(2)
i4 v[48:51],v[68:71],v[144:151],v1
i6 m0,s16,2048
i6 s25,s26,33556480
i1 v0,s[8:11],s25 offen sc1 lds
i4 v[52:55],v[68:71],v[152:159],v1
i4 v[56:59],v[68:71],a[32:39],v1
i6 m0,s16,3072
i6 s25,s26,33557504
i1 v0,s[8:11],s25 offen sc1 lds
i4 v[60:63],v[68:71],a[40:47],v1
i9 v[68:71],v0 offset:7168
i8 lgkmcnt(2)
i4 v[48:51],v[72:75],v[160:167],v1
i6 m0,s16,10240
i6 s25,s26,2048
i1 v0,s[8:11],s25 offen sc1 lds
i4 v[52:55],v[72:75],v[168:175],v1
i4 v[56:59],v[72:75],a[48:55],v1
i6 m0,s16,11264
i6 s25,s26,3072
i1 v0,s[8:11],s25 offen sc1 lds
i4 v[60:63],v[72:75],a[56:63],v1
i9 v[72:75],v0 offset:8192
i8 lgkmcnt(2)
i4 v[48:51],v[64:67],v[176:183],v1
i6 m0,s16,18432
i6 s25,s26,16779264
i1 v0,s[8:11],s25 offen sc1 lds
i4 v[52:55],v[64:67],v[184:191],v1
i4 v[56:59],v[64:67],a[64:71],v1
i6 m0,s16,19456
i6 s25,s26,16780288
i1 v0,s[8:11],s25 offen sc1 lds
i4 v[60:63],v[64:67],a[72:79],v1
i8 lgkmcnt(1)
i4 v[48:51],v[68:71],v[192:199],v1
i4 v[52:55],v[68:71],v[200:207],v1
i4 v[56:59],v[68:71],a[80:87],v1
i4 v[60:63],v[68:71],a[88:95],v1
i8 lgkmcnt(0)
i4 v[48:51],v[72:75],v[208:215],v1
i4 v[52:55],v[72:75],v[216:223],v1
i4 v[56:59],v[72:75],a[96:103],v1
i4 v[60:63],v[72:75],a[104:111],v1
i3 v48,v48,v49
i3 v49,v50,v51
i3 v50,v52,v53
i3 v51,v54,v55
i27 v[52:55],v[48:49],v[2:3],0
i15 0
i27 v[76:79],v[50:51],v[2:3],0
i3 v56,v56,v57
i3 v57,v58,v59
i3 v58,v60,v61
i3 v59,v62,v63
i21 v0,v[56:59] offset:14336
i3 v48,v52,v53
i3 v49,v54,v55
i15 0
i3 v50,v76,v77
i3 v51,v78,v79
i21 v0,v[48:51] offset:10240
i8 lgkmcnt(0)
s_barrier
i9 v[64:67],v0 offset:9216
i9 v[68:71],v0 offset:10240
i9 v[72:75],v0 offset:11264
i9 v[76:79],v0 offset:12288
i9 v[48:51],v0 offset:13312
i9 v[52:55],v0 offset:14336
i38 v5,v40,v41,v42
i38 v6,v43,v44,v45
i38 v5,v5,v46,v47
i8 lgkmcnt(5)
i2 v[60:63],v[64:67],v[8:11],0
i8 lgkmcnt(4)
i2 v[60:63],v[68:71],v[12:15],v[60:63]
i8 lgkmcnt(3)
i2 v[60:63],v[72:75],v[16:19],v[60:63]
i8 lgkmcnt(2)
i2 v[60:63],v[76:79],v[20:23],v[60:63]
i15 7
i51 v60,0x3e0293ee,v60
i51 v61,0x3e0293ee,v61
i51 v62,0x3e0293ee,v62
i51 v63,0x3e0293ee,v63
i38 v5,v5,v6,v60
i38 v5,v5,v61,v62
v_max_f32 v5, v5, v63
i11 v6,v5
i15 1
v_permlane16_swap_b32 v5, v6
v_max_f32 v5, v5, v6
i11 v6,v5
i15 1
i40 v5,v6
v_max_f32 v5, v5, v6
i33 v40,v40,v5
i33 v41,v41,v5
i33 v42,v42,v5
i33 v43,v43,v5
i33 v44,v44,v5
i33 v45,v45,v5
i33 v46,v46,v5
i33 v47,v47,v5
i33 v60,v60,v5
i33 v61,v61,v5
i33 v62,v62,v5
i33 v63,v63,v5
i19 v40,v40
i19 v41,v41
i19 v42,v42
i19 v43,v43
i19 v44,v44
i19 v45,v45
i19 v46,v46
i19 v47,v47
i19 v60,v60
i19 v61,v61
i19 v62,v62
i19 v63,v63
i14 v[12:13],s[52:53]
i14 v[14:15],s[52:53]
i14 v[16:17],s[54:55]
i3 v20,v40,v41
i3 v21,v42,v43
i3 v22,v44,v45
i3 v23,v46,v47
i3 v18,v60,v61
i3 v19,v62,v63
i8 lgkmcnt(0)
i2 v[8:11],v[12:15],v[20:23],0
i2 v[64:67],v[24:27],v[20:23],0
i2 v[68:71],v[28:31],v[20:23],0
i2 v[72:75],v[32:35],v[20:23],0
i2 v[76:79],v[36:39],v[20:23],0
i27 v[8:11],v[16:17],v[18:19],v[8:11]
i27 v[64:67],v[48:49],v[18:19],v[64:67]
i27 v[68:71],v[50:51],v[18:19],v[68:71]
i27 v[72:75],v[52:53],v[18:19],v[72:75]
i27 v[76:79],v[54:55],v[18:19],v[76:79]
v_rcp_f32 v6, v8
i15 0
i16 v[64:65],v[64:65],v[6:7] op_sel_hi:[1,0]
i16 v[66:67],v[66:67],v[6:7] op_sel_hi:[1,0]
i16 v[68:69],v[68:69],v[6:7] op_sel_hi:[1,0]
i16 v[70:71],v[70:71],v[6:7] op_sel_hi:[1,0]
i16 v[72:73],v[72:73],v[6:7] op_sel_hi:[1,0]
i16 v[74:75],v[74:75],v[6:7] op_sel_hi:[1,0]
i16 v[76:77],v[76:77],v[6:7] op_sel_hi:[1,0]
i16 v[78:79],v[78:79],v[6:7] op_sel_hi:[1,0]
i3 v64,v64,v65
i3 v65,v66,v67
i3 v66,v68,v69
i3 v67,v70,v71
i21 v0,v[64:67] offset:21504
i3 v72,v72,v73
i3 v73,v74,v75
i3 v74,v76,v77
i3 v75,v78,v79
i21 v0,v[72:75] offset:22528
i8 lgkmcnt(0)
s_barrier
i47 s63,0
i22 Lx1f_nr
i20 v40,151552,v0
i20 v41,90112,v0
ds_read_b32 v42, v40 offset:1028
i9 v[72:75],v40 offset:2048
i9 v[76:79],v40 offset:3072
i8 vmcnt(0)
i9 v[8:11],v41 offset:0
i9 v[12:15],v41 offset:1024
i9 v[16:19],v41 offset:2048
i9 v[20:23],v41 offset:3072
i9 v[24:27],v41 offset:4096
i9 v[28:31],v41 offset:5120
i9 v[32:35],v41 offset:6144
i9 v[36:39],v41 offset:7168
i8 lgkmcnt(7)
i2 v[44:47],v[72:75],v[8:11],0
i8 lgkmcnt(6)
i2 v[44:47],v[72:75],v[12:15],v[44:47]
i8 lgkmcnt(5)
i2 v[44:47],v[72:75],v[16:19],v[44:47]
i8 lgkmcnt(4)
i2 v[44:47],v[72:75],v[20:23],v[44:47]
i8 lgkmcnt(3)
i2 v[44:47],v[72:75],v[24:27],v[44:47]
i8 lgkmcnt(2)
i2 v[44:47],v[72:75],v[28:31],v[44:47]
i8 lgkmcnt(1)
i2 v[44:47],v[72:75],v[32:35],v[44:47]
i8 lgkmcnt(0)
i2 v[44:47],v[72:75],v[36:39],v[44:47]
i15 7
i3 v44,v44,v45
i3 v45,v46,v47
i41 v[44:45],v42,s[56:59],s35 offen
i6 s32,s32,1
Lx1f_nr:
i9 v[8:11],v0 offset:17408
i9 v[12:15],v0 offset:18432
i9 v[16:19],v0 offset:19456
i9 v[20:23],v0 offset:20480
i9 v[24:27],v0 offset:21504
i9 v[28:31],v0 offset:22528
i9 v[32:35],v0 offset:23552
i9 v[36:39],v0 offset:24576
s_mul_i32 s24, s20, 36864
i6 s24,s24,s29
i6 s24,s24,9216
i6 s25,s24,4096
i6 s26,s24,8192
i8 lgkmcnt(7)
i2 v[40:43],a[112:115],v[8:11],0
i8 lgkmcnt(6)
i2 v[40:43],a[116:119],v[12:15],v[40:43]
i8 lgkmcnt(5)
i2 v[40:43],a[120:123],v[16:19],v[40:43]
i8 lgkmcnt(4)
i2 v[40:43],a[124:127],v[20:23],v[40:43]
i8 lgkmcnt(3)
i2 v[44:47],a[112:115],v[24:27],0
i8 lgkmcnt(2)
i2 v[44:47],a[116:119],v[28:31],v[44:47]
i8 lgkmcnt(1)
i2 v[44:47],a[120:123],v[32:35],v[44:47]
i8 lgkmcnt(0)
i2 v[44:47],a[124:127],v[36:39],v[44:47]
i2 v[48:51],a[128:131],v[8:11],0
i2 v[48:51],a[132:135],v[12:15],v[48:51]
i2 v[48:51],a[136:139],v[16:19],v[48:51]
i2 v[48:51],a[140:143],v[20:23],v[48:51]
i3 v40,v40,v41
i3 v41,v42,v43
i3 v42,v44,v45
i3 v43,v46,v47
i13 v[40:43],v0,s[8:11],s24 offen offset:0
i2 v[52:55],a[128:131],v[24:27],0
i2 v[52:55],a[132:135],v[28:31],v[52:55]
i2 v[52:55],a[136:139],v[32:35],v[52:55]
i2 v[52:55],a[140:143],v[36:39],v[52:55]
i2 v[56:59],a[144:147],v[8:11],0
i2 v[56:59],a[148:151],v[12:15],v[56:59]
i2 v[56:59],a[152:155],v[16:19],v[56:59]
i2 v[56:59],a[156:159],v[20:23],v[56:59]
i3 v48,v48,v49
i3 v49,v50,v51
i3 v50,v52,v53
i3 v51,v54,v55
i13 v[48:51],v0,s[8:11],s24 offen offset:1024
i2 v[60:63],a[144:147],v[24:27],0
i2 v[60:63],a[148:151],v[28:31],v[60:63]
i2 v[60:63],a[152:155],v[32:35],v[60:63]
i2 v[60:63],a[156:159],v[36:39],v[60:63]
i2 v[64:67],a[160:163],v[8:11],0
i2 v[64:67],a[164:167],v[12:15],v[64:67]
i2 v[64:67],a[168:171],v[16:19],v[64:67]
i2 v[64:67],a[172:175],v[20:23],v[64:67]
i3 v56,v56,v57
i3 v57,v58,v59
i3 v58,v60,v61
i3 v59,v62,v63
i13 v[56:59],v0,s[8:11],s24 offen offset:2048
i2 v[68:71],a[160:163],v[24:27],0
i2 v[68:71],a[164:167],v[28:31],v[68:71]
i2 v[68:71],a[168:171],v[32:35],v[68:71]
i2 v[68:71],a[172:175],v[36:39],v[68:71]
i2 v[72:75],a[176:179],v[8:11],0
i2 v[72:75],a[180:183],v[12:15],v[72:75]
i2 v[72:75],a[184:187],v[16:19],v[72:75]
i2 v[72:75],a[188:191],v[20:23],v[72:75]
i3 v64,v64,v65
i3 v65,v66,v67
i3 v66,v68,v69
i3 v67,v70,v71
i13 v[64:67],v0,s[8:11],s24 offen offset:3072
i2 v[76:79],a[176:179],v[24:27],0
i2 v[76:79],a[180:183],v[28:31],v[76:79]
i2 v[76:79],a[184:187],v[32:35],v[76:79]
i2 v[76:79],a[188:191],v[36:39],v[76:79]
i2 v[40:43],a[192:195],v[8:11],0
i2 v[40:43],a[196:199],v[12:15],v[40:43]
i2 v[40:43],a[200:203],v[16:19],v[40:43]
i2 v[40:43],a[204:207],v[20:23],v[40:43]
i3 v72,v72,v73
i3 v73,v74,v75
i3 v74,v76,v77
i3 v75,v78,v79
i13 v[72:75],v0,s[8:11],s25 offen offset:0
i2 v[44:47],a[192:195],v[24:27],0
i2 v[44:47],a[196:199],v[28:31],v[44:47]
i2 v[44:47],a[200:203],v[32:35],v[44:47]
i2 v[44:47],a[204:207],v[36:39],v[44:47]
i2 v[48:51],a[208:211],v[8:11],0
i2 v[48:51],a[212:215],v[12:15],v[48:51]
i2 v[48:51],a[216:219],v[16:19],v[48:51]
i2 v[48:51],a[220:223],v[20:23],v[48:51]
i3 v40,v40,v41
i3 v41,v42,v43
i3 v42,v44,v45
i3 v43,v46,v47
i13 v[40:43],v0,s[8:11],s25 offen offset:1024
i2 v[52:55],a[208:211],v[24:27],0
i2 v[52:55],a[212:215],v[28:31],v[52:55]
i2 v[52:55],a[216:219],v[32:35],v[52:55]
i2 v[52:55],a[220:223],v[36:39],v[52:55]
i2 v[56:59],a[224:227],v[8:11],0
i2 v[56:59],a[228:231],v[12:15],v[56:59]
i2 v[56:59],a[232:235],v[16:19],v[56:59]
i2 v[56:59],a[236:239],v[20:23],v[56:59]
i3 v48,v48,v49
i3 v49,v50,v51
i3 v50,v52,v53
i3 v51,v54,v55
i13 v[48:51],v0,s[8:11],s25 offen offset:2048
i2 v[60:63],a[224:227],v[24:27],0
i2 v[60:63],a[228:231],v[28:31],v[60:63]
i2 v[60:63],a[232:235],v[32:35],v[60:63]
i2 v[60:63],a[236:239],v[36:39],v[60:63]
i2 v[64:67],a[240:243],v[8:11],0
i2 v[64:67],a[244:247],v[12:15],v[64:67]
i2 v[64:67],a[248:251],v[16:19],v[64:67]
i2 v[64:67],a[252:255],v[20:23],v[64:67]
i3 v56,v56,v57
i3 v57,v58,v59
i3 v58,v60,v61
i3 v59,v62,v63
i13 v[56:59],v0,s[8:11],s25 offen offset:3072
i2 v[68:71],a[240:243],v[24:27],0
i2 v[68:71],a[244:247],v[28:31],v[68:71]
i2 v[68:71],a[248:251],v[32:35],v[68:71]
i2 v[68:71],a[252:255],v[36:39],v[68:71]
i3 v64,v64,v65
i3 v65,v66,v67
i15 5
i3 v66,v68,v69
i3 v67,v70,v71
i13 v[64:67],v0,s[8:11],s26 offen offset:0
i5 s63,1
i5 s34,s29
i5 s35,s30
s_xor_b32 s29, s29, 2097152
i6 s22,s22,3
s_cmp_lt_u32 s22, 64
i22 Lx1f_top
i8 vmcnt(0)
s_barrier
i23 v76,2,v0
i18 v76,0x7c,v76
i36 v77,v76,s[8:11],s33 offen sc1
Lx1f_fl1:
i8 vmcnt(0)
v_cmp_gt_u32 vcc, s32, v77
s_cbranch_vccz Lx1f_fl1k
i36 v77,v76,s[8:11],s33 offen sc1
i6 s31,s31,1
i35 s31,400000
i22 L_endx
i44 Lx1f_fl1
Lx1f_fl1k:
i20 v78,151552,v0
ds_read_b32 v78, v78 offset:1024
i32 s14,s20,10
i6 s14,s14,256
i6 s14,s14,s34
i8 lgkmcnt(0)
i5 m0,90112
i6 s25,s14,0
i1 v78,s[8:11],s25 offen sc1 lds
i5 m0,91136
i6 s25,s14,147456
i1 v78,s[8:11],s25 offen sc1 lds
i5 m0,92160
i6 s25,s14,294912
i1 v78,s[8:11],s25 offen sc1 lds
i5 m0,93184
i6 s25,s14,442368
i1 v78,s[8:11],s25 offen sc1 lds
i5 m0,94208
i6 s25,s14,589824
i1 v78,s[8:11],s25 offen sc1 lds
i5 m0,95232
i6 s25,s14,737280
i1 v78,s[8:11],s25 offen sc1 lds
i5 m0,96256
i6 s25,s14,884736
i1 v78,s[8:11],s25 offen sc1 lds
i5 m0,97280
i6 s25,s14,1032192
i1 v78,s[8:11],s25 offen sc1 lds
i20 v40,151552,v0
i20 v41,90112,v0
ds_read_b32 v42, v40 offset:1028
i9 v[72:75],v40 offset:2048
i9 v[76:79],v40 offset:3072
i8 vmcnt(0)
i9 v[8:11],v41 offset:0
i9 v[12:15],v41 offset:1024
i9 v[16:19],v41 offset:2048
i9 v[20:23],v41 offset:3072
i9 v[24:27],v41 offset:4096
i9 v[28:31],v41 offset:5120
i9 v[32:35],v41 offset:6144
i9 v[36:39],v41 offset:7168
i8 lgkmcnt(7)
i2 v[44:47],v[72:75],v[8:11],0
i8 lgkmcnt(6)
i2 v[44:47],v[72:75],v[12:15],v[44:47]
i8 lgkmcnt(5)
i2 v[44:47],v[72:75],v[16:19],v[44:47]
i8 lgkmcnt(4)
i2 v[44:47],v[72:75],v[20:23],v[44:47]
i8 lgkmcnt(3)
i2 v[44:47],v[72:75],v[24:27],v[44:47]
i8 lgkmcnt(2)
i2 v[44:47],v[72:75],v[28:31],v[44:47]
i8 lgkmcnt(1)
i2 v[44:47],v[72:75],v[32:35],v[44:47]
i8 lgkmcnt(0)
i2 v[44:47],v[72:75],v[36:39],v[44:47]
i15 7
i3 v44,v44,v45
i3 v45,v46,v47
i41 v[44:45],v42,s[56:59],s35 offen
i8 vmcnt(0)
i44 L_endx
L_xs1:
Lx1s_top:
i32 s27,s22,18
i32 s24,s20,13
i6 s27,s27,s24
i32 s28,s22,14
i6 s28,s28,72351744
s_mul_i32 s30, s22, 73728
s_and_b32 s24, s22, 7
s_cmp_ge_u32 s24, 3
i22 Lx1s_rdyk
s_barrier
Lx1s_rdyk:
s_bitcmp1_b32 s18, 31
s_cbranch_scc0 Lx1s_pre
s_bitset0_b32 s18, 31
i6 m0,s18,2048
i6 s25,s27,33556480
i1 v0,s[8:11],s25 offen sc1 lds
i6 m0,s18,3072
i6 s25,s27,33557504
i1 v0,s[8:11],s25 offen sc1 lds
i6 m0,s18,10240
i6 s25,s27,2048
i1 v0,s[8:11],s25 offen sc1 lds
i6 m0,s18,11264
i6 s25,s27,3072
i1 v0,s[8:11],s25 offen sc1 lds
i6 m0,s18,18432
i6 s25,s27,16779264
i1 v0,s[8:11],s25 offen sc1 lds
i6 m0,s18,19456
i6 s25,s27,16780288
i1 v0,s[8:11],s25 offen sc1 lds
Lx1s_pre:
i20 v6,s18,v0
i8 vmcnt(0)
s_barrier
i9 v[8:11],v6 offset:1024
i9 v[48:51],v6 offset:8192
i9 v[12:15],v6 offset:3072
i9 v[52:55],v6 offset:10240
i9 v[16:19],v6 offset:5120
i9 v[56:59],v6 offset:12288
i9 v[20:23],v6 offset:7168
i9 v[60:63],v6 offset:14336
i9 v[24:27],v6 offset:9216
i9 v[28:31],v6 offset:11264
i9 v[32:35],v6 offset:13312
i9 v[36:39],v6 offset:15360
i8 lgkmcnt(10)
i2 v[40:43],v[48:51],v[8:11],0
i8 lgkmcnt(8)
i2 v[40:43],v[52:55],v[12:15],v[40:43]
i8 lgkmcnt(6)
i2 v[40:43],v[56:59],v[16:19],v[40:43]
i8 lgkmcnt(4)
i2 v[40:43],v[60:63],v[20:23],v[40:43]
i8 lgkmcnt(3)
i2 v[44:47],v[24:27],v[8:11],0
i8 lgkmcnt(2)
i2 v[44:47],v[28:31],v[12:15],v[44:47]
i8 lgkmcnt(1)
i2 v[44:47],v[32:35],v[16:19],v[44:47]
i8 lgkmcnt(0)
i2 v[44:47],v[36:39],v[20:23],v[44:47]
i9 v[24:27],v6 offset:16384
i9 v[28:31],v6 offset:17408
i9 v[32:35],v6 offset:18432
i9 v[36:39],v6 offset:19456
i11 v5,0xff800000
i26 v40,v5,v40,s[36:37]
i26 v41,v5,v41,s[38:39]
i26 v42,v5,v42,s[40:41]
i26 v43,v5,v43,s[42:43]
i26 v44,v5,v44,s[44:45]
i26 v45,v5,v45,s[46:47]
i26 v46,v5,v46,s[48:49]
i26 v47,v5,v47,s[50:51]
Lx1s_h:
i6 s24,s28,1024
i1 v[64:67],v4,s[8:11],s24 offen sc1
i6 s24,s28,5120
i1 v[68:71],v4,s[8:11],s24 offen sc1
i23 v76,2,v0
i18 v76,0x7c,v76
i36 v77,v76,s[8:11],s33 offen sc1
i6 s31,s31,1
i35 s31,400000
i22 L_endx
i8 vmcnt(0)
i48 v5,v64,v65,v66
i48 v5,v5,v67,v68
i48 v5,v5,v69,v70
v_max_u32 v5, v5, v71
i25 vcc,-1,v5
s_cbranch_vccz Lx1s_hk
s_cmp_ge_u32 s22, 60
i22 Lx1s_h
i11 v6,1024
i39 exec,1
Lx1s_hl:
s_sleep 12
i36 v5,v6,s[8:11],s28 offen sc1
i6 s31,s31,1
i35 s31,400000
i22 L_endx
i8 vmcnt(0)
i25 vcc,-1,v5
i49 Lx1s_hl
i39 exec,-1
i44 Lx1s_h
Lx1s_hk:
i21 v0,v[64:67] offset:1024
i21 v0,v[68:71] offset:5120
i47 s63,0
i22 Lx1s_nq
Lx1s_fl0:
i8 vmcnt(0)
v_cmp_gt_u32 vcc, s32, v77
s_cbranch_vccz Lx1s_fl0k
i36 v77,v76,s[8:11],s33 offen sc1
i6 s31,s31,1
i35 s31,400000
i22 L_endx
i44 Lx1s_fl0
Lx1s_fl0k:
Lx1s_nq:
i20 v78,151552,v0
ds_read_b32 v78, v78 offset:1024
i32 s14,s20,10
i6 s14,s14,256
i6 s14,s14,s34
s_xor_b32 s16, s18, 24576
i6 s24,s22,3
s_xor_b32 s24, s24, s22
s_cmp_ge_u32 s24, 8
i28 s24,0x80000000,0
s_or_b32 s18, s16, s24
i6 s26,s27,786432
s_or_b32 s26, s26, s24
i14 v[48:49],0
i14 v[50:51],0
i14 v[52:53],0
i14 v[54:55],0
i14 v[56:57],0
i14 v[58:59],0
i14 v[60:61],0
i14 v[62:63],0
i8 lgkmcnt(0)
s_barrier
i9 v[64:67],v0 offset:0
i9 v[68:71],v0 offset:1024
i9 v[72:75],v0 offset:2048
i8 lgkmcnt(2)
i4 v[48:51],v[64:67],v[80:87],v1
i5 m0,90112
i6 s25,s14,0
i1 v78,s[8:11],s25 offen sc1 lds
i4 v[52:55],v[64:67],v[88:95],v1
i4 v[56:59],v[64:67],v[224:231],v1
i5 m0,91136
i6 s25,s14,147456
i1 v78,s[8:11],s25 offen sc1 lds
i4 v[60:63],v[64:67],v[232:239],v1
i9 v[64:67],v0 offset:3072
i8 lgkmcnt(2)
i4 v[48:51],v[68:71],v[96:103],v1
i5 m0,92160
i6 s25,s14,294912
i1 v78,s[8:11],s25 offen sc1 lds
i4 v[52:55],v[68:71],v[104:111],v1
i4 v[56:59],v[68:71],v[240:247],v1
i5 m0,93184
i6 s25,s14,442368
i1 v78,s[8:11],s25 offen sc1 lds
i4 v[60:63],v[68:71],v[248:255],v1
i9 v[68:71],v0 offset:4096
i8 lgkmcnt(2)
i4 v[48:51],v[72:75],v[112:119],v1
i5 m0,94208
i6 s25,s14,589824
i1 v78,s[8:11],s25 offen sc1 lds
i4 v[52:55],v[72:75],v[120:127],v1
i4 v[56:59],v[72:75],a[0:7],v1
i5 m0,95232
i6 s25,s14,737280
i1 v78,s[8:11],s25 offen sc1 lds
i4 v[60:63],v[72:75],a[8:15],v1
i9 v[72:75],v0 offset:5120
i8 lgkmcnt(2)
i4 v[48:51],v[64:67],v[128:135],v1
i5 m0,96256
i6 s25,s14,884736
i1 v78,s[8:11],s25 offen sc1 lds
i4 v[52:55],v[64:67],v[136:143],v1
i4 v[56:59],v[64:67],a[16:23],v1
i5 m0,97280
i6 s25,s14,1032192
i1 v78,s[8:11],s25 offen sc1 lds
i4 v[60:63],v[64:67],a[24:31],v1
i9 v[64:67],v0 offset:6144
i8 lgkmcnt(2)
i4 v[48:51],v[68:71],v[144:151],v1
i6 m0,s16,2048
i6 s25,s26,33556480
i1 v0,s[8:11],s25 offen sc1 lds
i4 v[52:55],v[68:71],v[152:159],v1
i4 v[56:59],v[68:71],a[32:39],v1
i6 m0,s16,3072
i6 s25,s26,33557504
i1 v0,s[8:11],s25 offen sc1 lds
i4 v[60:63],v[68:71],a[40:47],v1
i9 v[68:71],v0 offset:7168
i8 lgkmcnt(2)
i4 v[48:51],v[72:75],v[160:167],v1
i6 m0,s16,10240
i6 s25,s26,2048
i1 v0,s[8:11],s25 offen sc1 lds
i4 v[52:55],v[72:75],v[168:175],v1
i4 v[56:59],v[72:75],a[48:55],v1
i6 m0,s16,11264
i6 s25,s26,3072
i1 v0,s[8:11],s25 offen sc1 lds
i4 v[60:63],v[72:75],a[56:63],v1
i9 v[72:75],v0 offset:8192
i8 lgkmcnt(2)
i4 v[48:51],v[64:67],v[176:183],v1
i6 m0,s16,18432
i6 s25,s26,16779264
i1 v0,s[8:11],s25 offen sc1 lds
i4 v[52:55],v[64:67],v[184:191],v1
i4 v[56:59],v[64:67],a[64:71],v1
i6 m0,s16,19456
i6 s25,s26,16780288
i1 v0,s[8:11],s25 offen sc1 lds
i4 v[60:63],v[64:67],a[72:79],v1
i8 lgkmcnt(1)
i4 v[48:51],v[68:71],v[192:199],v1
i4 v[52:55],v[68:71],v[200:207],v1
i4 v[56:59],v[68:71],a[80:87],v1
i4 v[60:63],v[68:71],a[88:95],v1
i8 lgkmcnt(0)
i4 v[48:51],v[72:75],v[208:215],v1
i4 v[52:55],v[72:75],v[216:223],v1
i4 v[56:59],v[72:75],a[96:103],v1
i4 v[60:63],v[72:75],a[104:111],v1
i3 v48,v48,v49
i3 v49,v50,v51
i3 v50,v52,v53
i3 v51,v54,v55
i27 v[52:55],v[48:49],v[2:3],0
i15 0
i27 v[76:79],v[50:51],v[2:3],0
i3 v56,v56,v57
i3 v57,v58,v59
i3 v58,v60,v61
i3 v59,v62,v63
i21 v0,v[56:59] offset:14336
i3 v48,v52,v53
i3 v49,v54,v55
i15 0
i3 v50,v76,v77
i3 v51,v78,v79
i21 v0,v[48:51] offset:10240
i8 lgkmcnt(0)
s_barrier
i9 v[64:67],v0 offset:9216
i9 v[68:71],v0 offset:10240
i9 v[72:75],v0 offset:11264
i9 v[76:79],v0 offset:12288
i9 v[48:51],v0 offset:13312
i9 v[52:55],v0 offset:14336
i38 v5,v40,v41,v42
i38 v6,v43,v44,v45
i38 v5,v5,v46,v47
i8 lgkmcnt(5)
i2 v[60:63],v[64:67],v[8:11],0
i8 lgkmcnt(4)
i2 v[60:63],v[68:71],v[12:15],v[60:63]
i8 lgkmcnt(3)
i2 v[60:63],v[72:75],v[16:19],v[60:63]
i8 lgkmcnt(2)
i2 v[60:63],v[76:79],v[20:23],v[60:63]
i15 7
i51 v60,0x3e0293ee,v60
i51 v61,0x3e0293ee,v61
i51 v62,0x3e0293ee,v62
i51 v63,0x3e0293ee,v63
i38 v5,v5,v6,v60
i38 v5,v5,v61,v62
v_max_f32 v5, v5, v63
i11 v6,v5
i15 1
v_permlane16_swap_b32 v5, v6
v_max_f32 v5, v5, v6
i11 v6,v5
i15 1
i40 v5,v6
v_max_f32 v5, v5, v6
i33 v40,v40,v5
i33 v41,v41,v5
i33 v42,v42,v5
i33 v43,v43,v5
i33 v44,v44,v5
i33 v45,v45,v5
i33 v46,v46,v5
i33 v47,v47,v5
i33 v60,v60,v5
i33 v61,v61,v5
i33 v62,v62,v5
i33 v63,v63,v5
i19 v40,v40
i19 v41,v41
i19 v42,v42
i19 v43,v43
i19 v44,v44
i19 v45,v45
i19 v46,v46
i19 v47,v47
i19 v60,v60
i19 v61,v61
i19 v62,v62
i19 v63,v63
i14 v[12:13],s[52:53]
i14 v[14:15],s[52:53]
i14 v[16:17],s[54:55]
i3 v20,v40,v41
i3 v21,v42,v43
i3 v22,v44,v45
i3 v23,v46,v47
i3 v18,v60,v61
i3 v19,v62,v63
i8 lgkmcnt(0)
i2 v[8:11],v[12:15],v[20:23],0
i2 v[64:67],v[24:27],v[20:23],0
i2 v[68:71],v[28:31],v[20:23],0
i2 v[72:75],v[32:35],v[20:23],0
i2 v[76:79],v[36:39],v[20:23],0
i27 v[8:11],v[16:17],v[18:19],v[8:11]
i27 v[64:67],v[48:49],v[18:19],v[64:67]
i27 v[68:71],v[50:51],v[18:19],v[68:71]
i27 v[72:75],v[52:53],v[18:19],v[72:75]
i27 v[76:79],v[54:55],v[18:19],v[76:79]
v_rcp_f32 v6, v8
i15 0
i16 v[64:65],v[64:65],v[6:7] op_sel_hi:[1,0]
i16 v[66:67],v[66:67],v[6:7] op_sel_hi:[1,0]
i16 v[68:69],v[68:69],v[6:7] op_sel_hi:[1,0]
i16 v[70:71],v[70:71],v[6:7] op_sel_hi:[1,0]
i16 v[72:73],v[72:73],v[6:7] op_sel_hi:[1,0]
i16 v[74:75],v[74:75],v[6:7] op_sel_hi:[1,0]
i16 v[76:77],v[76:77],v[6:7] op_sel_hi:[1,0]
i16 v[78:79],v[78:79],v[6:7] op_sel_hi:[1,0]
i3 v64,v64,v65
i3 v65,v66,v67
i3 v66,v68,v69
i3 v67,v70,v71
i21 v0,v[64:67] offset:21504
i3 v72,v72,v73
i3 v73,v74,v75
i3 v74,v76,v77
i3 v75,v78,v79
i21 v0,v[72:75] offset:22528
i8 lgkmcnt(0)
s_barrier
i47 s63,0
i22 Lx1s_nr
i20 v40,151552,v0
i20 v41,90112,v0
ds_read_b32 v42, v40 offset:1028
i9 v[72:75],v40 offset:2048
i9 v[76:79],v40 offset:3072
i8 vmcnt(0)
i9 v[8:11],v41 offset:0
i9 v[12:15],v41 offset:1024
i9 v[16:19],v41 offset:2048
i9 v[20:23],v41 offset:3072
i9 v[24:27],v41 offset:4096
i9 v[28:31],v41 offset:5120
i9 v[32:35],v41 offset:6144
i9 v[36:39],v41 offset:7168
i8 lgkmcnt(7)
i2 v[44:47],v[72:75],v[8:11],0
i8 lgkmcnt(6)
i2 v[44:47],v[72:75],v[12:15],v[44:47]
i8 lgkmcnt(5)
i2 v[44:47],v[72:75],v[16:19],v[44:47]
i8 lgkmcnt(4)
i2 v[44:47],v[72:75],v[20:23],v[44:47]
i8 lgkmcnt(3)
i2 v[44:47],v[72:75],v[24:27],v[44:47]
i8 lgkmcnt(2)
i2 v[44:47],v[72:75],v[28:31],v[44:47]
i8 lgkmcnt(1)
i2 v[44:47],v[72:75],v[32:35],v[44:47]
i8 lgkmcnt(0)
i2 v[44:47],v[72:75],v[36:39],v[44:47]
i15 7
i3 v44,v44,v45
i3 v45,v46,v47
i41 v[44:45],v42,s[56:59],s35 offen
i6 s32,s32,1
Lx1s_nr:
i9 v[8:11],v0 offset:17408
i9 v[12:15],v0 offset:18432
i9 v[16:19],v0 offset:19456
i9 v[20:23],v0 offset:20480
i9 v[24:27],v0 offset:21504
i9 v[28:31],v0 offset:22528
i9 v[32:35],v0 offset:23552
i9 v[36:39],v0 offset:24576
s_mul_i32 s24, s20, 36864
i6 s24,s24,s29
i6 s24,s24,9216
i6 s25,s24,4096
i6 s26,s24,8192
i8 lgkmcnt(7)
i2 v[40:43],a[112:115],v[8:11],0
i8 lgkmcnt(6)
i2 v[40:43],a[116:119],v[12:15],v[40:43]
i8 lgkmcnt(5)
i2 v[40:43],a[120:123],v[16:19],v[40:43]
i8 lgkmcnt(4)
i2 v[40:43],a[124:127],v[20:23],v[40:43]
i8 lgkmcnt(3)
i2 v[44:47],a[112:115],v[24:27],0
i8 lgkmcnt(2)
i2 v[44:47],a[116:119],v[28:31],v[44:47]
i8 lgkmcnt(1)
i2 v[44:47],a[120:123],v[32:35],v[44:47]
i8 lgkmcnt(0)
i2 v[44:47],a[124:127],v[36:39],v[44:47]
i2 v[48:51],a[128:131],v[8:11],0
i2 v[48:51],a[132:135],v[12:15],v[48:51]
i2 v[48:51],a[136:139],v[16:19],v[48:51]
i2 v[48:51],a[140:143],v[20:23],v[48:51]
i3 v40,v40,v41
i3 v41,v42,v43
i3 v42,v44,v45
i3 v43,v46,v47
i13 v[40:43],v0,s[8:11],s24 offen offset:0 sc1
i2 v[52:55],a[128:131],v[24:27],0
i2 v[52:55],a[132:135],v[28:31],v[52:55]
i2 v[52:55],a[136:139],v[32:35],v[52:55]
i2 v[52:55],a[140:143],v[36:39],v[52:55]
i2 v[56:59],a[144:147],v[8:11],0
i2 v[56:59],a[148:151],v[12:15],v[56:59]
i2 v[56:59],a[152:155],v[16:19],v[56:59]
i2 v[56:59],a[156:159],v[20:23],v[56:59]
i3 v48,v48,v49
i3 v49,v50,v51
i3 v50,v52,v53
i3 v51,v54,v55
i13 v[48:51],v0,s[8:11],s24 offen offset:1024 sc1
i2 v[60:63],a[144:147],v[24:27],0
i2 v[60:63],a[148:151],v[28:31],v[60:63]
i2 v[60:63],a[152:155],v[32:35],v[60:63]
i2 v[60:63],a[156:159],v[36:39],v[60:63]
i2 v[64:67],a[160:163],v[8:11],0
i2 v[64:67],a[164:167],v[12:15],v[64:67]
i2 v[64:67],a[168:171],v[16:19],v[64:67]
i2 v[64:67],a[172:175],v[20:23],v[64:67]
i3 v56,v56,v57
i3 v57,v58,v59
i3 v58,v60,v61
i3 v59,v62,v63
i13 v[56:59],v0,s[8:11],s24 offen offset:2048 sc1
i2 v[68:71],a[160:163],v[24:27],0
i2 v[68:71],a[164:167],v[28:31],v[68:71]
i2 v[68:71],a[168:171],v[32:35],v[68:71]
i2 v[68:71],a[172:175],v[36:39],v[68:71]
i2 v[72:75],a[176:179],v[8:11],0
i2 v[72:75],a[180:183],v[12:15],v[72:75]
i2 v[72:75],a[184:187],v[16:19],v[72:75]
i2 v[72:75],a[188:191],v[20:23],v[72:75]
i3 v64,v64,v65
i3 v65,v66,v67
i3 v66,v68,v69
i3 v67,v70,v71
i13 v[64:67],v0,s[8:11],s24 offen offset:3072 sc1
i2 v[76:79],a[176:179],v[24:27],0
i2 v[76:79],a[180:183],v[28:31],v[76:79]
i2 v[76:79],a[184:187],v[32:35],v[76:79]
i2 v[76:79],a[188:191],v[36:39],v[76:79]
i2 v[40:43],a[192:195],v[8:11],0
i2 v[40:43],a[196:199],v[12:15],v[40:43]
i2 v[40:43],a[200:203],v[16:19],v[40:43]
i2 v[40:43],a[204:207],v[20:23],v[40:43]
i3 v72,v72,v73
i3 v73,v74,v75
i3 v74,v76,v77
i3 v75,v78,v79
i13 v[72:75],v0,s[8:11],s25 offen offset:0 sc1
i2 v[44:47],a[192:195],v[24:27],0
i2 v[44:47],a[196:199],v[28:31],v[44:47]
i2 v[44:47],a[200:203],v[32:35],v[44:47]
i2 v[44:47],a[204:207],v[36:39],v[44:47]
i2 v[48:51],a[208:211],v[8:11],0
i2 v[48:51],a[212:215],v[12:15],v[48:51]
i2 v[48:51],a[216:219],v[16:19],v[48:51]
i2 v[48:51],a[220:223],v[20:23],v[48:51]
i3 v40,v40,v41
i3 v41,v42,v43
i3 v42,v44,v45
i3 v43,v46,v47
i13 v[40:43],v0,s[8:11],s25 offen offset:1024 sc1
i2 v[52:55],a[208:211],v[24:27],0
i2 v[52:55],a[212:215],v[28:31],v[52:55]
i2 v[52:55],a[216:219],v[32:35],v[52:55]
i2 v[52:55],a[220:223],v[36:39],v[52:55]
i2 v[56:59],a[224:227],v[8:11],0
i2 v[56:59],a[228:231],v[12:15],v[56:59]
i2 v[56:59],a[232:235],v[16:19],v[56:59]
i2 v[56:59],a[236:239],v[20:23],v[56:59]
i3 v48,v48,v49
i3 v49,v50,v51
i3 v50,v52,v53
i3 v51,v54,v55
i13 v[48:51],v0,s[8:11],s25 offen offset:2048 sc1
i2 v[60:63],a[224:227],v[24:27],0
i2 v[60:63],a[228:231],v[28:31],v[60:63]
i2 v[60:63],a[232:235],v[32:35],v[60:63]
i2 v[60:63],a[236:239],v[36:39],v[60:63]
i2 v[64:67],a[240:243],v[8:11],0
i2 v[64:67],a[244:247],v[12:15],v[64:67]
i2 v[64:67],a[248:251],v[16:19],v[64:67]
i2 v[64:67],a[252:255],v[20:23],v[64:67]
i3 v56,v56,v57
i3 v57,v58,v59
i3 v58,v60,v61
i3 v59,v62,v63
i13 v[56:59],v0,s[8:11],s25 offen offset:3072 sc1
i2 v[68:71],a[240:243],v[24:27],0
i2 v[68:71],a[244:247],v[28:31],v[68:71]
i2 v[68:71],a[248:251],v[32:35],v[68:71]
i2 v[68:71],a[252:255],v[36:39],v[68:71]
i3 v64,v64,v65
i3 v65,v66,v67
i15 5
i3 v66,v68,v69
i3 v67,v70,v71
i13 v[64:67],v0,s[8:11],s26 offen offset:0 sc1
i5 s63,1
i5 s34,s29
i5 s35,s30
s_xor_b32 s29, s29, 2097152
i6 s22,s22,3
s_cmp_lt_u32 s22, 64
i22 Lx1s_top
i8 vmcnt(0)
s_barrier
i23 v76,2,v0
i18 v76,0x7c,v76
i36 v77,v76,s[8:11],s33 offen sc1
Lx1s_fl1:
i8 vmcnt(0)
v_cmp_gt_u32 vcc, s32, v77
s_cbranch_vccz Lx1s_fl1k
i36 v77,v76,s[8:11],s33 offen sc1
i6 s31,s31,1
i35 s31,400000
i22 L_endx
i44 Lx1s_fl1
Lx1s_fl1k:
i20 v78,151552,v0
ds_read_b32 v78, v78 offset:1024
i32 s14,s20,10
i6 s14,s14,256
i6 s14,s14,s34
i8 lgkmcnt(0)
i5 m0,90112
i6 s25,s14,0
i1 v78,s[8:11],s25 offen sc1 lds
i5 m0,91136
i6 s25,s14,147456
i1 v78,s[8:11],s25 offen sc1 lds
i5 m0,92160
i6 s25,s14,294912
i1 v78,s[8:11],s25 offen sc1 lds
i5 m0,93184
i6 s25,s14,442368
i1 v78,s[8:11],s25 offen sc1 lds
i5 m0,94208
i6 s25,s14,589824
i1 v78,s[8:11],s25 offen sc1 lds
i5 m0,95232
i6 s25,s14,737280
i1 v78,s[8:11],s25 offen sc1 lds
i5 m0,96256
i6 s25,s14,884736
i1 v78,s[8:11],s25 offen sc1 lds
i5 m0,97280
i6 s25,s14,1032192
i1 v78,s[8:11],s25 offen sc1 lds
i20 v40,151552,v0
i20 v41,90112,v0
ds_read_b32 v42, v40 offset:1028
i9 v[72:75],v40 offset:2048
i9 v[76:79],v40 offset:3072
i8 vmcnt(0)
i9 v[8:11],v41 offset:0
i9 v[12:15],v41 offset:1024
i9 v[16:19],v41 offset:2048
i9 v[20:23],v41 offset:3072
i9 v[24:27],v41 offset:4096
i9 v[28:31],v41 offset:5120
i9 v[32:35],v41 offset:6144
i9 v[36:39],v41 offset:7168
i8 lgkmcnt(7)
i2 v[44:47],v[72:75],v[8:11],0
i8 lgkmcnt(6)
i2 v[44:47],v[72:75],v[12:15],v[44:47]
i8 lgkmcnt(5)
i2 v[44:47],v[72:75],v[16:19],v[44:47]
i8 lgkmcnt(4)
i2 v[44:47],v[72:75],v[20:23],v[44:47]
i8 lgkmcnt(3)
i2 v[44:47],v[72:75],v[24:27],v[44:47]
i8 lgkmcnt(2)
i2 v[44:47],v[72:75],v[28:31],v[44:47]
i8 lgkmcnt(1)
i2 v[44:47],v[72:75],v[32:35],v[44:47]
i8 lgkmcnt(0)
i2 v[44:47],v[72:75],v[36:39],v[44:47]
i15 7
i3 v44,v44,v45
i3 v45,v46,v47
i41 v[44:45],v42,s[56:59],s35 offen
i8 vmcnt(0)
i44 L_endx
L_xw2:
i23 v79,4,v0
i23 v20,2,v79
i18 v21,3,v79
i31 v21,4,v21
i17 v78,v20,13,v21
i32 s24,s20,8
i6 s24,s24,128
i20 v78,s24,v78
i54 s25,1152
s_mul_i32 s24, s20, 147456
i23 v20,1,v79
i18 v21,1,v79
i31 v21,4,v21
i45 v77,v20,s25,v21
i20 v77,s24,v77
i23 v22,4,v79
i34 v23,v79,2,2
i18 v24,3,v79
i17 v20,v22,3,v23
i31 v20,6,v20
i20 v20,81920,v20
i17 v75,v24,3,v20
i23 v21,1,v24
i17 v20,v21,5,v20
i18 v21,1,v24
i17 v76,v21,3,v20
i17 v20,v22,2,v23
i31 v20,5,v20
i17 v74,v24,3,v20
i20 v74,81920,v74
i50 s[64:65],s[0:1],64
i50 s[68:69],s[0:1],72
i50 s[72:73],s[0:1],80
i50 s[56:57],s[0:1],96
i8 lgkmcnt(0)
i5 s58,4718592
i5 s59,0x20000
i5 s66,4718592
i5 s67,0x20000
i5 s70,4718592
i5 s71,0x20000
i5 s74,4718592
i5 s75,0x20000
i5 m0,81920
i5 s24,0
i1 v78,s[64:67],s24 offen lds
i5 m0,82944
i5 s24,131072
i1 v78,s[64:67],s24 offen lds
i5 m0,83968
i5 s24,262144
i1 v78,s[64:67],s24 offen lds
i5 m0,84992
i5 s24,393216
i1 v78,s[64:67],s24 offen lds
i5 m0,86016
i5 s24,524288
i1 v78,s[64:67],s24 offen lds
i5 m0,87040
i5 s24,655360
i1 v78,s[64:67],s24 offen lds
i5 m0,88064
i5 s24,786432
i1 v78,s[64:67],s24 offen lds
i5 m0,89088
i5 s24,917504
i1 v78,s[64:67],s24 offen lds
i5 m0,90112
i5 s24,1048576
i1 v78,s[64:67],s24 offen lds
i5 m0,91136
i5 s24,1179648
i1 v78,s[64:67],s24 offen lds
i5 m0,92160
i5 s24,1310720
i1 v78,s[64:67],s24 offen lds
i5 m0,93184
i5 s24,1441792
i1 v78,s[64:67],s24 offen lds
i5 m0,94208
i5 s24,1572864
i1 v78,s[64:67],s24 offen lds
i5 m0,95232
i5 s24,1703936
i1 v78,s[64:67],s24 offen lds
i5 m0,96256
i5 s24,1835008
i1 v78,s[64:67],s24 offen lds
i5 m0,97280
i5 s24,1966080
i1 v78,s[64:67],s24 offen lds
i5 m0,98304
i5 s24,2097152
i1 v78,s[64:67],s24 offen lds
i5 m0,99328
i5 s24,2228224
i1 v78,s[64:67],s24 offen lds
i5 m0,100352
i5 s24,2359296
i1 v78,s[64:67],s24 offen lds
i5 m0,101376
i5 s24,2490368
i1 v78,s[64:67],s24 offen lds
i5 m0,102400
i5 s24,2621440
i1 v78,s[64:67],s24 offen lds
i5 m0,103424
i5 s24,2752512
i1 v78,s[64:67],s24 offen lds
i5 m0,104448
i5 s24,2883584
i1 v78,s[64:67],s24 offen lds
i5 m0,105472
i5 s24,3014656
i1 v78,s[64:67],s24 offen lds
i5 m0,106496
i5 s24,3145728
i1 v78,s[64:67],s24 offen lds
i5 m0,107520
i5 s24,3276800
i1 v78,s[64:67],s24 offen lds
i5 m0,108544
i5 s24,3407872
i1 v78,s[64:67],s24 offen lds
i5 m0,109568
i5 s24,3538944
i1 v78,s[64:67],s24 offen lds
i5 m0,110592
i5 s24,3670016
i1 v78,s[64:67],s24 offen lds
i5 m0,111616
i5 s24,3801088
i1 v78,s[64:67],s24 offen lds
i5 m0,112640
i5 s24,3932160
i1 v78,s[64:67],s24 offen lds
i5 m0,113664
i5 s24,4063232
i1 v78,s[64:67],s24 offen lds
i8 vmcnt(28)
i0 v[80:81],v76 offset:0
i0 v[82:83],v76 offset:256
i0 v[84:85],v76 offset:2048
i0 v[86:87],v76 offset:2304
i0 v[88:89],v76 offset:16
i0 v[90:91],v76 offset:272
i0 v[92:93],v76 offset:2064
i0 v[94:95],v76 offset:2320
i8 lgkmcnt(0)
i5 m0,81920
i5 s24,4194304
i1 v78,s[64:67],s24 offen lds
i5 m0,82944
i5 s24,4325376
i1 v78,s[64:67],s24 offen lds
i5 m0,83968
i5 s24,4456448
i1 v78,s[64:67],s24 offen lds
i5 m0,84992
i5 s24,4587520
i1 v78,s[64:67],s24 offen lds
i8 vmcnt(28)
i0 v[96:97],v76 offset:4096
i0 v[98:99],v76 offset:4352
i0 v[100:101],v76 offset:6144
i0 v[102:103],v76 offset:6400
i0 v[104:105],v76 offset:4112
i0 v[106:107],v76 offset:4368
i0 v[108:109],v76 offset:6160
i0 v[110:111],v76 offset:6416
i8 lgkmcnt(0)
i5 m0,86016
i5 s24,0
i1 v78,s[68:71],s24 offen lds
i5 m0,87040
i5 s24,131072
i1 v78,s[68:71],s24 offen lds
i5 m0,88064
i5 s24,262144
i1 v78,s[68:71],s24 offen lds
i5 m0,89088
i5 s24,393216
i1 v78,s[68:71],s24 offen lds
i8 vmcnt(28)
i0 v[112:113],v76 offset:8192
i0 v[114:115],v76 offset:8448
i0 v[116:117],v76 offset:10240
i0 v[118:119],v76 offset:10496
i0 v[120:121],v76 offset:8208
i0 v[122:123],v76 offset:8464
i0 v[124:125],v76 offset:10256
i0 v[126:127],v76 offset:10512
i8 lgkmcnt(0)
i5 m0,90112
i5 s24,524288
i1 v78,s[68:71],s24 offen lds
i5 m0,91136
i5 s24,655360
i1 v78,s[68:71],s24 offen lds
i5 m0,92160
i5 s24,786432
i1 v78,s[68:71],s24 offen lds
i5 m0,93184
i5 s24,917504
i1 v78,s[68:71],s24 offen lds
i8 vmcnt(28)
i0 v[128:129],v76 offset:12288
i0 v[130:131],v76 offset:12544
i0 v[132:133],v76 offset:14336
i0 v[134:135],v76 offset:14592
i0 v[136:137],v76 offset:12304
i0 v[138:139],v76 offset:12560
i0 v[140:141],v76 offset:14352
i0 v[142:143],v76 offset:14608
i8 lgkmcnt(0)
i5 m0,94208
i5 s24,1048576
i1 v78,s[68:71],s24 offen lds
i5 m0,95232
i5 s24,1179648
i1 v78,s[68:71],s24 offen lds
i5 m0,96256
i5 s24,1310720
i1 v78,s[68:71],s24 offen lds
i5 m0,97280
i5 s24,1441792
i1 v78,s[68:71],s24 offen lds
i8 vmcnt(28)
i0 v[144:145],v76 offset:16384
i0 v[146:147],v76 offset:16640
i0 v[148:149],v76 offset:18432
i0 v[150:151],v76 offset:18688
i0 v[152:153],v76 offset:16400
i0 v[154:155],v76 offset:16656
i0 v[156:157],v76 offset:18448
i0 v[158:159],v76 offset:18704
i8 lgkmcnt(0)
i5 m0,98304
i5 s24,1572864
i1 v78,s[68:71],s24 offen lds
i5 m0,99328
i5 s24,1703936
i1 v78,s[68:71],s24 offen lds
i5 m0,100352
i5 s24,1835008
i1 v78,s[68:71],s24 offen lds
i5 m0,101376
i5 s24,1966080
i1 v78,s[68:71],s24 offen lds
i8 vmcnt(28)
i0 v[160:161],v76 offset:20480
i0 v[162:163],v76 offset:20736
i0 v[164:165],v76 offset:22528
i0 v[166:167],v76 offset:22784
i0 v[168:169],v76 offset:20496
i0 v[170:171],v76 offset:20752
i0 v[172:173],v76 offset:22544
i0 v[174:175],v76 offset:22800
i8 lgkmcnt(0)
i5 m0,102400
i5 s24,2097152
i1 v78,s[68:71],s24 offen lds
i5 m0,103424
i5 s24,2228224
i1 v78,s[68:71],s24 offen lds
i5 m0,104448
i5 s24,2359296
i1 v78,s[68:71],s24 offen lds
i5 m0,105472
i5 s24,2490368
i1 v78,s[68:71],s24 offen lds
i8 vmcnt(28)
i0 v[176:177],v76 offset:24576
i0 v[178:179],v76 offset:24832
i0 v[180:181],v76 offset:26624
i0 v[182:183],v76 offset:26880
i0 v[184:185],v76 offset:24592
i0 v[186:187],v76 offset:24848
i0 v[188:189],v76 offset:26640
i0 v[190:191],v76 offset:26896
i8 lgkmcnt(0)
i5 m0,106496
i5 s24,2621440
i1 v78,s[68:71],s24 offen lds
i5 m0,107520
i5 s24,2752512
i1 v78,s[68:71],s24 offen lds
i5 m0,108544
i5 s24,2883584
i1 v78,s[68:71],s24 offen lds
i5 m0,109568
i5 s24,3014656
i1 v78,s[68:71],s24 offen lds
i8 vmcnt(28)
i0 v[192:193],v76 offset:28672
i0 v[194:195],v76 offset:28928
i0 v[196:197],v76 offset:30720
i0 v[198:199],v76 offset:30976
i0 v[200:201],v76 offset:28688
i0 v[202:203],v76 offset:28944
i0 v[204:205],v76 offset:30736
i0 v[206:207],v76 offset:30992
i8 lgkmcnt(0)
i5 m0,110592
i5 s24,3145728
i1 v78,s[68:71],s24 offen lds
i5 m0,111616
i5 s24,3276800
i1 v78,s[68:71],s24 offen lds
i5 m0,112640
i5 s24,3407872
i1 v78,s[68:71],s24 offen lds
i5 m0,113664
i5 s24,3538944
i1 v78,s[68:71],s24 offen lds
i8 vmcnt(28)
i0 v[208:209],v76 offset:0
i0 v[210:211],v76 offset:256
i0 v[212:213],v76 offset:2048
i0 v[214:215],v76 offset:2304
i0 v[216:217],v76 offset:16
i0 v[218:219],v76 offset:272
i0 v[220:221],v76 offset:2064
i0 v[222:223],v76 offset:2320
i8 lgkmcnt(0)
i5 m0,81920
i5 s24,3670016
i1 v78,s[68:71],s24 offen lds
i5 m0,82944
i5 s24,3801088
i1 v78,s[68:71],s24 offen lds
i5 m0,83968
i5 s24,3932160
i1 v78,s[68:71],s24 offen lds
i5 m0,84992
i5 s24,4063232
i1 v78,s[68:71],s24 offen lds
i8 vmcnt(28)
i0 v[224:225],v75 offset:4096
i0 v[226:227],v75 offset:4352
i0 v[228:229],v75 offset:6144
i0 v[230:231],v75 offset:6400
i0 v[232:233],v75 offset:4128
i0 v[234:235],v75 offset:4384
i0 v[236:237],v75 offset:6176
i0 v[238:239],v75 offset:6432
i8 lgkmcnt(0)
i5 m0,86016
i5 s24,4194304
i1 v78,s[68:71],s24 offen lds
i5 m0,87040
i5 s24,4325376
i1 v78,s[68:71],s24 offen lds
i5 m0,88064
i5 s24,4456448
i1 v78,s[68:71],s24 offen lds
i5 m0,89088
i5 s24,4587520
i1 v78,s[68:71],s24 offen lds
i8 vmcnt(28)
i0 v[240:241],v75 offset:8192
i0 v[242:243],v75 offset:8448
i0 v[244:245],v75 offset:10240
i0 v[246:247],v75 offset:10496
i0 v[248:249],v75 offset:8224
i0 v[250:251],v75 offset:8480
i0 v[252:253],v75 offset:10272
i0 v[254:255],v75 offset:10528
i8 lgkmcnt(0)
i5 m0,90112
i5 s24,576
i1 v77,s[72:75],s24 offen lds
i5 m0,91136
i5 s24,37440
i1 v77,s[72:75],s24 offen lds
i5 m0,92160
i5 s24,74304
i1 v77,s[72:75],s24 offen lds
i5 m0,93184
i5 s24,111168
i1 v77,s[72:75],s24 offen lds
i8 vmcnt(28)
i0 a[0:1],v75 offset:12288
i0 a[2:3],v75 offset:12544
i0 a[4:5],v75 offset:14336
i0 a[6:7],v75 offset:14592
i0 a[8:9],v75 offset:12320
i0 a[10:11],v75 offset:12576
i0 a[12:13],v75 offset:14368
i0 a[14:15],v75 offset:14624
i8 lgkmcnt(0)
i5 m0,94208
i5 s24,608
i1 v77,s[72:75],s24 offen lds
i5 m0,95232
i5 s24,37472
i1 v77,s[72:75],s24 offen lds
i5 m0,96256
i5 s24,74336
i1 v77,s[72:75],s24 offen lds
i5 m0,97280
i5 s24,111200
i1 v77,s[72:75],s24 offen lds
i8 vmcnt(28)
i0 a[16:17],v75 offset:16384
i0 a[18:19],v75 offset:16640
i0 a[20:21],v75 offset:18432
i0 a[22:23],v75 offset:18688
i0 a[24:25],v75 offset:16416
i0 a[26:27],v75 offset:16672
i0 a[28:29],v75 offset:18464
i0 a[30:31],v75 offset:18720
i8 lgkmcnt(0)
i5 m0,98304
i5 s24,640
i1 v77,s[72:75],s24 offen lds
i5 m0,99328
i5 s24,37504
i1 v77,s[72:75],s24 offen lds
i5 m0,100352
i5 s24,74368
i1 v77,s[72:75],s24 offen lds
i5 m0,101376
i5 s24,111232
i1 v77,s[72:75],s24 offen lds
i8 vmcnt(28)
i0 a[32:33],v75 offset:20480
i0 a[34:35],v75 offset:20736
i0 a[36:37],v75 offset:22528
i0 a[38:39],v75 offset:22784
i0 a[40:41],v75 offset:20512
i0 a[42:43],v75 offset:20768
i0 a[44:45],v75 offset:22560
i0 a[46:47],v75 offset:22816
i8 lgkmcnt(0)
i5 m0,102400
i5 s24,672
i1 v77,s[72:75],s24 offen lds
i5 m0,103424
i5 s24,37536
i1 v77,s[72:75],s24 offen lds
i5 m0,104448
i5 s24,74400
i1 v77,s[72:75],s24 offen lds
i5 m0,105472
i5 s24,111264
i1 v77,s[72:75],s24 offen lds
i8 vmcnt(28)
i0 a[48:49],v75 offset:24576
i0 a[50:51],v75 offset:24832
i0 a[52:53],v75 offset:26624
i0 a[54:55],v75 offset:26880
i0 a[56:57],v75 offset:24608
i0 a[58:59],v75 offset:24864
i0 a[60:61],v75 offset:26656
i0 a[62:63],v75 offset:26912
i8 lgkmcnt(0)
i5 m0,106496
i5 s24,704
i1 v77,s[72:75],s24 offen lds
i5 m0,107520
i5 s24,37568
i1 v77,s[72:75],s24 offen lds
i5 m0,108544
i5 s24,74432
i1 v77,s[72:75],s24 offen lds
i5 m0,109568
i5 s24,111296
i1 v77,s[72:75],s24 offen lds
i8 vmcnt(28)
i0 a[64:65],v75 offset:28672
i0 a[66:67],v75 offset:28928
i0 a[68:69],v75 offset:30720
i0 a[70:71],v75 offset:30976
i0 a[72:73],v75 offset:28704
i0 a[74:75],v75 offset:28960
i0 a[76:77],v75 offset:30752
i0 a[78:79],v75 offset:31008
i8 lgkmcnt(0)
i5 m0,110592
i5 s24,736
i1 v77,s[72:75],s24 offen lds
i5 m0,111616
i5 s24,37600
i1 v77,s[72:75],s24 offen lds
i5 m0,112640
i5 s24,74464
i1 v77,s[72:75],s24 offen lds
i5 m0,113664
i5 s24,111328
i1 v77,s[72:75],s24 offen lds
i8 vmcnt(28)
i0 a[80:81],v75 offset:0
i0 a[82:83],v75 offset:256
i0 a[84:85],v75 offset:2048
i0 a[86:87],v75 offset:2304
i0 a[88:89],v75 offset:32
i0 a[90:91],v75 offset:288
i0 a[92:93],v75 offset:2080
i0 a[94:95],v75 offset:2336
i8 lgkmcnt(0)
i5 m0,81920
i5 s24,768
i1 v77,s[72:75],s24 offen lds
i5 m0,82944
i5 s24,37632
i1 v77,s[72:75],s24 offen lds
i5 m0,83968
i5 s24,74496
i1 v77,s[72:75],s24 offen lds
i5 m0,84992
i5 s24,111360
i1 v77,s[72:75],s24 offen lds
i8 vmcnt(28)
i0 a[96:97],v75 offset:4096
i0 a[98:99],v75 offset:4352
i0 a[100:101],v75 offset:6144
i0 a[102:103],v75 offset:6400
i0 a[104:105],v75 offset:4128
i0 a[106:107],v75 offset:4384
i0 a[108:109],v75 offset:6176
i0 a[110:111],v75 offset:6432
i8 lgkmcnt(0)
i5 m0,86016
i5 s24,800
i1 v77,s[72:75],s24 offen lds
i5 m0,87040
i5 s24,37664
i1 v77,s[72:75],s24 offen lds
i5 m0,88064
i5 s24,74528
i1 v77,s[72:75],s24 offen lds
i5 m0,89088
i5 s24,111392
i1 v77,s[72:75],s24 offen lds
i8 vmcnt(28)
i0 a[112:113],v74 offset:8192
i0 a[114:115],v74 offset:8704
i0 a[116:117],v74 offset:9216
i0 a[118:119],v74 offset:9728
i0 a[120:121],v74 offset:10240
i0 a[122:123],v74 offset:10752
i0 a[124:125],v74 offset:11264
i0 a[126:127],v74 offset:11776
i8 lgkmcnt(0)
i5 m0,90112
i5 s24,832
i1 v77,s[72:75],s24 offen lds
i5 m0,91136
i5 s24,37696
i1 v77,s[72:75],s24 offen lds
i5 m0,92160
i5 s24,74560
i1 v77,s[72:75],s24 offen lds
i5 m0,93184
i5 s24,111424
i1 v77,s[72:75],s24 offen lds
i8 vmcnt(28)
i0 a[128:129],v74 offset:12288
i0 a[130:131],v74 offset:12800
i0 a[132:133],v74 offset:13312
i0 a[134:135],v74 offset:13824
i0 a[136:137],v74 offset:14336
i0 a[138:139],v74 offset:14848
i0 a[140:141],v74 offset:15360
i0 a[142:143],v74 offset:15872
i8 lgkmcnt(0)
i8 vmcnt(24)
i0 a[144:145],v74 offset:16384
i0 a[146:147],v74 offset:16896
i0 a[148:149],v74 offset:17408
i0 a[150:151],v74 offset:17920
i0 a[152:153],v74 offset:18432
i0 a[154:155],v74 offset:18944
i0 a[156:157],v74 offset:19456
i0 a[158:159],v74 offset:19968
i8 lgkmcnt(0)
i8 vmcnt(20)
i0 a[160:161],v74 offset:20480
i0 a[162:163],v74 offset:20992
i0 a[164:165],v74 offset:21504
i0 a[166:167],v74 offset:22016
i0 a[168:169],v74 offset:22528
i0 a[170:171],v74 offset:23040
i0 a[172:173],v74 offset:23552
i0 a[174:175],v74 offset:24064
i8 lgkmcnt(0)
i8 vmcnt(16)
i0 a[176:177],v74 offset:24576
i0 a[178:179],v74 offset:25088
i0 a[180:181],v74 offset:25600
i0 a[182:183],v74 offset:26112
i0 a[184:185],v74 offset:26624
i0 a[186:187],v74 offset:27136
i0 a[188:189],v74 offset:27648
i0 a[190:191],v74 offset:28160
i8 lgkmcnt(0)
i8 vmcnt(12)
i0 a[192:193],v74 offset:28672
i0 a[194:195],v74 offset:29184
i0 a[196:197],v74 offset:29696
i0 a[198:199],v74 offset:30208
i0 a[200:201],v74 offset:30720
i0 a[202:203],v74 offset:31232
i0 a[204:205],v74 offset:31744
i0 a[206:207],v74 offset:32256
i8 lgkmcnt(0)
i8 vmcnt(8)
i0 a[208:209],v74 offset:0
i0 a[210:211],v74 offset:512
i0 a[212:213],v74 offset:1024
i0 a[214:215],v74 offset:1536
i0 a[216:217],v74 offset:2048
i0 a[218:219],v74 offset:2560
i0 a[220:221],v74 offset:3072
i0 a[222:223],v74 offset:3584
i8 lgkmcnt(0)
i8 vmcnt(4)
i0 a[224:225],v74 offset:4096
i0 a[226:227],v74 offset:4608
i0 a[228:229],v74 offset:5120
i0 a[230:231],v74 offset:5632
i0 a[232:233],v74 offset:6144
i0 a[234:235],v74 offset:6656
i0 a[236:237],v74 offset:7168
i0 a[238:239],v74 offset:7680
i8 lgkmcnt(0)
i8 vmcnt(0)
i0 a[240:241],v74 offset:8192
i0 a[242:243],v74 offset:8704
i0 a[244:245],v74 offset:9216
i0 a[246:247],v74 offset:9728
i0 a[248:249],v74 offset:10240
i0 a[250:251],v74 offset:10752
i0 a[252:253],v74 offset:11264
i0 a[254:255],v74 offset:11776
i8 lgkmcnt(0)
i34 v21,v79,3,1
i25 vcc,1,v21
i11 v1,0x8888
i11 v20,0xdddd
i26 v1,v1,v20,vcc
i18 v20,7,v79
i34 v21,v79,4,1
i31 v21,2,v21
v_sub_u32 v20, v20, v21
i18 v21,1,v20
i31 v21,4,v21
i11 v22,0x3f80
i31 v22,v21,v22
v_ashrrev_i32 v20, 1, v20
i25 vcc,0,v20
i15 1
i26 v2,0,v22,vcc
i25 vcc,1,v20
i15 1
i26 v3,0,v22,vcc
i18 v4,0x33f,v0
i34 v20,v0,7,1
i24 v4,v20,6,v4
i34 v20,v0,6,1
i24 v4,v20,7,v4
i18 v20,16,v0
i11 v22,0x3f80
i31 v22,v20,v22
i34 v20,v0,5,3
i25 vcc,0,v20
i15 1
i26 v12,0,v22,vcc
i25 vcc,1,v20
i15 1
i26 v13,0,v22,vcc
i25 vcc,2,v20
i15 1
i26 v14,0,v22,vcc
i25 vcc,3,v20
i15 1
i26 v15,0,v22,vcc
i25 vcc,4,v20
i15 1
i26 v16,0,v22,vcc
i25 vcc,5,v20
i15 1
i26 v17,0,v22,vcc
i25 vcc,6,v20
i15 1
i26 v18,0,v22,vcc
i25 vcc,7,v20
i15 1
i26 v19,0,v22,vcc
i34 v20,v79,3,1
i18 v21,7,v79
i17 v20,v20,4,v21
i23 v21,5,v79
i34 v22,v79,4,1
i31 v22,2,v22
i17 v21,v21,4,v22
v_sub_u32 v21, v20, v21
i20 v21,0,v21
v_cmp_le_i32 s[36:37], 0, v21
v_cmp_le_i32 s[38:39], 1, v21
v_cmp_le_i32 s[40:41], 2, v21
v_cmp_le_i32 s[42:43], 3, v21
v_cmp_le_i32 s[44:45], 8, v21
v_cmp_le_i32 s[46:47], 9, v21
v_cmp_le_i32 s[48:49], 10, v21
v_cmp_le_i32 s[50:51], 11, v21
i23 v21,4,v79
i5 s25,36864
i18 v22,0xf0,v0
i45 v8,v21,s25,v22
i34 v22,v79,4,1
i17 v20,v22,3,v20
i54 s25,2304
i43 v9,s25,v20
i32 s24,s20,2
i6 s24,s24,2
i32 s24,s24,3
i6 s24,s24,1152
i32 s25,s20,3
i6 s25,s25,2176
s_cmp_lt_u32 s20, 16
i28 s62,0,0
i47 s62,1
i28 s25,s25,0x80000000
i11 v21,s24
i11 v22,s25
v_cmp_lt_u32 vcc, 31, v79
i15 1
i26 v21,v21,v22,vcc
i20 v9,v9,v21
i5 s52,0x3f803f80
i5 s53,0x3f803f80
i5 s54,0x3f003f00
i5 s55,0x3f003f00
i5 s31,0
i5 s63,0
i5 s34,0x80000000
i5 s18,2147516416
i5 s22,s19
i5 s32,1
i32 s33,s19,7
i6 s33,s33,74448896
s_mul_i32 s29, s19, 4194304
i6 s29,s29,75497472
i20 v20,155648,v0
i21 v20,v[2:5]
i21 v20,v[8:11] offset:1024
i21 v20,v[12:15] offset:2048
i21 v20,v[16:19] offset:3072
i8 lgkmcnt(0)
s_barrier
i11 v40,0
i5 s94,0
i46 s21,0
i22 L_xb2b
i39 exec,1
L_xb2:
i55 v41,v40,s[100:101] offset:48 sc1
i6 s94,s94,1
i35 s94,400000
i22 L_endx
i8 vmcnt(0)
v_cmp_gt_u32 vcc, 32, v41
i49 L_xb2z
i44 L_xb2k
L_xb2z:
s_sleep 4
i44 L_xb2
L_xb2k:
i39 exec,-1
L_xb2b:
s_barrier
i47 s99,2
i22 L_xs2
Lx2f_top:
i32 s27,s22,18
i32 s24,s20,13
i6 s27,s27,s24
i32 s28,s22,14
i6 s28,s28,72351744
s_mul_i32 s30, s22, 73728
s_and_b32 s24, s22, 7
s_cmp_ge_u32 s24, 3
i22 Lx2f_rdyk
s_barrier
Lx2f_rdyk:
s_bitcmp1_b32 s18, 31
s_cbranch_scc0 Lx2f_pre
s_bitset0_b32 s18, 31
i6 m0,s18,4096
i6 s25,s27,33558528
i1 v0,s[8:11],s25 offen sc1 lds
i6 m0,s18,5120
i6 s25,s27,33559552
i1 v0,s[8:11],s25 offen sc1 lds
i6 m0,s18,12288
i6 s25,s27,4096
i1 v0,s[8:11],s25 offen sc1 lds
i6 m0,s18,13312
i6 s25,s27,5120
i1 v0,s[8:11],s25 offen sc1 lds
i6 m0,s18,20480
i6 s25,s27,16781312
i1 v0,s[8:11],s25 offen sc1 lds
i6 m0,s18,21504
i6 s25,s27,16782336
i1 v0,s[8:11],s25 offen sc1 lds
Lx2f_pre:
i20 v6,s18,v0
i8 vmcnt(0)
s_barrier
i9 v[8:11],v6 offset:0
i9 v[48:51],v6 offset:8192
i9 v[12:15],v6 offset:2048
i9 v[52:55],v6 offset:10240
i9 v[16:19],v6 offset:4096
i9 v[56:59],v6 offset:12288
i9 v[20:23],v6 offset:6144
i9 v[60:63],v6 offset:14336
i9 v[24:27],v6 offset:9216
i9 v[28:31],v6 offset:11264
i9 v[32:35],v6 offset:13312
i9 v[36:39],v6 offset:15360
i8 lgkmcnt(10)
i2 v[40:43],v[48:51],v[8:11],0
i8 lgkmcnt(8)
i2 v[40:43],v[52:55],v[12:15],v[40:43]
i8 lgkmcnt(6)
i2 v[40:43],v[56:59],v[16:19],v[40:43]
i8 lgkmcnt(4)
i2 v[40:43],v[60:63],v[20:23],v[40:43]
i8 lgkmcnt(3)
i2 v[44:47],v[24:27],v[8:11],0
i8 lgkmcnt(2)
i2 v[44:47],v[28:31],v[12:15],v[44:47]
i8 lgkmcnt(1)
i2 v[44:47],v[32:35],v[16:19],v[44:47]
i8 lgkmcnt(0)
i2 v[44:47],v[36:39],v[20:23],v[44:47]
i9 v[24:27],v6 offset:20480
i9 v[28:31],v6 offset:21504
i9 v[32:35],v6 offset:22528
i9 v[36:39],v6 offset:23552
i11 v5,0xff800000
i26 v40,v5,v40,s[36:37]
i26 v41,v5,v41,s[38:39]
i26 v42,v5,v42,s[40:41]
i26 v43,v5,v43,s[42:43]
i26 v44,v5,v44,s[44:45]
i26 v45,v5,v45,s[46:47]
i26 v46,v5,v46,s[48:49]
i26 v47,v5,v47,s[50:51]
Lx2f_h:
i6 s24,s28,2048
i1 v[64:67],v4,s[8:11],s24 offen sc1
i6 s24,s28,6144
i1 v[68:71],v4,s[8:11],s24 offen sc1
i23 v76,2,v0
i18 v76,0x7c,v76
i36 v77,v76,s[8:11],s33 offen sc1
i6 s31,s31,1
i35 s31,400000
i22 L_endx
i8 vmcnt(0)
i48 v5,v64,v65,v66
i48 v5,v5,v67,v68
i48 v5,v5,v69,v70
v_max_u32 v5, v5, v71
i25 vcc,-1,v5
s_cbranch_vccz Lx2f_hk
s_cmp_ge_u32 s22, 60
i22 Lx2f_h
i11 v6,2048
i39 exec,1
Lx2f_hl:
s_sleep 12
i36 v5,v6,s[8:11],s28 offen sc1
i6 s31,s31,1
i35 s31,400000
i22 L_endx
i8 vmcnt(0)
i25 vcc,-1,v5
i49 Lx2f_hl
i39 exec,-1
i44 Lx2f_h
Lx2f_hk:
i21 v0,v[64:67] offset:2048
i21 v0,v[68:71] offset:6144
i47 s63,0
i22 Lx2f_nq
Lx2f_fl0:
i8 vmcnt(0)
v_cmp_gt_u32 vcc, s32, v77
s_cbranch_vccz Lx2f_fl0k
i36 v77,v76,s[8:11],s33 offen sc1
i6 s31,s31,1
i35 s31,400000
i22 L_endx
i44 Lx2f_fl0
Lx2f_fl0k:
Lx2f_nq:
i20 v78,155648,v0
ds_read_b32 v78, v78 offset:1024
i32 s14,s20,10
i6 s14,s14,512
i6 s14,s14,s34
s_xor_b32 s16, s18, 24576
i6 s24,s22,3
s_xor_b32 s24, s24, s22
s_cmp_ge_u32 s24, 8
i28 s24,0x80000000,0
s_or_b32 s18, s16, s24
i6 s26,s27,786432
s_or_b32 s26, s26, s24
i14 v[48:49],0
i14 v[50:51],0
i14 v[52:53],0
i14 v[54:55],0
i14 v[56:57],0
i14 v[58:59],0
i14 v[60:61],0
i14 v[62:63],0
i8 lgkmcnt(0)
s_barrier
i9 v[64:67],v0 offset:0
i9 v[68:71],v0 offset:1024
i9 v[72:75],v0 offset:2048
i8 lgkmcnt(2)
i4 v[48:51],v[64:67],v[80:87],v1
i5 m0,98304
i6 s25,s14,0
i1 v78,s[8:11],s25 offen sc1 lds
i4 v[52:55],v[64:67],v[88:95],v1
i4 v[56:59],v[64:67],v[224:231],v1
i5 m0,99328
i6 s25,s14,147456
i1 v78,s[8:11],s25 offen sc1 lds
i4 v[60:63],v[64:67],v[232:239],v1
i9 v[64:67],v0 offset:3072
i8 lgkmcnt(2)
i4 v[48:51],v[68:71],v[96:103],v1
i5 m0,100352
i6 s25,s14,294912
i1 v78,s[8:11],s25 offen sc1 lds
i4 v[52:55],v[68:71],v[104:111],v1
i4 v[56:59],v[68:71],v[240:247],v1
i5 m0,101376
i6 s25,s14,442368
i1 v78,s[8:11],s25 offen sc1 lds
i4 v[60:63],v[68:71],v[248:255],v1
i9 v[68:71],v0 offset:4096
i8 lgkmcnt(2)
i4 v[48:51],v[72:75],v[112:119],v1
i5 m0,102400
i6 s25,s14,589824
i1 v78,s[8:11],s25 offen sc1 lds
i4 v[52:55],v[72:75],v[120:127],v1
i4 v[56:59],v[72:75],a[0:7],v1
i5 m0,103424
i6 s25,s14,737280
i1 v78,s[8:11],s25 offen sc1 lds
i4 v[60:63],v[72:75],a[8:15],v1
i9 v[72:75],v0 offset:5120
i8 lgkmcnt(2)
i4 v[48:51],v[64:67],v[128:135],v1
i5 m0,104448
i6 s25,s14,884736
i1 v78,s[8:11],s25 offen sc1 lds
i4 v[52:55],v[64:67],v[136:143],v1
i4 v[56:59],v[64:67],a[16:23],v1
i5 m0,105472
i6 s25,s14,1032192
i1 v78,s[8:11],s25 offen sc1 lds
i4 v[60:63],v[64:67],a[24:31],v1
i9 v[64:67],v0 offset:6144
i8 lgkmcnt(2)
i4 v[48:51],v[68:71],v[144:151],v1
i6 m0,s16,4096
i6 s25,s26,33558528
i1 v0,s[8:11],s25 offen sc1 lds
i4 v[52:55],v[68:71],v[152:159],v1
i4 v[56:59],v[68:71],a[32:39],v1
i6 m0,s16,5120
i6 s25,s26,33559552
i1 v0,s[8:11],s25 offen sc1 lds
i4 v[60:63],v[68:71],a[40:47],v1
i9 v[68:71],v0 offset:7168
i8 lgkmcnt(2)
i4 v[48:51],v[72:75],v[160:167],v1
i6 m0,s16,12288
i6 s25,s26,4096
i1 v0,s[8:11],s25 offen sc1 lds
i4 v[52:55],v[72:75],v[168:175],v1
i4 v[56:59],v[72:75],a[48:55],v1
i6 m0,s16,13312
i6 s25,s26,5120
i1 v0,s[8:11],s25 offen sc1 lds
i4 v[60:63],v[72:75],a[56:63],v1
i9 v[72:75],v0 offset:8192
i8 lgkmcnt(2)
i4 v[48:51],v[64:67],v[176:183],v1
i6 m0,s16,20480
i6 s25,s26,16781312
i1 v0,s[8:11],s25 offen sc1 lds
i4 v[52:55],v[64:67],v[184:191],v1
i4 v[56:59],v[64:67],a[64:71],v1
i6 m0,s16,21504
i6 s25,s26,16782336
i1 v0,s[8:11],s25 offen sc1 lds
i4 v[60:63],v[64:67],a[72:79],v1
i8 lgkmcnt(1)
i4 v[48:51],v[68:71],v[192:199],v1
i4 v[52:55],v[68:71],v[200:207],v1
i4 v[56:59],v[68:71],a[80:87],v1
i4 v[60:63],v[68:71],a[88:95],v1
i8 lgkmcnt(0)
i4 v[48:51],v[72:75],v[208:215],v1
i4 v[52:55],v[72:75],v[216:223],v1
i4 v[56:59],v[72:75],a[96:103],v1
i4 v[60:63],v[72:75],a[104:111],v1
i3 v48,v48,v49
i3 v49,v50,v51
i3 v50,v52,v53
i3 v51,v54,v55
i27 v[52:55],v[48:49],v[2:3],0
i15 0
i27 v[76:79],v[50:51],v[2:3],0
i3 v56,v56,v57
i3 v57,v58,v59
i3 v58,v60,v61
i3 v59,v62,v63
i21 v0,v[56:59] offset:15360
i3 v48,v52,v53
i3 v49,v54,v55
i15 0
i3 v50,v76,v77
i3 v51,v78,v79
i21 v0,v[48:51] offset:11264
i8 lgkmcnt(0)
s_barrier
i9 v[64:67],v0 offset:9216
i9 v[68:71],v0 offset:10240
i9 v[72:75],v0 offset:11264
i9 v[76:79],v0 offset:12288
i9 v[48:51],v0 offset:15360
i9 v[52:55],v0 offset:16384
i38 v5,v40,v41,v42
i38 v6,v43,v44,v45
i38 v5,v5,v46,v47
i8 lgkmcnt(5)
i2 v[60:63],v[64:67],v[8:11],0
i8 lgkmcnt(4)
i2 v[60:63],v[68:71],v[12:15],v[60:63]
i8 lgkmcnt(3)
i2 v[60:63],v[72:75],v[16:19],v[60:63]
i8 lgkmcnt(2)
i2 v[60:63],v[76:79],v[20:23],v[60:63]
i15 7
i51 v60,0x3e0293ee,v60
i51 v61,0x3e0293ee,v61
i51 v62,0x3e0293ee,v62
i51 v63,0x3e0293ee,v63
i38 v5,v5,v6,v60
i38 v5,v5,v61,v62
v_max_f32 v5, v5, v63
i11 v6,v5
i15 1
v_permlane16_swap_b32 v5, v6
v_max_f32 v5, v5, v6
i11 v6,v5
i15 1
i40 v5,v6
v_max_f32 v5, v5, v6
i33 v40,v40,v5
i33 v41,v41,v5
i33 v42,v42,v5
i33 v43,v43,v5
i33 v44,v44,v5
i33 v45,v45,v5
i33 v46,v46,v5
i33 v47,v47,v5
i33 v60,v60,v5
i33 v61,v61,v5
i33 v62,v62,v5
i33 v63,v63,v5
i19 v40,v40
i19 v41,v41
i19 v42,v42
i19 v43,v43
i19 v44,v44
i19 v45,v45
i19 v46,v46
i19 v47,v47
i19 v60,v60
i19 v61,v61
i19 v62,v62
i19 v63,v63
i14 v[12:13],s[52:53]
i14 v[14:15],s[52:53]
i14 v[16:17],s[54:55]
i3 v20,v40,v41
i3 v21,v42,v43
i3 v22,v44,v45
i3 v23,v46,v47
i3 v18,v60,v61
i3 v19,v62,v63
i8 lgkmcnt(0)
i2 v[8:11],v[12:15],v[20:23],0
i2 v[64:67],v[24:27],v[20:23],0
i2 v[68:71],v[28:31],v[20:23],0
i2 v[72:75],v[32:35],v[20:23],0
i2 v[76:79],v[36:39],v[20:23],0
i27 v[8:11],v[16:17],v[18:19],v[8:11]
i27 v[64:67],v[48:49],v[18:19],v[64:67]
i27 v[68:71],v[50:51],v[18:19],v[68:71]
i27 v[72:75],v[52:53],v[18:19],v[72:75]
i27 v[76:79],v[54:55],v[18:19],v[76:79]
v_rcp_f32 v6, v8
i15 0
i16 v[64:65],v[64:65],v[6:7] op_sel_hi:[1,0]
i16 v[66:67],v[66:67],v[6:7] op_sel_hi:[1,0]
i16 v[68:69],v[68:69],v[6:7] op_sel_hi:[1,0]
i16 v[70:71],v[70:71],v[6:7] op_sel_hi:[1,0]
i16 v[72:73],v[72:73],v[6:7] op_sel_hi:[1,0]
i16 v[74:75],v[74:75],v[6:7] op_sel_hi:[1,0]
i16 v[76:77],v[76:77],v[6:7] op_sel_hi:[1,0]
i16 v[78:79],v[78:79],v[6:7] op_sel_hi:[1,0]
i3 v64,v64,v65
i3 v65,v66,v67
i3 v66,v68,v69
i3 v67,v70,v71
i21 v0,v[64:67] offset:19456
i3 v72,v72,v73
i3 v73,v74,v75
i3 v74,v76,v77
i3 v75,v78,v79
i21 v0,v[72:75] offset:20480
i8 lgkmcnt(0)
s_barrier
i47 s63,0
i22 Lx2f_nr
i20 v40,155648,v0
i20 v41,98304,v0
ds_read_b32 v42, v40 offset:1028
i9 v[72:75],v40 offset:2048
i9 v[76:79],v40 offset:3072
i8 vmcnt(0)
i9 v[8:11],v41 offset:0
i9 v[12:15],v41 offset:1024
i9 v[16:19],v41 offset:2048
i9 v[20:23],v41 offset:3072
i9 v[24:27],v41 offset:4096
i9 v[28:31],v41 offset:5120
i9 v[32:35],v41 offset:6144
i9 v[36:39],v41 offset:7168
i8 lgkmcnt(7)
i2 v[44:47],v[72:75],v[8:11],0
i8 lgkmcnt(6)
i2 v[44:47],v[72:75],v[12:15],v[44:47]
i8 lgkmcnt(5)
i2 v[44:47],v[72:75],v[16:19],v[44:47]
i8 lgkmcnt(4)
i2 v[44:47],v[72:75],v[20:23],v[44:47]
i8 lgkmcnt(3)
i2 v[44:47],v[72:75],v[24:27],v[44:47]
i8 lgkmcnt(2)
i2 v[44:47],v[72:75],v[28:31],v[44:47]
i8 lgkmcnt(1)
i2 v[44:47],v[72:75],v[32:35],v[44:47]
i8 lgkmcnt(0)
i2 v[44:47],v[72:75],v[36:39],v[44:47]
i15 7
i3 v44,v44,v45
i3 v45,v46,v47
i41 v[44:45],v42,s[56:59],s35 offen
i6 s32,s32,1
Lx2f_nr:
i9 v[8:11],v0 offset:17408
i9 v[12:15],v0 offset:18432
i9 v[16:19],v0 offset:19456
i9 v[20:23],v0 offset:20480
i9 v[24:27],v0 offset:21504
i9 v[28:31],v0 offset:22528
i9 v[32:35],v0 offset:23552
i9 v[36:39],v0 offset:24576
s_mul_i32 s24, s20, 36864
i6 s24,s24,s29
i6 s24,s24,18432
i6 s25,s24,4096
i6 s26,s24,8192
i8 lgkmcnt(7)
i2 v[40:43],a[112:115],v[8:11],0
i8 lgkmcnt(6)
i2 v[40:43],a[116:119],v[12:15],v[40:43]
i8 lgkmcnt(5)
i2 v[40:43],a[120:123],v[16:19],v[40:43]
i8 lgkmcnt(4)
i2 v[40:43],a[124:127],v[20:23],v[40:43]
i8 lgkmcnt(3)
i2 v[44:47],a[112:115],v[24:27],0
i8 lgkmcnt(2)
i2 v[44:47],a[116:119],v[28:31],v[44:47]
i8 lgkmcnt(1)
i2 v[44:47],a[120:123],v[32:35],v[44:47]
i8 lgkmcnt(0)
i2 v[44:47],a[124:127],v[36:39],v[44:47]
i2 v[48:51],a[128:131],v[8:11],0
i2 v[48:51],a[132:135],v[12:15],v[48:51]
i2 v[48:51],a[136:139],v[16:19],v[48:51]
i2 v[48:51],a[140:143],v[20:23],v[48:51]
i3 v40,v40,v41
i3 v41,v42,v43
i3 v42,v44,v45
i3 v43,v46,v47
i13 v[40:43],v0,s[8:11],s24 offen offset:0
i2 v[52:55],a[128:131],v[24:27],0
i2 v[52:55],a[132:135],v[28:31],v[52:55]
i2 v[52:55],a[136:139],v[32:35],v[52:55]
i2 v[52:55],a[140:143],v[36:39],v[52:55]
i2 v[56:59],a[144:147],v[8:11],0
i2 v[56:59],a[148:151],v[12:15],v[56:59]
i2 v[56:59],a[152:155],v[16:19],v[56:59]
i2 v[56:59],a[156:159],v[20:23],v[56:59]
i3 v48,v48,v49
i3 v49,v50,v51
i3 v50,v52,v53
i3 v51,v54,v55
i13 v[48:51],v0,s[8:11],s24 offen offset:1024
i2 v[60:63],a[144:147],v[24:27],0
i2 v[60:63],a[148:151],v[28:31],v[60:63]
i2 v[60:63],a[152:155],v[32:35],v[60:63]
i2 v[60:63],a[156:159],v[36:39],v[60:63]
i2 v[64:67],a[160:163],v[8:11],0
i2 v[64:67],a[164:167],v[12:15],v[64:67]
i2 v[64:67],a[168:171],v[16:19],v[64:67]
i2 v[64:67],a[172:175],v[20:23],v[64:67]
i3 v56,v56,v57
i3 v57,v58,v59
i3 v58,v60,v61
i3 v59,v62,v63
i13 v[56:59],v0,s[8:11],s24 offen offset:2048
i2 v[68:71],a[160:163],v[24:27],0
i2 v[68:71],a[164:167],v[28:31],v[68:71]
i2 v[68:71],a[168:171],v[32:35],v[68:71]
i2 v[68:71],a[172:175],v[36:39],v[68:71]
i2 v[72:75],a[176:179],v[8:11],0
i2 v[72:75],a[180:183],v[12:15],v[72:75]
i2 v[72:75],a[184:187],v[16:19],v[72:75]
i2 v[72:75],a[188:191],v[20:23],v[72:75]
i3 v64,v64,v65
i3 v65,v66,v67
i3 v66,v68,v69
i3 v67,v70,v71
i13 v[64:67],v0,s[8:11],s24 offen offset:3072
i2 v[76:79],a[176:179],v[24:27],0
i2 v[76:79],a[180:183],v[28:31],v[76:79]
i2 v[76:79],a[184:187],v[32:35],v[76:79]
i2 v[76:79],a[188:191],v[36:39],v[76:79]
i2 v[40:43],a[192:195],v[8:11],0
i2 v[40:43],a[196:199],v[12:15],v[40:43]
i2 v[40:43],a[200:203],v[16:19],v[40:43]
i2 v[40:43],a[204:207],v[20:23],v[40:43]
i3 v72,v72,v73
i3 v73,v74,v75
i3 v74,v76,v77
i3 v75,v78,v79
i13 v[72:75],v0,s[8:11],s25 offen offset:0
i2 v[44:47],a[192:195],v[24:27],0
i2 v[44:47],a[196:199],v[28:31],v[44:47]
i2 v[44:47],a[200:203],v[32:35],v[44:47]
i2 v[44:47],a[204:207],v[36:39],v[44:47]
i2 v[48:51],a[208:211],v[8:11],0
i2 v[48:51],a[212:215],v[12:15],v[48:51]
i2 v[48:51],a[216:219],v[16:19],v[48:51]
i2 v[48:51],a[220:223],v[20:23],v[48:51]
i3 v40,v40,v41
i3 v41,v42,v43
i3 v42,v44,v45
i3 v43,v46,v47
i13 v[40:43],v0,s[8:11],s25 offen offset:1024
i2 v[52:55],a[208:211],v[24:27],0
i2 v[52:55],a[212:215],v[28:31],v[52:55]
i2 v[52:55],a[216:219],v[32:35],v[52:55]
i2 v[52:55],a[220:223],v[36:39],v[52:55]
i2 v[56:59],a[224:227],v[8:11],0
i2 v[56:59],a[228:231],v[12:15],v[56:59]
i2 v[56:59],a[232:235],v[16:19],v[56:59]
i2 v[56:59],a[236:239],v[20:23],v[56:59]
i3 v48,v48,v49
i3 v49,v50,v51
i3 v50,v52,v53
i3 v51,v54,v55
i13 v[48:51],v0,s[8:11],s25 offen offset:2048
i2 v[60:63],a[224:227],v[24:27],0
i2 v[60:63],a[228:231],v[28:31],v[60:63]
i2 v[60:63],a[232:235],v[32:35],v[60:63]
i2 v[60:63],a[236:239],v[36:39],v[60:63]
i2 v[64:67],a[240:243],v[8:11],0
i2 v[64:67],a[244:247],v[12:15],v[64:67]
i2 v[64:67],a[248:251],v[16:19],v[64:67]
i2 v[64:67],a[252:255],v[20:23],v[64:67]
i3 v56,v56,v57
i3 v57,v58,v59
i3 v58,v60,v61
i3 v59,v62,v63
i13 v[56:59],v0,s[8:11],s25 offen offset:3072
i2 v[68:71],a[240:243],v[24:27],0
i2 v[68:71],a[244:247],v[28:31],v[68:71]
i2 v[68:71],a[248:251],v[32:35],v[68:71]
i2 v[68:71],a[252:255],v[36:39],v[68:71]
i3 v64,v64,v65
i3 v65,v66,v67
i15 5
i3 v66,v68,v69
i3 v67,v70,v71
i13 v[64:67],v0,s[8:11],s26 offen offset:0
i5 s63,1
i5 s34,s29
i5 s35,s30
s_xor_b32 s29, s29, 2097152
i6 s22,s22,3
s_cmp_lt_u32 s22, 64
i22 Lx2f_top
i8 vmcnt(0)
s_barrier
i23 v76,2,v0
i18 v76,0x7c,v76
i36 v77,v76,s[8:11],s33 offen sc1
Lx2f_fl1:
i8 vmcnt(0)
v_cmp_gt_u32 vcc, s32, v77
s_cbranch_vccz Lx2f_fl1k
i36 v77,v76,s[8:11],s33 offen sc1
i6 s31,s31,1
i35 s31,400000
i22 L_endx
i44 Lx2f_fl1
Lx2f_fl1k:
i20 v78,155648,v0
ds_read_b32 v78, v78 offset:1024
i32 s14,s20,10
i6 s14,s14,512
i6 s14,s14,s34
i8 lgkmcnt(0)
i5 m0,98304
i6 s25,s14,0
i1 v78,s[8:11],s25 offen sc1 lds
i5 m0,99328
i6 s25,s14,147456
i1 v78,s[8:11],s25 offen sc1 lds
i5 m0,100352
i6 s25,s14,294912
i1 v78,s[8:11],s25 offen sc1 lds
i5 m0,101376
i6 s25,s14,442368
i1 v78,s[8:11],s25 offen sc1 lds
i5 m0,102400
i6 s25,s14,589824
i1 v78,s[8:11],s25 offen sc1 lds
i5 m0,103424
i6 s25,s14,737280
i1 v78,s[8:11],s25 offen sc1 lds
i5 m0,104448
i6 s25,s14,884736
i1 v78,s[8:11],s25 offen sc1 lds
i5 m0,105472
i6 s25,s14,1032192
i1 v78,s[8:11],s25 offen sc1 lds
i20 v40,155648,v0
i20 v41,98304,v0
ds_read_b32 v42, v40 offset:1028
i9 v[72:75],v40 offset:2048
i9 v[76:79],v40 offset:3072
i8 vmcnt(0)
i9 v[8:11],v41 offset:0
i9 v[12:15],v41 offset:1024
i9 v[16:19],v41 offset:2048
i9 v[20:23],v41 offset:3072
i9 v[24:27],v41 offset:4096
i9 v[28:31],v41 offset:5120
i9 v[32:35],v41 offset:6144
i9 v[36:39],v41 offset:7168
i8 lgkmcnt(7)
i2 v[44:47],v[72:75],v[8:11],0
i8 lgkmcnt(6)
i2 v[44:47],v[72:75],v[12:15],v[44:47]
i8 lgkmcnt(5)
i2 v[44:47],v[72:75],v[16:19],v[44:47]
i8 lgkmcnt(4)
i2 v[44:47],v[72:75],v[20:23],v[44:47]
i8 lgkmcnt(3)
i2 v[44:47],v[72:75],v[24:27],v[44:47]
i8 lgkmcnt(2)
i2 v[44:47],v[72:75],v[28:31],v[44:47]
i8 lgkmcnt(1)
i2 v[44:47],v[72:75],v[32:35],v[44:47]
i8 lgkmcnt(0)
i2 v[44:47],v[72:75],v[36:39],v[44:47]
i15 7
i3 v44,v44,v45
i3 v45,v46,v47
i41 v[44:45],v42,s[56:59],s35 offen
i8 vmcnt(0)
i44 L_endx
L_xs2:
Lx2s_top:
i32 s27,s22,18
i32 s24,s20,13
i6 s27,s27,s24
i32 s28,s22,14
i6 s28,s28,72351744
s_mul_i32 s30, s22, 73728
s_and_b32 s24, s22, 7
s_cmp_ge_u32 s24, 3
i22 Lx2s_rdyk
s_barrier
Lx2s_rdyk:
s_bitcmp1_b32 s18, 31
s_cbranch_scc0 Lx2s_pre
s_bitset0_b32 s18, 31
i6 m0,s18,4096
i6 s25,s27,33558528
i1 v0,s[8:11],s25 offen sc1 lds
i6 m0,s18,5120
i6 s25,s27,33559552
i1 v0,s[8:11],s25 offen sc1 lds
i6 m0,s18,12288
i6 s25,s27,4096
i1 v0,s[8:11],s25 offen sc1 lds
i6 m0,s18,13312
i6 s25,s27,5120
i1 v0,s[8:11],s25 offen sc1 lds
i6 m0,s18,20480
i6 s25,s27,16781312
i1 v0,s[8:11],s25 offen sc1 lds
i6 m0,s18,21504
i6 s25,s27,16782336
i1 v0,s[8:11],s25 offen sc1 lds
Lx2s_pre:
i20 v6,s18,v0
i8 vmcnt(0)
s_barrier
i9 v[8:11],v6 offset:0
i9 v[48:51],v6 offset:8192
i9 v[12:15],v6 offset:2048
i9 v[52:55],v6 offset:10240
i9 v[16:19],v6 offset:4096
i9 v[56:59],v6 offset:12288
i9 v[20:23],v6 offset:6144
i9 v[60:63],v6 offset:14336
i9 v[24:27],v6 offset:9216
i9 v[28:31],v6 offset:11264
i9 v[32:35],v6 offset:13312
i9 v[36:39],v6 offset:15360
i8 lgkmcnt(10)
i2 v[40:43],v[48:51],v[8:11],0
i8 lgkmcnt(8)
i2 v[40:43],v[52:55],v[12:15],v[40:43]
i8 lgkmcnt(6)
i2 v[40:43],v[56:59],v[16:19],v[40:43]
i8 lgkmcnt(4)
i2 v[40:43],v[60:63],v[20:23],v[40:43]
i8 lgkmcnt(3)
i2 v[44:47],v[24:27],v[8:11],0
i8 lgkmcnt(2)
i2 v[44:47],v[28:31],v[12:15],v[44:47]
i8 lgkmcnt(1)
i2 v[44:47],v[32:35],v[16:19],v[44:47]
i8 lgkmcnt(0)
i2 v[44:47],v[36:39],v[20:23],v[44:47]
i9 v[24:27],v6 offset:20480
i9 v[28:31],v6 offset:21504
i9 v[32:35],v6 offset:22528
i9 v[36:39],v6 offset:23552
i11 v5,0xff800000
i26 v40,v5,v40,s[36:37]
i26 v41,v5,v41,s[38:39]
i26 v42,v5,v42,s[40:41]
i26 v43,v5,v43,s[42:43]
i26 v44,v5,v44,s[44:45]
i26 v45,v5,v45,s[46:47]
i26 v46,v5,v46,s[48:49]
i26 v47,v5,v47,s[50:51]
Lx2s_h:
i6 s24,s28,2048
i1 v[64:67],v4,s[8:11],s24 offen sc1
i6 s24,s28,6144
i1 v[68:71],v4,s[8:11],s24 offen sc1
i23 v76,2,v0
i18 v76,0x7c,v76
i36 v77,v76,s[8:11],s33 offen sc1
i6 s31,s31,1
i35 s31,400000
i22 L_endx
i8 vmcnt(0)
i48 v5,v64,v65,v66
i48 v5,v5,v67,v68
i48 v5,v5,v69,v70
v_max_u32 v5, v5, v71
i25 vcc,-1,v5
s_cbranch_vccz Lx2s_hk
s_cmp_ge_u32 s22, 60
i22 Lx2s_h
i11 v6,2048
i39 exec,1
Lx2s_hl:
s_sleep 12
i36 v5,v6,s[8:11],s28 offen sc1
i6 s31,s31,1
i35 s31,400000
i22 L_endx
i8 vmcnt(0)
i25 vcc,-1,v5
i49 Lx2s_hl
i39 exec,-1
i44 Lx2s_h
Lx2s_hk:
i21 v0,v[64:67] offset:2048
i21 v0,v[68:71] offset:6144
i47 s63,0
i22 Lx2s_nq
Lx2s_fl0:
i8 vmcnt(0)
v_cmp_gt_u32 vcc, s32, v77
s_cbranch_vccz Lx2s_fl0k
i36 v77,v76,s[8:11],s33 offen sc1
i6 s31,s31,1
i35 s31,400000
i22 L_endx
i44 Lx2s_fl0
Lx2s_fl0k:
Lx2s_nq:
i20 v78,155648,v0
ds_read_b32 v78, v78 offset:1024
i32 s14,s20,10
i6 s14,s14,512
i6 s14,s14,s34
s_xor_b32 s16, s18, 24576
i6 s24,s22,3
s_xor_b32 s24, s24, s22
s_cmp_ge_u32 s24, 8
i28 s24,0x80000000,0
s_or_b32 s18, s16, s24
i6 s26,s27,786432
s_or_b32 s26, s26, s24
i14 v[48:49],0
i14 v[50:51],0
i14 v[52:53],0
i14 v[54:55],0
i14 v[56:57],0
i14 v[58:59],0
i14 v[60:61],0
i14 v[62:63],0
i8 lgkmcnt(0)
s_barrier
i9 v[64:67],v0 offset:0
i9 v[68:71],v0 offset:1024
i9 v[72:75],v0 offset:2048
i8 lgkmcnt(2)
i4 v[48:51],v[64:67],v[80:87],v1
i5 m0,98304
i6 s25,s14,0
i1 v78,s[8:11],s25 offen sc1 lds
i4 v[52:55],v[64:67],v[88:95],v1
i4 v[56:59],v[64:67],v[224:231],v1
i5 m0,99328
i6 s25,s14,147456
i1 v78,s[8:11],s25 offen sc1 lds
i4 v[60:63],v[64:67],v[232:239],v1
i9 v[64:67],v0 offset:3072
i8 lgkmcnt(2)
i4 v[48:51],v[68:71],v[96:103],v1
i5 m0,100352
i6 s25,s14,294912
i1 v78,s[8:11],s25 offen sc1 lds
i4 v[52:55],v[68:71],v[104:111],v1
i4 v[56:59],v[68:71],v[240:247],v1
i5 m0,101376
i6 s25,s14,442368
i1 v78,s[8:11],s25 offen sc1 lds
i4 v[60:63],v[68:71],v[248:255],v1
i9 v[68:71],v0 offset:4096
i8 lgkmcnt(2)
i4 v[48:51],v[72:75],v[112:119],v1
i5 m0,102400
i6 s25,s14,589824
i1 v78,s[8:11],s25 offen sc1 lds
i4 v[52:55],v[72:75],v[120:127],v1
i4 v[56:59],v[72:75],a[0:7],v1
i5 m0,103424
i6 s25,s14,737280
i1 v78,s[8:11],s25 offen sc1 lds
i4 v[60:63],v[72:75],a[8:15],v1
i9 v[72:75],v0 offset:5120
i8 lgkmcnt(2)
i4 v[48:51],v[64:67],v[128:135],v1
i5 m0,104448
i6 s25,s14,884736
i1 v78,s[8:11],s25 offen sc1 lds
i4 v[52:55],v[64:67],v[136:143],v1
i4 v[56:59],v[64:67],a[16:23],v1
i5 m0,105472
i6 s25,s14,1032192
i1 v78,s[8:11],s25 offen sc1 lds
i4 v[60:63],v[64:67],a[24:31],v1
i9 v[64:67],v0 offset:6144
i8 lgkmcnt(2)
i4 v[48:51],v[68:71],v[144:151],v1
i6 m0,s16,4096
i6 s25,s26,33558528
i1 v0,s[8:11],s25 offen sc1 lds
i4 v[52:55],v[68:71],v[152:159],v1
i4 v[56:59],v[68:71],a[32:39],v1
i6 m0,s16,5120
i6 s25,s26,33559552
i1 v0,s[8:11],s25 offen sc1 lds
i4 v[60:63],v[68:71],a[40:47],v1
i9 v[68:71],v0 offset:7168
i8 lgkmcnt(2)
i4 v[48:51],v[72:75],v[160:167],v1
i6 m0,s16,12288
i6 s25,s26,4096
i1 v0,s[8:11],s25 offen sc1 lds
i4 v[52:55],v[72:75],v[168:175],v1
i4 v[56:59],v[72:75],a[48:55],v1
i6 m0,s16,13312
i6 s25,s26,5120
i1 v0,s[8:11],s25 offen sc1 lds
i4 v[60:63],v[72:75],a[56:63],v1
i9 v[72:75],v0 offset:8192
i8 lgkmcnt(2)
i4 v[48:51],v[64:67],v[176:183],v1
i6 m0,s16,20480
i6 s25,s26,16781312
i1 v0,s[8:11],s25 offen sc1 lds
i4 v[52:55],v[64:67],v[184:191],v1
i4 v[56:59],v[64:67],a[64:71],v1
i6 m0,s16,21504
i6 s25,s26,16782336
i1 v0,s[8:11],s25 offen sc1 lds
i4 v[60:63],v[64:67],a[72:79],v1
i8 lgkmcnt(1)
i4 v[48:51],v[68:71],v[192:199],v1
i4 v[52:55],v[68:71],v[200:207],v1
i4 v[56:59],v[68:71],a[80:87],v1
i4 v[60:63],v[68:71],a[88:95],v1
i8 lgkmcnt(0)
i4 v[48:51],v[72:75],v[208:215],v1
i4 v[52:55],v[72:75],v[216:223],v1
i4 v[56:59],v[72:75],a[96:103],v1
i4 v[60:63],v[72:75],a[104:111],v1
i3 v48,v48,v49
i3 v49,v50,v51
i3 v50,v52,v53
i3 v51,v54,v55
i27 v[52:55],v[48:49],v[2:3],0
i15 0
i27 v[76:79],v[50:51],v[2:3],0
i3 v56,v56,v57
i3 v57,v58,v59
i3 v58,v60,v61
i3 v59,v62,v63
i21 v0,v[56:59] offset:15360
i3 v48,v52,v53
i3 v49,v54,v55
i15 0
i3 v50,v76,v77
i3 v51,v78,v79
i21 v0,v[48:51] offset:11264
i8 lgkmcnt(0)
s_barrier
i9 v[64:67],v0 offset:9216
i9 v[68:71],v0 offset:10240
i9 v[72:75],v0 offset:11264
i9 v[76:79],v0 offset:12288
i9 v[48:51],v0 offset:15360
i9 v[52:55],v0 offset:16384
i38 v5,v40,v41,v42
i38 v6,v43,v44,v45
i38 v5,v5,v46,v47
i8 lgkmcnt(5)
i2 v[60:63],v[64:67],v[8:11],0
i8 lgkmcnt(4)
i2 v[60:63],v[68:71],v[12:15],v[60:63]
i8 lgkmcnt(3)
i2 v[60:63],v[72:75],v[16:19],v[60:63]
i8 lgkmcnt(2)
i2 v[60:63],v[76:79],v[20:23],v[60:63]
i15 7
i51 v60,0x3e0293ee,v60
i51 v61,0x3e0293ee,v61
i51 v62,0x3e0293ee,v62
i51 v63,0x3e0293ee,v63
i38 v5,v5,v6,v60
i38 v5,v5,v61,v62
v_max_f32 v5, v5, v63
i11 v6,v5
i15 1
v_permlane16_swap_b32 v5, v6
v_max_f32 v5, v5, v6
i11 v6,v5
i15 1
i40 v5,v6
v_max_f32 v5, v5, v6
i33 v40,v40,v5
i33 v41,v41,v5
i33 v42,v42,v5
i33 v43,v43,v5
i33 v44,v44,v5
i33 v45,v45,v5
i33 v46,v46,v5
i33 v47,v47,v5
i33 v60,v60,v5
i33 v61,v61,v5
i33 v62,v62,v5
i33 v63,v63,v5
i19 v40,v40
i19 v41,v41
i19 v42,v42
i19 v43,v43
i19 v44,v44
i19 v45,v45
i19 v46,v46
i19 v47,v47
i19 v60,v60
i19 v61,v61
i19 v62,v62
i19 v63,v63
i14 v[12:13],s[52:53]
i14 v[14:15],s[52:53]
i14 v[16:17],s[54:55]
i3 v20,v40,v41
i3 v21,v42,v43
i3 v22,v44,v45
i3 v23,v46,v47
i3 v18,v60,v61
i3 v19,v62,v63
i8 lgkmcnt(0)
i2 v[8:11],v[12:15],v[20:23],0
i2 v[64:67],v[24:27],v[20:23],0
i2 v[68:71],v[28:31],v[20:23],0
i2 v[72:75],v[32:35],v[20:23],0
i2 v[76:79],v[36:39],v[20:23],0
i27 v[8:11],v[16:17],v[18:19],v[8:11]
i27 v[64:67],v[48:49],v[18:19],v[64:67]
i27 v[68:71],v[50:51],v[18:19],v[68:71]
i27 v[72:75],v[52:53],v[18:19],v[72:75]
i27 v[76:79],v[54:55],v[18:19],v[76:79]
v_rcp_f32 v6, v8
i15 0
i16 v[64:65],v[64:65],v[6:7] op_sel_hi:[1,0]
i16 v[66:67],v[66:67],v[6:7] op_sel_hi:[1,0]
i16 v[68:69],v[68:69],v[6:7] op_sel_hi:[1,0]
i16 v[70:71],v[70:71],v[6:7] op_sel_hi:[1,0]
i16 v[72:73],v[72:73],v[6:7] op_sel_hi:[1,0]
i16 v[74:75],v[74:75],v[6:7] op_sel_hi:[1,0]
i16 v[76:77],v[76:77],v[6:7] op_sel_hi:[1,0]
i16 v[78:79],v[78:79],v[6:7] op_sel_hi:[1,0]
i3 v64,v64,v65
i3 v65,v66,v67
i3 v66,v68,v69
i3 v67,v70,v71
i21 v0,v[64:67] offset:19456
i3 v72,v72,v73
i3 v73,v74,v75
i3 v74,v76,v77
i3 v75,v78,v79
i21 v0,v[72:75] offset:20480
i8 lgkmcnt(0)
s_barrier
i47 s63,0
i22 Lx2s_nr
i20 v40,155648,v0
i20 v41,98304,v0
ds_read_b32 v42, v40 offset:1028
i9 v[72:75],v40 offset:2048
i9 v[76:79],v40 offset:3072
i8 vmcnt(0)
i9 v[8:11],v41 offset:0
i9 v[12:15],v41 offset:1024
i9 v[16:19],v41 offset:2048
i9 v[20:23],v41 offset:3072
i9 v[24:27],v41 offset:4096
i9 v[28:31],v41 offset:5120
i9 v[32:35],v41 offset:6144
i9 v[36:39],v41 offset:7168
i8 lgkmcnt(7)
i2 v[44:47],v[72:75],v[8:11],0
i8 lgkmcnt(6)
i2 v[44:47],v[72:75],v[12:15],v[44:47]
i8 lgkmcnt(5)
i2 v[44:47],v[72:75],v[16:19],v[44:47]
i8 lgkmcnt(4)
i2 v[44:47],v[72:75],v[20:23],v[44:47]
i8 lgkmcnt(3)
i2 v[44:47],v[72:75],v[24:27],v[44:47]
i8 lgkmcnt(2)
i2 v[44:47],v[72:75],v[28:31],v[44:47]
i8 lgkmcnt(1)
i2 v[44:47],v[72:75],v[32:35],v[44:47]
i8 lgkmcnt(0)
i2 v[44:47],v[72:75],v[36:39],v[44:47]
i15 7
i3 v44,v44,v45
i3 v45,v46,v47
i41 v[44:45],v42,s[56:59],s35 offen
i6 s32,s32,1
Lx2s_nr:
i9 v[8:11],v0 offset:17408
i9 v[12:15],v0 offset:18432
i9 v[16:19],v0 offset:19456
i9 v[20:23],v0 offset:20480
i9 v[24:27],v0 offset:21504
i9 v[28:31],v0 offset:22528
i9 v[32:35],v0 offset:23552
i9 v[36:39],v0 offset:24576
s_mul_i32 s24, s20, 36864
i6 s24,s24,s29
i6 s24,s24,18432
i6 s25,s24,4096
i6 s26,s24,8192
i8 lgkmcnt(7)
i2 v[40:43],a[112:115],v[8:11],0
i8 lgkmcnt(6)
i2 v[40:43],a[116:119],v[12:15],v[40:43]
i8 lgkmcnt(5)
i2 v[40:43],a[120:123],v[16:19],v[40:43]
i8 lgkmcnt(4)
i2 v[40:43],a[124:127],v[20:23],v[40:43]
i8 lgkmcnt(3)
i2 v[44:47],a[112:115],v[24:27],0
i8 lgkmcnt(2)
i2 v[44:47],a[116:119],v[28:31],v[44:47]
i8 lgkmcnt(1)
i2 v[44:47],a[120:123],v[32:35],v[44:47]
i8 lgkmcnt(0)
i2 v[44:47],a[124:127],v[36:39],v[44:47]
i2 v[48:51],a[128:131],v[8:11],0
i2 v[48:51],a[132:135],v[12:15],v[48:51]
i2 v[48:51],a[136:139],v[16:19],v[48:51]
i2 v[48:51],a[140:143],v[20:23],v[48:51]
i3 v40,v40,v41
i3 v41,v42,v43
i3 v42,v44,v45
i3 v43,v46,v47
i13 v[40:43],v0,s[8:11],s24 offen offset:0 sc1
i2 v[52:55],a[128:131],v[24:27],0
i2 v[52:55],a[132:135],v[28:31],v[52:55]
i2 v[52:55],a[136:139],v[32:35],v[52:55]
i2 v[52:55],a[140:143],v[36:39],v[52:55]
i2 v[56:59],a[144:147],v[8:11],0
i2 v[56:59],a[148:151],v[12:15],v[56:59]
i2 v[56:59],a[152:155],v[16:19],v[56:59]
i2 v[56:59],a[156:159],v[20:23],v[56:59]
i3 v48,v48,v49
i3 v49,v50,v51
i3 v50,v52,v53
i3 v51,v54,v55
i13 v[48:51],v0,s[8:11],s24 offen offset:1024 sc1
i2 v[60:63],a[144:147],v[24:27],0
i2 v[60:63],a[148:151],v[28:31],v[60:63]
i2 v[60:63],a[152:155],v[32:35],v[60:63]
i2 v[60:63],a[156:159],v[36:39],v[60:63]
i2 v[64:67],a[160:163],v[8:11],0
i2 v[64:67],a[164:167],v[12:15],v[64:67]
i2 v[64:67],a[168:171],v[16:19],v[64:67]
i2 v[64:67],a[172:175],v[20:23],v[64:67]
i3 v56,v56,v57
i3 v57,v58,v59
i3 v58,v60,v61
i3 v59,v62,v63
i13 v[56:59],v0,s[8:11],s24 offen offset:2048 sc1
i2 v[68:71],a[160:163],v[24:27],0
i2 v[68:71],a[164:167],v[28:31],v[68:71]
i2 v[68:71],a[168:171],v[32:35],v[68:71]
i2 v[68:71],a[172:175],v[36:39],v[68:71]
i2 v[72:75],a[176:179],v[8:11],0
i2 v[72:75],a[180:183],v[12:15],v[72:75]
i2 v[72:75],a[184:187],v[16:19],v[72:75]
i2 v[72:75],a[188:191],v[20:23],v[72:75]
i3 v64,v64,v65
i3 v65,v66,v67
i3 v66,v68,v69
i3 v67,v70,v71
i13 v[64:67],v0,s[8:11],s24 offen offset:3072 sc1
i2 v[76:79],a[176:179],v[24:27],0
i2 v[76:79],a[180:183],v[28:31],v[76:79]
i2 v[76:79],a[184:187],v[32:35],v[76:79]
i2 v[76:79],a[188:191],v[36:39],v[76:79]
i2 v[40:43],a[192:195],v[8:11],0
i2 v[40:43],a[196:199],v[12:15],v[40:43]
i2 v[40:43],a[200:203],v[16:19],v[40:43]
i2 v[40:43],a[204:207],v[20:23],v[40:43]
i3 v72,v72,v73
i3 v73,v74,v75
i3 v74,v76,v77
i3 v75,v78,v79
i13 v[72:75],v0,s[8:11],s25 offen offset:0 sc1
i2 v[44:47],a[192:195],v[24:27],0
i2 v[44:47],a[196:199],v[28:31],v[44:47]
i2 v[44:47],a[200:203],v[32:35],v[44:47]
i2 v[44:47],a[204:207],v[36:39],v[44:47]
i2 v[48:51],a[208:211],v[8:11],0
i2 v[48:51],a[212:215],v[12:15],v[48:51]
i2 v[48:51],a[216:219],v[16:19],v[48:51]
i2 v[48:51],a[220:223],v[20:23],v[48:51]
i3 v40,v40,v41
i3 v41,v42,v43
i3 v42,v44,v45
i3 v43,v46,v47
i13 v[40:43],v0,s[8:11],s25 offen offset:1024 sc1
i2 v[52:55],a[208:211],v[24:27],0
i2 v[52:55],a[212:215],v[28:31],v[52:55]
i2 v[52:55],a[216:219],v[32:35],v[52:55]
i2 v[52:55],a[220:223],v[36:39],v[52:55]
i2 v[56:59],a[224:227],v[8:11],0
i2 v[56:59],a[228:231],v[12:15],v[56:59]
i2 v[56:59],a[232:235],v[16:19],v[56:59]
i2 v[56:59],a[236:239],v[20:23],v[56:59]
i3 v48,v48,v49
i3 v49,v50,v51
i3 v50,v52,v53
i3 v51,v54,v55
i13 v[48:51],v0,s[8:11],s25 offen offset:2048 sc1
i2 v[60:63],a[224:227],v[24:27],0
i2 v[60:63],a[228:231],v[28:31],v[60:63]
i2 v[60:63],a[232:235],v[32:35],v[60:63]
i2 v[60:63],a[236:239],v[36:39],v[60:63]
i2 v[64:67],a[240:243],v[8:11],0
i2 v[64:67],a[244:247],v[12:15],v[64:67]
i2 v[64:67],a[248:251],v[16:19],v[64:67]
i2 v[64:67],a[252:255],v[20:23],v[64:67]
i3 v56,v56,v57
i3 v57,v58,v59
i3 v58,v60,v61
i3 v59,v62,v63
i13 v[56:59],v0,s[8:11],s25 offen offset:3072 sc1
i2 v[68:71],a[240:243],v[24:27],0
i2 v[68:71],a[244:247],v[28:31],v[68:71]
i2 v[68:71],a[248:251],v[32:35],v[68:71]
i2 v[68:71],a[252:255],v[36:39],v[68:71]
i3 v64,v64,v65
i3 v65,v66,v67
i15 5
i3 v66,v68,v69
i3 v67,v70,v71
i13 v[64:67],v0,s[8:11],s26 offen offset:0 sc1
i5 s63,1
i5 s34,s29
i5 s35,s30
s_xor_b32 s29, s29, 2097152
i6 s22,s22,3
s_cmp_lt_u32 s22, 64
i22 Lx2s_top
i8 vmcnt(0)
s_barrier
i23 v76,2,v0
i18 v76,0x7c,v76
i36 v77,v76,s[8:11],s33 offen sc1
Lx2s_fl1:
i8 vmcnt(0)
v_cmp_gt_u32 vcc, s32, v77
s_cbranch_vccz Lx2s_fl1k
i36 v77,v76,s[8:11],s33 offen sc1
i6 s31,s31,1
i35 s31,400000
i22 L_endx
i44 Lx2s_fl1
Lx2s_fl1k:
i20 v78,155648,v0
ds_read_b32 v78, v78 offset:1024
i32 s14,s20,10
i6 s14,s14,512
i6 s14,s14,s34
i8 lgkmcnt(0)
i5 m0,98304
i6 s25,s14,0
i1 v78,s[8:11],s25 offen sc1 lds
i5 m0,99328
i6 s25,s14,147456
i1 v78,s[8:11],s25 offen sc1 lds
i5 m0,100352
i6 s25,s14,294912
i1 v78,s[8:11],s25 offen sc1 lds
i5 m0,101376
i6 s25,s14,442368
i1 v78,s[8:11],s25 offen sc1 lds
i5 m0,102400
i6 s25,s14,589824
i1 v78,s[8:11],s25 offen sc1 lds
i5 m0,103424
i6 s25,s14,737280
i1 v78,s[8:11],s25 offen sc1 lds
i5 m0,104448
i6 s25,s14,884736
i1 v78,s[8:11],s25 offen sc1 lds
i5 m0,105472
i6 s25,s14,1032192
i1 v78,s[8:11],s25 offen sc1 lds
i20 v40,155648,v0
i20 v41,98304,v0
ds_read_b32 v42, v40 offset:1028
i9 v[72:75],v40 offset:2048
i9 v[76:79],v40 offset:3072
i8 vmcnt(0)
i9 v[8:11],v41 offset:0
i9 v[12:15],v41 offset:1024
i9 v[16:19],v41 offset:2048
i9 v[20:23],v41 offset:3072
i9 v[24:27],v41 offset:4096
i9 v[28:31],v41 offset:5120
i9 v[32:35],v41 offset:6144
i9 v[36:39],v41 offset:7168
i8 lgkmcnt(7)
i2 v[44:47],v[72:75],v[8:11],0
i8 lgkmcnt(6)
i2 v[44:47],v[72:75],v[12:15],v[44:47]
i8 lgkmcnt(5)
i2 v[44:47],v[72:75],v[16:19],v[44:47]
i8 lgkmcnt(4)
i2 v[44:47],v[72:75],v[20:23],v[44:47]
i8 lgkmcnt(3)
i2 v[44:47],v[72:75],v[24:27],v[44:47]
i8 lgkmcnt(2)
i2 v[44:47],v[72:75],v[28:31],v[44:47]
i8 lgkmcnt(1)
i2 v[44:47],v[72:75],v[32:35],v[44:47]
i8 lgkmcnt(0)
i2 v[44:47],v[72:75],v[36:39],v[44:47]
i15 7
i3 v44,v44,v45
i3 v45,v46,v47
i41 v[44:45],v42,s[56:59],s35 offen
i8 vmcnt(0)
i44 L_endx
L_endx:
s_endpgm
L_role2:
i44 L_role
L_chain:
i5 s87,0
i47 s21,0
i22 L_cw0
i47 s21,1
i22 L_cw1
i47 s21,2
i22 L_cw2
L_cw3:
i23 v79,4,v0
i23 v28,4,v79
i18 v29,0xf0,v0
i17 v78,v28,13,v29
i32 s22,s20,8
i20 v78,s22,v78
i54 s23,1152
i45 v77,v28,s23,v29
s_mul_i32 s22, s20, 147456
i20 v77,s22,v77
i23 v28,3,v79
i18 v29,0x70,v0
i45 v76,v28,s23,v29
i20 v76,s22,v76
i47 s99,0
i22 Lc3_ptr
i50 s[60:61],s[0:1],56
i50 s[64:65],s[0:1],64
i50 s[68:69],s[0:1],72
i50 s[72:73],s[0:1],80
i8 lgkmcnt(0)
Lc3_ptr:
i5 s62,4718592
i5 s63,0x20000
i5 s66,4718592
i5 s67,0x20000
i5 s70,4718592
i5 s71,0x20000
i5 s74,4718592
i5 s75,0x20000
i5 s42,1040356334
i5 s43,1040356334
i5 s22,393216
i5 s23,110592
Lc3_first:
i6 m0,s23,0
i6 s24,s22,0
i1 v78,s[64:67],s24 offen lds
i6 m0,s23,1024
i6 s24,s22,32768
i1 v78,s[64:67],s24 offen lds
i6 m0,s23,2048
i6 s24,s22,65536
i1 v78,s[64:67],s24 offen lds
i6 m0,s23,3072
i6 s24,s22,98304
i1 v78,s[64:67],s24 offen lds
i6 s22,s22,524288
i6 s23,s23,4096
s_cmp_lt_u32 s23, 147456
i22 Lc3_first
i23 v30,4,v79
i34 v31,v79,2,2
i18 v32,3,v79
i20 v4,110592,v0
i18 v28,1,v30
i17 v28,v28,3,v31
i31 v28,8,v28
i20 v28,192,v28
i17 v68,v32,3,v28
i23 v29,1,v32
i17 v28,v29,5,v28
i18 v29,1,v32
i17 v72,v29,3,v28
i23 v33,1,v30
i23 v29,1,v31
i17 v28,v33,2,v29
i18 v29,1,v31
i31 v34,3,v32
i17 v64,v28,8,v34
i17 v64,v29,5,v64
i20 v64,192,v64
i18 v35,1,v30
i17 v28,v35,4,v28
i17 v60,v28,7,v34
i20 v60,96,v60
i5 s22,36864
i54 s23,4096
i45 v74,v33,s23,v72
i20 v74,147456,v74
i20 v75,8192,v74
i45 v72,v33,s22,v72
i20 v73,73728,v72
i45 v70,v33,s23,v68
i20 v70,147456,v70
i20 v71,8192,v70
i45 v68,v33,s22,v68
i20 v69,73728,v68
i45 v66,v35,s23,v64
i20 v66,147456,v66
i20 v67,8192,v66
i45 v64,v35,s22,v64
i20 v65,73728,v64
i45 v62,v29,s23,v60
i20 v62,147456,v62
i20 v63,8192,v62
i45 v60,v29,s22,v60
i20 v61,73728,v60
i34 v29,v79,3,1
i25 vcc,1,v29
i11 v1,0x8888
i11 v28,0xdddd
i26 v1,v1,v28,vcc
i18 v28,7,v79
i34 v29,v79,4,1
i31 v29,2,v29
v_sub_u32 v28, v28, v29
i18 v29,1,v28
i31 v29,4,v29
i11 v30,0x3f80
i31 v30,v29,v30
v_ashrrev_i32 v28, 1, v28
i25 vcc,0,v28
i15 1
i26 v2,0,v30,vcc
i25 vcc,1,v28
i15 1
i26 v3,0,v30,vcc
i20 v6,147456,v0
i34 v28,v0,8,1
i18 v29,0x70,v0
i23 v7,5,v0
i18 v7,0x18,v7
i17 v7,v29,1,v7
i20 v7,158768,v7
i54 s23,9216
i23 v56,7,v0
i45 v56,v56,s23,v29
i24 v57,v28,3,v29
i23 v30,9,v0
i24 v57,v30,2,v57
i34 v31,v0,7,1
i24 v57,v31,31,v57
i18 v58,0x33f,v0
i24 v58,v31,6,v58
i34 v32,v0,6,1
i24 v58,v32,7,v58
i34 v59,v0,1,8
i24 v59,v30,2,v59
i18 v28,16,v0
i11 v30,0x3f80
i31 v30,v28,v30
i34 v28,v0,5,2
i34 v28,v0,5,3
i25 vcc,0,v28
i15 1
i26 v8,0,v30,vcc
i25 vcc,1,v28
i15 1
i26 v9,0,v30,vcc
i25 vcc,2,v28
i15 1
i26 v10,0,v30,vcc
i25 vcc,3,v28
i15 1
i26 v11,0,v30,vcc
i25 vcc,4,v28
i15 1
i26 v16,0,v30,vcc
i25 vcc,5,v28
i15 1
i26 v17,0,v30,vcc
i25 vcc,6,v28
i15 1
i26 v18,0,v30,vcc
i25 vcc,7,v28
i15 1
i26 v19,0,v30,vcc
i23 v28,8,v0
i24 v28,v28,7,v29
i20 v13,151552,v28
i17 v12,v31,3,v13
i17 v14,v31,9,v13
i23 v15,1,v0
i5 s44,0xff00ff00
i5 s45,0xff00ff00
i5 s48,0x3e803e80
i5 s49,0x3e803e80
i5 s50,0x3f803f80
i5 s51,0x3f803f80
i5 s54,562036736
i5 s55,1568669696
i5 s25,0
i5 s46,0
i5 s47,0
s_mul_i32 s38, s20, 8192
i6 s38,s38,6144
i6 s39,s38,16777216
i6 s40,s38,50331648
s_mul_i32 s79, s20, 9216
i6 s79,s79,67108864
i32 s23,s20,7
i6 s7,s23,67121152
i6 s41,s23,70266880
i5 s78,524288
i54 s77,9216
i6 s34,s41,49152
i6 s52,s41,32768
i6 s53,s41,2097152
i8 vmcnt(32)
s_barrier
i0 a[168:169],v72 offset:0
i0 a[170:171],v72 offset:1024
i0 a[172:173],v73 offset:0
i0 a[174:175],v73 offset:1024
i0 v[48:49],v72 offset:16
i0 v[50:51],v72 offset:1040
i0 v[52:53],v73 offset:16
i0 v[54:55],v73 offset:1040
i8 lgkmcnt(0)
s_barrier
i21 v4,v[48:51] offset:0
i21 v4,v[52:55] offset:1024
i8 lgkmcnt(0)
i8 vmcnt(28)
s_barrier
i5 m0,159744
i5 s22,2490368
i1 v78,s[68:71],s22 offen lds
i5 m0,160768
i5 s22,2523136
i1 v78,s[68:71],s22 offen lds
i5 m0,161792
i5 s22,2555904
i1 v78,s[68:71],s22 offen lds
i5 m0,162816
i5 s22,2588672
i1 v78,s[68:71],s22 offen lds
i0 a[176:177],v72 offset:4096
i0 a[178:179],v72 offset:5120
i0 a[180:181],v73 offset:4096
i0 a[182:183],v73 offset:5120
i0 v[48:49],v72 offset:4112
i0 v[50:51],v72 offset:5136
i0 v[52:53],v73 offset:4112
i0 v[54:55],v73 offset:5136
i8 lgkmcnt(0)
s_barrier
i21 v4,v[48:51] offset:2048
i21 v4,v[52:55] offset:3072
i8 lgkmcnt(0)
i8 vmcnt(28)
s_barrier
i0 a[184:185],v72 offset:8192
i0 a[186:187],v72 offset:9216
i0 a[188:189],v73 offset:8192
i0 a[190:191],v73 offset:9216
i0 v[48:49],v72 offset:8208
i0 v[50:51],v72 offset:9232
i0 v[52:53],v73 offset:8208
i0 v[54:55],v73 offset:9232
i8 lgkmcnt(0)
s_barrier
i21 v4,v[48:51] offset:4096
i21 v4,v[52:55] offset:5120
i8 lgkmcnt(0)
i8 vmcnt(24)
s_barrier
i0 a[160:161],v72 offset:12288
i0 a[162:163],v72 offset:13312
i0 a[164:165],v73 offset:12288
i0 a[166:167],v73 offset:13312
i0 v[48:49],v72 offset:12304
i0 v[50:51],v72 offset:13328
i0 v[52:53],v73 offset:12304
i0 v[54:55],v73 offset:13328
i8 lgkmcnt(0)
s_barrier
i21 v4,v[48:51] offset:6144
i21 v4,v[52:55] offset:7168
i8 lgkmcnt(0)
i8 vmcnt(20)
s_barrier
i0 a[208:209],v72 offset:16384
i0 a[210:211],v72 offset:17408
i0 a[212:213],v73 offset:16384
i0 a[214:215],v73 offset:17408
i0 v[48:49],v72 offset:16400
i0 v[50:51],v72 offset:17424
i0 v[52:53],v73 offset:16400
i0 v[54:55],v73 offset:17424
i8 lgkmcnt(0)
s_barrier
i21 v4,v[48:51] offset:8192
i21 v4,v[52:55] offset:9216
i8 lgkmcnt(0)
i8 vmcnt(16)
s_barrier
i0 a[216:217],v72 offset:20480
i0 a[218:219],v72 offset:21504
i0 a[220:221],v73 offset:20480
i0 a[222:223],v73 offset:21504
i0 v[48:49],v72 offset:20496
i0 v[50:51],v72 offset:21520
i0 v[52:53],v73 offset:20496
i0 v[54:55],v73 offset:21520
i8 lgkmcnt(0)
s_barrier
i21 v4,v[48:51] offset:10240
i21 v4,v[52:55] offset:11264
i8 lgkmcnt(0)
i8 vmcnt(12)
s_barrier
i5 m0,131072
i5 s22,3014656
i1 v78,s[68:71],s22 offen lds
i5 m0,132096
i5 s22,3047424
i1 v78,s[68:71],s22 offen lds
i5 m0,133120
i5 s22,3080192
i1 v78,s[68:71],s22 offen lds
i5 m0,134144
i5 s22,3112960
i1 v78,s[68:71],s22 offen lds
i0 a[224:225],v72 offset:24576
i0 a[226:227],v72 offset:25600
i0 a[228:229],v73 offset:24576
i0 a[230:231],v73 offset:25600
i0 v[48:49],v72 offset:24592
i0 v[50:51],v72 offset:25616
i0 v[52:53],v73 offset:24592
i0 v[54:55],v73 offset:25616
i8 lgkmcnt(0)
s_barrier
i21 v4,v[48:51] offset:12288
i21 v4,v[52:55] offset:13312
i8 lgkmcnt(0)
i8 vmcnt(12)
s_barrier
i5 m0,135168
i5 s22,3538944
i1 v78,s[68:71],s22 offen lds
i5 m0,136192
i5 s22,3571712
i1 v78,s[68:71],s22 offen lds
i5 m0,137216
i5 s22,3604480
i1 v78,s[68:71],s22 offen lds
i5 m0,138240
i5 s22,3637248
i1 v78,s[68:71],s22 offen lds
i0 a[200:201],v72 offset:28672
i0 a[202:203],v72 offset:29696
i0 a[204:205],v73 offset:28672
i0 a[206:207],v73 offset:29696
i0 v[48:49],v72 offset:28688
i0 v[50:51],v72 offset:29712
i0 v[52:53],v73 offset:28688
i0 v[54:55],v73 offset:29712
i8 lgkmcnt(0)
s_barrier
i21 v4,v[48:51] offset:14336
i21 v4,v[52:55] offset:15360
i8 lgkmcnt(0)
i8 vmcnt(12)
s_barrier
i5 m0,139264
i5 s22,4063232
i1 v78,s[68:71],s22 offen lds
i5 m0,140288
i5 s22,4096000
i1 v78,s[68:71],s22 offen lds
i5 m0,141312
i5 s22,4128768
i1 v78,s[68:71],s22 offen lds
i5 m0,142336
i5 s22,4161536
i1 v78,s[68:71],s22 offen lds
i0 a[192:193],v72 offset:32768
i0 a[194:195],v72 offset:33792
i0 a[196:197],v73 offset:32768
i0 a[198:199],v73 offset:33792
i0 v[48:49],v72 offset:32784
i0 v[50:51],v72 offset:33808
i0 v[52:53],v73 offset:32784
i0 v[54:55],v73 offset:33808
i8 lgkmcnt(0)
s_barrier
i21 v4,v[48:51] offset:16384
i21 v4,v[52:55] offset:17408
i8 lgkmcnt(0)
i8 vmcnt(12)
s_barrier
i5 m0,143360
i5 s22,129024
i1 v77,s[72:75],s22 offen lds
i5 m0,144384
i5 s22,133632
i1 v77,s[72:75],s22 offen lds
i5 m0,145408
i5 s22,138240
i1 v77,s[72:75],s22 offen lds
i5 m0,146432
i5 s22,142848
i1 v77,s[72:75],s22 offen lds
i0 a[64:65],v70 offset:0
i0 a[66:67],v70 offset:1024
i0 a[68:69],v71 offset:0
i0 a[70:71],v71 offset:1024
i0 a[72:73],v70 offset:32
i0 a[74:75],v70 offset:1056
i0 a[76:77],v71 offset:32
i0 a[78:79],v71 offset:1056
i8 lgkmcnt(0)
s_barrier
i8 vmcnt(12)
s_barrier
i5 m0,159744
i5 s22,393216
i1 v78,s[60:63],s22 offen lds
i5 m0,160768
i5 s22,425984
i1 v78,s[60:63],s22 offen lds
i5 m0,161792
i5 s22,458752
i1 v78,s[60:63],s22 offen lds
i5 m0,162816
i5 s22,491520
i1 v78,s[60:63],s22 offen lds
i0 a[240:241],v68 offset:20480
i0 a[242:243],v68 offset:21504
i0 a[244:245],v69 offset:20480
i0 a[246:247],v69 offset:21504
i0 v[48:49],v68 offset:20512
i0 v[50:51],v68 offset:21536
i0 v[52:53],v69 offset:20512
i0 v[54:55],v69 offset:21536
i8 lgkmcnt(0)
s_barrier
i21 v4,v[48:51] offset:18432
i21 v4,v[52:55] offset:19456
i8 lgkmcnt(0)
i8 vmcnt(12)
s_barrier
i0 a[232:233],v68 offset:24576
i0 a[234:235],v68 offset:25600
i0 a[236:237],v69 offset:24576
i0 a[238:239],v69 offset:25600
i0 v[48:49],v68 offset:24608
i0 v[50:51],v68 offset:25632
i0 v[52:53],v69 offset:24608
i0 v[54:55],v69 offset:25632
i8 lgkmcnt(0)
s_barrier
i21 v4,v[48:51] offset:20480
i21 v4,v[52:55] offset:21504
i8 lgkmcnt(0)
i8 vmcnt(8)
s_barrier
i5 m0,135168
i5 s22,917504
i1 v78,s[60:63],s22 offen lds
i5 m0,136192
i5 s22,950272
i1 v78,s[60:63],s22 offen lds
i5 m0,137216
i5 s22,983040
i1 v78,s[60:63],s22 offen lds
i5 m0,138240
i5 s22,1015808
i1 v78,s[60:63],s22 offen lds
i0 a[48:49],v68 offset:28672
i0 a[50:51],v68 offset:29696
i0 a[52:53],v69 offset:28672
i0 a[54:55],v69 offset:29696
i0 a[56:57],v68 offset:28704
i0 a[58:59],v68 offset:29728
i0 a[60:61],v69 offset:28704
i0 a[62:63],v69 offset:29728
i8 lgkmcnt(0)
s_barrier
i8 vmcnt(8)
s_barrier
i5 m0,139264
i5 s22,1441792
i1 v78,s[60:63],s22 offen lds
i5 m0,140288
i5 s22,1474560
i1 v78,s[60:63],s22 offen lds
i5 m0,141312
i5 s22,1507328
i1 v78,s[60:63],s22 offen lds
i5 m0,142336
i5 s22,1540096
i1 v78,s[60:63],s22 offen lds
i0 a[248:249],v64 offset:32768
i0 a[250:251],v64 offset:33280
i0 a[252:253],v64 offset:34816
i0 a[254:255],v64 offset:35328
i0 v[48:49],v65 offset:32768
i0 v[50:51],v65 offset:33280
i0 v[52:53],v65 offset:34816
i0 v[54:55],v65 offset:35328
i8 lgkmcnt(0)
s_barrier
i21 v4,v[48:51] offset:22528
i21 v4,v[52:55] offset:23552
i8 lgkmcnt(0)
i8 vmcnt(8)
s_barrier
i5 m0,143360
i5 s22,1966080
i1 v78,s[60:63],s22 offen lds
i5 m0,144384
i5 s22,1998848
i1 v78,s[60:63],s22 offen lds
i5 m0,145408
i5 s22,2031616
i1 v78,s[60:63],s22 offen lds
i5 m0,146432
i5 s22,2064384
i1 v78,s[60:63],s22 offen lds
i0 v[96:97],v74 offset:0
i0 v[98:99],v74 offset:1024
i0 v[100:101],v75 offset:0
i0 v[102:103],v75 offset:1024
i0 v[104:105],v74 offset:16
i0 v[106:107],v74 offset:1040
i0 v[108:109],v75 offset:16
i0 v[110:111],v75 offset:1040
i8 lgkmcnt(0)
i8 vmcnt(8)
s_barrier
i5 m0,159744
i5 s22,2490368
i1 v78,s[60:63],s22 offen lds
i5 m0,160768
i5 s22,2523136
i1 v78,s[60:63],s22 offen lds
i5 m0,161792
i5 s22,2555904
i1 v78,s[60:63],s22 offen lds
i5 m0,162816
i5 s22,2588672
i1 v78,s[60:63],s22 offen lds
i0 v[112:113],v72 offset:24576
i0 v[114:115],v72 offset:25600
i0 v[116:117],v73 offset:24576
i0 v[118:119],v73 offset:25600
i0 v[120:121],v72 offset:24592
i0 v[122:123],v72 offset:25616
i0 v[124:125],v73 offset:24592
i0 v[126:127],v73 offset:25616
i8 lgkmcnt(0)
i8 vmcnt(8)
s_barrier
i5 m0,135168
i5 s22,3014656
i1 v78,s[60:63],s22 offen lds
i5 m0,136192
i5 s22,3047424
i1 v78,s[60:63],s22 offen lds
i5 m0,137216
i5 s22,3080192
i1 v78,s[60:63],s22 offen lds
i5 m0,138240
i5 s22,3112960
i1 v78,s[60:63],s22 offen lds
i0 v[128:129],v72 offset:28672
i0 v[130:131],v72 offset:29696
i0 v[132:133],v73 offset:28672
i0 v[134:135],v73 offset:29696
i0 v[136:137],v72 offset:28688
i0 v[138:139],v72 offset:29712
i0 v[140:141],v73 offset:28688
i0 v[142:143],v73 offset:29712
i8 lgkmcnt(0)
i8 vmcnt(8)
s_barrier
i5 m0,139264
i5 s22,3538944
i1 v78,s[60:63],s22 offen lds
i5 m0,140288
i5 s22,3571712
i1 v78,s[60:63],s22 offen lds
i5 m0,141312
i5 s22,3604480
i1 v78,s[60:63],s22 offen lds
i5 m0,142336
i5 s22,3637248
i1 v78,s[60:63],s22 offen lds
i0 v[80:81],v72 offset:32768
i0 v[82:83],v72 offset:33792
i0 v[84:85],v73 offset:32768
i0 v[86:87],v73 offset:33792
i0 v[88:89],v72 offset:32784
i0 v[90:91],v72 offset:33808
i0 v[92:93],v73 offset:32784
i0 v[94:95],v73 offset:33808
i8 lgkmcnt(0)
i8 vmcnt(8)
s_barrier
i5 m0,143360
i5 s22,4063232
i1 v78,s[60:63],s22 offen lds
i5 m0,144384
i5 s22,4096000
i1 v78,s[60:63],s22 offen lds
i5 m0,145408
i5 s22,4128768
i1 v78,s[60:63],s22 offen lds
i5 m0,146432
i5 s22,4161536
i1 v78,s[60:63],s22 offen lds
i0 v[176:177],v74 offset:0
i0 v[178:179],v74 offset:1024
i0 v[180:181],v75 offset:0
i0 v[182:183],v75 offset:1024
i0 v[184:185],v74 offset:16
i0 v[186:187],v74 offset:1040
i0 v[188:189],v75 offset:16
i0 v[190:191],v75 offset:1040
i8 lgkmcnt(0)
i8 vmcnt(8)
s_barrier
i5 m0,159744
i5 s22,4587520
i1 v78,s[60:63],s22 offen lds
i5 m0,160768
i5 s22,4620288
i1 v78,s[60:63],s22 offen lds
i5 m0,161792
i5 s22,4653056
i1 v78,s[60:63],s22 offen lds
i5 m0,162816
i5 s22,4685824
i1 v78,s[60:63],s22 offen lds
i0 v[192:193],v72 offset:24576
i0 v[194:195],v72 offset:25600
i0 v[196:197],v73 offset:24576
i0 v[198:199],v73 offset:25600
i0 v[200:201],v72 offset:24592
i0 v[202:203],v72 offset:25616
i0 v[204:205],v73 offset:24592
i0 v[206:207],v73 offset:25616
i8 lgkmcnt(0)
i8 vmcnt(8)
s_barrier
i5 m0,135168
i5 s22,393216
i1 v78,s[68:71],s22 offen lds
i5 m0,136192
i5 s22,425984
i1 v78,s[68:71],s22 offen lds
i5 m0,137216
i5 s22,458752
i1 v78,s[68:71],s22 offen lds
i5 m0,138240
i5 s22,491520
i1 v78,s[68:71],s22 offen lds
i0 v[208:209],v72 offset:28672
i0 v[210:211],v72 offset:29696
i0 v[212:213],v73 offset:28672
i0 v[214:215],v73 offset:29696
i0 v[216:217],v72 offset:28688
i0 v[218:219],v72 offset:29712
i0 v[220:221],v73 offset:28688
i0 v[222:223],v73 offset:29712
i8 lgkmcnt(0)
i31 v26,2,v0
s_getpc_b64 s[88:89]
Lc3_pc:
i6 s88,s88,Lc3f_top-Lc3_pc
s_addc_u32 s89, s89, 0
i20 v27,4096,v26
i55 v26,v26,s[88:89]
i55 v27,v27,s[88:89]
i8 vmcnt(10)
s_barrier
i5 m0,139264
i5 s22,917504
i1 v78,s[68:71],s22 offen lds
i5 m0,140288
i5 s22,950272
i1 v78,s[68:71],s22 offen lds
i5 m0,141312
i5 s22,983040
i1 v78,s[68:71],s22 offen lds
i5 m0,142336
i5 s22,1015808
i1 v78,s[68:71],s22 offen lds
i0 v[160:161],v72 offset:32768
i0 v[162:163],v72 offset:33792
i0 v[164:165],v73 offset:32768
i0 v[166:167],v73 offset:33792
i0 v[168:169],v72 offset:32784
i0 v[170:171],v72 offset:33808
i0 v[172:173],v73 offset:32784
i0 v[174:175],v73 offset:33808
i8 lgkmcnt(0)
i8 vmcnt(10)
s_barrier
i5 m0,143360
i5 s22,1441792
i1 v78,s[68:71],s22 offen lds
i5 m0,144384
i5 s22,1474560
i1 v78,s[68:71],s22 offen lds
i5 m0,145408
i5 s22,1507328
i1 v78,s[68:71],s22 offen lds
i5 m0,146432
i5 s22,1540096
i1 v78,s[68:71],s22 offen lds
i0 v[144:145],v74 offset:0
i0 v[146:147],v74 offset:1024
i0 v[148:149],v75 offset:0
i0 v[150:151],v75 offset:1024
i0 v[152:153],v74 offset:16
i0 v[154:155],v74 offset:1040
i0 v[156:157],v75 offset:16
i0 v[158:159],v75 offset:1040
i8 lgkmcnt(0)
i8 vmcnt(10)
s_barrier
i5 m0,159744
i5 s22,1966080
i1 v78,s[68:71],s22 offen lds
i5 m0,160768
i5 s22,1998848
i1 v78,s[68:71],s22 offen lds
i5 m0,161792
i5 s22,2031616
i1 v78,s[68:71],s22 offen lds
i5 m0,162816
i5 s22,2064384
i1 v78,s[68:71],s22 offen lds
i0 v[240:241],v68 offset:24576
i0 v[242:243],v68 offset:25600
i0 v[244:245],v69 offset:24576
i0 v[246:247],v69 offset:25600
i0 v[248:249],v68 offset:24608
i0 v[250:251],v68 offset:25632
i0 v[252:253],v69 offset:24608
i0 v[254:255],v69 offset:25632
i8 lgkmcnt(0)
i8 vmcnt(8)
s_barrier
i5 m0,135168
i5 s22,4587520
i1 v78,s[68:71],s22 offen lds
i5 m0,136192
i5 s22,4620288
i1 v78,s[68:71],s22 offen lds
i5 m0,137216
i5 s22,4653056
i1 v78,s[68:71],s22 offen lds
i5 m0,138240
i5 s22,4685824
i1 v78,s[68:71],s22 offen lds
i0 a[0:1],v68 offset:28672
i0 a[2:3],v68 offset:29696
i0 a[4:5],v69 offset:28672
i0 a[6:7],v69 offset:29696
i0 a[8:9],v68 offset:28704
i0 a[10:11],v68 offset:29728
i0 a[12:13],v69 offset:28704
i0 a[14:15],v69 offset:29728
i8 lgkmcnt(0)
i8 vmcnt(8)
s_barrier
i5 m0,139264
i5 s22,55552
i1 v77,s[72:75],s22 offen lds
i5 m0,140288
i5 s22,60160
i1 v77,s[72:75],s22 offen lds
i5 m0,141312
i5 s22,64768
i1 v77,s[72:75],s22 offen lds
i5 m0,142336
i5 s22,69376
i1 v77,s[72:75],s22 offen lds
i0 a[16:17],v68 offset:32768
i0 a[18:19],v68 offset:33792
i0 a[20:21],v69 offset:32768
i0 a[22:23],v69 offset:33792
i0 a[24:25],v68 offset:32800
i0 a[26:27],v68 offset:33824
i0 a[28:29],v69 offset:32800
i0 a[30:31],v69 offset:33824
i8 lgkmcnt(0)
i8 vmcnt(8)
s_barrier
i5 m0,143360
i5 s22,55808
i1 v77,s[72:75],s22 offen lds
i5 m0,144384
i5 s22,60416
i1 v77,s[72:75],s22 offen lds
i5 m0,145408
i5 s22,65024
i1 v77,s[72:75],s22 offen lds
i5 m0,146432
i5 s22,69632
i1 v77,s[72:75],s22 offen lds
i0 v[224:225],v70 offset:0
i0 v[226:227],v70 offset:1024
i0 v[228:229],v71 offset:0
i0 v[230:231],v71 offset:1024
i0 v[232:233],v70 offset:32
i0 v[234:235],v70 offset:1056
i0 v[236:237],v71 offset:32
i0 v[238:239],v71 offset:1056
i8 lgkmcnt(0)
i8 vmcnt(8)
s_barrier
i5 m0,159744
i5 s22,129536
i1 v77,s[72:75],s22 offen lds
i5 m0,160768
i5 s22,134144
i1 v77,s[72:75],s22 offen lds
i5 m0,161792
i5 s22,138752
i1 v77,s[72:75],s22 offen lds
i5 m0,162816
i5 s22,143360
i1 v77,s[72:75],s22 offen lds
i0 a[32:33],v68 offset:24576
i0 a[34:35],v68 offset:25600
i0 a[36:37],v69 offset:24576
i0 a[38:39],v69 offset:25600
i0 a[40:41],v68 offset:24608
i0 a[42:43],v68 offset:25632
i0 a[44:45],v69 offset:24608
i0 a[46:47],v69 offset:25632
i8 lgkmcnt(0)
i8 vmcnt(8)
s_barrier
i5 m0,135168
i5 s22,56064
i1 v77,s[72:75],s22 offen lds
i5 m0,136192
i5 s22,60672
i1 v77,s[72:75],s22 offen lds
i5 m0,137216
i5 s22,65280
i1 v77,s[72:75],s22 offen lds
i5 m0,138240
i5 s22,69888
i1 v77,s[72:75],s22 offen lds
i0 a[80:81],v64 offset:28672
i0 a[82:83],v64 offset:29184
i0 a[84:85],v64 offset:30720
i0 a[86:87],v64 offset:31232
i0 a[88:89],v65 offset:28672
i0 a[90:91],v65 offset:29184
i0 a[92:93],v65 offset:30720
i0 a[94:95],v65 offset:31232
i8 lgkmcnt(0)
i8 vmcnt(8)
s_barrier
i5 m0,139264
i5 s22,129792
i1 v77,s[72:75],s22 offen lds
i5 m0,140288
i5 s22,134400
i1 v77,s[72:75],s22 offen lds
i5 m0,141312
i5 s22,139008
i1 v77,s[72:75],s22 offen lds
i5 m0,142336
i5 s22,143616
i1 v77,s[72:75],s22 offen lds
i0 a[96:97],v64 offset:32768
i0 a[98:99],v64 offset:33280
i0 a[100:101],v64 offset:34816
i0 a[102:103],v64 offset:35328
i0 a[104:105],v65 offset:32768
i0 a[106:107],v65 offset:33280
i0 a[108:109],v65 offset:34816
i0 a[110:111],v65 offset:35328
i8 lgkmcnt(0)
i8 vmcnt(8)
s_barrier
i0 a[112:113],v66 offset:0
i0 a[114:115],v66 offset:512
i0 a[116:117],v66 offset:2048
i0 a[118:119],v66 offset:2560
i0 a[120:121],v67 offset:0
i0 a[122:123],v67 offset:512
i0 a[124:125],v67 offset:2048
i0 a[126:127],v67 offset:2560
i8 lgkmcnt(0)
i8 vmcnt(4)
s_barrier
i0 a[128:129],v64 offset:24576
i0 a[130:131],v64 offset:25088
i0 a[132:133],v64 offset:26624
i0 a[134:135],v64 offset:27136
i0 a[136:137],v65 offset:24576
i0 a[138:139],v65 offset:25088
i0 a[140:141],v65 offset:26624
i0 a[142:143],v65 offset:27136
i8 lgkmcnt(0)
i8 vmcnt(0)
s_barrier
i5 m0,135168
i5 s22,55296
i1 v77,s[72:75],s22 offen lds
i5 m0,136192
i5 s22,59904
i1 v77,s[72:75],s22 offen lds
i5 m0,137216
i5 s22,64512
i1 v77,s[72:75],s22 offen lds
i5 m0,138240
i5 s22,69120
i1 v77,s[72:75],s22 offen lds
i0 a[144:145],v64 offset:28672
i0 a[146:147],v64 offset:29184
i0 a[148:149],v64 offset:30720
i0 a[150:151],v64 offset:31232
i0 a[152:153],v65 offset:28672
i0 a[154:155],v65 offset:29184
i0 a[156:157],v65 offset:30720
i0 a[158:159],v65 offset:31232
i8 lgkmcnt(0)
i8 vmcnt(0)
s_barrier
i5 m0,139264
i5 s22,129280
i1 v77,s[72:75],s22 offen lds
i5 m0,140288
i5 s22,133888
i1 v77,s[72:75],s22 offen lds
i5 m0,141312
i5 s22,138496
i1 v77,s[72:75],s22 offen lds
i5 m0,142336
i5 s22,143104
i1 v77,s[72:75],s22 offen lds
i5 m0,143360
i5 s22,111616
i1 v76,s[72:75],s22 offen lds
i5 m0,144384
i5 s22,120832
i1 v76,s[72:75],s22 offen lds
i5 m0,145408
i5 s22,130048
i1 v76,s[72:75],s22 offen lds
i5 m0,146432
i5 s22,139264
i1 v76,s[72:75],s22 offen lds
i0 v[40:41],v64 offset:24576
i0 v[42:43],v64 offset:25088
i0 v[44:45],v64 offset:26624
i0 v[46:47],v64 offset:27136
i0 v[48:49],v65 offset:24576
i0 v[50:51],v65 offset:25088
i0 v[52:53],v65 offset:26624
i0 v[54:55],v65 offset:27136
i8 lgkmcnt(0)
s_barrier
i21 v4,v[40:43] offset:24576
i21 v4,v[44:47] offset:25600
i21 v4,v[48:51] offset:26624
i21 v4,v[52:55] offset:27648
i8 lgkmcnt(0)
i8 vmcnt(4)
s_barrier
i0 v[40:41],v64 offset:28672
i0 v[42:43],v64 offset:29184
i0 v[44:45],v64 offset:30720
i0 v[46:47],v64 offset:31232
i0 v[48:49],v65 offset:28672
i0 v[50:51],v65 offset:29184
i0 v[52:53],v65 offset:30720
i0 v[54:55],v65 offset:31232
i8 lgkmcnt(0)
s_barrier
i21 v4,v[40:43] offset:28672
i21 v4,v[44:47] offset:29696
i21 v4,v[48:51] offset:30720
i21 v4,v[52:55] offset:31744
i8 lgkmcnt(0)
i8 vmcnt(0)
s_barrier
i0 v[40:41],v60 offset:32768
i0 v[42:43],v60 offset:33024
i0 v[44:45],v60 offset:33792
i0 v[46:47],v60 offset:34048
i0 v[48:49],v61 offset:32768
i0 v[50:51],v61 offset:33024
i0 v[52:53],v61 offset:33792
i0 v[54:55],v61 offset:34048
i8 lgkmcnt(0)
s_barrier
i21 v4,v[40:43] offset:32768
i21 v4,v[44:47] offset:33792
i21 v4,v[48:51] offset:34816
i21 v4,v[52:55] offset:35840
i8 lgkmcnt(0)
i8 vmcnt(0)
s_barrier
s_barrier
i11 v44,147456
i9 v[40:43],v44
i8 lgkmcnt(0)
i37 s99,v40
i37 s98,v41
i37 s20,v42
i37 s92,v43
s_barrier
i46 s92,0
i22 L_role2
i47 s99,2
i22 L_cs3
i11 v16,v58
i11 v25,v57
i11 v23,0x80000000
i11 v22,0
i11 v5,64
i39 s[72:73],s[100:101]
i54 s74,256
i5 s75,0x20000
i54 s4,64
i6 s5,s38,262144
i5 s35,70257664
i5 s36,70262784
i5 s37,70261760
i18 v56,0x1f0,v0
i31 v56,2,v56
i23 v57,9,v0
i24 v56,v57,24,v56
i36 v56,v56,s[8:11],s38 offen sc1
i14 v[28:29],0
i14 v[30:31],0
i14 v[32:33],0
i14 v[34:35],0
i14 v[44:45],0
i14 v[46:47],0
i14 v[48:49],0
i14 v[50:51],0
i8 lgkmcnt(0)
Lc3f_top:
i1 v[52:55],v16,s[8:11],s35 offen sc1
i9 v[64:67],v4 offset:6144
i9 v[68:71],v4 offset:7168
i9 v[72:75],v4 offset:0
i9 v[76:79],v4 offset:1024
i14 v[36:37],0
i14 v[38:39],0
i14 v[40:41],0
i14 v[42:43],0
i11 v0,v0
i15 2
i11 v0,v0
i15 2
i11 v0,v0
i15 2
i11 v0,v0
i15 2
i1 v[52:55],v16,s[8:11],s35 offen sc1
i11 v0,v0
i15 2
i11 v0,v0
i15 2
i11 v0,v0
i15 2
i11 v0,v0
i15 2
i11 v0,v0
i15 2
Lc3f_pb:
i8 vmcnt(1)
i48 v17,v52,v53,v54
v_max_u32 v17, v17, v55
i25 vcc,-1,v17
i11 v0,v0
i11 v0,v0
i11 v0,v0
i11 v0,v0
i11 v0,v0
i49 Lc3f_pb2
Lc3f_go:
i4 v[28:31],v[52:55],v[80:87],v1
i21 v6,v[52:55] offset:3072
i5 s52,s34
i4 v[32:35],v[52:55],v[88:95],v1
i1 v[60:63],v16,s[8:11],s37 offen sc1
s_xor_b32 s78, s78, 524288
s_bfe_i32 s76, s25, 0x10001
i4 v[36:39],v[52:55],a[160:167],v1
i8 lgkmcnt(1)
i1 v[24:27],v16,s[8:11],s36 offen sc1
v_subrev_u32 v22, 64, v5
i4 v[40:43],v[52:55],v[64:71],v1
i6 s34,s41,s47
i6 s47,s47,16384
v_ashrrev_i32 v22, 31, v22
i4 v[44:47],v[52:55],v[224:231],v1
s_and_b32 s47, s47, 65535
i54 s24,1040
i6 s33,s41,s47
i4 v[48:51],v[52:55],v[232:239],v1
i8 lgkmcnt(0)
s_barrier
i9 v[56:59],v6 offset:0
i9 v[8:11],v6 offset:1024
i1 v[18:21],v0,s[8:11],s39 offen sc1
i8 lgkmcnt(1)
i4 v[28:31],v[56:59],v[96:103],v1
i9 v[64:67],v4 offset:2048
i6 s35,s47,70257664
i4 v[32:35],v[56:59],v[104:111],v1
i9 v[68:71],v4 offset:3072
i6 s28,s79,s78
i4 v[36:39],v[56:59],a[168:175],v1
i9 v[12:15],v6 offset:2048
i6 s26,s28,1536
i4 v[40:43],v[56:59],v[72:79],v1
i9 v[72:75],v4 offset:4096
i8 lgkmcnt(4)
i4 v[44:47],v[56:59],v[240:247],v1
i9 v[76:79],v4 offset:5120
i18 v5,0xf0,v0
i4 v[28:31],v[8:11],v[112:119],v1
i6 s27,s28,5632
i6 s28,s28,8960
i31 v5,3,v5
i4 v[32:35],v[8:11],v[120:127],v1
i34 v17,v0,8,1
i4 v[36:39],v[8:11],a[176:183],v1
i8 lgkmcnt(2)
i24 v5,v17,24,v5
i4 v[40:43],v[8:11],v[64:71],v1
i8 vmcnt(1)
i48 v17,v60,v61,v62
i4 v[28:31],v[12:15],v[128:135],v1
i9 v[64:67],v4 offset:16384
i48 v17,v17,v24,v25
i4 v[32:35],v[12:15],v[136:143],v1
i9 v[68:71],v4 offset:17408
i48 v17,v17,v26,v27
i4 v[36:39],v[12:15],a[184:191],v1
i8 lgkmcnt(2)
i48 v17,v17,v63,v22
i4 v[40:43],v[12:15],v[72:79],v1
i25 vcc,-1,v17
i4 v[48:51],v[56:59],v[248:255],v1
i49 Lc3f_lp
Lc3f_lok:
i4 v[28:31],v[24:27],v[144:151],v1
i21 v6,v[60:63] offset:7168
i4 v[32:35],v[24:27],v[152:159],v1
i1 v[8:11],v0,s[8:11],s38 offen sc1
i4 v[36:39],v[24:27],a[192:199],v1
i8 lgkmcnt(1)
i4 v[40:43],v[24:27],v[64:71],v1
i9 v[72:75],v4 offset:14336
i4 v[44:47],v[24:27],a[32:39],v1
i9 v[76:79],v4 offset:15360
i1 v[12:15],v0,s[8:11],s38 offen offset:1024 sc1
i4 v[48:51],v[24:27],a[40:47],v1
i1 v[24:27],v0,s[8:11],s39 offen offset:1024 sc1
i8 lgkmcnt(2)
s_barrier
i9 v[56:59],v6 offset:4096
i4 v[44:47],v[60:63],a[48:55],v1
i36 v5,v5,s[8:11],s5 offen sc1
i6 s38,s38,262144
i18 v16,0x70,v0
i4 v[48:51],v[60:63],a[56:63],v1
i9 v[52:55],v6 offset:6144
i31 v16,1,v16
i4 v[28:31],v[60:63],v[160:167],v1
i9 v[64:67],v4 offset:8192
i23 v17,8,v0
i4 v[32:35],v[60:63],v[168:175],v1
i9 v[68:71],v4 offset:9216
i45 v17,v17,s24,v16
i4 v[36:39],v[60:63],a[200:207],v1
i8 vmcnt(4)
i8 lgkmcnt(4)
i20 v17,155648,v17
i4 v[40:43],v[60:63],v[72:79],v1
i9 v[60:63],v6 offset:5120
i8 lgkmcnt(4)
i4 v[28:31],v[56:59],v[176:183],v1
i9 v[72:75],v4 offset:10240
i18 v16,0x80,v0
i4 v[32:35],v[56:59],v[184:191],v1
i9 v[76:79],v4 offset:11264
i17 v16,v16,1,v17
i4 v[36:39],v[56:59],a[208:215],v1
i8 lgkmcnt(3)
i6 s37,s47,70261760
i6 s36,s47,70262784
i4 v[40:43],v[56:59],v[64:71],v1
i9 v[64:67],v4 offset:12288
i8 lgkmcnt(3)
i4 v[28:31],v[60:63],v[192:199],v1
i9 v[68:71],v4 offset:13312
i6 s39,s39,262144
i4 v[32:35],v[60:63],v[200:207],v1
i36 v5,off,s[72:75],s4 sc1
i6 s5,s5,262144
i4 v[36:39],v[60:63],a[216:223],v1
i8 lgkmcnt(2)
i4 v[40:43],v[60:63],v[72:79],v1
i9 v[72:75],v4 offset:18432
i4 v[28:31],v[52:55],v[208:215],v1
i9 v[76:79],v4 offset:19456
i4 v[32:35],v[52:55],v[216:223],v1
i4 v[36:39],v[52:55],a[224:231],v1
i8 lgkmcnt(2)
i4 v[40:43],v[52:55],v[64:71],v1
i9 v[64:67],v4 offset:20480
i3 v28,v28,v29
i3 v29,v30,v31
i3 v30,v32,v33
i3 v31,v34,v35
i3 v36,v36,v37
i3 v37,v38,v39
i27 v[32:35],v[28:29],v[2:3],0
i3 v38,v40,v41
i3 v39,v42,v43
i27 v[40:43],v[30:31],v[2:3],0
i9 v[68:71],v4 offset:21504
i8 vmcnt(3)
i27 v[28:31],v[36:37],v[2:3],0
i3 v32,v32,v33
i3 v33,v34,v35
i27 v[56:59],v[38:39],v[2:3],0
i3 v34,v40,v41
i3 v35,v42,v43
i11 v0,v0
i11 v0,v0
i2 v[40:43],v[8:11],v[32:35],0
i9 v[8:11],v6 offset:1024
i3 v28,v28,v29
i3 v29,v30,v31
i2 v[36:39],v[12:15],v[32:35],0
i9 v[12:15],v6 offset:2048
i3 v30,v56,v57
i3 v31,v58,v59
i11 v0,v0
i11 v0,v0
i2 v[56:59],v[28:31],v[32:35],0
i8 lgkmcnt(2)
i3 v40,v40,v41
i3 v41,v42,v43
i3 v36,v36,v37
i3 v37,v38,v39
i4 v[44:47],v[52:55],a[232:239],v1
ds_write_b64 v7, v[40:41] offset:0
ds_write_b64 v7, v[36:37] offset:256
i3 v56,v56,v57
i3 v57,v58,v59
i4 v[48:51],v[52:55],v[64:71],v1
ds_write_b64 v7, v[56:57] offset:512
i4 v[48:51],v[60:63],v[72:79],v1
i9 v[28:31],v6 offset:13312
i4 v[44:47],v[60:63],a[240:247],v1
i9 v[60:63],v6 offset:4096
i8 lgkmcnt(5)
i4 v[44:47],v[12:15],a[16:23],v1
i9 v[32:35],v6 offset:15360
i4 v[48:51],v[12:15],a[24:31],v1
i8 lgkmcnt(3)
s_barrier
i9 v[12:15],v16
i4 v[44:47],v[8:11],a[0:7],v1
i9 v[40:43],v16 offset:16
i6 s4,s25,3
i4 v[48:51],v[8:11],a[8:15],v1
i9 v[36:39],v17 offset:512
i8 lgkmcnt(4)
i4 v[44:47],v[60:63],a[64:71],v1
i9 v[64:67],v4 offset:24576
i14 v[52:53],0
i4 v[48:51],v[60:63],a[72:79],v1
i9 v[68:71],v4 offset:25600
i8 lgkmcnt(3)
i2 v[8:11],v[28:31],v[12:15],0
i9 v[72:75],v4 offset:26624
i2 v[8:11],v[32:35],v[40:43],v[8:11]
i8 lgkmcnt(3)
i3 v16,v44,v45
i2 v[56:59],v[28:31],v[36:39],0
i3 v17,v46,v47
i3 v22,v48,v49
i2 v[56:59],v[32:35],v[36:39],v[56:59]
i9 v[76:79],v4 offset:27648
i19 v12,v8
i19 v13,v9
i19 v14,v10
i19 v15,v11
i3 v23,v50,v51
i3 v50,v12,v13
i3 v51,v14,v15
i16 v[56:57],v[56:57],s[42:43]
i16 v[58:59],v[58:59],s[42:43]
i19 v40,v56
i8 vmcnt(2)
i2 v[32:35],v[20:23],v[50:53],0
i9 v[60:63],v6 offset:14336
i19 v41,v57
i2 v[12:15],v[26:29],v[50:53],0
i19 v42,v58
i19 v43,v59
i3 v48,v40,v41
i3 v49,v42,v43
i14 v[36:37],s[48:49]
i14 v[38:39],s[50:51]
i2 v[28:31],v[16:19],v[48:51],0
i11 v0,v0
i2 v[40:43],v[36:39],v[48:51],0
i2 v[44:47],v[22:25],v[48:51],0
i8 lgkmcnt(0)
i29 v28,v32,v28 row_ror:8 row_mask:0xf bank_mask:0x3
i29 v29,v33,v29 row_ror:8 row_mask:0xf bank_mask:0x3
i29 v30,v34,v30 row_ror:8 row_mask:0xf bank_mask:0x3
i29 v31,v35,v31 row_ror:8 row_mask:0xf bank_mask:0x3
i29 v40,v40,v40 row_ror:8 row_mask:0xf bank_mask:0xf
v_rcp_f32 v42, v40
v_cmp_nlt_f32 vcc, s54, v40
v_cmp_ngt_f32 s[22:23], s55, v40
i29 v28,v44,v12 row_ror:8 row_mask:0xf bank_mask:0xc
i29 v29,v45,v13 row_ror:8 row_mask:0xf bank_mask:0xc
i29 v30,v46,v14 row_ror:8 row_mask:0xf bank_mask:0xc
i29 v31,v47,v15 row_ror:8 row_mask:0xf bank_mask:0xc
i16 v[28:29],v[28:29],v[42:43] op_sel_hi:[1,0]
i16 v[30:31],v[30:31],v[42:43] op_sel_hi:[1,0]
i3 v28,v28,v29
i3 v29,v30,v31
ds_write_b64 v60, v[28:29] offset:1536
i14 v[40:41],0
i14 v[42:43],0
i14 v[12:13],0
i14 v[14:15],0
i14 v[36:37],0
i14 v[38:39],0
i53 vcc,vcc,s[22:23]
i22 Lc3f_slow
Lc3f_cont:
i14 v[56:57],0
i14 v[58:59],0
i14 v[8:9],0
i14 v[10:11],0
i8 lgkmcnt(0)
s_barrier
i9 v[28:31],v61 offset:0
i9 v[32:35],v61 offset:512
i9 v[44:47],v61 offset:1024
i9 v[48:51],v61 offset:1536
i9 v[16:19],v4 offset:22528
i9 v[20:23],v4 offset:23552
i8 lgkmcnt(5)
i4 v[56:59],v[28:31],v[64:71],v1
i9 v[64:67],v4 offset:28672
i8 lgkmcnt(5)
i4 v[56:59],v[32:35],v[72:79],v1
i9 v[68:71],v4 offset:29696
i8 lgkmcnt(5)
i4 v[56:59],v[44:47],a[248:255],v1
i9 v[72:75],v4 offset:30720
i8 lgkmcnt(3)
i4 v[56:59],v[48:51],v[16:23],v1
i9 v[76:79],v4 offset:31744
i9 v[16:19],v62 offset:0
i4 v[36:39],v[28:31],a[80:87],v1
i9 v[20:23],v62 offset:1024
i23 v26,9,v0
i4 v[36:39],v[32:35],a[88:95],v1
i8 lgkmcnt(4)
s_lshr_b32 s4, s4, 3
i3 v56,v56,v57
i4 v[36:39],v[44:47],v[64:71],v1
i8 lgkmcnt(2)
s_min_u32 s4, s4, 7
i3 v57,v58,v59
i4 v[36:39],v[48:51],v[72:79],v1
i9 v[64:67],v4 offset:32768
v_bfi_b32 v56, 1, s76, v56
i4 v[8:11],v[28:31],a[96:103],v1
i41 v[56:57],v63,s[8:11],s26 offen offset:0
i32 s4,s4,2
i4 v[8:11],v[32:35],a[104:111],v1
i9 v[68:71],v4 offset:33792
i3 v36,v36,v37
i4 v[8:11],v[44:47],a[112:119],v1
i9 v[72:75],v4 offset:34816
i3 v37,v38,v39
i4 v[8:11],v[48:51],a[120:127],v1
i9 v[76:79],v4 offset:35840
v_bfi_b32 v36, 1, s76, v36
i4 v[12:15],v[28:31],a[128:135],v1
i41 v[36:37],v63,s[8:11],s26 offen offset:2048
i6 s4,s4,64
i4 v[12:15],v[32:35],a[136:143],v1
i8 lgkmcnt(2)
i3 v8,v8,v9
i4 v[40:43],v[16:19],v[64:71],v1
i8 lgkmcnt(0)
i3 v9,v10,v11
i4 v[40:43],v[20:23],v[72:79],v1
v_bfi_b32 v8, 1, s76, v8
i4 v[12:15],v[44:47],a[144:151],v1
i41 v[8:9],v63,s[8:11],s27 offen offset:0
i4 v[12:15],v[48:51],a[152:159],v1
i40 v40,v42
i40 v41,v43
v_add_f32 v40, v40, v42
v_add_f32 v41, v41, v43
i3 v40,v40,v41
i18 v27,0xff,v63
v_bfi_b32 v40, 1, s76, v40
i24 v27,v26,2,v27
i3 v12,v12,v13
i3 v13,v14,v15
v_bfi_b32 v12, 1, s76, v12
i41 v[12:13],v63,s[8:11],s27 offen offset:2048
i52 v40,v27,s[8:11],s28 offen
i14 v[28:29],0
i14 v[30:31],0
i14 v[32:33],0
i14 v[34:35],0
i14 v[44:45],0
i14 v[46:47],0
i14 v[48:49],0
i14 v[50:51],0
i24 v25,v26,2,v25
i34 v17,v0,8,1
i24 v25,v17,3,v25
i34 v17,v0,7,1
i24 v25,v17,31,v25
i18 v16,0x33f,v0
i24 v16,v17,6,v16
i34 v17,v0,6,1
i24 v16,v17,7,v16
i11 v0,v0
i15 2
i11 v0,v0
i15 2
i11 v0,v0
i15 2
i11 v0,v0
i15 2
i11 v0,v0
i15 2
i11 v0,v0
i15 2
i11 v0,v0
i15 2
i11 v0,v0
i15 2
i11 v0,v0
i15 2
i11 v0,v0
i15 2
i11 v0,v0
i15 2
i11 v0,v0
i15 2
i11 v0,v0
i15 2
i11 v0,v0
i15 2
i11 v0,v0
i15 2
i11 v0,v0
i15 2
i11 v0,v0
i15 2
i11 v0,v0
i15 2
i11 v0,v0
i15 2
i11 v0,v0
i15 2
i11 v0,v0
i15 2
i11 v0,v0
i15 2
i11 v0,v0
i15 2
i11 v0,v0
i15 2
i11 v0,v0
i15 2
i11 v0,v0
i15 2
i11 v0,v0
i15 2
i11 v0,v0
i15 2
i11 v0,v0
i15 2
i11 v0,v0
i15 2
i11 v0,v0
i15 2
i11 v0,v0
i15 2
i11 v0,v0
i15 2
i11 v0,v0
i15 2
i11 v0,v0
i15 2
i11 v0,v0
i15 2
i11 v0,v0
i15 2
i11 v0,v0
i15 2
i11 v0,v0
i15 2
i11 v0,v0
i15 2
i11 v0,v0
i15 2
i11 v0,v0
i15 2
i11 v0,v0
i15 2
i11 v0,v0
i15 2
i11 v0,v0
i15 2
i11 v0,v0
i15 2
i11 v0,v0
i15 2
i11 v0,v0
i15 2
i11 v0,v0
i15 2
i11 v0,v0
i15 2
Lc3f_tail:
i6 s25,s25,1
s_cmp_lt_u32 s25, 63
i22 Lc3f_top
i44 Lc3f_out
Lc3f_pb2:
i53 exec,vcc,1
i1 v[52:55],v16,s[8:11],s35 offen sc1
i39 exec,-1
i6 s46,s46,1
i35 s46,400000
i22 L_endc
i11 v0,v0
i15 2
i11 v0,v0
i15 2
i11 v0,v0
i15 2
i11 v0,v0
i15 2
i44 Lc3f_pb
Lc3f_lp:
i53 exec,vcc,1
i1 v[60:63],v16,s[8:11],s37 offen sc1
i1 v[24:27],v16,s[8:11],s36 offen sc1
i39 exec,-1
i36 v23,off,s[72:75],s4 sc1
i11 v0,v0
i15 2
i11 v0,v0
i15 2
i11 v0,v0
i15 2
i11 v0,v0
i15 2
i11 v0,v0
i15 2
Lc3f_lp2:
i53 exec,vcc,1
i1 v[60:63],v16,s[8:11],s37 offen sc1
i1 v[24:27],v16,s[8:11],s36 offen sc1
i39 exec,-1
i36 v23,off,s[72:75],s4 sc1
i6 s46,s46,1
i35 s46,400000
i22 L_endc
i11 v0,v0
i15 2
i11 v0,v0
i15 2
i8 vmcnt(3)
v_subrev_u32 v22, 64, v23
v_ashrrev_i32 v22, 31, v22
i48 v17,v60,v61,v62
i48 v17,v17,v24,v25
i48 v17,v17,v26,v27
i48 v17,v17,v63,v22
i25 vcc,-1,v17
i49 Lc3f_lp2
i44 Lc3f_lok
Lc3f_slow:
i38 v28,v8,v9,v10
i38 v29,v11,v56,v57
i38 v28,v28,v58,v59
v_max_f32 v28, v28, v29
i11 v0,v0
i11 v0,v0
v_max_f32_dpp v28, v28, v28 row_ror:8 row_mask:0xf bank_mask:0xf
i11 v29,v28
i11 v0,v0
i11 v0,v0
v_permlane16_swap_b32 v28, v29
v_max_f32 v28, v28, v29
i11 v29,v28
i11 v0,v0
i11 v0,v0
i40 v28,v29
v_max_f32 v28, v28, v29
i33 v8,v8,v28
i19 v8,v8
i33 v9,v9,v28
i19 v9,v9
i33 v10,v10,v28
i19 v10,v10
i33 v11,v11,v28
i19 v11,v11
i33 v56,v56,v28
i19 v56,v56
i33 v57,v57,v28
i19 v57,v57
i33 v58,v58,v28
i19 v58,v58
i33 v59,v59,v28
i19 v59,v59
i3 v48,v56,v57
i3 v49,v58,v59
i3 v50,v8,v9
i3 v51,v10,v11
i14 v[28:29],0
i14 v[36:37],s[48:49]
i14 v[38:39],s[50:51]
i2 v[32:35],v[20:23],v[50:53],0
i2 v[12:15],v[26:29],v[50:53],0
i2 v[28:31],v[16:19],v[48:51],0
i2 v[40:43],v[36:39],v[48:51],0
i2 v[44:47],v[22:25],v[48:51],0
i29 v28,v32,v28 row_ror:8 row_mask:0xf bank_mask:0x3
i29 v29,v33,v29 row_ror:8 row_mask:0xf bank_mask:0x3
i29 v30,v34,v30 row_ror:8 row_mask:0xf bank_mask:0x3
i29 v31,v35,v31 row_ror:8 row_mask:0xf bank_mask:0x3
i29 v40,v40,v40 row_ror:8 row_mask:0xf bank_mask:0xf
v_rcp_f32 v42, v40
v_cmp_nlt_f32 vcc, s54, v40
v_cmp_ngt_f32 s[22:23], s55, v40
i29 v28,v44,v12 row_ror:8 row_mask:0xf bank_mask:0xc
i29 v29,v45,v13 row_ror:8 row_mask:0xf bank_mask:0xc
i29 v30,v46,v14 row_ror:8 row_mask:0xf bank_mask:0xc
i29 v31,v47,v15 row_ror:8 row_mask:0xf bank_mask:0xc
i16 v[28:29],v[28:29],v[42:43] op_sel_hi:[1,0]
i16 v[30:31],v[30:31],v[42:43] op_sel_hi:[1,0]
i3 v28,v28,v29
i3 v29,v30,v31
ds_write_b64 v60, v[28:29] offset:1536
i14 v[40:41],0
i14 v[42:43],0
i14 v[12:13],0
i14 v[14:15],0
i14 v[36:37],0
i14 v[38:39],0
i44 Lc3f_cont
Lc3f_out:
i8 vmcnt(0)
i44 L_endc
L_cs3:
i11 v16,v58
i11 v25,v57
i11 v23,0x80000000
i11 v22,0
i11 v5,64
i39 s[72:73],s[100:101]
i54 s74,256
i5 s75,0x20000
i54 s4,64
i6 s5,s38,262144
i5 s35,70257664
i5 s36,70262784
i5 s37,70261760
i18 v56,0x1f0,v0
i31 v56,2,v56
i23 v57,9,v0
i24 v56,v57,24,v56
i36 v56,v56,s[8:11],s38 offen sc1
i14 v[28:29],0
i14 v[30:31],0
i14 v[32:33],0
i14 v[34:35],0
i14 v[44:45],0
i14 v[46:47],0
i14 v[48:49],0
i14 v[50:51],0
i8 lgkmcnt(0)
Lc3s_top:
i1 v[52:55],v16,s[8:11],s35 offen sc1
i9 v[64:67],v4 offset:6144
i9 v[68:71],v4 offset:7168
i9 v[72:75],v4 offset:0
i9 v[76:79],v4 offset:1024
i14 v[36:37],0
i14 v[38:39],0
i14 v[40:41],0
i14 v[42:43],0
i11 v0,v0
i15 2
i11 v0,v0
i15 2
i11 v0,v0
i15 2
i11 v0,v0
i15 2
i1 v[52:55],v16,s[8:11],s35 offen sc1
i11 v0,v0
i15 2
i11 v0,v0
i15 2
i11 v0,v0
i15 2
i11 v0,v0
i15 2
i11 v0,v0
i15 2
Lc3s_pb:
i8 vmcnt(1)
i48 v17,v52,v53,v54
v_max_u32 v17, v17, v55
i25 vcc,-1,v17
i11 v0,v0
i11 v0,v0
i11 v0,v0
i11 v0,v0
i11 v0,v0
i49 Lc3s_pb2
Lc3s_go:
i4 v[28:31],v[52:55],v[80:87],v1
i21 v6,v[52:55] offset:3072
i5 s52,s34
i4 v[32:35],v[52:55],v[88:95],v1
i1 v[60:63],v16,s[8:11],s37 offen sc1
s_xor_b32 s78, s78, 524288
s_bfe_i32 s76, s25, 0x10001
i4 v[36:39],v[52:55],a[160:167],v1
i8 lgkmcnt(1)
i1 v[24:27],v16,s[8:11],s36 offen sc1
v_subrev_u32 v22, 64, v5
i4 v[40:43],v[52:55],v[64:71],v1
i6 s34,s41,s47
i6 s47,s47,16384
v_ashrrev_i32 v22, 31, v22
i4 v[44:47],v[52:55],v[224:231],v1
s_and_b32 s47, s47, 65535
i54 s24,1040
i6 s33,s41,s47
i4 v[48:51],v[52:55],v[232:239],v1
i8 lgkmcnt(0)
s_barrier
i9 v[56:59],v6 offset:0
i9 v[8:11],v6 offset:1024
i1 v[18:21],v0,s[8:11],s39 offen sc1
i8 lgkmcnt(1)
i4 v[28:31],v[56:59],v[96:103],v1
i9 v[64:67],v4 offset:2048
i6 s35,s47,70257664
i4 v[32:35],v[56:59],v[104:111],v1
i9 v[68:71],v4 offset:3072
i6 s28,s79,s78
i4 v[36:39],v[56:59],a[168:175],v1
i9 v[12:15],v6 offset:2048
i6 s26,s28,1536
i4 v[40:43],v[56:59],v[72:79],v1
i9 v[72:75],v4 offset:4096
i8 lgkmcnt(4)
i4 v[44:47],v[56:59],v[240:247],v1
i9 v[76:79],v4 offset:5120
i18 v5,0xf0,v0
i4 v[28:31],v[8:11],v[112:119],v1
i6 s27,s28,5632
i6 s28,s28,8960
i31 v5,3,v5
i4 v[32:35],v[8:11],v[120:127],v1
i34 v17,v0,8,1
i4 v[36:39],v[8:11],a[176:183],v1
i8 lgkmcnt(2)
i24 v5,v17,24,v5
i4 v[40:43],v[8:11],v[64:71],v1
i8 vmcnt(1)
i48 v17,v60,v61,v62
i4 v[28:31],v[12:15],v[128:135],v1
i9 v[64:67],v4 offset:16384
i48 v17,v17,v24,v25
i4 v[32:35],v[12:15],v[136:143],v1
i9 v[68:71],v4 offset:17408
i48 v17,v17,v26,v27
i4 v[36:39],v[12:15],a[184:191],v1
i8 lgkmcnt(2)
i48 v17,v17,v63,v22
i4 v[40:43],v[12:15],v[72:79],v1
i25 vcc,-1,v17
i4 v[48:51],v[56:59],v[248:255],v1
i49 Lc3s_lp
Lc3s_lok:
i4 v[28:31],v[24:27],v[144:151],v1
i21 v6,v[60:63] offset:7168
i4 v[32:35],v[24:27],v[152:159],v1
i1 v[8:11],v0,s[8:11],s38 offen sc1
i4 v[36:39],v[24:27],a[192:199],v1
i8 lgkmcnt(1)
i4 v[40:43],v[24:27],v[64:71],v1
i9 v[72:75],v4 offset:14336
i4 v[44:47],v[24:27],a[32:39],v1
i9 v[76:79],v4 offset:15360
i1 v[12:15],v0,s[8:11],s38 offen offset:1024 sc1
i4 v[48:51],v[24:27],a[40:47],v1
i1 v[24:27],v0,s[8:11],s39 offen offset:1024 sc1
i8 lgkmcnt(2)
s_barrier
i9 v[56:59],v6 offset:4096
i4 v[44:47],v[60:63],a[48:55],v1
i36 v5,v5,s[8:11],s5 offen sc1
i6 s38,s38,262144
i18 v16,0x70,v0
i4 v[48:51],v[60:63],a[56:63],v1
i9 v[52:55],v6 offset:6144
i31 v16,1,v16
i4 v[28:31],v[60:63],v[160:167],v1
i9 v[64:67],v4 offset:8192
i23 v17,8,v0
i4 v[32:35],v[60:63],v[168:175],v1
i9 v[68:71],v4 offset:9216
i45 v17,v17,s24,v16
i4 v[36:39],v[60:63],a[200:207],v1
i8 vmcnt(4)
i8 lgkmcnt(4)
i20 v17,155648,v17
i4 v[40:43],v[60:63],v[72:79],v1
i9 v[60:63],v6 offset:5120
i8 lgkmcnt(4)
i4 v[28:31],v[56:59],v[176:183],v1
i9 v[72:75],v4 offset:10240
i18 v16,0x80,v0
i4 v[32:35],v[56:59],v[184:191],v1
i9 v[76:79],v4 offset:11264
i17 v16,v16,1,v17
i4 v[36:39],v[56:59],a[208:215],v1
i8 lgkmcnt(3)
i6 s37,s47,70261760
i6 s36,s47,70262784
i4 v[40:43],v[56:59],v[64:71],v1
i9 v[64:67],v4 offset:12288
i8 lgkmcnt(3)
i4 v[28:31],v[60:63],v[192:199],v1
i9 v[68:71],v4 offset:13312
i6 s39,s39,262144
i4 v[32:35],v[60:63],v[200:207],v1
i36 v5,off,s[72:75],s4 sc1
i6 s5,s5,262144
i4 v[36:39],v[60:63],a[216:223],v1
i8 lgkmcnt(2)
i4 v[40:43],v[60:63],v[72:79],v1
i9 v[72:75],v4 offset:18432
i4 v[28:31],v[52:55],v[208:215],v1
i9 v[76:79],v4 offset:19456
i4 v[32:35],v[52:55],v[216:223],v1
i4 v[36:39],v[52:55],a[224:231],v1
i8 lgkmcnt(2)
i4 v[40:43],v[52:55],v[64:71],v1
i9 v[64:67],v4 offset:20480
i3 v28,v28,v29
i3 v29,v30,v31
i3 v30,v32,v33
i3 v31,v34,v35
i3 v36,v36,v37
i3 v37,v38,v39
i27 v[32:35],v[28:29],v[2:3],0
i3 v38,v40,v41
i3 v39,v42,v43
i27 v[40:43],v[30:31],v[2:3],0
i9 v[68:71],v4 offset:21504
i8 vmcnt(3)
i27 v[28:31],v[36:37],v[2:3],0
i3 v32,v32,v33
i3 v33,v34,v35
i27 v[56:59],v[38:39],v[2:3],0
i3 v34,v40,v41
i3 v35,v42,v43
i11 v0,v0
i11 v0,v0
i2 v[40:43],v[8:11],v[32:35],0
i9 v[8:11],v6 offset:1024
i3 v28,v28,v29
i3 v29,v30,v31
i2 v[36:39],v[12:15],v[32:35],0
i9 v[12:15],v6 offset:2048
i3 v30,v56,v57
i3 v31,v58,v59
i11 v0,v0
i11 v0,v0
i2 v[56:59],v[28:31],v[32:35],0
i8 lgkmcnt(2)
i3 v40,v40,v41
i3 v41,v42,v43
i3 v36,v36,v37
i3 v37,v38,v39
i4 v[44:47],v[52:55],a[232:239],v1
ds_write_b64 v7, v[40:41] offset:0
ds_write_b64 v7, v[36:37] offset:256
i3 v56,v56,v57
i3 v57,v58,v59
i4 v[48:51],v[52:55],v[64:71],v1
ds_write_b64 v7, v[56:57] offset:512
i4 v[48:51],v[60:63],v[72:79],v1
i9 v[28:31],v6 offset:13312
i4 v[44:47],v[60:63],a[240:247],v1
i9 v[60:63],v6 offset:4096
i8 lgkmcnt(5)
i4 v[44:47],v[12:15],a[16:23],v1
i9 v[32:35],v6 offset:15360
i4 v[48:51],v[12:15],a[24:31],v1
i8 lgkmcnt(3)
s_barrier
i9 v[12:15],v16
i4 v[44:47],v[8:11],a[0:7],v1
i9 v[40:43],v16 offset:16
i6 s4,s25,3
i4 v[48:51],v[8:11],a[8:15],v1
i9 v[36:39],v17 offset:512
i8 lgkmcnt(4)
i4 v[44:47],v[60:63],a[64:71],v1
i9 v[64:67],v4 offset:24576
i14 v[52:53],0
i4 v[48:51],v[60:63],a[72:79],v1
i9 v[68:71],v4 offset:25600
i8 lgkmcnt(3)
i2 v[8:11],v[28:31],v[12:15],0
i9 v[72:75],v4 offset:26624
i2 v[8:11],v[32:35],v[40:43],v[8:11]
i8 lgkmcnt(3)
i3 v16,v44,v45
i2 v[56:59],v[28:31],v[36:39],0
i3 v17,v46,v47
i3 v22,v48,v49
i2 v[56:59],v[32:35],v[36:39],v[56:59]
i9 v[76:79],v4 offset:27648
i19 v12,v8
i19 v13,v9
i19 v14,v10
i19 v15,v11
i3 v23,v50,v51
i3 v50,v12,v13
i3 v51,v14,v15
i16 v[56:57],v[56:57],s[42:43]
i16 v[58:59],v[58:59],s[42:43]
i19 v40,v56
i8 vmcnt(2)
i2 v[32:35],v[20:23],v[50:53],0
i9 v[60:63],v6 offset:14336
i19 v41,v57
i2 v[12:15],v[26:29],v[50:53],0
i19 v42,v58
i19 v43,v59
i3 v48,v40,v41
i3 v49,v42,v43
i14 v[36:37],s[48:49]
i14 v[38:39],s[50:51]
i2 v[28:31],v[16:19],v[48:51],0
i11 v0,v0
i2 v[40:43],v[36:39],v[48:51],0
i2 v[44:47],v[22:25],v[48:51],0
i8 lgkmcnt(0)
i29 v28,v32,v28 row_ror:8 row_mask:0xf bank_mask:0x3
i29 v29,v33,v29 row_ror:8 row_mask:0xf bank_mask:0x3
i29 v30,v34,v30 row_ror:8 row_mask:0xf bank_mask:0x3
i29 v31,v35,v31 row_ror:8 row_mask:0xf bank_mask:0x3
i29 v40,v40,v40 row_ror:8 row_mask:0xf bank_mask:0xf
v_rcp_f32 v42, v40
v_cmp_nlt_f32 vcc, s54, v40
v_cmp_ngt_f32 s[22:23], s55, v40
i29 v28,v44,v12 row_ror:8 row_mask:0xf bank_mask:0xc
i29 v29,v45,v13 row_ror:8 row_mask:0xf bank_mask:0xc
i29 v30,v46,v14 row_ror:8 row_mask:0xf bank_mask:0xc
i29 v31,v47,v15 row_ror:8 row_mask:0xf bank_mask:0xc
i16 v[28:29],v[28:29],v[42:43] op_sel_hi:[1,0]
i16 v[30:31],v[30:31],v[42:43] op_sel_hi:[1,0]
i3 v28,v28,v29
i3 v29,v30,v31
ds_write_b64 v60, v[28:29] offset:1536
i14 v[40:41],0
i14 v[42:43],0
i14 v[12:13],0
i14 v[14:15],0
i14 v[36:37],0
i14 v[38:39],0
i53 vcc,vcc,s[22:23]
i22 Lc3s_slow
Lc3s_cont:
i14 v[56:57],0
i14 v[58:59],0
i14 v[8:9],0
i14 v[10:11],0
i8 lgkmcnt(0)
s_barrier
i9 v[28:31],v61 offset:0
i9 v[32:35],v61 offset:512
i9 v[44:47],v61 offset:1024
i9 v[48:51],v61 offset:1536
i9 v[16:19],v4 offset:22528
i9 v[20:23],v4 offset:23552
i8 lgkmcnt(5)
i4 v[56:59],v[28:31],v[64:71],v1
i9 v[64:67],v4 offset:28672
i8 lgkmcnt(5)
i4 v[56:59],v[32:35],v[72:79],v1
i9 v[68:71],v4 offset:29696
i8 lgkmcnt(5)
i4 v[56:59],v[44:47],a[248:255],v1
i9 v[72:75],v4 offset:30720
i8 lgkmcnt(3)
i4 v[56:59],v[48:51],v[16:23],v1
i9 v[76:79],v4 offset:31744
i9 v[16:19],v62 offset:0
i4 v[36:39],v[28:31],a[80:87],v1
i9 v[20:23],v62 offset:1024
i23 v26,9,v0
i4 v[36:39],v[32:35],a[88:95],v1
i8 lgkmcnt(4)
s_lshr_b32 s4, s4, 3
i3 v56,v56,v57
i4 v[36:39],v[44:47],v[64:71],v1
i8 lgkmcnt(2)
s_min_u32 s4, s4, 7
i3 v57,v58,v59
i4 v[36:39],v[48:51],v[72:79],v1
i9 v[64:67],v4 offset:32768
v_bfi_b32 v56, 1, s76, v56
i4 v[8:11],v[28:31],a[96:103],v1
i41 v[56:57],v63,s[8:11],s26 offen offset:0 sc1
i32 s4,s4,2
i4 v[8:11],v[32:35],a[104:111],v1
i9 v[68:71],v4 offset:33792
i3 v36,v36,v37
i4 v[8:11],v[44:47],a[112:119],v1
i9 v[72:75],v4 offset:34816
i3 v37,v38,v39
i4 v[8:11],v[48:51],a[120:127],v1
i9 v[76:79],v4 offset:35840
v_bfi_b32 v36, 1, s76, v36
i4 v[12:15],v[28:31],a[128:135],v1
i41 v[36:37],v63,s[8:11],s26 offen offset:2048 sc1
i6 s4,s4,64
i4 v[12:15],v[32:35],a[136:143],v1
i8 lgkmcnt(2)
i3 v8,v8,v9
i4 v[40:43],v[16:19],v[64:71],v1
i8 lgkmcnt(0)
i3 v9,v10,v11
i4 v[40:43],v[20:23],v[72:79],v1
v_bfi_b32 v8, 1, s76, v8
i4 v[12:15],v[44:47],a[144:151],v1
i41 v[8:9],v63,s[8:11],s27 offen offset:0 sc1
i4 v[12:15],v[48:51],a[152:159],v1
i40 v40,v42
i40 v41,v43
v_add_f32 v40, v40, v42
v_add_f32 v41, v41, v43
i3 v40,v40,v41
i18 v27,0xff,v63
v_bfi_b32 v40, 1, s76, v40
i24 v27,v26,2,v27
i3 v12,v12,v13
i3 v13,v14,v15
v_bfi_b32 v12, 1, s76, v12
i41 v[12:13],v63,s[8:11],s27 offen offset:2048 sc1
i52 v40,v27,s[8:11],s28 offen sc1
i14 v[28:29],0
i14 v[30:31],0
i14 v[32:33],0
i14 v[34:35],0
i14 v[44:45],0
i14 v[46:47],0
i14 v[48:49],0
i14 v[50:51],0
i24 v25,v26,2,v25
i34 v17,v0,8,1
i24 v25,v17,3,v25
i34 v17,v0,7,1
i24 v25,v17,31,v25
i18 v16,0x33f,v0
i24 v16,v17,6,v16
i34 v17,v0,6,1
i24 v16,v17,7,v16
i11 v0,v0
i15 2
i11 v0,v0
i15 2
i11 v0,v0
i15 2
i11 v0,v0
i15 2
i11 v0,v0
i15 2
i11 v0,v0
i15 2
i11 v0,v0
i15 2
i11 v0,v0
i15 2
i11 v0,v0
i15 2
i11 v0,v0
i15 2
i11 v0,v0
i15 2
i11 v0,v0
i15 2
i11 v0,v0
i15 2
i11 v0,v0
i15 2
i11 v0,v0
i15 2
i11 v0,v0
i15 2
i11 v0,v0
i15 2
i11 v0,v0
i15 2
i11 v0,v0
i15 2
i11 v0,v0
i15 2
i11 v0,v0
i15 2
i11 v0,v0
i15 2
i11 v0,v0
i15 2
i11 v0,v0
i15 2
i11 v0,v0
i15 2
i11 v0,v0
i15 2
i11 v0,v0
i15 2
i11 v0,v0
i15 2
i11 v0,v0
i15 2
i11 v0,v0
i15 2
i11 v0,v0
i15 2
i11 v0,v0
i15 2
i11 v0,v0
i15 2
i11 v0,v0
i15 2
i11 v0,v0
i15 2
i11 v0,v0
i15 2
i11 v0,v0
i15 2
i11 v0,v0
i15 2
i11 v0,v0
i15 2
i11 v0,v0
i15 2
i11 v0,v0
i15 2
i11 v0,v0
i15 2
i11 v0,v0
i15 2
i11 v0,v0
i15 2
i11 v0,v0
i15 2
i11 v0,v0
i15 2
i11 v0,v0
i15 2
i11 v0,v0
i15 2
i11 v0,v0
i15 2
i11 v0,v0
i15 2
Lc3s_tail:
i6 s25,s25,1
s_cmp_lt_u32 s25, 63
i22 Lc3s_top
i44 Lc3s_out
Lc3s_pb2:
i53 exec,vcc,1
i1 v[52:55],v16,s[8:11],s35 offen sc1
i39 exec,-1
i6 s46,s46,1
i35 s46,400000
i22 L_endc
i11 v0,v0
i15 2
i11 v0,v0
i15 2
i11 v0,v0
i15 2
i11 v0,v0
i15 2
i44 Lc3s_pb
Lc3s_lp:
i53 exec,vcc,1
i1 v[60:63],v16,s[8:11],s37 offen sc1
i1 v[24:27],v16,s[8:11],s36 offen sc1
i39 exec,-1
i36 v23,off,s[72:75],s4 sc1
i11 v0,v0
i15 2
i11 v0,v0
i15 2
i11 v0,v0
i15 2
i11 v0,v0
i15 2
i11 v0,v0
i15 2
Lc3s_lp2:
i53 exec,vcc,1
i1 v[60:63],v16,s[8:11],s37 offen sc1
i1 v[24:27],v16,s[8:11],s36 offen sc1
i39 exec,-1
i36 v23,off,s[72:75],s4 sc1
i6 s46,s46,1
i35 s46,400000
i22 L_endc
i11 v0,v0
i15 2
i11 v0,v0
i15 2
i8 vmcnt(3)
v_subrev_u32 v22, 64, v23
v_ashrrev_i32 v22, 31, v22
i48 v17,v60,v61,v62
i48 v17,v17,v24,v25
i48 v17,v17,v26,v27
i48 v17,v17,v63,v22
i25 vcc,-1,v17
i49 Lc3s_lp2
i44 Lc3s_lok
Lc3s_slow:
i38 v28,v8,v9,v10
i38 v29,v11,v56,v57
i38 v28,v28,v58,v59
v_max_f32 v28, v28, v29
i11 v0,v0
i11 v0,v0
v_max_f32_dpp v28, v28, v28 row_ror:8 row_mask:0xf bank_mask:0xf
i11 v29,v28
i11 v0,v0
i11 v0,v0
v_permlane16_swap_b32 v28, v29
v_max_f32 v28, v28, v29
i11 v29,v28
i11 v0,v0
i11 v0,v0
i40 v28,v29
v_max_f32 v28, v28, v29
i33 v8,v8,v28
i19 v8,v8
i33 v9,v9,v28
i19 v9,v9
i33 v10,v10,v28
i19 v10,v10
i33 v11,v11,v28
i19 v11,v11
i33 v56,v56,v28
i19 v56,v56
i33 v57,v57,v28
i19 v57,v57
i33 v58,v58,v28
i19 v58,v58
i33 v59,v59,v28
i19 v59,v59
i3 v48,v56,v57
i3 v49,v58,v59
i3 v50,v8,v9
i3 v51,v10,v11
i14 v[28:29],0
i14 v[36:37],s[48:49]
i14 v[38:39],s[50:51]
i2 v[32:35],v[20:23],v[50:53],0
i2 v[12:15],v[26:29],v[50:53],0
i2 v[28:31],v[16:19],v[48:51],0
i2 v[40:43],v[36:39],v[48:51],0
i2 v[44:47],v[22:25],v[48:51],0
i29 v28,v32,v28 row_ror:8 row_mask:0xf bank_mask:0x3
i29 v29,v33,v29 row_ror:8 row_mask:0xf bank_mask:0x3
i29 v30,v34,v30 row_ror:8 row_mask:0xf bank_mask:0x3
i29 v31,v35,v31 row_ror:8 row_mask:0xf bank_mask:0x3
i29 v40,v40,v40 row_ror:8 row_mask:0xf bank_mask:0xf
v_rcp_f32 v42, v40
v_cmp_nlt_f32 vcc, s54, v40
v_cmp_ngt_f32 s[22:23], s55, v40
i29 v28,v44,v12 row_ror:8 row_mask:0xf bank_mask:0xc
i29 v29,v45,v13 row_ror:8 row_mask:0xf bank_mask:0xc
i29 v30,v46,v14 row_ror:8 row_mask:0xf bank_mask:0xc
i29 v31,v47,v15 row_ror:8 row_mask:0xf bank_mask:0xc
i16 v[28:29],v[28:29],v[42:43] op_sel_hi:[1,0]
i16 v[30:31],v[30:31],v[42:43] op_sel_hi:[1,0]
i3 v28,v28,v29
i3 v29,v30,v31
ds_write_b64 v60, v[28:29] offset:1536
i14 v[40:41],0
i14 v[42:43],0
i14 v[12:13],0
i14 v[14:15],0
i14 v[36:37],0
i14 v[38:39],0
i44 Lc3s_cont
Lc3s_out:
i8 vmcnt(0)
i44 L_endc
L_cw0:
i23 v79,4,v0
i23 v28,4,v79
i18 v29,0xf0,v0
i17 v78,v28,13,v29
i32 s22,s20,8
i20 v78,s22,v78
i54 s23,1152
i45 v77,v28,s23,v29
s_mul_i32 s22, s20, 147456
i20 v77,s22,v77
i23 v28,3,v79
i18 v29,0x70,v0
i45 v76,v28,s23,v29
i20 v76,s22,v76
i47 s99,0
i22 Lc0_ptr
i50 s[60:61],s[0:1],56
i50 s[64:65],s[0:1],64
i50 s[68:69],s[0:1],72
i50 s[72:73],s[0:1],80
i8 lgkmcnt(0)
Lc0_ptr:
i5 s62,4718592
i5 s63,0x20000
i5 s66,4718592
i5 s67,0x20000
i5 s70,4718592
i5 s71,0x20000
i5 s74,4718592
i5 s75,0x20000
i5 s42,1040356334
i5 s43,1040356334
i5 s22,0
i5 s23,0
Lc0_first:
i6 m0,s23,0
i6 s24,s22,0
i1 v78,s[64:67],s24 offen lds
i6 m0,s23,1024
i6 s24,s22,32768
i1 v78,s[64:67],s24 offen lds
i6 m0,s23,2048
i6 s24,s22,65536
i1 v78,s[64:67],s24 offen lds
i6 m0,s23,3072
i6 s24,s22,98304
i1 v78,s[64:67],s24 offen lds
i6 s22,s22,524288
i6 s23,s23,4096
s_cmp_lt_u32 s23, 36864
i22 Lc0_first
i23 v30,4,v79
i34 v31,v79,2,2
i18 v32,3,v79
i20 v4,0,v0
i18 v28,1,v30
i17 v28,v28,3,v31
i31 v28,8,v28
i20 v28,0,v28
i17 v68,v32,3,v28
i23 v29,1,v32
i17 v28,v29,5,v28
i18 v29,1,v32
i17 v72,v29,3,v28
i23 v33,1,v30
i23 v29,1,v31
i17 v28,v33,2,v29
i18 v29,1,v31
i31 v34,3,v32
i17 v64,v28,8,v34
i17 v64,v29,5,v64
i20 v64,0,v64
i18 v35,1,v30
i17 v28,v35,4,v28
i17 v60,v28,7,v34
i20 v60,0,v60
i5 s22,36864
i54 s23,4096
i45 v74,v33,s23,v72
i20 v74,147456,v74
i20 v75,8192,v74
i45 v72,v33,s22,v72
i20 v73,73728,v72
i45 v70,v33,s23,v68
i20 v70,147456,v70
i20 v71,8192,v70
i45 v68,v33,s22,v68
i20 v69,73728,v68
i45 v66,v35,s23,v64
i20 v66,147456,v66
i20 v67,8192,v66
i45 v64,v35,s22,v64
i20 v65,73728,v64
i45 v62,v29,s23,v60
i20 v62,147456,v62
i20 v63,8192,v62
i45 v60,v29,s22,v60
i20 v61,73728,v60
i34 v29,v79,3,1
i25 vcc,1,v29
i11 v1,0x8888
i11 v28,0xdddd
i26 v1,v1,v28,vcc
i18 v28,7,v79
i34 v29,v79,4,1
i31 v29,2,v29
v_sub_u32 v28, v28, v29
i18 v29,1,v28
i31 v29,4,v29
i11 v30,0x3f80
i31 v30,v29,v30
v_ashrrev_i32 v28, 1, v28
i25 vcc,0,v28
i15 1
i26 v2,0,v30,vcc
i25 vcc,1,v28
i15 1
i26 v3,0,v30,vcc
i20 v6,147456,v0
i34 v28,v0,8,1
i18 v29,0x70,v0
i23 v7,5,v0
i18 v7,0x18,v7
i17 v7,v29,1,v7
i20 v7,155648,v7
i54 s23,9216
i23 v56,7,v0
i45 v56,v56,s23,v29
i24 v57,v28,3,v29
i23 v30,9,v0
i24 v57,v30,2,v57
i34 v31,v0,7,1
i24 v57,v31,31,v57
i18 v58,0x33f,v0
i24 v58,v31,6,v58
i34 v32,v0,6,1
i24 v58,v32,7,v58
i34 v59,v0,1,8
i24 v59,v30,2,v59
i18 v28,16,v0
i11 v30,0x3f80
i31 v30,v28,v30
i34 v28,v0,5,2
i34 v28,v0,5,3
i25 vcc,0,v28
i15 1
i26 v8,0,v30,vcc
i25 vcc,1,v28
i15 1
i26 v9,0,v30,vcc
i25 vcc,2,v28
i15 1
i26 v10,0,v30,vcc
i25 vcc,3,v28
i15 1
i26 v11,0,v30,vcc
i25 vcc,4,v28
i15 1
i26 v16,0,v30,vcc
i25 vcc,5,v28
i15 1
i26 v17,0,v30,vcc
i25 vcc,6,v28
i15 1
i26 v18,0,v30,vcc
i25 vcc,7,v28
i15 1
i26 v19,0,v30,vcc
i23 v28,8,v0
i24 v28,v28,7,v29
i20 v13,151552,v28
i17 v12,v31,3,v13
i17 v14,v31,9,v13
i23 v15,1,v0
i5 s44,0xff00ff00
i5 s45,0xff00ff00
i5 s48,0x3e803e80
i5 s49,0x3e803e80
i5 s50,0x3f803f80
i5 s51,0x3f803f80
i5 s54,562036736
i5 s55,1568669696
i5 s25,0
i5 s46,0
i5 s47,0
s_mul_i32 s38, s20, 8192
i6 s38,s38,0
i6 s39,s38,16777216
i6 s40,s38,50331648
s_mul_i32 s79, s20, 9216
i6 s79,s79,67108864
i32 s23,s20,7
i6 s7,s23,67108864
i6 s41,s23,70254592
i5 s78,524288
i54 s77,9216
i6 s34,s41,49152
i6 s52,s41,32768
i6 s53,s41,2097152
i8 vmcnt(32)
s_barrier
i0 a[160:161],v72 offset:0
i0 a[162:163],v72 offset:1024
i0 a[164:165],v73 offset:0
i0 a[166:167],v73 offset:1024
i0 v[48:49],v72 offset:16
i0 v[50:51],v72 offset:1040
i0 v[52:53],v73 offset:16
i0 v[54:55],v73 offset:1040
i8 lgkmcnt(0)
s_barrier
i21 v4,v[48:51] offset:0
i21 v4,v[52:55] offset:1024
i8 lgkmcnt(0)
i8 vmcnt(28)
s_barrier
i5 m0,147456
i5 s22,2097152
i1 v78,s[68:71],s22 offen lds
i5 m0,148480
i5 s22,2129920
i1 v78,s[68:71],s22 offen lds
i5 m0,149504
i5 s22,2162688
i1 v78,s[68:71],s22 offen lds
i5 m0,150528
i5 s22,2195456
i1 v78,s[68:71],s22 offen lds
i0 a[168:169],v72 offset:4096
i0 a[170:171],v72 offset:5120
i0 a[172:173],v73 offset:4096
i0 a[174:175],v73 offset:5120
i0 v[48:49],v72 offset:4112
i0 v[50:51],v72 offset:5136
i0 v[52:53],v73 offset:4112
i0 v[54:55],v73 offset:5136
i8 lgkmcnt(0)
s_barrier
i21 v4,v[48:51] offset:2048
i21 v4,v[52:55] offset:3072
i8 lgkmcnt(0)
i8 vmcnt(28)
s_barrier
i0 a[176:177],v72 offset:8192
i0 a[178:179],v72 offset:9216
i0 a[180:181],v73 offset:8192
i0 a[182:183],v73 offset:9216
i0 v[48:49],v72 offset:8208
i0 v[50:51],v72 offset:9232
i0 v[52:53],v73 offset:8208
i0 v[54:55],v73 offset:9232
i8 lgkmcnt(0)
s_barrier
i21 v4,v[48:51] offset:4096
i21 v4,v[52:55] offset:5120
i8 lgkmcnt(0)
i8 vmcnt(24)
s_barrier
i0 a[184:185],v72 offset:12288
i0 a[186:187],v72 offset:13312
i0 a[188:189],v73 offset:12288
i0 a[190:191],v73 offset:13312
i0 v[48:49],v72 offset:12304
i0 v[50:51],v72 offset:13328
i0 v[52:53],v73 offset:12304
i0 v[54:55],v73 offset:13328
i8 lgkmcnt(0)
s_barrier
i21 v4,v[48:51] offset:6144
i21 v4,v[52:55] offset:7168
i8 lgkmcnt(0)
i8 vmcnt(20)
s_barrier
i0 a[200:201],v72 offset:16384
i0 a[202:203],v72 offset:17408
i0 a[204:205],v73 offset:16384
i0 a[206:207],v73 offset:17408
i0 v[48:49],v72 offset:16400
i0 v[50:51],v72 offset:17424
i0 v[52:53],v73 offset:16400
i0 v[54:55],v73 offset:17424
i8 lgkmcnt(0)
s_barrier
i21 v4,v[48:51] offset:8192
i21 v4,v[52:55] offset:9216
i8 lgkmcnt(0)
i8 vmcnt(16)
s_barrier
i0 a[208:209],v72 offset:20480
i0 a[210:211],v72 offset:21504
i0 a[212:213],v73 offset:20480
i0 a[214:215],v73 offset:21504
i0 v[48:49],v72 offset:20496
i0 v[50:51],v72 offset:21520
i0 v[52:53],v73 offset:20496
i0 v[54:55],v73 offset:21520
i8 lgkmcnt(0)
s_barrier
i21 v4,v[48:51] offset:10240
i21 v4,v[52:55] offset:11264
i8 lgkmcnt(0)
i11 v8,0
i39 exec,1
global_load_dwordx4 v[12:15], v8, s[100:101] offset:0 sc1
global_load_dwordx4 v[16:19], v8, s[100:101] offset:16 sc1
i39 exec,-1
i8 vmcnt(14)
s_barrier
i5 m0,20480
i5 s22,2621440
i1 v78,s[68:71],s22 offen lds
i5 m0,21504
i5 s22,2654208
i1 v78,s[68:71],s22 offen lds
i5 m0,22528
i5 s22,2686976
i1 v78,s[68:71],s22 offen lds
i5 m0,23552
i5 s22,2719744
i1 v78,s[68:71],s22 offen lds
i0 a[216:217],v72 offset:24576
i0 a[218:219],v72 offset:25600
i0 a[220:221],v73 offset:24576
i0 a[222:223],v73 offset:25600
i0 v[48:49],v72 offset:24592
i0 v[50:51],v72 offset:25616
i0 v[52:53],v73 offset:24592
i0 v[54:55],v73 offset:25616
i8 lgkmcnt(0)
s_barrier
i21 v4,v[48:51] offset:12288
i21 v4,v[52:55] offset:13312
i8 lgkmcnt(0)
i8 vmcnt(14)
s_barrier
i5 m0,24576
i5 s22,3145728
i1 v78,s[68:71],s22 offen lds
i5 m0,25600
i5 s22,3178496
i1 v78,s[68:71],s22 offen lds
i5 m0,26624
i5 s22,3211264
i1 v78,s[68:71],s22 offen lds
i5 m0,27648
i5 s22,3244032
i1 v78,s[68:71],s22 offen lds
i0 a[224:225],v72 offset:28672
i0 a[226:227],v72 offset:29696
i0 a[228:229],v73 offset:28672
i0 a[230:231],v73 offset:29696
i0 v[48:49],v72 offset:28688
i0 v[50:51],v72 offset:29712
i0 v[52:53],v73 offset:28688
i0 v[54:55],v73 offset:29712
i8 lgkmcnt(0)
s_barrier
i21 v4,v[48:51] offset:14336
i21 v4,v[52:55] offset:15360
i8 lgkmcnt(0)
i8 vmcnt(14)
s_barrier
i5 m0,28672
i5 s22,3670016
i1 v78,s[68:71],s22 offen lds
i5 m0,29696
i5 s22,3702784
i1 v78,s[68:71],s22 offen lds
i5 m0,30720
i5 s22,3735552
i1 v78,s[68:71],s22 offen lds
i5 m0,31744
i5 s22,3768320
i1 v78,s[68:71],s22 offen lds
i0 a[192:193],v72 offset:32768
i0 a[194:195],v72 offset:33792
i0 a[196:197],v73 offset:32768
i0 a[198:199],v73 offset:33792
i0 v[48:49],v72 offset:32784
i0 v[50:51],v72 offset:33808
i0 v[52:53],v73 offset:32784
i0 v[54:55],v73 offset:33808
i8 lgkmcnt(0)
s_barrier
i21 v4,v[48:51] offset:16384
i21 v4,v[52:55] offset:17408
i8 lgkmcnt(0)
i8 vmcnt(12)
i46 s99,0
i22 L_q0k
v_min3_u32 v10, v12, v13, v14
v_min3_u32 v10, v10, v15, v16
v_min3_u32 v10, v10, v17, v18
v_min_u32 v10, v10, v19
i15 0
i37 s92,v10
i15 0
i47 s92,32
i28 s99,1,0
i46 s99,0
i22 L_v20k
i11 v40,0
i5 s94,0
i39 exec,1
L_v20a:
i55 v41,v40,s[100:101] offset:160 sc1
i6 s94,s94,1
i35 s94,400000
i22 L_endc
i8 vmcnt(0)
v_cmp_gt_u32 vcc, 0x100, v41
i49 L_v20az
i44 L_v20ak
L_v20az:
s_sleep 2
i44 L_v20a
L_v20ak:
i39 exec,-1
global_load_dwordx4 v[44:47], v40, s[100:101] offset:0 sc1
global_load_dwordx4 v[48:51], v40, s[100:101] offset:16 sc1
i8 vmcnt(0)
i5 s93,0
i5 s94,s97
i37 s92,v44
i15 0
i46 s92,32
i28 s93,1,s93
i35 s96,0
i28 s92,s92,0
i6 s94,s94,s92
i37 s92,v45
i15 0
i46 s92,32
i28 s93,1,s93
i35 s96,1
i28 s92,s92,0
i6 s94,s94,s92
i37 s92,v46
i15 0
i46 s92,32
i28 s93,1,s93
i35 s96,2
i28 s92,s92,0
i6 s94,s94,s92
i37 s92,v47
i15 0
i46 s92,32
i28 s93,1,s93
i35 s96,3
i28 s92,s92,0
i6 s94,s94,s92
i37 s92,v48
i15 0
i46 s92,32
i28 s93,1,s93
i35 s96,4
i28 s92,s92,0
i6 s94,s94,s92
i37 s92,v49
i15 0
i46 s92,32
i28 s93,1,s93
i35 s96,5
i28 s92,s92,0
i6 s94,s94,s92
i37 s92,v50
i15 0
i46 s92,32
i28 s93,1,s93
i35 s96,6
i28 s92,s92,0
i6 s94,s94,s92
i37 s92,v51
i15 0
i46 s92,32
i28 s93,1,s93
i35 s96,7
i28 s92,s92,0
i6 s94,s94,s92
i5 s99,1
i47 s93,0
i22 L_v20k
i5 s99,2
s_lshr_b32 s98, s94, 5
s_and_b32 s86, s94, 31
i5 s87,1
L_v20k:
L_q0k:
i46 s87,0
i22 L_q0e
s_mul_i32 s3, s20, 9216
i6 s3,s3,67108864
i32 s93,s20,11
i6 s93,s93,70254592
i14 v[20:21],-1
i14 v[22:23],-1
i47 s99,2
i22 L_q0s
i6 s92,s3,0
i13 v[20:23],v0,s[8:11],s92 offen offset:0
i13 v[20:23],v0,s[8:11],s92 offen offset:1024
i13 v[20:23],v0,s[8:11],s92 offen offset:2048
i13 v[20:23],v0,s[8:11],s92 offen offset:3072
i6 s92,s3,4096
i13 v[20:23],v0,s[8:11],s92 offen offset:0
i13 v[20:23],v0,s[8:11],s92 offen offset:1024
i13 v[20:23],v0,s[8:11],s92 offen offset:2048
i13 v[20:23],v0,s[8:11],s92 offen offset:3072
i6 s92,s3,8192
i13 v[20:23],v0,s[8:11],s92 offen offset:0
i6 s92,s3,524288
i13 v[20:23],v0,s[8:11],s92 offen offset:0
i13 v[20:23],v0,s[8:11],s92 offen offset:1024
i13 v[20:23],v0,s[8:11],s92 offen offset:2048
i13 v[20:23],v0,s[8:11],s92 offen offset:3072
i6 s92,s3,528384
i13 v[20:23],v0,s[8:11],s92 offen offset:0
i13 v[20:23],v0,s[8:11],s92 offen offset:1024
i13 v[20:23],v0,s[8:11],s92 offen offset:2048
i13 v[20:23],v0,s[8:11],s92 offen offset:3072
i6 s92,s3,532480
i13 v[20:23],v0,s[8:11],s92 offen offset:0
i13 v[20:23],v0,s[8:11],s93 offen offset:0
i13 v[20:23],v0,s[8:11],s93 offen offset:1024
i44 L_q0e
L_q0s:
i6 s92,s3,0
i13 v[20:23],v0,s[8:11],s92 offen offset:0 sc1
i13 v[20:23],v0,s[8:11],s92 offen offset:1024 sc1
i13 v[20:23],v0,s[8:11],s92 offen offset:2048 sc1
i13 v[20:23],v0,s[8:11],s92 offen offset:3072 sc1
i6 s92,s3,4096
i13 v[20:23],v0,s[8:11],s92 offen offset:0 sc1
i13 v[20:23],v0,s[8:11],s92 offen offset:1024 sc1
i13 v[20:23],v0,s[8:11],s92 offen offset:2048 sc1
i13 v[20:23],v0,s[8:11],s92 offen offset:3072 sc1
i6 s92,s3,8192
i13 v[20:23],v0,s[8:11],s92 offen offset:0 sc1
i6 s92,s3,524288
i13 v[20:23],v0,s[8:11],s92 offen offset:0 sc1
i13 v[20:23],v0,s[8:11],s92 offen offset:1024 sc1
i13 v[20:23],v0,s[8:11],s92 offen offset:2048 sc1
i13 v[20:23],v0,s[8:11],s92 offen offset:3072 sc1
i6 s92,s3,528384
i13 v[20:23],v0,s[8:11],s92 offen offset:0 sc1
i13 v[20:23],v0,s[8:11],s92 offen offset:1024 sc1
i13 v[20:23],v0,s[8:11],s92 offen offset:2048 sc1
i13 v[20:23],v0,s[8:11],s92 offen offset:3072 sc1
i6 s92,s3,532480
i13 v[20:23],v0,s[8:11],s92 offen offset:0 sc1
i13 v[20:23],v0,s[8:11],s93 offen offset:0 sc1
i13 v[20:23],v0,s[8:11],s93 offen offset:1024 sc1
L_q0e:
s_barrier
i5 m0,32768
i5 s22,73728
i1 v77,s[72:75],s22 offen lds
i5 m0,33792
i5 s22,78336
i1 v77,s[72:75],s22 offen lds
i5 m0,34816
i5 s22,82944
i1 v77,s[72:75],s22 offen lds
i5 m0,35840
i5 s22,87552
i1 v77,s[72:75],s22 offen lds
i0 a[48:49],v70 offset:0
i0 a[50:51],v70 offset:1024
i0 a[52:53],v71 offset:0
i0 a[54:55],v71 offset:1024
i0 a[56:57],v70 offset:32
i0 a[58:59],v70 offset:1056
i0 a[60:61],v71 offset:32
i0 a[62:63],v71 offset:1056
i8 lgkmcnt(0)
s_barrier
i8 vmcnt(32)
s_barrier
i5 m0,147456
i5 s22,0
i1 v78,s[60:63],s22 offen lds
i5 m0,148480
i5 s22,32768
i1 v78,s[60:63],s22 offen lds
i5 m0,149504
i5 s22,65536
i1 v78,s[60:63],s22 offen lds
i5 m0,150528
i5 s22,98304
i1 v78,s[60:63],s22 offen lds
i0 a[64:65],v68 offset:20480
i0 a[66:67],v68 offset:21504
i0 a[68:69],v69 offset:20480
i0 a[70:71],v69 offset:21504
i0 a[72:73],v68 offset:20512
i0 a[74:75],v68 offset:21536
i0 a[76:77],v69 offset:20512
i0 a[78:79],v69 offset:21536
i8 lgkmcnt(0)
s_barrier
i8 vmcnt(32)
s_barrier
i0 a[240:241],v68 offset:24576
i0 a[242:243],v68 offset:25600
i0 a[244:245],v69 offset:24576
i0 a[246:247],v69 offset:25600
i0 v[48:49],v68 offset:24608
i0 v[50:51],v68 offset:25632
i0 v[52:53],v69 offset:24608
i0 v[54:55],v69 offset:25632
i8 lgkmcnt(0)
s_barrier
i21 v4,v[48:51] offset:18432
i21 v4,v[52:55] offset:19456
i8 lgkmcnt(0)
i8 vmcnt(28)
s_barrier
i5 m0,24576
i5 s22,524288
i1 v78,s[60:63],s22 offen lds
i5 m0,25600
i5 s22,557056
i1 v78,s[60:63],s22 offen lds
i5 m0,26624
i5 s22,589824
i1 v78,s[60:63],s22 offen lds
i5 m0,27648
i5 s22,622592
i1 v78,s[60:63],s22 offen lds
i0 a[232:233],v68 offset:28672
i0 a[234:235],v68 offset:29696
i0 a[236:237],v69 offset:28672
i0 a[238:239],v69 offset:29696
i0 v[48:49],v68 offset:28704
i0 v[50:51],v68 offset:29728
i0 v[52:53],v69 offset:28704
i0 v[54:55],v69 offset:29728
i8 lgkmcnt(0)
s_barrier
i21 v4,v[48:51] offset:20480
i21 v4,v[52:55] offset:21504
i8 lgkmcnt(0)
i8 vmcnt(8)
s_barrier
i5 m0,28672
i5 s22,1048576
i1 v78,s[60:63],s22 offen lds
i5 m0,29696
i5 s22,1081344
i1 v78,s[60:63],s22 offen lds
i5 m0,30720
i5 s22,1114112
i1 v78,s[60:63],s22 offen lds
i5 m0,31744
i5 s22,1146880
i1 v78,s[60:63],s22 offen lds
i0 a[248:249],v64 offset:32768
i0 a[250:251],v64 offset:33280
i0 a[252:253],v64 offset:34816
i0 a[254:255],v64 offset:35328
i0 v[48:49],v65 offset:32768
i0 v[50:51],v65 offset:33280
i0 v[52:53],v65 offset:34816
i0 v[54:55],v65 offset:35328
i8 lgkmcnt(0)
s_barrier
i21 v4,v[48:51] offset:22528
i21 v4,v[52:55] offset:23552
i8 lgkmcnt(0)
i8 vmcnt(8)
s_barrier
i5 m0,32768
i5 s22,1572864
i1 v78,s[60:63],s22 offen lds
i5 m0,33792
i5 s22,1605632
i1 v78,s[60:63],s22 offen lds
i5 m0,34816
i5 s22,1638400
i1 v78,s[60:63],s22 offen lds
i5 m0,35840
i5 s22,1671168
i1 v78,s[60:63],s22 offen lds
i0 v[80:81],v74 offset:0
i0 v[82:83],v74 offset:1024
i0 v[84:85],v75 offset:0
i0 v[86:87],v75 offset:1024
i0 v[88:89],v74 offset:16
i0 v[90:91],v74 offset:1040
i0 v[92:93],v75 offset:16
i0 v[94:95],v75 offset:1040
i8 lgkmcnt(0)
i46 s87,0
i22 L_q1e
i11 v8,0
i11 v9,1
i39 exec,1
global_atomic_add v8, v9, s[100:101] offset:36
i39 exec,-1
i50 s[88:89],s[0:1],48
i18 v8,7,v79
i54 s92,1152
i23 v9,4,v79
i31 v9,5,v9
i45 v8,v8,s92,v9
s_min_u32 s92, s20, 8
i32 s92,s92,7
i8 lgkmcnt(0)
i5 s90,9216
i5 s91,0x20000
i1 v[12:15],v8,s[88:91],s92 offen offset:0
i1 v[16:19],v8,s[88:91],s92 offen offset:16
L_q1e:
i8 vmcnt(11)
s_barrier
i5 m0,147456
i5 s22,2097152
i1 v78,s[60:63],s22 offen lds
i5 m0,148480
i5 s22,2129920
i1 v78,s[60:63],s22 offen lds
i5 m0,149504
i5 s22,2162688
i1 v78,s[60:63],s22 offen lds
i5 m0,150528
i5 s22,2195456
i1 v78,s[60:63],s22 offen lds
i0 v[96:97],v72 offset:24576
i0 v[98:99],v72 offset:25600
i0 v[100:101],v73 offset:24576
i0 v[102:103],v73 offset:25600
i0 v[104:105],v72 offset:24592
i0 v[106:107],v72 offset:25616
i0 v[108:109],v73 offset:24592
i0 v[110:111],v73 offset:25616
i8 lgkmcnt(0)
i8 vmcnt(11)
s_barrier
i5 m0,24576
i5 s22,2621440
i1 v78,s[60:63],s22 offen lds
i5 m0,25600
i5 s22,2654208
i1 v78,s[60:63],s22 offen lds
i5 m0,26624
i5 s22,2686976
i1 v78,s[60:63],s22 offen lds
i5 m0,27648
i5 s22,2719744
i1 v78,s[60:63],s22 offen lds
i0 v[112:113],v72 offset:28672
i0 v[114:115],v72 offset:29696
i0 v[116:117],v73 offset:28672
i0 v[118:119],v73 offset:29696
i0 v[120:121],v72 offset:28688
i0 v[122:123],v72 offset:29712
i0 v[124:125],v73 offset:28688
i0 v[126:127],v73 offset:29712
i8 lgkmcnt(0)
i8 vmcnt(11)
s_barrier
i5 m0,28672
i5 s22,3145728
i1 v78,s[60:63],s22 offen lds
i5 m0,29696
i5 s22,3178496
i1 v78,s[60:63],s22 offen lds
i5 m0,30720
i5 s22,3211264
i1 v78,s[60:63],s22 offen lds
i5 m0,31744
i5 s22,3244032
i1 v78,s[60:63],s22 offen lds
i0 v[128:129],v72 offset:32768
i0 v[130:131],v72 offset:33792
i0 v[132:133],v73 offset:32768
i0 v[134:135],v73 offset:33792
i0 v[136:137],v72 offset:32784
i0 v[138:139],v72 offset:33808
i0 v[140:141],v73 offset:32784
i0 v[142:143],v73 offset:33808
i8 lgkmcnt(0)
i8 vmcnt(8)
s_barrier
i5 m0,32768
i5 s22,3670016
i1 v78,s[60:63],s22 offen lds
i5 m0,33792
i5 s22,3702784
i1 v78,s[60:63],s22 offen lds
i5 m0,34816
i5 s22,3735552
i1 v78,s[60:63],s22 offen lds
i5 m0,35840
i5 s22,3768320
i1 v78,s[60:63],s22 offen lds
i0 v[160:161],v74 offset:0
i0 v[162:163],v74 offset:1024
i0 v[164:165],v75 offset:0
i0 v[166:167],v75 offset:1024
i0 v[168:169],v74 offset:16
i0 v[170:171],v74 offset:1040
i0 v[172:173],v75 offset:16
i0 v[174:175],v75 offset:1040
i8 lgkmcnt(0)
i8 vmcnt(8)
s_barrier
i5 m0,147456
i5 s22,4194304
i1 v78,s[60:63],s22 offen lds
i5 m0,148480
i5 s22,4227072
i1 v78,s[60:63],s22 offen lds
i5 m0,149504
i5 s22,4259840
i1 v78,s[60:63],s22 offen lds
i5 m0,150528
i5 s22,4292608
i1 v78,s[60:63],s22 offen lds
i0 v[176:177],v72 offset:24576
i0 v[178:179],v72 offset:25600
i0 v[180:181],v73 offset:24576
i0 v[182:183],v73 offset:25600
i0 v[184:185],v72 offset:24592
i0 v[186:187],v72 offset:25616
i0 v[188:189],v73 offset:24592
i0 v[190:191],v73 offset:25616
i8 lgkmcnt(0)
i8 vmcnt(8)
s_barrier
i5 m0,24576
i5 s22,0
i1 v78,s[68:71],s22 offen lds
i5 m0,25600
i5 s22,32768
i1 v78,s[68:71],s22 offen lds
i5 m0,26624
i5 s22,65536
i1 v78,s[68:71],s22 offen lds
i5 m0,27648
i5 s22,98304
i1 v78,s[68:71],s22 offen lds
i0 v[192:193],v72 offset:28672
i0 v[194:195],v72 offset:29696
i0 v[196:197],v73 offset:28672
i0 v[198:199],v73 offset:29696
i0 v[200:201],v72 offset:28688
i0 v[202:203],v72 offset:29712
i0 v[204:205],v73 offset:28688
i0 v[206:207],v73 offset:29712
i8 lgkmcnt(0)
i31 v26,2,v0
s_getpc_b64 s[88:89]
Lc0_pc:
i6 s88,s88,Lc0f_top-Lc0_pc
s_addc_u32 s89, s89, 0
i20 v27,4096,v26
i55 v26,v26,s[88:89]
i55 v27,v27,s[88:89]
i8 vmcnt(10)
s_barrier
i5 m0,28672
i5 s22,524288
i1 v78,s[68:71],s22 offen lds
i5 m0,29696
i5 s22,557056
i1 v78,s[68:71],s22 offen lds
i5 m0,30720
i5 s22,589824
i1 v78,s[68:71],s22 offen lds
i5 m0,31744
i5 s22,622592
i1 v78,s[68:71],s22 offen lds
i0 v[208:209],v72 offset:32768
i0 v[210:211],v72 offset:33792
i0 v[212:213],v73 offset:32768
i0 v[214:215],v73 offset:33792
i0 v[216:217],v72 offset:32784
i0 v[218:219],v72 offset:33808
i0 v[220:221],v73 offset:32784
i0 v[222:223],v73 offset:33808
i8 lgkmcnt(0)
i8 vmcnt(10)
s_barrier
i5 m0,32768
i5 s22,1048576
i1 v78,s[68:71],s22 offen lds
i5 m0,33792
i5 s22,1081344
i1 v78,s[68:71],s22 offen lds
i5 m0,34816
i5 s22,1114112
i1 v78,s[68:71],s22 offen lds
i5 m0,35840
i5 s22,1146880
i1 v78,s[68:71],s22 offen lds
i0 v[144:145],v74 offset:0
i0 v[146:147],v74 offset:1024
i0 v[148:149],v75 offset:0
i0 v[150:151],v75 offset:1024
i0 v[152:153],v74 offset:16
i0 v[154:155],v74 offset:1040
i0 v[156:157],v75 offset:16
i0 v[158:159],v75 offset:1040
i8 lgkmcnt(0)
i8 vmcnt(10)
s_barrier
i5 m0,147456
i5 s22,1572864
i1 v78,s[68:71],s22 offen lds
i5 m0,148480
i5 s22,1605632
i1 v78,s[68:71],s22 offen lds
i5 m0,149504
i5 s22,1638400
i1 v78,s[68:71],s22 offen lds
i5 m0,150528
i5 s22,1671168
i1 v78,s[68:71],s22 offen lds
i0 v[224:225],v68 offset:24576
i0 v[226:227],v68 offset:25600
i0 v[228:229],v69 offset:24576
i0 v[230:231],v69 offset:25600
i0 v[232:233],v68 offset:24608
i0 v[234:235],v68 offset:25632
i0 v[236:237],v69 offset:24608
i0 v[238:239],v69 offset:25632
i8 lgkmcnt(0)
i8 vmcnt(8)
s_barrier
i5 m0,24576
i5 s22,4194304
i1 v78,s[68:71],s22 offen lds
i5 m0,25600
i5 s22,4227072
i1 v78,s[68:71],s22 offen lds
i5 m0,26624
i5 s22,4259840
i1 v78,s[68:71],s22 offen lds
i5 m0,27648
i5 s22,4292608
i1 v78,s[68:71],s22 offen lds
i0 v[240:241],v68 offset:28672
i0 v[242:243],v68 offset:29696
i0 v[244:245],v69 offset:28672
i0 v[246:247],v69 offset:29696
i0 v[248:249],v68 offset:28704
i0 v[250:251],v68 offset:29728
i0 v[252:253],v69 offset:28704
i0 v[254:255],v69 offset:29728
i8 lgkmcnt(0)
i8 vmcnt(8)
s_barrier
i5 m0,28672
i5 s22,256
i1 v77,s[72:75],s22 offen lds
i5 m0,29696
i5 s22,4864
i1 v77,s[72:75],s22 offen lds
i5 m0,30720
i5 s22,9472
i1 v77,s[72:75],s22 offen lds
i5 m0,31744
i5 s22,14080
i1 v77,s[72:75],s22 offen lds
i0 a[0:1],v68 offset:32768
i0 a[2:3],v68 offset:33792
i0 a[4:5],v69 offset:32768
i0 a[6:7],v69 offset:33792
i0 a[8:9],v68 offset:32800
i0 a[10:11],v68 offset:33824
i0 a[12:13],v69 offset:32800
i0 a[14:15],v69 offset:33824
i8 lgkmcnt(0)
i8 vmcnt(8)
s_barrier
i5 m0,32768
i5 s22,512
i1 v77,s[72:75],s22 offen lds
i5 m0,33792
i5 s22,5120
i1 v77,s[72:75],s22 offen lds
i5 m0,34816
i5 s22,9728
i1 v77,s[72:75],s22 offen lds
i5 m0,35840
i5 s22,14336
i1 v77,s[72:75],s22 offen lds
i0 a[16:17],v70 offset:0
i0 a[18:19],v70 offset:1024
i0 a[20:21],v71 offset:0
i0 a[22:23],v71 offset:1024
i0 a[24:25],v70 offset:32
i0 a[26:27],v70 offset:1056
i0 a[28:29],v71 offset:32
i0 a[30:31],v71 offset:1056
i8 lgkmcnt(0)
i8 vmcnt(8)
s_barrier
i5 m0,147456
i5 s22,74240
i1 v77,s[72:75],s22 offen lds
i5 m0,148480
i5 s22,78848
i1 v77,s[72:75],s22 offen lds
i5 m0,149504
i5 s22,83456
i1 v77,s[72:75],s22 offen lds
i5 m0,150528
i5 s22,88064
i1 v77,s[72:75],s22 offen lds
i0 a[32:33],v68 offset:24576
i0 a[34:35],v68 offset:25600
i0 a[36:37],v69 offset:24576
i0 a[38:39],v69 offset:25600
i0 a[40:41],v68 offset:24608
i0 a[42:43],v68 offset:25632
i0 a[44:45],v69 offset:24608
i0 a[46:47],v69 offset:25632
i8 lgkmcnt(0)
i8 vmcnt(8)
s_barrier
i5 m0,24576
i5 s22,768
i1 v77,s[72:75],s22 offen lds
i5 m0,25600
i5 s22,5376
i1 v77,s[72:75],s22 offen lds
i5 m0,26624
i5 s22,9984
i1 v77,s[72:75],s22 offen lds
i5 m0,27648
i5 s22,14592
i1 v77,s[72:75],s22 offen lds
i0 a[80:81],v64 offset:28672
i0 a[82:83],v64 offset:29184
i0 a[84:85],v64 offset:30720
i0 a[86:87],v64 offset:31232
i0 a[88:89],v65 offset:28672
i0 a[90:91],v65 offset:29184
i0 a[92:93],v65 offset:30720
i0 a[94:95],v65 offset:31232
i8 lgkmcnt(0)
i8 vmcnt(8)
s_barrier
i5 m0,28672
i5 s22,74496
i1 v77,s[72:75],s22 offen lds
i5 m0,29696
i5 s22,79104
i1 v77,s[72:75],s22 offen lds
i5 m0,30720
i5 s22,83712
i1 v77,s[72:75],s22 offen lds
i5 m0,31744
i5 s22,88320
i1 v77,s[72:75],s22 offen lds
i0 a[96:97],v64 offset:32768
i0 a[98:99],v64 offset:33280
i0 a[100:101],v64 offset:34816
i0 a[102:103],v64 offset:35328
i0 a[104:105],v65 offset:32768
i0 a[106:107],v65 offset:33280
i0 a[108:109],v65 offset:34816
i0 a[110:111],v65 offset:35328
i8 lgkmcnt(0)
i11 v36,0
i39 exec,1
i55 v37,v36,s[100:101] offset:36 sc1
i55 v38,v36,s[100:101] offset:48 sc1
i55 v39,v36,s[100:101] offset:64 sc1
i39 exec,-1
i8 vmcnt(11)
s_barrier
i0 a[112:113],v66 offset:0
i0 a[114:115],v66 offset:512
i0 a[116:117],v66 offset:2048
i0 a[118:119],v66 offset:2560
i0 a[120:121],v67 offset:0
i0 a[122:123],v67 offset:512
i0 a[124:125],v67 offset:2048
i0 a[126:127],v67 offset:2560
i8 lgkmcnt(0)
i8 vmcnt(7)
s_barrier
i0 a[128:129],v64 offset:24576
i0 a[130:131],v64 offset:25088
i0 a[132:133],v64 offset:26624
i0 a[134:135],v64 offset:27136
i0 a[136:137],v65 offset:24576
i0 a[138:139],v65 offset:25088
i0 a[140:141],v65 offset:26624
i0 a[142:143],v65 offset:27136
i8 lgkmcnt(0)
i8 vmcnt(3)
s_barrier
i5 m0,24576
i5 s22,0
i1 v77,s[72:75],s22 offen lds
i5 m0,25600
i5 s22,4608
i1 v77,s[72:75],s22 offen lds
i5 m0,26624
i5 s22,9216
i1 v77,s[72:75],s22 offen lds
i5 m0,27648
i5 s22,13824
i1 v77,s[72:75],s22 offen lds
i0 a[144:145],v64 offset:28672
i0 a[146:147],v64 offset:29184
i0 a[148:149],v64 offset:30720
i0 a[150:151],v64 offset:31232
i0 a[152:153],v65 offset:28672
i0 a[154:155],v65 offset:29184
i0 a[156:157],v65 offset:30720
i0 a[158:159],v65 offset:31232
i8 lgkmcnt(0)
i8 vmcnt(4)
i46 s87,0
i22 L_q2e
i5 s94,0
i39 exec,1
L_z0:
v_add3_u32 v37, v38, v37, v39
v_cmp_gt_u32 vcc, 0x80, v37
s_cbranch_vccz L_z0k
s_sleep 8
i55 v37,v36,s[100:101] offset:36 sc1
i55 v38,v36,s[100:101] offset:48 sc1
i55 v39,v36,s[100:101] offset:64 sc1
i6 s94,s94,1
i35 s94,400000
i22 L_endc
i8 vmcnt(0)
i44 L_z0
L_z0k:
i39 exec,-1
i34 v9,v79,3,1
i11 v10,0x05040100
i11 v11,0x07060302
i25 vcc,1,v9
i15 1
i26 v10,v10,v11,vcc
i18 v11,0x33f,v0
i24 v11,v9,6,v11
i34 v9,v0,6,1
i24 v11,v9,7,v11
s_cmp_lt_u32 s20, 9
i28 s93,0,0x80000000
i32 s92,s20,10
i6 s93,s93,s92
v_perm_b32 v12, v13, v12, v10
v_min_u32 v12, -2, v12
v_perm_b32 v13, v15, v14, v10
v_min_u32 v13, -2, v13
v_perm_b32 v14, v17, v16, v10
v_min_u32 v14, -2, v14
v_perm_b32 v15, v19, v18, v10
v_min_u32 v15, -2, v15
i6 s92,s93,70254592
i13 v[12:15],v11,s[8:11],s92 offen sc1
i6 s92,s93,72351744
i13 v[12:15],v11,s[8:11],s92 offen sc1
i31 v24,6,v0
i31 v25,8,v0
i5 s92,70254592
i36 v24,v24,s[8:11],s92 offen sc1
i5 s92,67108864
i36 v24,v25,s[8:11],s92 offen sc1
i5 s92,67371008
i36 v24,v25,s[8:11],s92 offen sc1
i5 s92,67633152
i36 v24,v25,s[8:11],s92 offen sc1
i5 s92,67895296
i36 v24,v25,s[8:11],s92 offen sc1
L_q2e:
i8 vmcnt(7)
s_barrier
i5 m0,28672
i5 s22,73984
i1 v77,s[72:75],s22 offen lds
i5 m0,29696
i5 s22,78592
i1 v77,s[72:75],s22 offen lds
i5 m0,30720
i5 s22,83200
i1 v77,s[72:75],s22 offen lds
i5 m0,31744
i5 s22,87808
i1 v77,s[72:75],s22 offen lds
i5 m0,32768
i5 s22,1024
i1 v76,s[72:75],s22 offen lds
i5 m0,33792
i5 s22,10240
i1 v76,s[72:75],s22 offen lds
i5 m0,34816
i5 s22,19456
i1 v76,s[72:75],s22 offen lds
i5 m0,35840
i5 s22,28672
i1 v76,s[72:75],s22 offen lds
i0 v[40:41],v64 offset:24576
i0 v[42:43],v64 offset:25088
i0 v[44:45],v64 offset:26624
i0 v[46:47],v64 offset:27136
i0 v[48:49],v65 offset:24576
i0 v[50:51],v65 offset:25088
i0 v[52:53],v65 offset:26624
i0 v[54:55],v65 offset:27136
i8 lgkmcnt(0)
s_barrier
i21 v4,v[40:43] offset:24576
i21 v4,v[44:47] offset:25600
i21 v4,v[48:51] offset:26624
i21 v4,v[52:55] offset:27648
i8 lgkmcnt(0)
i8 vmcnt(4)
s_barrier
i0 v[40:41],v64 offset:28672
i0 v[42:43],v64 offset:29184
i0 v[44:45],v64 offset:30720
i0 v[46:47],v64 offset:31232
i0 v[48:49],v65 offset:28672
i0 v[50:51],v65 offset:29184
i0 v[52:53],v65 offset:30720
i0 v[54:55],v65 offset:31232
i8 lgkmcnt(0)
s_barrier
i21 v4,v[40:43] offset:28672
i21 v4,v[44:47] offset:29696
i21 v4,v[48:51] offset:30720
i21 v4,v[52:55] offset:31744
i8 lgkmcnt(0)
i8 vmcnt(0)
s_barrier
i0 v[40:41],v60 offset:32768
i0 v[42:43],v60 offset:33024
i0 v[44:45],v60 offset:33792
i0 v[46:47],v60 offset:34048
i0 v[48:49],v61 offset:32768
i0 v[50:51],v61 offset:33024
i0 v[52:53],v61 offset:33792
i0 v[54:55],v61 offset:34048
i8 lgkmcnt(0)
s_barrier
i21 v4,v[40:43] offset:32768
i21 v4,v[44:47] offset:33792
i21 v4,v[48:51] offset:34816
i21 v4,v[52:55] offset:35840
i8 lgkmcnt(0)
i8 vmcnt(0)
s_barrier
i46 s87,0
i28 s20,s86,s20
i11 v40,s99
i11 v41,s98
i11 v42,s20
i11 v43,s87
i11 v44,147456
i21 v44,v[40:43]
i8 lgkmcnt(0)
s_barrier
i11 v44,147456
i9 v[40:43],v44
i8 lgkmcnt(0)
i37 s99,v40
i37 s98,v41
i37 s20,v42
i37 s92,v43
s_barrier
i46 s92,0
i22 L_role2
i47 s99,2
i22 L_cs0
i11 v16,v58
i11 v25,v57
i11 v23,0x80000000
i11 v22,0
i11 v5,64
i39 s[72:73],s[100:101]
i54 s74,256
i5 s75,0x20000
i54 s4,64
i6 s5,s38,262144
i5 s35,70254592
i5 s36,70262784
i5 s37,70258688
i18 v56,0x1f0,v0
i31 v56,2,v56
i23 v57,9,v0
i24 v56,v57,24,v56
i36 v56,v56,s[8:11],s38 offen sc1
i14 v[28:29],0
i14 v[30:31],0
i14 v[32:33],0
i14 v[34:35],0
i14 v[44:45],0
i14 v[46:47],0
i14 v[48:49],0
i14 v[50:51],0
i8 lgkmcnt(0)
Lc0f_top:
i11 v0,v0
i15 2
i11 v0,v0
i15 2
i11 v0,v0
i15 2
i11 v0,v0
i15 2
i11 v0,v0
i15 2
i11 v0,v0
i15 2
i11 v0,v0
i15 2
i11 v0,v0
i15 2
i1 v[52:55],v16,s[8:11],s35 offen sc1
i9 v[64:67],v4 offset:0
i9 v[68:71],v4 offset:1024
i9 v[72:75],v4 offset:2048
i9 v[76:79],v4 offset:3072
i14 v[36:37],0
i14 v[38:39],0
i14 v[40:41],0
i14 v[42:43],0
i11 v18,-1
i52 v18,v25,s[8:11],s52 offen
i11 v0,v0
i15 2
i11 v0,v0
i15 2
i11 v0,v0
i15 2
i11 v0,v0
i15 2
i1 v[52:55],v16,s[8:11],s35 offen sc1
i11 v0,v0
i15 2
i11 v0,v0
i15 2
i11 v0,v0
i15 2
i11 v0,v0
i15 2
i11 v0,v0
i15 2
Lc0f_pb:
i8 vmcnt(1)
i48 v17,v52,v53,v54
v_max_u32 v17, v17, v55
i25 vcc,-1,v17
i11 v0,v0
i11 v0,v0
i11 v0,v0
i11 v0,v0
i11 v0,v0
i49 Lc0f_pb2
Lc0f_go:
i4 v[28:31],v[52:55],v[80:87],v1
i21 v6,v[52:55] offset:0
i5 s52,s34
i4 v[32:35],v[52:55],v[88:95],v1
i1 v[60:63],v16,s[8:11],s37 offen sc1
s_xor_b32 s78, s78, 524288
s_bfe_i32 s76, s25, 0x10001
i4 v[36:39],v[52:55],a[160:167],v1
i8 lgkmcnt(1)
i1 v[24:27],v16,s[8:11],s36 offen sc1
i6 s34,s41,s47
i4 v[40:43],v[52:55],v[64:71],v1
i6 s47,s47,16384
s_and_b32 s47, s47, 65535
i54 s24,1040
i4 v[44:47],v[52:55],v[224:231],v1
i6 s33,s41,s47
i6 s35,s47,70254592
i6 s28,s79,s78
i4 v[48:51],v[52:55],v[232:239],v1
i8 lgkmcnt(0)
s_barrier
i9 v[56:59],v6 offset:1024
i9 v[8:11],v6 offset:2048
i1 v[18:21],v0,s[8:11],s39 offen sc1
i8 lgkmcnt(1)
i4 v[28:31],v[56:59],v[96:103],v1
i9 v[64:67],v4 offset:4096
i6 s26,s28,0
i4 v[32:35],v[56:59],v[104:111],v1
i9 v[68:71],v4 offset:5120
i6 s27,s28,4096
i4 v[36:39],v[56:59],a[168:175],v1
i9 v[12:15],v6 offset:3072
i6 s28,s28,8192
i4 v[40:43],v[56:59],v[72:79],v1
i9 v[72:75],v4 offset:6144
i8 lgkmcnt(4)
i4 v[44:47],v[56:59],v[240:247],v1
i9 v[76:79],v4 offset:7168
i18 v5,0xf0,v0
i4 v[28:31],v[8:11],v[112:119],v1
i6 s29,s7,s78
i6 s30,s29,73728
i31 v5,3,v5
i4 v[32:35],v[8:11],v[120:127],v1
i6 s31,s29,147456
i6 s32,s29,221184
i34 v17,v0,8,1
i4 v[36:39],v[8:11],a[176:183],v1
i8 lgkmcnt(2)
i24 v5,v17,24,v5
i4 v[40:43],v[8:11],v[64:71],v1
i8 vmcnt(1)
i48 v17,v60,v61,v62
i4 v[28:31],v[12:15],v[128:135],v1
i9 v[64:67],v4 offset:16384
i48 v17,v17,v24,v25
i4 v[32:35],v[12:15],v[136:143],v1
i9 v[68:71],v4 offset:17408
i48 v17,v17,v26,v27
i4 v[36:39],v[12:15],a[184:191],v1
i8 lgkmcnt(2)
v_max_u32 v17, v17, v63
i4 v[40:43],v[12:15],v[72:79],v1
i25 vcc,-1,v17
i4 v[48:51],v[56:59],v[248:255],v1
i49 Lc0f_lp
Lc0f_lok:
i4 v[28:31],v[24:27],v[144:151],v1
i21 v6,v[60:63] offset:4096
i4 v[32:35],v[24:27],v[152:159],v1
i1 v[8:11],v0,s[8:11],s38 offen sc1
i4 v[36:39],v[24:27],a[192:199],v1
i8 lgkmcnt(1)
i4 v[40:43],v[24:27],v[64:71],v1
i9 v[72:75],v4 offset:8192
i4 v[44:47],v[24:27],a[32:39],v1
i9 v[76:79],v4 offset:9216
i1 v[12:15],v0,s[8:11],s38 offen offset:1024 sc1
i4 v[48:51],v[24:27],a[40:47],v1
i1 v[24:27],v0,s[8:11],s39 offen offset:1024 sc1
i8 lgkmcnt(2)
s_barrier
i9 v[56:59],v6 offset:5120
i4 v[44:47],v[60:63],a[48:55],v1
i36 v5,v5,s[8:11],s5 offen sc1
i6 s38,s38,262144
i18 v16,0x70,v0
i4 v[48:51],v[60:63],a[56:63],v1
i9 v[52:55],v6 offset:7168
i31 v16,1,v16
i4 v[28:31],v[60:63],v[160:167],v1
i9 v[64:67],v4 offset:10240
i23 v17,8,v0
i4 v[32:35],v[60:63],v[168:175],v1
i9 v[68:71],v4 offset:11264
i45 v17,v17,s24,v16
i4 v[36:39],v[60:63],a[200:207],v1
i8 vmcnt(4)
i8 lgkmcnt(4)
i20 v17,155648,v17
i4 v[40:43],v[60:63],v[72:79],v1
i9 v[60:63],v6 offset:6144
i8 lgkmcnt(4)
i4 v[28:31],v[56:59],v[176:183],v1
i9 v[72:75],v4 offset:12288
i18 v16,0x80,v0
i4 v[32:35],v[56:59],v[184:191],v1
i9 v[76:79],v4 offset:13312
i17 v16,v16,1,v17
i4 v[36:39],v[56:59],a[208:215],v1
i8 lgkmcnt(3)
i6 s37,s47,70258688
i6 s36,s47,70262784
i4 v[40:43],v[56:59],v[64:71],v1
i9 v[64:67],v4 offset:14336
i8 lgkmcnt(3)
i4 v[28:31],v[60:63],v[192:199],v1
i9 v[68:71],v4 offset:15360
i6 s39,s39,262144
i4 v[32:35],v[60:63],v[200:207],v1
i52 v22,v23,s[8:11],s53 offen sc1
i6 s5,s5,262144
i4 v[36:39],v[60:63],a[216:223],v1
i8 lgkmcnt(2)
i4 v[40:43],v[60:63],v[72:79],v1
i9 v[72:75],v4 offset:18432
i4 v[28:31],v[52:55],v[208:215],v1
i9 v[76:79],v4 offset:19456
i4 v[32:35],v[52:55],v[216:223],v1
i4 v[36:39],v[52:55],a[224:231],v1
i8 lgkmcnt(2)
i4 v[40:43],v[52:55],v[64:71],v1
i9 v[64:67],v4 offset:20480
i3 v28,v28,v29
i3 v29,v30,v31
i3 v30,v32,v33
i3 v31,v34,v35
i3 v36,v36,v37
i3 v37,v38,v39
i27 v[32:35],v[28:29],v[2:3],0
i3 v38,v40,v41
i3 v39,v42,v43
i27 v[40:43],v[30:31],v[2:3],0
i9 v[68:71],v4 offset:21504
i8 vmcnt(3)
i27 v[28:31],v[36:37],v[2:3],0
i3 v32,v32,v33
i3 v33,v34,v35
i27 v[56:59],v[38:39],v[2:3],0
i3 v34,v40,v41
i3 v35,v42,v43
i11 v0,v0
i11 v0,v0
i2 v[40:43],v[8:11],v[32:35],0
i9 v[8:11],v6 offset:2048
i3 v28,v28,v29
i3 v29,v30,v31
i2 v[36:39],v[12:15],v[32:35],0
i9 v[12:15],v6 offset:3072
i3 v30,v56,v57
i3 v31,v58,v59
i11 v0,v0
i11 v0,v0
i2 v[56:59],v[28:31],v[32:35],0
i8 lgkmcnt(2)
i3 v40,v40,v41
i3 v41,v42,v43
i3 v36,v36,v37
i3 v37,v38,v39
i4 v[44:47],v[52:55],a[232:239],v1
ds_write_b64 v7, v[40:41] offset:0
ds_write_b64 v7, v[36:37] offset:256
i3 v56,v56,v57
i3 v57,v58,v59
i4 v[48:51],v[52:55],v[64:71],v1
ds_write_b64 v7, v[56:57] offset:512
i4 v[48:51],v[60:63],v[72:79],v1
i9 v[28:31],v6 offset:13312
i4 v[44:47],v[60:63],a[240:247],v1
i9 v[60:63],v6 offset:5120
i8 lgkmcnt(5)
i4 v[44:47],v[12:15],a[16:23],v1
i9 v[32:35],v6 offset:15360
i4 v[48:51],v[12:15],a[24:31],v1
i8 lgkmcnt(3)
s_barrier
i9 v[12:15],v16
i4 v[44:47],v[8:11],a[0:7],v1
i9 v[40:43],v16 offset:16
i6 s53,s53,16384
i4 v[48:51],v[8:11],a[8:15],v1
i9 v[36:39],v17 offset:512
i8 lgkmcnt(4)
i4 v[44:47],v[60:63],a[64:71],v1
i9 v[64:67],v4 offset:24576
i14 v[52:53],0
i4 v[48:51],v[60:63],a[72:79],v1
i9 v[68:71],v4 offset:25600
i8 lgkmcnt(3)
i2 v[8:11],v[28:31],v[12:15],0
i9 v[72:75],v4 offset:26624
i2 v[8:11],v[32:35],v[40:43],v[8:11]
i8 lgkmcnt(3)
i3 v16,v44,v45
i2 v[56:59],v[28:31],v[36:39],0
i3 v17,v46,v47
i3 v22,v48,v49
i2 v[56:59],v[32:35],v[36:39],v[56:59]
i9 v[76:79],v4 offset:27648
i19 v12,v8
i19 v13,v9
i19 v14,v10
i19 v15,v11
i3 v23,v50,v51
i3 v50,v12,v13
i3 v51,v14,v15
i16 v[56:57],v[56:57],s[42:43]
i16 v[58:59],v[58:59],s[42:43]
i19 v40,v56
i8 vmcnt(2)
i2 v[32:35],v[20:23],v[50:53],0
i9 v[60:63],v6 offset:14336
i19 v41,v57
i2 v[12:15],v[26:29],v[50:53],0
i19 v42,v58
i19 v43,v59
i3 v48,v40,v41
i3 v49,v42,v43
i14 v[36:37],s[48:49]
i14 v[38:39],s[50:51]
i2 v[28:31],v[16:19],v[48:51],0
i11 v0,v0
i2 v[40:43],v[36:39],v[48:51],0
i2 v[44:47],v[22:25],v[48:51],0
i8 lgkmcnt(0)
i29 v28,v32,v28 row_ror:8 row_mask:0xf bank_mask:0x3
i29 v29,v33,v29 row_ror:8 row_mask:0xf bank_mask:0x3
i29 v30,v34,v30 row_ror:8 row_mask:0xf bank_mask:0x3
i29 v31,v35,v31 row_ror:8 row_mask:0xf bank_mask:0x3
i29 v40,v40,v40 row_ror:8 row_mask:0xf bank_mask:0xf
v_rcp_f32 v42, v40
v_cmp_nlt_f32 vcc, s54, v40
v_cmp_ngt_f32 s[22:23], s55, v40
i29 v28,v44,v12 row_ror:8 row_mask:0xf bank_mask:0xc
i29 v29,v45,v13 row_ror:8 row_mask:0xf bank_mask:0xc
i29 v30,v46,v14 row_ror:8 row_mask:0xf bank_mask:0xc
i29 v31,v47,v15 row_ror:8 row_mask:0xf bank_mask:0xc
i16 v[28:29],v[28:29],v[42:43] op_sel_hi:[1,0]
i16 v[30:31],v[30:31],v[42:43] op_sel_hi:[1,0]
i3 v28,v28,v29
i3 v29,v30,v31
ds_write_b64 v60, v[28:29] offset:0
i14 v[40:41],0
i14 v[42:43],0
i14 v[12:13],0
i14 v[14:15],0
i14 v[36:37],0
i14 v[38:39],0
i53 vcc,vcc,s[22:23]
i22 Lc0f_slow
Lc0f_cont:
i14 v[56:57],0
i14 v[58:59],0
i14 v[8:9],0
i14 v[10:11],0
i8 lgkmcnt(0)
s_barrier
i9 v[28:31],v61 offset:0
i9 v[32:35],v61 offset:512
i9 v[44:47],v61 offset:1024
i9 v[48:51],v61 offset:1536
i9 v[16:19],v4 offset:22528
i9 v[20:23],v4 offset:23552
i8 lgkmcnt(5)
i4 v[56:59],v[28:31],v[64:71],v1
i9 v[64:67],v4 offset:28672
i8 lgkmcnt(5)
i4 v[56:59],v[32:35],v[72:79],v1
i9 v[68:71],v4 offset:29696
i8 lgkmcnt(5)
i4 v[56:59],v[44:47],a[248:255],v1
i9 v[72:75],v4 offset:30720
i8 lgkmcnt(3)
i4 v[56:59],v[48:51],v[16:23],v1
i9 v[76:79],v4 offset:31744
i9 v[16:19],v62 offset:0
i4 v[36:39],v[28:31],a[80:87],v1
i9 v[20:23],v62 offset:1024
i23 v26,9,v0
i4 v[36:39],v[32:35],a[88:95],v1
i8 lgkmcnt(4)
i3 v56,v56,v57
i4 v[36:39],v[44:47],v[64:71],v1
i8 lgkmcnt(2)
i3 v57,v58,v59
i4 v[36:39],v[48:51],v[72:79],v1
i9 v[64:67],v4 offset:32768
v_bfi_b32 v56, 1, s76, v56
i4 v[8:11],v[28:31],a[96:103],v1
i41 v[56:57],v63,s[8:11],s26 offen offset:0
i4 v[8:11],v[32:35],a[104:111],v1
i9 v[68:71],v4 offset:33792
i3 v36,v36,v37
i4 v[8:11],v[44:47],a[112:119],v1
i9 v[72:75],v4 offset:34816
i3 v37,v38,v39
i4 v[8:11],v[48:51],a[120:127],v1
i9 v[76:79],v4 offset:35840
v_bfi_b32 v36, 1, s76, v36
i4 v[12:15],v[28:31],a[128:135],v1
i41 v[36:37],v63,s[8:11],s26 offen offset:2048
i4 v[12:15],v[32:35],a[136:143],v1
i8 lgkmcnt(2)
i3 v8,v8,v9
i4 v[40:43],v[16:19],v[64:71],v1
i8 lgkmcnt(0)
i3 v9,v10,v11
i4 v[40:43],v[20:23],v[72:79],v1
i9 v[72:75],v6 offset:13312
v_bfi_b32 v8, 1, s76, v8
i4 v[12:15],v[44:47],a[144:151],v1
i41 v[8:9],v63,s[8:11],s27 offen offset:0
i4 v[12:15],v[48:51],a[152:159],v1
i40 v40,v42
i40 v41,v43
v_add_f32 v40, v40, v42
v_add_f32 v41, v41, v43
i3 v40,v40,v41
i18 v27,0xff,v63
v_bfi_b32 v40, 1, s76, v40
i24 v27,v26,2,v27
i3 v12,v12,v13
i3 v13,v14,v15
v_bfi_b32 v12, 1, s76, v12
i41 v[12:13],v63,s[8:11],s27 offen offset:2048
i52 v40,v27,s[8:11],s28 offen
i23 v24,7,v0
i18 v25,0x70,v0
i45 v24,v24,s77,v25
i11 v0,v0
i15 2
i11 v0,v0
i15 2
i11 v0,v0
i15 2
i11 v0,v0
i15 2
i11 v0,v0
i15 2
i11 v0,v0
i15 2
i11 v0,v0
i15 2
i11 v0,v0
i15 2
i11 v0,v0
i15 2
i11 v0,v0
i15 2
i11 v0,v0
i15 2
i11 v0,v0
i15 2
i11 v0,v0
i15 2
i1 v[52:55],v24,s[8:11],s29 offen sc1
i1 v[56:59],v24,s[8:11],s30 offen sc1
i1 v[8:11],v24,s[8:11],s31 offen sc1
i1 v[12:15],v24,s[8:11],s32 offen sc1
i14 v[28:29],0
i14 v[30:31],0
i14 v[32:33],0
i14 v[34:35],0
i14 v[44:45],0
i14 v[46:47],0
i14 v[48:49],0
i14 v[50:51],0
i24 v25,v26,2,v25
i34 v17,v0,8,1
i24 v25,v17,3,v25
i34 v17,v0,7,1
i24 v25,v17,31,v25
i18 v16,0x33f,v0
i24 v16,v17,6,v16
i34 v17,v0,6,1
i24 v16,v17,7,v16
i11 v0,v0
i15 2
i11 v0,v0
i15 2
i11 v0,v0
i15 2
i11 v0,v0
i15 2
i8 lgkmcnt(0)
i8 vmcnt(3)
i2 v[64:67],v[52:55],v[72:75],0
i42 v20,v52,v54,s76 bitop3:0x81
i8 vmcnt(2)
i2 v[64:67],v[56:59],v[72:75],v[64:67]
i42 v21,v56,v58,s76 bitop3:0x81
i8 vmcnt(1)
i2 v[64:67],v[8:11],v[72:75],v[64:67]
i42 v22,v8,v10,s76 bitop3:0x81
i8 vmcnt(0)
i2 v[64:67],v[12:15],v[72:75],v[64:67]
i42 v23,v12,v14,s76 bitop3:0x81
i42 v17,v20,v21,v22 bitop3:0x80
i42 v17,v17,v23,1 bitop3:0x80
i25 vcc,0,v17
i11 v0,v0
i11 v0,v0
i11 v0,v0
i11 v0,v0
i40 v64,v66
i40 v65,v67
v_pk_add_f32 v[64:65], v[64:65], v[66:67]
i3 v64,v64,v65
i49 Lc0f_rf
Lc0f_rn:
i52 v64,v25,s[8:11],s33 offen
i11 v22,v64
i11 v23,v25
i6 s25,s25,1
s_cmp_lt_u32 s25, 63
i22 Lc0f_top
i44 Lc0f_out
Lc0f_rf:
i18 v17,1,v20
i25 s[12:13],0,v17
i18 v17,1,v21
i25 s[14:15],0,v17
i18 v17,1,v22
i25 s[16:17],0,v17
i18 v17,1,v23
i25 s[18:19],0,v17
i53 exec,s[12:13],1
i1 v[52:55],v24,s[8:11],s29 offen sc1
i53 exec,s[14:15],1
i1 v[56:59],v24,s[8:11],s30 offen sc1
i53 exec,s[16:17],1
i1 v[8:11],v24,s[8:11],s31 offen sc1
i53 exec,s[18:19],1
i1 v[12:15],v24,s[8:11],s32 offen sc1
i39 exec,-1
i11 v0,v0
i15 2
i11 v0,v0
i15 2
i11 v0,v0
i15 2
i11 v0,v0
i15 2
Lc0f_rg:
i53 exec,s[12:13],1
i1 v[52:55],v24,s[8:11],s29 offen sc1
i53 exec,s[14:15],1
i1 v[56:59],v24,s[8:11],s30 offen sc1
i53 exec,s[16:17],1
i1 v[8:11],v24,s[8:11],s31 offen sc1
i53 exec,s[18:19],1
i1 v[12:15],v24,s[8:11],s32 offen sc1
i39 exec,-1
i6 s46,s46,1
i35 s46,400000
i22 L_endc
i8 vmcnt(4)
i42 v20,v52,v54,s76 bitop3:0x81
i42 v21,v56,v58,s76 bitop3:0x81
i42 v22,v8,v10,s76 bitop3:0x81
i42 v23,v12,v14,s76 bitop3:0x81
i2 v[64:67],v[52:55],v[72:75],0
i18 v17,1,v20
i25 s[12:13],0,v17
i2 v[64:67],v[56:59],v[72:75],v[64:67]
i18 v17,1,v21
i25 s[14:15],0,v17
i2 v[64:67],v[8:11],v[72:75],v[64:67]
i18 v17,1,v22
i25 s[16:17],0,v17
i2 v[64:67],v[12:15],v[72:75],v[64:67]
i18 v17,1,v23
i25 s[18:19],0,v17
i42 v17,v20,v21,v22 bitop3:0x80
i42 v17,v17,v23,1 bitop3:0x80
i25 vcc,0,v17
i11 v0,v0
i11 v0,v0
i11 v0,v0
i40 v64,v66
i40 v65,v67
v_pk_add_f32 v[64:65], v[64:65], v[66:67]
i3 v64,v64,v65
i49 Lc0f_rg
i44 Lc0f_rn
Lc0f_pb2:
i53 exec,vcc,1
i1 v[52:55],v16,s[8:11],s35 offen sc1
i39 exec,-1
i6 s46,s46,1
i35 s46,400000
i22 L_endc
i11 v0,v0
i15 2
i11 v0,v0
i15 2
i11 v0,v0
i15 2
i11 v0,v0
i15 2
i44 Lc0f_pb
Lc0f_lp:
i53 exec,vcc,1
i1 v[60:63],v16,s[8:11],s37 offen sc1
i1 v[24:27],v16,s[8:11],s36 offen sc1
i39 exec,-1
i11 v0,v0
i15 2
i11 v0,v0
i15 2
i11 v0,v0
i15 2
i11 v0,v0
i15 2
i11 v0,v0
i15 2
Lc0f_lp2:
i53 exec,vcc,1
i1 v[60:63],v16,s[8:11],s37 offen sc1
i1 v[24:27],v16,s[8:11],s36 offen sc1
i39 exec,-1
i6 s46,s46,1
i35 s46,400000
i22 L_endc
i11 v0,v0
i15 2
i11 v0,v0
i15 2
i8 vmcnt(2)
i48 v17,v60,v61,v62
i48 v17,v17,v24,v25
i48 v17,v17,v26,v27
v_max_u32 v17, v17, v63
i25 vcc,-1,v17
i49 Lc0f_lp2
i44 Lc0f_lok
Lc0f_slow:
i38 v28,v8,v9,v10
i38 v29,v11,v56,v57
i38 v28,v28,v58,v59
v_max_f32 v28, v28, v29
i11 v0,v0
i11 v0,v0
v_max_f32_dpp v28, v28, v28 row_ror:8 row_mask:0xf bank_mask:0xf
i11 v29,v28
i11 v0,v0
i11 v0,v0
v_permlane16_swap_b32 v28, v29
v_max_f32 v28, v28, v29
i11 v29,v28
i11 v0,v0
i11 v0,v0
i40 v28,v29
v_max_f32 v28, v28, v29
i33 v8,v8,v28
i19 v8,v8
i33 v9,v9,v28
i19 v9,v9
i33 v10,v10,v28
i19 v10,v10
i33 v11,v11,v28
i19 v11,v11
i33 v56,v56,v28
i19 v56,v56
i33 v57,v57,v28
i19 v57,v57
i33 v58,v58,v28
i19 v58,v58
i33 v59,v59,v28
i19 v59,v59
i3 v48,v56,v57
i3 v49,v58,v59
i3 v50,v8,v9
i3 v51,v10,v11
i14 v[28:29],0
i14 v[36:37],s[48:49]
i14 v[38:39],s[50:51]
i2 v[32:35],v[20:23],v[50:53],0
i2 v[12:15],v[26:29],v[50:53],0
i2 v[28:31],v[16:19],v[48:51],0
i2 v[40:43],v[36:39],v[48:51],0
i2 v[44:47],v[22:25],v[48:51],0
i29 v28,v32,v28 row_ror:8 row_mask:0xf bank_mask:0x3
i29 v29,v33,v29 row_ror:8 row_mask:0xf bank_mask:0x3
i29 v30,v34,v30 row_ror:8 row_mask:0xf bank_mask:0x3
i29 v31,v35,v31 row_ror:8 row_mask:0xf bank_mask:0x3
i29 v40,v40,v40 row_ror:8 row_mask:0xf bank_mask:0xf
v_rcp_f32 v42, v40
v_cmp_nlt_f32 vcc, s54, v40
v_cmp_ngt_f32 s[22:23], s55, v40
i29 v28,v44,v12 row_ror:8 row_mask:0xf bank_mask:0xc
i29 v29,v45,v13 row_ror:8 row_mask:0xf bank_mask:0xc
i29 v30,v46,v14 row_ror:8 row_mask:0xf bank_mask:0xc
i29 v31,v47,v15 row_ror:8 row_mask:0xf bank_mask:0xc
i16 v[28:29],v[28:29],v[42:43] op_sel_hi:[1,0]
i16 v[30:31],v[30:31],v[42:43] op_sel_hi:[1,0]
i3 v28,v28,v29
i3 v29,v30,v31
ds_write_b64 v60, v[28:29] offset:0
i14 v[40:41],0
i14 v[42:43],0
i14 v[12:13],0
i14 v[14:15],0
i14 v[36:37],0
i14 v[38:39],0
i44 Lc0f_cont
Lc0f_out:
i52 v22,v23,s[8:11],s53 offen sc1
i8 vmcnt(0)
i44 L_endc
L_cs0:
i11 v16,v58
i11 v25,v57
i11 v23,0x80000000
i11 v22,0
i11 v5,64
i39 s[72:73],s[100:101]
i54 s74,256
i5 s75,0x20000
i54 s4,64
i6 s5,s38,262144
i5 s35,70254592
i5 s36,70262784
i5 s37,70258688
i18 v56,0x1f0,v0
i31 v56,2,v56
i23 v57,9,v0
i24 v56,v57,24,v56
i36 v56,v56,s[8:11],s38 offen sc1
i14 v[28:29],0
i14 v[30:31],0
i14 v[32:33],0
i14 v[34:35],0
i14 v[44:45],0
i14 v[46:47],0
i14 v[48:49],0
i14 v[50:51],0
i8 lgkmcnt(0)
Lc0s_top:
i11 v0,v0
i15 2
i11 v0,v0
i15 2
i11 v0,v0
i15 2
i11 v0,v0
i15 2
i11 v0,v0
i15 2
i11 v0,v0
i15 2
i11 v0,v0
i15 2
i11 v0,v0
i15 2
i1 v[52:55],v16,s[8:11],s35 offen sc1
i9 v[64:67],v4 offset:0
i9 v[68:71],v4 offset:1024
i9 v[72:75],v4 offset:2048
i9 v[76:79],v4 offset:3072
i14 v[36:37],0
i14 v[38:39],0
i14 v[40:41],0
i14 v[42:43],0
i11 v18,-1
i52 v18,v25,s[8:11],s52 offen sc1
i11 v0,v0
i15 2
i11 v0,v0
i15 2
i11 v0,v0
i15 2
i11 v0,v0
i15 2
i1 v[52:55],v16,s[8:11],s35 offen sc1
i11 v0,v0
i15 2
i11 v0,v0
i15 2
i11 v0,v0
i15 2
i11 v0,v0
i15 2
i11 v0,v0
i15 2
Lc0s_pb:
i8 vmcnt(1)
i48 v17,v52,v53,v54
v_max_u32 v17, v17, v55
i25 vcc,-1,v17
i11 v0,v0
i11 v0,v0
i11 v0,v0
i11 v0,v0
i11 v0,v0
i49 Lc0s_pb2
Lc0s_go:
i4 v[28:31],v[52:55],v[80:87],v1
i21 v6,v[52:55] offset:0
i5 s52,s34
i4 v[32:35],v[52:55],v[88:95],v1
i1 v[60:63],v16,s[8:11],s37 offen sc1
s_xor_b32 s78, s78, 524288
s_bfe_i32 s76, s25, 0x10001
i4 v[36:39],v[52:55],a[160:167],v1
i8 lgkmcnt(1)
i1 v[24:27],v16,s[8:11],s36 offen sc1
i6 s34,s41,s47
i4 v[40:43],v[52:55],v[64:71],v1
i6 s47,s47,16384
s_and_b32 s47, s47, 65535
i54 s24,1040
i4 v[44:47],v[52:55],v[224:231],v1
i6 s33,s41,s47
i6 s35,s47,70254592
i6 s28,s79,s78
i4 v[48:51],v[52:55],v[232:239],v1
i8 lgkmcnt(0)
s_barrier
i9 v[56:59],v6 offset:1024
i9 v[8:11],v6 offset:2048
i1 v[18:21],v0,s[8:11],s39 offen sc1
i8 lgkmcnt(1)
i4 v[28:31],v[56:59],v[96:103],v1
i9 v[64:67],v4 offset:4096
i6 s26,s28,0
i4 v[32:35],v[56:59],v[104:111],v1
i9 v[68:71],v4 offset:5120
i6 s27,s28,4096
i4 v[36:39],v[56:59],a[168:175],v1
i9 v[12:15],v6 offset:3072
i6 s28,s28,8192
i4 v[40:43],v[56:59],v[72:79],v1
i9 v[72:75],v4 offset:6144
i8 lgkmcnt(4)
i4 v[44:47],v[56:59],v[240:247],v1
i9 v[76:79],v4 offset:7168
i18 v5,0xf0,v0
i4 v[28:31],v[8:11],v[112:119],v1
i6 s29,s7,s78
i6 s30,s29,73728
i31 v5,3,v5
i4 v[32:35],v[8:11],v[120:127],v1
i6 s31,s29,147456
i6 s32,s29,221184
i34 v17,v0,8,1
i4 v[36:39],v[8:11],a[176:183],v1
i8 lgkmcnt(2)
i24 v5,v17,24,v5
i4 v[40:43],v[8:11],v[64:71],v1
i8 vmcnt(1)
i48 v17,v60,v61,v62
i4 v[28:31],v[12:15],v[128:135],v1
i9 v[64:67],v4 offset:16384
i48 v17,v17,v24,v25
i4 v[32:35],v[12:15],v[136:143],v1
i9 v[68:71],v4 offset:17408
i48 v17,v17,v26,v27
i4 v[36:39],v[12:15],a[184:191],v1
i8 lgkmcnt(2)
v_max_u32 v17, v17, v63
i4 v[40:43],v[12:15],v[72:79],v1
i25 vcc,-1,v17
i4 v[48:51],v[56:59],v[248:255],v1
i49 Lc0s_lp
Lc0s_lok:
i4 v[28:31],v[24:27],v[144:151],v1
i21 v6,v[60:63] offset:4096
i4 v[32:35],v[24:27],v[152:159],v1
i1 v[8:11],v0,s[8:11],s38 offen sc1
i4 v[36:39],v[24:27],a[192:199],v1
i8 lgkmcnt(1)
i4 v[40:43],v[24:27],v[64:71],v1
i9 v[72:75],v4 offset:8192
i4 v[44:47],v[24:27],a[32:39],v1
i9 v[76:79],v4 offset:9216
i1 v[12:15],v0,s[8:11],s38 offen offset:1024 sc1
i4 v[48:51],v[24:27],a[40:47],v1
i1 v[24:27],v0,s[8:11],s39 offen offset:1024 sc1
i8 lgkmcnt(2)
s_barrier
i9 v[56:59],v6 offset:5120
i4 v[44:47],v[60:63],a[48:55],v1
i36 v5,v5,s[8:11],s5 offen sc1
i6 s38,s38,262144
i18 v16,0x70,v0
i4 v[48:51],v[60:63],a[56:63],v1
i9 v[52:55],v6 offset:7168
i31 v16,1,v16
i4 v[28:31],v[60:63],v[160:167],v1
i9 v[64:67],v4 offset:10240
i23 v17,8,v0
i4 v[32:35],v[60:63],v[168:175],v1
i9 v[68:71],v4 offset:11264
i45 v17,v17,s24,v16
i4 v[36:39],v[60:63],a[200:207],v1
i8 vmcnt(4)
i8 lgkmcnt(4)
i20 v17,155648,v17
i4 v[40:43],v[60:63],v[72:79],v1
i9 v[60:63],v6 offset:6144
i8 lgkmcnt(4)
i4 v[28:31],v[56:59],v[176:183],v1
i9 v[72:75],v4 offset:12288
i18 v16,0x80,v0
i4 v[32:35],v[56:59],v[184:191],v1
i9 v[76:79],v4 offset:13312
i17 v16,v16,1,v17
i4 v[36:39],v[56:59],a[208:215],v1
i8 lgkmcnt(3)
i6 s37,s47,70258688
i6 s36,s47,70262784
i4 v[40:43],v[56:59],v[64:71],v1
i9 v[64:67],v4 offset:14336
i8 lgkmcnt(3)
i4 v[28:31],v[60:63],v[192:199],v1
i9 v[68:71],v4 offset:15360
i6 s39,s39,262144
i4 v[32:35],v[60:63],v[200:207],v1
i52 v22,v23,s[8:11],s53 offen sc1
i6 s5,s5,262144
i4 v[36:39],v[60:63],a[216:223],v1
i8 lgkmcnt(2)
i4 v[40:43],v[60:63],v[72:79],v1
i9 v[72:75],v4 offset:18432
i4 v[28:31],v[52:55],v[208:215],v1
i9 v[76:79],v4 offset:19456
i4 v[32:35],v[52:55],v[216:223],v1
i4 v[36:39],v[52:55],a[224:231],v1
i8 lgkmcnt(2)
i4 v[40:43],v[52:55],v[64:71],v1
i9 v[64:67],v4 offset:20480
i3 v28,v28,v29
i3 v29,v30,v31
i3 v30,v32,v33
i3 v31,v34,v35
i3 v36,v36,v37
i3 v37,v38,v39
i27 v[32:35],v[28:29],v[2:3],0
i3 v38,v40,v41
i3 v39,v42,v43
i27 v[40:43],v[30:31],v[2:3],0
i9 v[68:71],v4 offset:21504
i8 vmcnt(3)
i27 v[28:31],v[36:37],v[2:3],0
i3 v32,v32,v33
i3 v33,v34,v35
i27 v[56:59],v[38:39],v[2:3],0
i3 v34,v40,v41
i3 v35,v42,v43
i11 v0,v0
i11 v0,v0
i2 v[40:43],v[8:11],v[32:35],0
i9 v[8:11],v6 offset:2048
i3 v28,v28,v29
i3 v29,v30,v31
i2 v[36:39],v[12:15],v[32:35],0
i9 v[12:15],v6 offset:3072
i3 v30,v56,v57
i3 v31,v58,v59
i11 v0,v0
i11 v0,v0
i2 v[56:59],v[28:31],v[32:35],0
i8 lgkmcnt(2)
i3 v40,v40,v41
i3 v41,v42,v43
i3 v36,v36,v37
i3 v37,v38,v39
i4 v[44:47],v[52:55],a[232:239],v1
ds_write_b64 v7, v[40:41] offset:0
ds_write_b64 v7, v[36:37] offset:256
i3 v56,v56,v57
i3 v57,v58,v59
i4 v[48:51],v[52:55],v[64:71],v1
ds_write_b64 v7, v[56:57] offset:512
i4 v[48:51],v[60:63],v[72:79],v1
i9 v[28:31],v6 offset:13312
i4 v[44:47],v[60:63],a[240:247],v1
i9 v[60:63],v6 offset:5120
i8 lgkmcnt(5)
i4 v[44:47],v[12:15],a[16:23],v1
i9 v[32:35],v6 offset:15360
i4 v[48:51],v[12:15],a[24:31],v1
i8 lgkmcnt(3)
s_barrier
i9 v[12:15],v16
i4 v[44:47],v[8:11],a[0:7],v1
i9 v[40:43],v16 offset:16
i6 s53,s53,16384
i4 v[48:51],v[8:11],a[8:15],v1
i9 v[36:39],v17 offset:512
i8 lgkmcnt(4)
i4 v[44:47],v[60:63],a[64:71],v1
i9 v[64:67],v4 offset:24576
i14 v[52:53],0
i4 v[48:51],v[60:63],a[72:79],v1
i9 v[68:71],v4 offset:25600
i8 lgkmcnt(3)
i2 v[8:11],v[28:31],v[12:15],0
i9 v[72:75],v4 offset:26624
i2 v[8:11],v[32:35],v[40:43],v[8:11]
i8 lgkmcnt(3)
i3 v16,v44,v45
i2 v[56:59],v[28:31],v[36:39],0
i3 v17,v46,v47
i3 v22,v48,v49
i2 v[56:59],v[32:35],v[36:39],v[56:59]
i9 v[76:79],v4 offset:27648
i19 v12,v8
i19 v13,v9
i19 v14,v10
i19 v15,v11
i3 v23,v50,v51
i3 v50,v12,v13
i3 v51,v14,v15
i16 v[56:57],v[56:57],s[42:43]
i16 v[58:59],v[58:59],s[42:43]
i19 v40,v56
i8 vmcnt(2)
i2 v[32:35],v[20:23],v[50:53],0
i9 v[60:63],v6 offset:14336
i19 v41,v57
i2 v[12:15],v[26:29],v[50:53],0
i19 v42,v58
i19 v43,v59
i3 v48,v40,v41
i3 v49,v42,v43
i14 v[36:37],s[48:49]
i14 v[38:39],s[50:51]
i2 v[28:31],v[16:19],v[48:51],0
i11 v0,v0
i2 v[40:43],v[36:39],v[48:51],0
i2 v[44:47],v[22:25],v[48:51],0
i8 lgkmcnt(0)
i29 v28,v32,v28 row_ror:8 row_mask:0xf bank_mask:0x3
i29 v29,v33,v29 row_ror:8 row_mask:0xf bank_mask:0x3
i29 v30,v34,v30 row_ror:8 row_mask:0xf bank_mask:0x3
i29 v31,v35,v31 row_ror:8 row_mask:0xf bank_mask:0x3
i29 v40,v40,v40 row_ror:8 row_mask:0xf bank_mask:0xf
v_rcp_f32 v42, v40
v_cmp_nlt_f32 vcc, s54, v40
v_cmp_ngt_f32 s[22:23], s55, v40
i29 v28,v44,v12 row_ror:8 row_mask:0xf bank_mask:0xc
i29 v29,v45,v13 row_ror:8 row_mask:0xf bank_mask:0xc
i29 v30,v46,v14 row_ror:8 row_mask:0xf bank_mask:0xc
i29 v31,v47,v15 row_ror:8 row_mask:0xf bank_mask:0xc
i16 v[28:29],v[28:29],v[42:43] op_sel_hi:[1,0]
i16 v[30:31],v[30:31],v[42:43] op_sel_hi:[1,0]
i3 v28,v28,v29
i3 v29,v30,v31
ds_write_b64 v60, v[28:29] offset:0
i14 v[40:41],0
i14 v[42:43],0
i14 v[12:13],0
i14 v[14:15],0
i14 v[36:37],0
i14 v[38:39],0
i53 vcc,vcc,s[22:23]
i22 Lc0s_slow
Lc0s_cont:
i14 v[56:57],0
i14 v[58:59],0
i14 v[8:9],0
i14 v[10:11],0
i8 lgkmcnt(0)
s_barrier
i9 v[28:31],v61 offset:0
i9 v[32:35],v61 offset:512
i9 v[44:47],v61 offset:1024
i9 v[48:51],v61 offset:1536
i9 v[16:19],v4 offset:22528
i9 v[20:23],v4 offset:23552
i8 lgkmcnt(5)
i4 v[56:59],v[28:31],v[64:71],v1
i9 v[64:67],v4 offset:28672
i8 lgkmcnt(5)
i4 v[56:59],v[32:35],v[72:79],v1
i9 v[68:71],v4 offset:29696
i8 lgkmcnt(5)
i4 v[56:59],v[44:47],a[248:255],v1
i9 v[72:75],v4 offset:30720
i8 lgkmcnt(3)
i4 v[56:59],v[48:51],v[16:23],v1
i9 v[76:79],v4 offset:31744
i9 v[16:19],v62 offset:0
i4 v[36:39],v[28:31],a[80:87],v1
i9 v[20:23],v62 offset:1024
i23 v26,9,v0
i4 v[36:39],v[32:35],a[88:95],v1
i8 lgkmcnt(4)
i3 v56,v56,v57
i4 v[36:39],v[44:47],v[64:71],v1
i8 lgkmcnt(2)
i3 v57,v58,v59
i4 v[36:39],v[48:51],v[72:79],v1
i9 v[64:67],v4 offset:32768
v_bfi_b32 v56, 1, s76, v56
i4 v[8:11],v[28:31],a[96:103],v1
i41 v[56:57],v63,s[8:11],s26 offen offset:0 sc1
i4 v[8:11],v[32:35],a[104:111],v1
i9 v[68:71],v4 offset:33792
i3 v36,v36,v37
i4 v[8:11],v[44:47],a[112:119],v1
i9 v[72:75],v4 offset:34816
i3 v37,v38,v39
i4 v[8:11],v[48:51],a[120:127],v1
i9 v[76:79],v4 offset:35840
v_bfi_b32 v36, 1, s76, v36
i4 v[12:15],v[28:31],a[128:135],v1
i41 v[36:37],v63,s[8:11],s26 offen offset:2048 sc1
i4 v[12:15],v[32:35],a[136:143],v1
i8 lgkmcnt(2)
i3 v8,v8,v9
i4 v[40:43],v[16:19],v[64:71],v1
i8 lgkmcnt(0)
i3 v9,v10,v11
i4 v[40:43],v[20:23],v[72:79],v1
i9 v[72:75],v6 offset:13312
v_bfi_b32 v8, 1, s76, v8
i4 v[12:15],v[44:47],a[144:151],v1
i41 v[8:9],v63,s[8:11],s27 offen offset:0 sc1
i4 v[12:15],v[48:51],a[152:159],v1
i40 v40,v42
i40 v41,v43
v_add_f32 v40, v40, v42
v_add_f32 v41, v41, v43
i3 v40,v40,v41
i18 v27,0xff,v63
v_bfi_b32 v40, 1, s76, v40
i24 v27,v26,2,v27
i3 v12,v12,v13
i3 v13,v14,v15
v_bfi_b32 v12, 1, s76, v12
i41 v[12:13],v63,s[8:11],s27 offen offset:2048 sc1
i52 v40,v27,s[8:11],s28 offen sc1
i23 v24,7,v0
i18 v25,0x70,v0
i45 v24,v24,s77,v25
i11 v0,v0
i15 2
i11 v0,v0
i15 2
i11 v0,v0
i15 2
i11 v0,v0
i15 2
i11 v0,v0
i15 2
i11 v0,v0
i15 2
i11 v0,v0
i15 2
i11 v0,v0
i15 2
i11 v0,v0
i15 2
i11 v0,v0
i15 2
i11 v0,v0
i15 2
i11 v0,v0
i15 2
i11 v0,v0
i15 2
i1 v[52:55],v24,s[8:11],s29 offen sc1
i1 v[56:59],v24,s[8:11],s30 offen sc1
i1 v[8:11],v24,s[8:11],s31 offen sc1
i1 v[12:15],v24,s[8:11],s32 offen sc1
i14 v[28:29],0
i14 v[30:31],0
i14 v[32:33],0
i14 v[34:35],0
i14 v[44:45],0
i14 v[46:47],0
i14 v[48:49],0
i14 v[50:51],0
i24 v25,v26,2,v25
i34 v17,v0,8,1
i24 v25,v17,3,v25
i34 v17,v0,7,1
i24 v25,v17,31,v25
i18 v16,0x33f,v0
i24 v16,v17,6,v16
i34 v17,v0,6,1
i24 v16,v17,7,v16
i11 v0,v0
i15 2
i11 v0,v0
i15 2
i11 v0,v0
i15 2
i11 v0,v0
i15 2
i8 lgkmcnt(0)
i8 vmcnt(3)
i2 v[64:67],v[52:55],v[72:75],0
i42 v20,v52,v54,s76 bitop3:0x81
i8 vmcnt(2)
i2 v[64:67],v[56:59],v[72:75],v[64:67]
i42 v21,v56,v58,s76 bitop3:0x81
i8 vmcnt(1)
i2 v[64:67],v[8:11],v[72:75],v[64:67]
i42 v22,v8,v10,s76 bitop3:0x81
i8 vmcnt(0)
i2 v[64:67],v[12:15],v[72:75],v[64:67]
i42 v23,v12,v14,s76 bitop3:0x81
i42 v17,v20,v21,v22 bitop3:0x80
i42 v17,v17,v23,1 bitop3:0x80
i25 vcc,0,v17
i11 v0,v0
i11 v0,v0
i11 v0,v0
i11 v0,v0
i40 v64,v66
i40 v65,v67
v_pk_add_f32 v[64:65], v[64:65], v[66:67]
i3 v64,v64,v65
i49 Lc0s_rf
Lc0s_rn:
i52 v64,v25,s[8:11],s33 offen sc1
i11 v22,v64
i11 v23,v25
i6 s25,s25,1
s_cmp_lt_u32 s25, 63
i22 Lc0s_top
i44 Lc0s_out
Lc0s_rf:
i18 v17,1,v20
i25 s[12:13],0,v17
i18 v17,1,v21
i25 s[14:15],0,v17
i18 v17,1,v22
i25 s[16:17],0,v17
i18 v17,1,v23
i25 s[18:19],0,v17
i53 exec,s[12:13],1
i1 v[52:55],v24,s[8:11],s29 offen sc1
i53 exec,s[14:15],1
i1 v[56:59],v24,s[8:11],s30 offen sc1
i53 exec,s[16:17],1
i1 v[8:11],v24,s[8:11],s31 offen sc1
i53 exec,s[18:19],1
i1 v[12:15],v24,s[8:11],s32 offen sc1
i39 exec,-1
i11 v0,v0
i15 2
i11 v0,v0
i15 2
i11 v0,v0
i15 2
i11 v0,v0
i15 2
Lc0s_rg:
i53 exec,s[12:13],1
i1 v[52:55],v24,s[8:11],s29 offen sc1
i53 exec,s[14:15],1
i1 v[56:59],v24,s[8:11],s30 offen sc1
i53 exec,s[16:17],1
i1 v[8:11],v24,s[8:11],s31 offen sc1
i53 exec,s[18:19],1
i1 v[12:15],v24,s[8:11],s32 offen sc1
i39 exec,-1
i6 s46,s46,1
i35 s46,400000
i22 L_endc
i8 vmcnt(4)
i42 v20,v52,v54,s76 bitop3:0x81
i42 v21,v56,v58,s76 bitop3:0x81
i42 v22,v8,v10,s76 bitop3:0x81
i42 v23,v12,v14,s76 bitop3:0x81
i2 v[64:67],v[52:55],v[72:75],0
i18 v17,1,v20
i25 s[12:13],0,v17
i2 v[64:67],v[56:59],v[72:75],v[64:67]
i18 v17,1,v21
i25 s[14:15],0,v17
i2 v[64:67],v[8:11],v[72:75],v[64:67]
i18 v17,1,v22
i25 s[16:17],0,v17
i2 v[64:67],v[12:15],v[72:75],v[64:67]
i18 v17,1,v23
i25 s[18:19],0,v17
i42 v17,v20,v21,v22 bitop3:0x80
i42 v17,v17,v23,1 bitop3:0x80
i25 vcc,0,v17
i11 v0,v0
i11 v0,v0
i11 v0,v0
i40 v64,v66
i40 v65,v67
v_pk_add_f32 v[64:65], v[64:65], v[66:67]
i3 v64,v64,v65
i49 Lc0s_rg
i44 Lc0s_rn
Lc0s_pb2:
i53 exec,vcc,1
i1 v[52:55],v16,s[8:11],s35 offen sc1
i39 exec,-1
i6 s46,s46,1
i35 s46,400000
i22 L_endc
i11 v0,v0
i15 2
i11 v0,v0
i15 2
i11 v0,v0
i15 2
i11 v0,v0
i15 2
i44 Lc0s_pb
Lc0s_lp:
i53 exec,vcc,1
i1 v[60:63],v16,s[8:11],s37 offen sc1
i1 v[24:27],v16,s[8:11],s36 offen sc1
i39 exec,-1
i11 v0,v0
i15 2
i11 v0,v0
i15 2
i11 v0,v0
i15 2
i11 v0,v0
i15 2
i11 v0,v0
i15 2
Lc0s_lp2:
i53 exec,vcc,1
i1 v[60:63],v16,s[8:11],s37 offen sc1
i1 v[24:27],v16,s[8:11],s36 offen sc1
i39 exec,-1
i6 s46,s46,1
i35 s46,400000
i22 L_endc
i11 v0,v0
i15 2
i11 v0,v0
i15 2
i8 vmcnt(2)
i48 v17,v60,v61,v62
i48 v17,v17,v24,v25
i48 v17,v17,v26,v27
v_max_u32 v17, v17, v63
i25 vcc,-1,v17
i49 Lc0s_lp2
i44 Lc0s_lok
Lc0s_slow:
i38 v28,v8,v9,v10
i38 v29,v11,v56,v57
i38 v28,v28,v58,v59
v_max_f32 v28, v28, v29
i11 v0,v0
i11 v0,v0
v_max_f32_dpp v28, v28, v28 row_ror:8 row_mask:0xf bank_mask:0xf
i11 v29,v28
i11 v0,v0
i11 v0,v0
v_permlane16_swap_b32 v28, v29
v_max_f32 v28, v28, v29
i11 v29,v28
i11 v0,v0
i11 v0,v0
i40 v28,v29
v_max_f32 v28, v28, v29
i33 v8,v8,v28
i19 v8,v8
i33 v9,v9,v28
i19 v9,v9
i33 v10,v10,v28
i19 v10,v10
i33 v11,v11,v28
i19 v11,v11
i33 v56,v56,v28
i19 v56,v56
i33 v57,v57,v28
i19 v57,v57
i33 v58,v58,v28
i19 v58,v58
i33 v59,v59,v28
i19 v59,v59
i3 v48,v56,v57
i3 v49,v58,v59
i3 v50,v8,v9
i3 v51,v10,v11
i14 v[28:29],0
i14 v[36:37],s[48:49]
i14 v[38:39],s[50:51]
i2 v[32:35],v[20:23],v[50:53],0
i2 v[12:15],v[26:29],v[50:53],0
i2 v[28:31],v[16:19],v[48:51],0
i2 v[40:43],v[36:39],v[48:51],0
i2 v[44:47],v[22:25],v[48:51],0
i29 v28,v32,v28 row_ror:8 row_mask:0xf bank_mask:0x3
i29 v29,v33,v29 row_ror:8 row_mask:0xf bank_mask:0x3
i29 v30,v34,v30 row_ror:8 row_mask:0xf bank_mask:0x3
i29 v31,v35,v31 row_ror:8 row_mask:0xf bank_mask:0x3
i29 v40,v40,v40 row_ror:8 row_mask:0xf bank_mask:0xf
v_rcp_f32 v42, v40
v_cmp_nlt_f32 vcc, s54, v40
v_cmp_ngt_f32 s[22:23], s55, v40
i29 v28,v44,v12 row_ror:8 row_mask:0xf bank_mask:0xc
i29 v29,v45,v13 row_ror:8 row_mask:0xf bank_mask:0xc
i29 v30,v46,v14 row_ror:8 row_mask:0xf bank_mask:0xc
i29 v31,v47,v15 row_ror:8 row_mask:0xf bank_mask:0xc
i16 v[28:29],v[28:29],v[42:43] op_sel_hi:[1,0]
i16 v[30:31],v[30:31],v[42:43] op_sel_hi:[1,0]
i3 v28,v28,v29
i3 v29,v30,v31
ds_write_b64 v60, v[28:29] offset:0
i14 v[40:41],0
i14 v[42:43],0
i14 v[12:13],0
i14 v[14:15],0
i14 v[36:37],0
i14 v[38:39],0
i44 Lc0s_cont
Lc0s_out:
i52 v22,v23,s[8:11],s53 offen sc1
i8 vmcnt(0)
i44 L_endc
L_cw1:
i23 v79,4,v0
i23 v28,4,v79
i18 v29,0xf0,v0
i17 v78,v28,13,v29
i32 s22,s20,8
i20 v78,s22,v78
i54 s23,1152
i45 v77,v28,s23,v29
s_mul_i32 s22, s20, 147456
i20 v77,s22,v77
i23 v28,3,v79
i18 v29,0x70,v0
i45 v76,v28,s23,v29
i20 v76,s22,v76
i47 s99,0
i22 Lc1_ptr
i50 s[60:61],s[0:1],56
i50 s[64:65],s[0:1],64
i50 s[68:69],s[0:1],72
i50 s[72:73],s[0:1],80
i8 lgkmcnt(0)
Lc1_ptr:
i5 s62,4718592
i5 s63,0x20000
i5 s66,4718592
i5 s67,0x20000
i5 s70,4718592
i5 s71,0x20000
i5 s74,4718592
i5 s75,0x20000
i5 s42,1040356334
i5 s43,1040356334
i5 s22,131072
i5 s23,36864
Lc1_first:
i6 m0,s23,0
i6 s24,s22,0
i1 v78,s[64:67],s24 offen lds
i6 m0,s23,1024
i6 s24,s22,32768
i1 v78,s[64:67],s24 offen lds
i6 m0,s23,2048
i6 s24,s22,65536
i1 v78,s[64:67],s24 offen lds
i6 m0,s23,3072
i6 s24,s22,98304
i1 v78,s[64:67],s24 offen lds
i6 s22,s22,524288
i6 s23,s23,4096
s_cmp_lt_u32 s23, 73728
i22 Lc1_first
i23 v30,4,v79
i34 v31,v79,2,2
i18 v32,3,v79
i20 v4,36864,v0
i18 v28,1,v30
i17 v28,v28,3,v31
i31 v28,8,v28
i20 v28,64,v28
i17 v68,v32,3,v28
i23 v29,1,v32
i17 v28,v29,5,v28
i18 v29,1,v32
i17 v72,v29,3,v28
i23 v33,1,v30
i23 v29,1,v31
i17 v28,v33,2,v29
i18 v29,1,v31
i31 v34,3,v32
i17 v64,v28,8,v34
i17 v64,v29,5,v64
i20 v64,64,v64
i18 v35,1,v30
i17 v28,v35,4,v28
i17 v60,v28,7,v34
i20 v60,32,v60
i5 s22,36864
i54 s23,4096
i45 v74,v33,s23,v72
i20 v74,147456,v74
i20 v75,8192,v74
i45 v72,v33,s22,v72
i20 v73,73728,v72
i45 v70,v33,s23,v68
i20 v70,147456,v70
i20 v71,8192,v70
i45 v68,v33,s22,v68
i20 v69,73728,v68
i45 v66,v35,s23,v64
i20 v66,147456,v66
i20 v67,8192,v66
i45 v64,v35,s22,v64
i20 v65,73728,v64
i45 v62,v29,s23,v60
i20 v62,147456,v62
i20 v63,8192,v62
i45 v60,v29,s22,v60
i20 v61,73728,v60
i34 v29,v79,3,1
i25 vcc,1,v29
i11 v1,0x8888
i11 v28,0xdddd
i26 v1,v1,v28,vcc
i18 v28,7,v79
i34 v29,v79,4,1
i31 v29,2,v29
v_sub_u32 v28, v28, v29
i18 v29,1,v28
i31 v29,4,v29
i11 v30,0x3f80
i31 v30,v29,v30
v_ashrrev_i32 v28, 1, v28
i25 vcc,0,v28
i15 1
i26 v2,0,v30,vcc
i25 vcc,1,v28
i15 1
i26 v3,0,v30,vcc
i20 v6,147456,v0
i34 v28,v0,8,1
i18 v29,0x70,v0
i23 v7,5,v0
i18 v7,0x18,v7
i17 v7,v29,1,v7
i20 v7,156688,v7
i54 s23,9216
i23 v56,7,v0
i45 v56,v56,s23,v29
i24 v57,v28,3,v29
i23 v30,9,v0
i24 v57,v30,2,v57
i34 v31,v0,7,1
i24 v57,v31,31,v57
i18 v58,0x33f,v0
i24 v58,v31,6,v58
i34 v32,v0,6,1
i24 v58,v32,7,v58
i34 v59,v0,1,8
i24 v59,v30,2,v59
i18 v28,16,v0
i11 v30,0x3f80
i31 v30,v28,v30
i34 v28,v0,5,2
i34 v28,v0,5,3
i25 vcc,0,v28
i15 1
i26 v8,0,v30,vcc
i25 vcc,1,v28
i15 1
i26 v9,0,v30,vcc
i25 vcc,2,v28
i15 1
i26 v10,0,v30,vcc
i25 vcc,3,v28
i15 1
i26 v11,0,v30,vcc
i25 vcc,4,v28
i15 1
i26 v16,0,v30,vcc
i25 vcc,5,v28
i15 1
i26 v17,0,v30,vcc
i25 vcc,6,v28
i15 1
i26 v18,0,v30,vcc
i25 vcc,7,v28
i15 1
i26 v19,0,v30,vcc
i23 v28,8,v0
i24 v28,v28,7,v29
i20 v13,151552,v28
i17 v12,v31,3,v13
i17 v14,v31,9,v13
i23 v15,1,v0
i5 s44,0xff00ff00
i5 s45,0xff00ff00
i5 s48,0x3e803e80
i5 s49,0x3e803e80
i5 s50,0x3f803f80
i5 s51,0x3f803f80
i5 s54,562036736
i5 s55,1568669696
i5 s25,0
i5 s46,0
i5 s47,0
s_mul_i32 s38, s20, 8192
i6 s38,s38,2048
i6 s39,s38,16777216
i6 s40,s38,50331648
s_mul_i32 s79, s20, 9216
i6 s79,s79,67108864
i32 s23,s20,7
i6 s7,s23,67112960
i6 s41,s23,70258688
i5 s78,524288
i54 s77,9216
i6 s34,s41,49152
i6 s52,s41,32768
i6 s53,s41,2097152
i8 vmcnt(32)
s_barrier
i0 a[184:185],v72 offset:0
i0 a[186:187],v72 offset:1024
i0 a[188:189],v73 offset:0
i0 a[190:191],v73 offset:1024
i0 v[48:49],v72 offset:16
i0 v[50:51],v72 offset:1040
i0 v[52:53],v73 offset:16
i0 v[54:55],v73 offset:1040
i8 lgkmcnt(0)
s_barrier
i21 v4,v[48:51] offset:0
i21 v4,v[52:55] offset:1024
i8 lgkmcnt(0)
i8 vmcnt(28)
s_barrier
i5 m0,151552
i5 s22,2228224
i1 v78,s[68:71],s22 offen lds
i5 m0,152576
i5 s22,2260992
i1 v78,s[68:71],s22 offen lds
i5 m0,153600
i5 s22,2293760
i1 v78,s[68:71],s22 offen lds
i5 m0,154624
i5 s22,2326528
i1 v78,s[68:71],s22 offen lds
i0 a[160:161],v72 offset:4096
i0 a[162:163],v72 offset:5120
i0 a[164:165],v73 offset:4096
i0 a[166:167],v73 offset:5120
i0 v[48:49],v72 offset:4112
i0 v[50:51],v72 offset:5136
i0 v[52:53],v73 offset:4112
i0 v[54:55],v73 offset:5136
i8 lgkmcnt(0)
s_barrier
i21 v4,v[48:51] offset:2048
i21 v4,v[52:55] offset:3072
i8 lgkmcnt(0)
i8 vmcnt(28)
s_barrier
i0 a[168:169],v72 offset:8192
i0 a[170:171],v72 offset:9216
i0 a[172:173],v73 offset:8192
i0 a[174:175],v73 offset:9216
i0 v[48:49],v72 offset:8208
i0 v[50:51],v72 offset:9232
i0 v[52:53],v73 offset:8208
i0 v[54:55],v73 offset:9232
i8 lgkmcnt(0)
s_barrier
i21 v4,v[48:51] offset:4096
i21 v4,v[52:55] offset:5120
i8 lgkmcnt(0)
i8 vmcnt(24)
s_barrier
i0 a[176:177],v72 offset:12288
i0 a[178:179],v72 offset:13312
i0 a[180:181],v73 offset:12288
i0 a[182:183],v73 offset:13312
i0 v[48:49],v72 offset:12304
i0 v[50:51],v72 offset:13328
i0 v[52:53],v73 offset:12304
i0 v[54:55],v73 offset:13328
i8 lgkmcnt(0)
s_barrier
i21 v4,v[48:51] offset:6144
i21 v4,v[52:55] offset:7168
i8 lgkmcnt(0)
i8 vmcnt(20)
s_barrier
i0 a[224:225],v72 offset:16384
i0 a[226:227],v72 offset:17408
i0 a[228:229],v73 offset:16384
i0 a[230:231],v73 offset:17408
i0 v[48:49],v72 offset:16400
i0 v[50:51],v72 offset:17424
i0 v[52:53],v73 offset:16400
i0 v[54:55],v73 offset:17424
i8 lgkmcnt(0)
s_barrier
i21 v4,v[48:51] offset:8192
i21 v4,v[52:55] offset:9216
i8 lgkmcnt(0)
i8 vmcnt(16)
s_barrier
i0 a[200:201],v72 offset:20480
i0 a[202:203],v72 offset:21504
i0 a[204:205],v73 offset:20480
i0 a[206:207],v73 offset:21504
i0 v[48:49],v72 offset:20496
i0 v[50:51],v72 offset:21520
i0 v[52:53],v73 offset:20496
i0 v[54:55],v73 offset:21520
i8 lgkmcnt(0)
s_barrier
i21 v4,v[48:51] offset:10240
i21 v4,v[52:55] offset:11264
i8 lgkmcnt(0)
i8 vmcnt(12)
s_barrier
i5 m0,57344
i5 s22,2752512
i1 v78,s[68:71],s22 offen lds
i5 m0,58368
i5 s22,2785280
i1 v78,s[68:71],s22 offen lds
i5 m0,59392
i5 s22,2818048
i1 v78,s[68:71],s22 offen lds
i5 m0,60416
i5 s22,2850816
i1 v78,s[68:71],s22 offen lds
i0 a[208:209],v72 offset:24576
i0 a[210:211],v72 offset:25600
i0 a[212:213],v73 offset:24576
i0 a[214:215],v73 offset:25600
i0 v[48:49],v72 offset:24592
i0 v[50:51],v72 offset:25616
i0 v[52:53],v73 offset:24592
i0 v[54:55],v73 offset:25616
i8 lgkmcnt(0)
s_barrier
i21 v4,v[48:51] offset:12288
i21 v4,v[52:55] offset:13312
i8 lgkmcnt(0)
i8 vmcnt(12)
s_barrier
i5 m0,61440
i5 s22,3276800
i1 v78,s[68:71],s22 offen lds
i5 m0,62464
i5 s22,3309568
i1 v78,s[68:71],s22 offen lds
i5 m0,63488
i5 s22,3342336
i1 v78,s[68:71],s22 offen lds
i5 m0,64512
i5 s22,3375104
i1 v78,s[68:71],s22 offen lds
i0 a[216:217],v72 offset:28672
i0 a[218:219],v72 offset:29696
i0 a[220:221],v73 offset:28672
i0 a[222:223],v73 offset:29696
i0 v[48:49],v72 offset:28688
i0 v[50:51],v72 offset:29712
i0 v[52:53],v73 offset:28688
i0 v[54:55],v73 offset:29712
i8 lgkmcnt(0)
s_barrier
i21 v4,v[48:51] offset:14336
i21 v4,v[52:55] offset:15360
i8 lgkmcnt(0)
i8 vmcnt(12)
s_barrier
i5 m0,65536
i5 s22,3801088
i1 v78,s[68:71],s22 offen lds
i5 m0,66560
i5 s22,3833856
i1 v78,s[68:71],s22 offen lds
i5 m0,67584
i5 s22,3866624
i1 v78,s[68:71],s22 offen lds
i5 m0,68608
i5 s22,3899392
i1 v78,s[68:71],s22 offen lds
i0 a[192:193],v72 offset:32768
i0 a[194:195],v72 offset:33792
i0 a[196:197],v73 offset:32768
i0 a[198:199],v73 offset:33792
i0 v[48:49],v72 offset:32784
i0 v[50:51],v72 offset:33808
i0 v[52:53],v73 offset:32784
i0 v[54:55],v73 offset:33808
i8 lgkmcnt(0)
s_barrier
i21 v4,v[48:51] offset:16384
i21 v4,v[52:55] offset:17408
i8 lgkmcnt(0)
i8 vmcnt(12)
s_barrier
i5 m0,69632
i5 s22,92160
i1 v77,s[72:75],s22 offen lds
i5 m0,70656
i5 s22,96768
i1 v77,s[72:75],s22 offen lds
i5 m0,71680
i5 s22,101376
i1 v77,s[72:75],s22 offen lds
i5 m0,72704
i5 s22,105984
i1 v77,s[72:75],s22 offen lds
i0 a[232:233],v70 offset:0
i0 a[234:235],v70 offset:1024
i0 a[236:237],v71 offset:0
i0 a[238:239],v71 offset:1024
i0 v[48:49],v70 offset:32
i0 v[50:51],v70 offset:1056
i0 v[52:53],v71 offset:32
i0 v[54:55],v71 offset:1056
i8 lgkmcnt(0)
s_barrier
i21 v4,v[48:51] offset:18432
i21 v4,v[52:55] offset:19456
i8 lgkmcnt(0)
i8 vmcnt(12)
s_barrier
i5 m0,151552
i5 s22,131072
i1 v78,s[60:63],s22 offen lds
i5 m0,152576
i5 s22,163840
i1 v78,s[60:63],s22 offen lds
i5 m0,153600
i5 s22,196608
i1 v78,s[60:63],s22 offen lds
i5 m0,154624
i5 s22,229376
i1 v78,s[60:63],s22 offen lds
i0 a[48:49],v68 offset:20480
i0 a[50:51],v68 offset:21504
i0 a[52:53],v69 offset:20480
i0 a[54:55],v69 offset:21504
i0 a[56:57],v68 offset:20512
i0 a[58:59],v68 offset:21536
i0 a[60:61],v69 offset:20512
i0 a[62:63],v69 offset:21536
i8 lgkmcnt(0)
s_barrier
i8 vmcnt(12)
s_barrier
i0 a[64:65],v68 offset:24576
i0 a[66:67],v68 offset:25600
i0 a[68:69],v69 offset:24576
i0 a[70:71],v69 offset:25600
i0 a[72:73],v68 offset:24608
i0 a[74:75],v68 offset:25632
i0 a[76:77],v69 offset:24608
i0 a[78:79],v69 offset:25632
i8 lgkmcnt(0)
s_barrier
i8 vmcnt(8)
s_barrier
i5 m0,61440
i5 s22,655360
i1 v78,s[60:63],s22 offen lds
i5 m0,62464
i5 s22,688128
i1 v78,s[60:63],s22 offen lds
i5 m0,63488
i5 s22,720896
i1 v78,s[60:63],s22 offen lds
i5 m0,64512
i5 s22,753664
i1 v78,s[60:63],s22 offen lds
i0 a[240:241],v68 offset:28672
i0 a[242:243],v68 offset:29696
i0 a[244:245],v69 offset:28672
i0 a[246:247],v69 offset:29696
i0 v[48:49],v68 offset:28704
i0 v[50:51],v68 offset:29728
i0 v[52:53],v69 offset:28704
i0 v[54:55],v69 offset:29728
i8 lgkmcnt(0)
s_barrier
i21 v4,v[48:51] offset:20480
i21 v4,v[52:55] offset:21504
i8 lgkmcnt(0)
i8 vmcnt(8)
s_barrier
i5 m0,65536
i5 s22,1179648
i1 v78,s[60:63],s22 offen lds
i5 m0,66560
i5 s22,1212416
i1 v78,s[60:63],s22 offen lds
i5 m0,67584
i5 s22,1245184
i1 v78,s[60:63],s22 offen lds
i5 m0,68608
i5 s22,1277952
i1 v78,s[60:63],s22 offen lds
i0 a[248:249],v64 offset:32768
i0 a[250:251],v64 offset:33280
i0 a[252:253],v64 offset:34816
i0 a[254:255],v64 offset:35328
i0 v[48:49],v65 offset:32768
i0 v[50:51],v65 offset:33280
i0 v[52:53],v65 offset:34816
i0 v[54:55],v65 offset:35328
i8 lgkmcnt(0)
s_barrier
i21 v4,v[48:51] offset:22528
i21 v4,v[52:55] offset:23552
i8 lgkmcnt(0)
i8 vmcnt(8)
s_barrier
i5 m0,69632
i5 s22,1703936
i1 v78,s[60:63],s22 offen lds
i5 m0,70656
i5 s22,1736704
i1 v78,s[60:63],s22 offen lds
i5 m0,71680
i5 s22,1769472
i1 v78,s[60:63],s22 offen lds
i5 m0,72704
i5 s22,1802240
i1 v78,s[60:63],s22 offen lds
i0 v[128:129],v74 offset:0
i0 v[130:131],v74 offset:1024
i0 v[132:133],v75 offset:0
i0 v[134:135],v75 offset:1024
i0 v[136:137],v74 offset:16
i0 v[138:139],v74 offset:1040
i0 v[140:141],v75 offset:16
i0 v[142:143],v75 offset:1040
i8 lgkmcnt(0)
i8 vmcnt(8)
s_barrier
i5 m0,151552
i5 s22,2228224
i1 v78,s[60:63],s22 offen lds
i5 m0,152576
i5 s22,2260992
i1 v78,s[60:63],s22 offen lds
i5 m0,153600
i5 s22,2293760
i1 v78,s[60:63],s22 offen lds
i5 m0,154624
i5 s22,2326528
i1 v78,s[60:63],s22 offen lds
i0 v[80:81],v72 offset:24576
i0 v[82:83],v72 offset:25600
i0 v[84:85],v73 offset:24576
i0 v[86:87],v73 offset:25600
i0 v[88:89],v72 offset:24592
i0 v[90:91],v72 offset:25616
i0 v[92:93],v73 offset:24592
i0 v[94:95],v73 offset:25616
i8 lgkmcnt(0)
i8 vmcnt(8)
s_barrier
i5 m0,61440
i5 s22,2752512
i1 v78,s[60:63],s22 offen lds
i5 m0,62464
i5 s22,2785280
i1 v78,s[60:63],s22 offen lds
i5 m0,63488
i5 s22,2818048
i1 v78,s[60:63],s22 offen lds
i5 m0,64512
i5 s22,2850816
i1 v78,s[60:63],s22 offen lds
i0 v[96:97],v72 offset:28672
i0 v[98:99],v72 offset:29696
i0 v[100:101],v73 offset:28672
i0 v[102:103],v73 offset:29696
i0 v[104:105],v72 offset:28688
i0 v[106:107],v72 offset:29712
i0 v[108:109],v73 offset:28688
i0 v[110:111],v73 offset:29712
i8 lgkmcnt(0)
i8 vmcnt(8)
s_barrier
i5 m0,65536
i5 s22,3276800
i1 v78,s[60:63],s22 offen lds
i5 m0,66560
i5 s22,3309568
i1 v78,s[60:63],s22 offen lds
i5 m0,67584
i5 s22,3342336
i1 v78,s[60:63],s22 offen lds
i5 m0,68608
i5 s22,3375104
i1 v78,s[60:63],s22 offen lds
i0 v[112:113],v72 offset:32768
i0 v[114:115],v72 offset:33792
i0 v[116:117],v73 offset:32768
i0 v[118:119],v73 offset:33792
i0 v[120:121],v72 offset:32784
i0 v[122:123],v72 offset:33808
i0 v[124:125],v73 offset:32784
i0 v[126:127],v73 offset:33808
i8 lgkmcnt(0)
i8 vmcnt(8)
s_barrier
i5 m0,69632
i5 s22,3801088
i1 v78,s[60:63],s22 offen lds
i5 m0,70656
i5 s22,3833856
i1 v78,s[60:63],s22 offen lds
i5 m0,71680
i5 s22,3866624
i1 v78,s[60:63],s22 offen lds
i5 m0,72704
i5 s22,3899392
i1 v78,s[60:63],s22 offen lds
i0 v[208:209],v74 offset:0
i0 v[210:211],v74 offset:1024
i0 v[212:213],v75 offset:0
i0 v[214:215],v75 offset:1024
i0 v[216:217],v74 offset:16
i0 v[218:219],v74 offset:1040
i0 v[220:221],v75 offset:16
i0 v[222:223],v75 offset:1040
i8 lgkmcnt(0)
i8 vmcnt(8)
s_barrier
i5 m0,151552
i5 s22,4325376
i1 v78,s[60:63],s22 offen lds
i5 m0,152576
i5 s22,4358144
i1 v78,s[60:63],s22 offen lds
i5 m0,153600
i5 s22,4390912
i1 v78,s[60:63],s22 offen lds
i5 m0,154624
i5 s22,4423680
i1 v78,s[60:63],s22 offen lds
i0 v[160:161],v72 offset:24576
i0 v[162:163],v72 offset:25600
i0 v[164:165],v73 offset:24576
i0 v[166:167],v73 offset:25600
i0 v[168:169],v72 offset:24592
i0 v[170:171],v72 offset:25616
i0 v[172:173],v73 offset:24592
i0 v[174:175],v73 offset:25616
i8 lgkmcnt(0)
i8 vmcnt(8)
s_barrier
i5 m0,61440
i5 s22,131072
i1 v78,s[68:71],s22 offen lds
i5 m0,62464
i5 s22,163840
i1 v78,s[68:71],s22 offen lds
i5 m0,63488
i5 s22,196608
i1 v78,s[68:71],s22 offen lds
i5 m0,64512
i5 s22,229376
i1 v78,s[68:71],s22 offen lds
i0 v[176:177],v72 offset:28672
i0 v[178:179],v72 offset:29696
i0 v[180:181],v73 offset:28672
i0 v[182:183],v73 offset:29696
i0 v[184:185],v72 offset:28688
i0 v[186:187],v72 offset:29712
i0 v[188:189],v73 offset:28688
i0 v[190:191],v73 offset:29712
i8 lgkmcnt(0)
i31 v26,2,v0
s_getpc_b64 s[88:89]
Lc1_pc:
i6 s88,s88,Lc1f_top-Lc1_pc
s_addc_u32 s89, s89, 0
i20 v27,4096,v26
i55 v26,v26,s[88:89]
i55 v27,v27,s[88:89]
i8 vmcnt(10)
s_barrier
i5 m0,65536
i5 s22,655360
i1 v78,s[68:71],s22 offen lds
i5 m0,66560
i5 s22,688128
i1 v78,s[68:71],s22 offen lds
i5 m0,67584
i5 s22,720896
i1 v78,s[68:71],s22 offen lds
i5 m0,68608
i5 s22,753664
i1 v78,s[68:71],s22 offen lds
i0 v[192:193],v72 offset:32768
i0 v[194:195],v72 offset:33792
i0 v[196:197],v73 offset:32768
i0 v[198:199],v73 offset:33792
i0 v[200:201],v72 offset:32784
i0 v[202:203],v72 offset:33808
i0 v[204:205],v73 offset:32784
i0 v[206:207],v73 offset:33808
i8 lgkmcnt(0)
i8 vmcnt(10)
s_barrier
i5 m0,69632
i5 s22,1179648
i1 v78,s[68:71],s22 offen lds
i5 m0,70656
i5 s22,1212416
i1 v78,s[68:71],s22 offen lds
i5 m0,71680
i5 s22,1245184
i1 v78,s[68:71],s22 offen lds
i5 m0,72704
i5 s22,1277952
i1 v78,s[68:71],s22 offen lds
i0 v[144:145],v74 offset:0
i0 v[146:147],v74 offset:1024
i0 v[148:149],v75 offset:0
i0 v[150:151],v75 offset:1024
i0 v[152:153],v74 offset:16
i0 v[154:155],v74 offset:1040
i0 v[156:157],v75 offset:16
i0 v[158:159],v75 offset:1040
i8 lgkmcnt(0)
i8 vmcnt(10)
s_barrier
i5 m0,151552
i5 s22,1703936
i1 v78,s[68:71],s22 offen lds
i5 m0,152576
i5 s22,1736704
i1 v78,s[68:71],s22 offen lds
i5 m0,153600
i5 s22,1769472
i1 v78,s[68:71],s22 offen lds
i5 m0,154624
i5 s22,1802240
i1 v78,s[68:71],s22 offen lds
i0 a[16:17],v68 offset:24576
i0 a[18:19],v68 offset:25600
i0 a[20:21],v69 offset:24576
i0 a[22:23],v69 offset:25600
i0 a[24:25],v68 offset:24608
i0 a[26:27],v68 offset:25632
i0 a[28:29],v69 offset:24608
i0 a[30:31],v69 offset:25632
i8 lgkmcnt(0)
i8 vmcnt(8)
s_barrier
i5 m0,61440
i5 s22,4325376
i1 v78,s[68:71],s22 offen lds
i5 m0,62464
i5 s22,4358144
i1 v78,s[68:71],s22 offen lds
i5 m0,63488
i5 s22,4390912
i1 v78,s[68:71],s22 offen lds
i5 m0,64512
i5 s22,4423680
i1 v78,s[68:71],s22 offen lds
i0 v[224:225],v68 offset:28672
i0 v[226:227],v68 offset:29696
i0 v[228:229],v69 offset:28672
i0 v[230:231],v69 offset:29696
i0 v[232:233],v68 offset:28704
i0 v[234:235],v68 offset:29728
i0 v[236:237],v69 offset:28704
i0 v[238:239],v69 offset:29728
i8 lgkmcnt(0)
i8 vmcnt(8)
s_barrier
i5 m0,65536
i5 s22,18688
i1 v77,s[72:75],s22 offen lds
i5 m0,66560
i5 s22,23296
i1 v77,s[72:75],s22 offen lds
i5 m0,67584
i5 s22,27904
i1 v77,s[72:75],s22 offen lds
i5 m0,68608
i5 s22,32512
i1 v77,s[72:75],s22 offen lds
i0 v[240:241],v68 offset:32768
i0 v[242:243],v68 offset:33792
i0 v[244:245],v69 offset:32768
i0 v[246:247],v69 offset:33792
i0 v[248:249],v68 offset:32800
i0 v[250:251],v68 offset:33824
i0 v[252:253],v69 offset:32800
i0 v[254:255],v69 offset:33824
i8 lgkmcnt(0)
i8 vmcnt(8)
s_barrier
i5 m0,69632
i5 s22,18944
i1 v77,s[72:75],s22 offen lds
i5 m0,70656
i5 s22,23552
i1 v77,s[72:75],s22 offen lds
i5 m0,71680
i5 s22,28160
i1 v77,s[72:75],s22 offen lds
i5 m0,72704
i5 s22,32768
i1 v77,s[72:75],s22 offen lds
i0 a[0:1],v70 offset:0
i0 a[2:3],v70 offset:1024
i0 a[4:5],v71 offset:0
i0 a[6:7],v71 offset:1024
i0 a[8:9],v70 offset:32
i0 a[10:11],v70 offset:1056
i0 a[12:13],v71 offset:32
i0 a[14:15],v71 offset:1056
i8 lgkmcnt(0)
i8 vmcnt(8)
s_barrier
i5 m0,151552
i5 s22,92672
i1 v77,s[72:75],s22 offen lds
i5 m0,152576
i5 s22,97280
i1 v77,s[72:75],s22 offen lds
i5 m0,153600
i5 s22,101888
i1 v77,s[72:75],s22 offen lds
i5 m0,154624
i5 s22,106496
i1 v77,s[72:75],s22 offen lds
i0 a[32:33],v68 offset:24576
i0 a[34:35],v68 offset:25600
i0 a[36:37],v69 offset:24576
i0 a[38:39],v69 offset:25600
i0 a[40:41],v68 offset:24608
i0 a[42:43],v68 offset:25632
i0 a[44:45],v69 offset:24608
i0 a[46:47],v69 offset:25632
i8 lgkmcnt(0)
i8 vmcnt(8)
s_barrier
i5 m0,61440
i5 s22,19200
i1 v77,s[72:75],s22 offen lds
i5 m0,62464
i5 s22,23808
i1 v77,s[72:75],s22 offen lds
i5 m0,63488
i5 s22,28416
i1 v77,s[72:75],s22 offen lds
i5 m0,64512
i5 s22,33024
i1 v77,s[72:75],s22 offen lds
i0 a[80:81],v64 offset:28672
i0 a[82:83],v64 offset:29184
i0 a[84:85],v64 offset:30720
i0 a[86:87],v64 offset:31232
i0 a[88:89],v65 offset:28672
i0 a[90:91],v65 offset:29184
i0 a[92:93],v65 offset:30720
i0 a[94:95],v65 offset:31232
i8 lgkmcnt(0)
i8 vmcnt(8)
s_barrier
i5 m0,65536
i5 s22,92928
i1 v77,s[72:75],s22 offen lds
i5 m0,66560
i5 s22,97536
i1 v77,s[72:75],s22 offen lds
i5 m0,67584
i5 s22,102144
i1 v77,s[72:75],s22 offen lds
i5 m0,68608
i5 s22,106752
i1 v77,s[72:75],s22 offen lds
i0 a[96:97],v64 offset:32768
i0 a[98:99],v64 offset:33280
i0 a[100:101],v64 offset:34816
i0 a[102:103],v64 offset:35328
i0 a[104:105],v65 offset:32768
i0 a[106:107],v65 offset:33280
i0 a[108:109],v65 offset:34816
i0 a[110:111],v65 offset:35328
i8 lgkmcnt(0)
i8 vmcnt(8)
s_barrier
i0 a[112:113],v66 offset:0
i0 a[114:115],v66 offset:512
i0 a[116:117],v66 offset:2048
i0 a[118:119],v66 offset:2560
i0 a[120:121],v67 offset:0
i0 a[122:123],v67 offset:512
i0 a[124:125],v67 offset:2048
i0 a[126:127],v67 offset:2560
i8 lgkmcnt(0)
i8 vmcnt(4)
s_barrier
i0 a[128:129],v64 offset:24576
i0 a[130:131],v64 offset:25088
i0 a[132:133],v64 offset:26624
i0 a[134:135],v64 offset:27136
i0 a[136:137],v65 offset:24576
i0 a[138:139],v65 offset:25088
i0 a[140:141],v65 offset:26624
i0 a[142:143],v65 offset:27136
i8 lgkmcnt(0)
i8 vmcnt(0)
s_barrier
i5 m0,61440
i5 s22,18432
i1 v77,s[72:75],s22 offen lds
i5 m0,62464
i5 s22,23040
i1 v77,s[72:75],s22 offen lds
i5 m0,63488
i5 s22,27648
i1 v77,s[72:75],s22 offen lds
i5 m0,64512
i5 s22,32256
i1 v77,s[72:75],s22 offen lds
i0 a[144:145],v64 offset:28672
i0 a[146:147],v64 offset:29184
i0 a[148:149],v64 offset:30720
i0 a[150:151],v64 offset:31232
i0 a[152:153],v65 offset:28672
i0 a[154:155],v65 offset:29184
i0 a[156:157],v65 offset:30720
i0 a[158:159],v65 offset:31232
i8 lgkmcnt(0)
i8 vmcnt(0)
s_barrier
i5 m0,65536
i5 s22,92416
i1 v77,s[72:75],s22 offen lds
i5 m0,66560
i5 s22,97024
i1 v77,s[72:75],s22 offen lds
i5 m0,67584
i5 s22,101632
i1 v77,s[72:75],s22 offen lds
i5 m0,68608
i5 s22,106240
i1 v77,s[72:75],s22 offen lds
i5 m0,69632
i5 s22,37888
i1 v76,s[72:75],s22 offen lds
i5 m0,70656
i5 s22,47104
i1 v76,s[72:75],s22 offen lds
i5 m0,71680
i5 s22,56320
i1 v76,s[72:75],s22 offen lds
i5 m0,72704
i5 s22,65536
i1 v76,s[72:75],s22 offen lds
i0 v[40:41],v64 offset:24576
i0 v[42:43],v64 offset:25088
i0 v[44:45],v64 offset:26624
i0 v[46:47],v64 offset:27136
i0 v[48:49],v65 offset:24576
i0 v[50:51],v65 offset:25088
i0 v[52:53],v65 offset:26624
i0 v[54:55],v65 offset:27136
i8 lgkmcnt(0)
s_barrier
i21 v4,v[40:43] offset:24576
i21 v4,v[44:47] offset:25600
i21 v4,v[48:51] offset:26624
i21 v4,v[52:55] offset:27648
i8 lgkmcnt(0)
i8 vmcnt(4)
s_barrier
i0 v[40:41],v64 offset:28672
i0 v[42:43],v64 offset:29184
i0 v[44:45],v64 offset:30720
i0 v[46:47],v64 offset:31232
i0 v[48:49],v65 offset:28672
i0 v[50:51],v65 offset:29184
i0 v[52:53],v65 offset:30720
i0 v[54:55],v65 offset:31232
i8 lgkmcnt(0)
s_barrier
i21 v4,v[40:43] offset:28672
i21 v4,v[44:47] offset:29696
i21 v4,v[48:51] offset:30720
i21 v4,v[52:55] offset:31744
i8 lgkmcnt(0)
i8 vmcnt(0)
s_barrier
i0 v[40:41],v60 offset:32768
i0 v[42:43],v60 offset:33024
i0 v[44:45],v60 offset:33792
i0 v[46:47],v60 offset:34048
i0 v[48:49],v61 offset:32768
i0 v[50:51],v61 offset:33024
i0 v[52:53],v61 offset:33792
i0 v[54:55],v61 offset:34048
i8 lgkmcnt(0)
s_barrier
i21 v4,v[40:43] offset:32768
i21 v4,v[44:47] offset:33792
i21 v4,v[48:51] offset:34816
i21 v4,v[52:55] offset:35840
i8 lgkmcnt(0)
i8 vmcnt(0)
s_barrier
s_barrier
i11 v44,147456
i9 v[40:43],v44
i8 lgkmcnt(0)
i37 s99,v40
i37 s98,v41
i37 s20,v42
i37 s92,v43
s_barrier
i46 s92,0
i22 L_role2
i21 v6,v[8:11] offset:13312
i21 v6,v[12:15] offset:14336
i21 v6,v[16:19] offset:15360
i8 lgkmcnt(0)
i47 s99,2
i22 L_cs1
i11 v16,v58
i11 v25,v57
i11 v23,0x80000000
i11 v22,0
i11 v5,64
i39 s[72:73],s[100:101]
i54 s74,256
i5 s75,0x20000
i54 s4,64
i6 s5,s38,262144
i5 s35,70255616
i5 s36,70262784
i5 s37,70259712
i18 v56,0x1f0,v0
i31 v56,2,v56
i23 v57,9,v0
i24 v56,v57,24,v56
i36 v56,v56,s[8:11],s38 offen sc1
i14 v[28:29],0
i14 v[30:31],0
i14 v[32:33],0
i14 v[34:35],0
i14 v[44:45],0
i14 v[46:47],0
i14 v[48:49],0
i14 v[50:51],0
i8 lgkmcnt(0)
Lc1f_top:
i1 v[52:55],v16,s[8:11],s35 offen sc1
i9 v[64:67],v4 offset:2048
i9 v[68:71],v4 offset:3072
i9 v[72:75],v4 offset:4096
i9 v[76:79],v4 offset:5120
i14 v[36:37],0
i14 v[38:39],0
i14 v[40:41],0
i14 v[42:43],0
i11 v18,-1
i52 v18,v25,s[8:11],s52 offen
i11 v0,v0
i15 2
i11 v0,v0
i15 2
i11 v0,v0
i15 2
i11 v0,v0
i15 2
i1 v[52:55],v16,s[8:11],s35 offen sc1
i11 v0,v0
i15 2
i11 v0,v0
i15 2
i11 v0,v0
i15 2
i11 v0,v0
i15 2
i11 v0,v0
i15 2
Lc1f_pb:
i8 vmcnt(1)
i48 v17,v52,v53,v54
v_max_u32 v17, v17, v55
i25 vcc,-1,v17
i11 v0,v0
i11 v0,v0
i11 v0,v0
i11 v0,v0
i11 v0,v0
i49 Lc1f_pb2
Lc1f_go:
i4 v[28:31],v[52:55],v[80:87],v1
i21 v6,v[52:55] offset:1024
i5 s52,s34
i4 v[32:35],v[52:55],v[88:95],v1
i1 v[60:63],v16,s[8:11],s37 offen sc1
s_xor_b32 s78, s78, 524288
s_bfe_i32 s76, s25, 0x10001
i4 v[36:39],v[52:55],a[160:167],v1
i8 lgkmcnt(1)
i1 v[24:27],v16,s[8:11],s36 offen sc1
i6 s34,s41,s47
i4 v[40:43],v[52:55],v[64:71],v1
i6 s47,s47,16384
s_and_b32 s47, s47, 65535
i54 s24,1040
i4 v[44:47],v[52:55],v[224:231],v1
i6 s33,s41,s47
i6 s35,s47,70255616
i6 s28,s79,s78
i4 v[48:51],v[52:55],v[232:239],v1
i8 lgkmcnt(0)
s_barrier
i9 v[56:59],v6 offset:2048
i9 v[8:11],v6 offset:3072
i1 v[18:21],v0,s[8:11],s39 offen sc1
i8 lgkmcnt(1)
i4 v[28:31],v[56:59],v[96:103],v1
i9 v[64:67],v4 offset:6144
i6 s26,s28,512
i4 v[32:35],v[56:59],v[104:111],v1
i9 v[68:71],v4 offset:7168
i6 s27,s28,4608
i4 v[36:39],v[56:59],a[168:175],v1
i9 v[12:15],v6 offset:0
i6 s28,s28,8448
i4 v[40:43],v[56:59],v[72:79],v1
i9 v[72:75],v4 offset:0
i8 lgkmcnt(4)
i4 v[44:47],v[56:59],v[240:247],v1
i9 v[76:79],v4 offset:1024
i18 v5,0xf0,v0
i4 v[28:31],v[8:11],v[112:119],v1
i6 s29,s7,s78
i6 s30,s29,73728
i31 v5,3,v5
i4 v[32:35],v[8:11],v[120:127],v1
i6 s31,s29,147456
i6 s32,s29,221184
i34 v17,v0,8,1
i4 v[36:39],v[8:11],a[176:183],v1
i8 lgkmcnt(2)
i24 v5,v17,24,v5
i4 v[40:43],v[8:11],v[64:71],v1
i8 vmcnt(1)
i48 v17,v60,v61,v62
i4 v[28:31],v[12:15],v[128:135],v1
i9 v[64:67],v4 offset:16384
i48 v17,v17,v24,v25
i4 v[32:35],v[12:15],v[136:143],v1
i9 v[68:71],v4 offset:17408
i48 v17,v17,v26,v27
i4 v[36:39],v[12:15],a[184:191],v1
i8 lgkmcnt(2)
v_max_u32 v17, v17, v63
i4 v[40:43],v[12:15],v[72:79],v1
i25 vcc,-1,v17
i4 v[48:51],v[56:59],v[248:255],v1
i49 Lc1f_lp
Lc1f_lok:
i4 v[28:31],v[24:27],v[144:151],v1
i21 v6,v[60:63] offset:5120
i4 v[32:35],v[24:27],v[152:159],v1
i1 v[8:11],v0,s[8:11],s38 offen sc1
i4 v[36:39],v[24:27],a[192:199],v1
i8 lgkmcnt(1)
i4 v[40:43],v[24:27],v[64:71],v1
i9 v[72:75],v4 offset:10240
i4 v[44:47],v[24:27],a[32:39],v1
i9 v[76:79],v4 offset:11264
i1 v[12:15],v0,s[8:11],s38 offen offset:1024 sc1
i4 v[48:51],v[24:27],a[40:47],v1
i1 v[24:27],v0,s[8:11],s39 offen offset:1024 sc1
i8 lgkmcnt(2)
s_barrier
i9 v[56:59],v6 offset:6144
i4 v[44:47],v[60:63],a[48:55],v1
i36 v5,v5,s[8:11],s5 offen sc1
i6 s38,s38,262144
i18 v16,0x70,v0
i4 v[48:51],v[60:63],a[56:63],v1
i9 v[52:55],v6 offset:4096
i31 v16,1,v16
i4 v[28:31],v[60:63],v[160:167],v1
i9 v[64:67],v4 offset:12288
i23 v17,8,v0
i4 v[32:35],v[60:63],v[168:175],v1
i9 v[68:71],v4 offset:13312
i45 v17,v17,s24,v16
i4 v[36:39],v[60:63],a[200:207],v1
i8 vmcnt(4)
i8 lgkmcnt(4)
i20 v17,155648,v17
i4 v[40:43],v[60:63],v[72:79],v1
i9 v[60:63],v6 offset:7168
i8 lgkmcnt(4)
i4 v[28:31],v[56:59],v[176:183],v1
i9 v[72:75],v4 offset:14336
i18 v16,0x80,v0
i4 v[32:35],v[56:59],v[184:191],v1
i9 v[76:79],v4 offset:15360
i17 v16,v16,1,v17
i4 v[36:39],v[56:59],a[208:215],v1
i8 lgkmcnt(3)
i6 s37,s47,70259712
i6 s36,s47,70262784
i4 v[40:43],v[56:59],v[64:71],v1
i9 v[64:67],v4 offset:8192
i8 lgkmcnt(3)
i4 v[28:31],v[60:63],v[192:199],v1
i9 v[68:71],v4 offset:9216
i6 s39,s39,262144
i4 v[32:35],v[60:63],v[200:207],v1
i52 v22,v23,s[8:11],s53 offen sc1
i6 s5,s5,262144
i4 v[36:39],v[60:63],a[216:223],v1
i8 lgkmcnt(2)
i4 v[40:43],v[60:63],v[72:79],v1
i9 v[72:75],v4 offset:20480
i4 v[28:31],v[52:55],v[208:215],v1
i9 v[76:79],v4 offset:21504
i4 v[32:35],v[52:55],v[216:223],v1
i4 v[36:39],v[52:55],a[224:231],v1
i8 lgkmcnt(2)
i4 v[40:43],v[52:55],v[64:71],v1
i9 v[64:67],v4 offset:18432
i3 v28,v28,v29
i3 v29,v30,v31
i3 v30,v32,v33
i3 v31,v34,v35
i3 v36,v36,v37
i3 v37,v38,v39
i27 v[32:35],v[28:29],v[2:3],0
i3 v38,v40,v41
i3 v39,v42,v43
i27 v[40:43],v[30:31],v[2:3],0
i9 v[68:71],v4 offset:19456
i8 vmcnt(3)
i27 v[28:31],v[36:37],v[2:3],0
i3 v32,v32,v33
i3 v33,v34,v35
i27 v[56:59],v[38:39],v[2:3],0
i3 v34,v40,v41
i3 v35,v42,v43
i11 v0,v0
i11 v0,v0
i2 v[40:43],v[8:11],v[32:35],0
i9 v[8:11],v6 offset:3072
i3 v28,v28,v29
i3 v29,v30,v31
i2 v[36:39],v[12:15],v[32:35],0
i9 v[12:15],v6 offset:0
i3 v30,v56,v57
i3 v31,v58,v59
i11 v0,v0
i11 v0,v0
i2 v[56:59],v[28:31],v[32:35],0
i8 lgkmcnt(2)
i3 v40,v40,v41
i3 v41,v42,v43
i3 v36,v36,v37
i3 v37,v38,v39
i4 v[44:47],v[52:55],a[232:239],v1
ds_write_b64 v7, v[40:41] offset:0
ds_write_b64 v7, v[36:37] offset:256
i3 v56,v56,v57
i3 v57,v58,v59
i4 v[48:51],v[52:55],v[64:71],v1
ds_write_b64 v7, v[56:57] offset:512
i4 v[48:51],v[60:63],v[72:79],v1
i9 v[28:31],v6 offset:13312
i4 v[44:47],v[60:63],a[240:247],v1
i9 v[60:63],v6 offset:6144
i8 lgkmcnt(5)
i4 v[44:47],v[12:15],a[16:23],v1
i9 v[32:35],v6 offset:15360
i4 v[48:51],v[12:15],a[24:31],v1
i8 lgkmcnt(3)
s_barrier
i9 v[12:15],v16
i4 v[44:47],v[8:11],a[0:7],v1
i9 v[40:43],v16 offset:16
i6 s53,s53,16384
i4 v[48:51],v[8:11],a[8:15],v1
i9 v[36:39],v17 offset:512
i8 lgkmcnt(4)
i4 v[44:47],v[60:63],a[64:71],v1
i9 v[64:67],v4 offset:24576
i14 v[52:53],0
i4 v[48:51],v[60:63],a[72:79],v1
i9 v[68:71],v4 offset:25600
i8 lgkmcnt(3)
i2 v[8:11],v[28:31],v[12:15],0
i9 v[72:75],v4 offset:26624
i2 v[8:11],v[32:35],v[40:43],v[8:11]
i8 lgkmcnt(3)
i3 v16,v44,v45
i2 v[56:59],v[28:31],v[36:39],0
i3 v17,v46,v47
i3 v22,v48,v49
i2 v[56:59],v[32:35],v[36:39],v[56:59]
i9 v[76:79],v4 offset:27648
i19 v12,v8
i19 v13,v9
i19 v14,v10
i19 v15,v11
i3 v23,v50,v51
i3 v50,v12,v13
i3 v51,v14,v15
i16 v[56:57],v[56:57],s[42:43]
i16 v[58:59],v[58:59],s[42:43]
i19 v40,v56
i8 vmcnt(2)
i2 v[32:35],v[20:23],v[50:53],0
i9 v[60:63],v6 offset:14336
i19 v41,v57
i2 v[12:15],v[26:29],v[50:53],0
i19 v42,v58
i19 v43,v59
i3 v48,v40,v41
i3 v49,v42,v43
i14 v[36:37],s[48:49]
i14 v[38:39],s[50:51]
i2 v[28:31],v[16:19],v[48:51],0
i11 v0,v0
i2 v[40:43],v[36:39],v[48:51],0
i2 v[44:47],v[22:25],v[48:51],0
i8 lgkmcnt(0)
i29 v28,v32,v28 row_ror:8 row_mask:0xf bank_mask:0x3
i29 v29,v33,v29 row_ror:8 row_mask:0xf bank_mask:0x3
i29 v30,v34,v30 row_ror:8 row_mask:0xf bank_mask:0x3
i29 v31,v35,v31 row_ror:8 row_mask:0xf bank_mask:0x3
i29 v40,v40,v40 row_ror:8 row_mask:0xf bank_mask:0xf
v_rcp_f32 v42, v40
v_cmp_nlt_f32 vcc, s54, v40
v_cmp_ngt_f32 s[22:23], s55, v40
i29 v28,v44,v12 row_ror:8 row_mask:0xf bank_mask:0xc
i29 v29,v45,v13 row_ror:8 row_mask:0xf bank_mask:0xc
i29 v30,v46,v14 row_ror:8 row_mask:0xf bank_mask:0xc
i29 v31,v47,v15 row_ror:8 row_mask:0xf bank_mask:0xc
i16 v[28:29],v[28:29],v[42:43] op_sel_hi:[1,0]
i16 v[30:31],v[30:31],v[42:43] op_sel_hi:[1,0]
i3 v28,v28,v29
i3 v29,v30,v31
ds_write_b64 v60, v[28:29] offset:512
i14 v[40:41],0
i14 v[42:43],0
i14 v[12:13],0
i14 v[14:15],0
i14 v[36:37],0
i14 v[38:39],0
i53 vcc,vcc,s[22:23]
i22 Lc1f_slow
Lc1f_cont:
i14 v[56:57],0
i14 v[58:59],0
i14 v[8:9],0
i14 v[10:11],0
i8 lgkmcnt(0)
s_barrier
i9 v[28:31],v61 offset:0
i9 v[32:35],v61 offset:512
i9 v[44:47],v61 offset:1024
i9 v[48:51],v61 offset:1536
i9 v[16:19],v4 offset:22528
i9 v[20:23],v4 offset:23552
i8 lgkmcnt(5)
i4 v[56:59],v[28:31],v[64:71],v1
i9 v[64:67],v4 offset:28672
i8 lgkmcnt(5)
i4 v[56:59],v[32:35],v[72:79],v1
i9 v[68:71],v4 offset:29696
i8 lgkmcnt(5)
i4 v[56:59],v[44:47],a[248:255],v1
i9 v[72:75],v4 offset:30720
i8 lgkmcnt(3)
i4 v[56:59],v[48:51],v[16:23],v1
i9 v[76:79],v4 offset:31744
i9 v[16:19],v62 offset:0
i4 v[36:39],v[28:31],a[80:87],v1
i9 v[20:23],v62 offset:1024
i23 v26,9,v0
i4 v[36:39],v[32:35],a[88:95],v1
i8 lgkmcnt(4)
i3 v56,v56,v57
i4 v[36:39],v[44:47],v[64:71],v1
i8 lgkmcnt(2)
i3 v57,v58,v59
i4 v[36:39],v[48:51],v[72:79],v1
i9 v[64:67],v4 offset:32768
v_bfi_b32 v56, 1, s76, v56
i4 v[8:11],v[28:31],a[96:103],v1
i41 v[56:57],v63,s[8:11],s26 offen offset:0
i4 v[8:11],v[32:35],a[104:111],v1
i9 v[68:71],v4 offset:33792
i3 v36,v36,v37
i4 v[8:11],v[44:47],a[112:119],v1
i9 v[72:75],v4 offset:34816
i3 v37,v38,v39
i4 v[8:11],v[48:51],a[120:127],v1
i9 v[76:79],v4 offset:35840
v_bfi_b32 v36, 1, s76, v36
i4 v[12:15],v[28:31],a[128:135],v1
i41 v[36:37],v63,s[8:11],s26 offen offset:2048
i4 v[12:15],v[32:35],a[136:143],v1
i8 lgkmcnt(2)
i3 v8,v8,v9
i4 v[40:43],v[16:19],v[64:71],v1
i8 lgkmcnt(0)
i3 v9,v10,v11
i4 v[40:43],v[20:23],v[72:79],v1
i9 v[72:75],v6 offset:13312
v_bfi_b32 v8, 1, s76, v8
i4 v[12:15],v[44:47],a[144:151],v1
i41 v[8:9],v63,s[8:11],s27 offen offset:0
i4 v[12:15],v[48:51],a[152:159],v1
i40 v40,v42
i40 v41,v43
v_add_f32 v40, v40, v42
v_add_f32 v41, v41, v43
i3 v40,v40,v41
i18 v27,0xff,v63
v_bfi_b32 v40, 1, s76, v40
i24 v27,v26,2,v27
i3 v12,v12,v13
i3 v13,v14,v15
v_bfi_b32 v12, 1, s76, v12
i41 v[12:13],v63,s[8:11],s27 offen offset:2048
i52 v40,v27,s[8:11],s28 offen
i23 v24,7,v0
i18 v25,0x70,v0
i45 v24,v24,s77,v25
i11 v0,v0
i15 2
i11 v0,v0
i15 2
i11 v0,v0
i15 2
i11 v0,v0
i15 2
i11 v0,v0
i15 2
i11 v0,v0
i15 2
i11 v0,v0
i15 2
i11 v0,v0
i15 2
i11 v0,v0
i15 2
i11 v0,v0
i15 2
i11 v0,v0
i15 2
i11 v0,v0
i15 2
i11 v0,v0
i15 2
i11 v0,v0
i15 2
i11 v0,v0
i15 2
i11 v0,v0
i15 2
i11 v0,v0
i15 2
i11 v0,v0
i15 2
i11 v0,v0
i15 2
i11 v0,v0
i15 2
i11 v0,v0
i15 2
i11 v0,v0
i15 2
i11 v0,v0
i15 2
i1 v[52:55],v24,s[8:11],s29 offen sc1
i1 v[56:59],v24,s[8:11],s30 offen sc1
i1 v[8:11],v24,s[8:11],s31 offen sc1
i1 v[12:15],v24,s[8:11],s32 offen sc1
i14 v[28:29],0
i14 v[30:31],0
i14 v[32:33],0
i14 v[34:35],0
i14 v[44:45],0
i14 v[46:47],0
i14 v[48:49],0
i14 v[50:51],0
i24 v25,v26,2,v25
i34 v17,v0,8,1
i24 v25,v17,3,v25
i34 v17,v0,7,1
i24 v25,v17,31,v25
i18 v16,0x33f,v0
i24 v16,v17,6,v16
i34 v17,v0,6,1
i24 v16,v17,7,v16
i11 v0,v0
i15 2
i11 v0,v0
i15 2
i11 v0,v0
i15 2
i11 v0,v0
i15 2
i8 lgkmcnt(0)
i8 vmcnt(3)
i2 v[64:67],v[52:55],v[72:75],0
i42 v20,v52,v54,s76 bitop3:0x81
i8 vmcnt(2)
i2 v[64:67],v[56:59],v[72:75],v[64:67]
i42 v21,v56,v58,s76 bitop3:0x81
i8 vmcnt(1)
i2 v[64:67],v[8:11],v[72:75],v[64:67]
i42 v22,v8,v10,s76 bitop3:0x81
i8 vmcnt(0)
i2 v[64:67],v[12:15],v[72:75],v[64:67]
i42 v23,v12,v14,s76 bitop3:0x81
i42 v17,v20,v21,v22 bitop3:0x80
i42 v17,v17,v23,1 bitop3:0x80
i25 vcc,0,v17
i11 v0,v0
i11 v0,v0
i11 v0,v0
i11 v0,v0
i40 v64,v66
i40 v65,v67
v_pk_add_f32 v[64:65], v[64:65], v[66:67]
i3 v64,v64,v65
i49 Lc1f_rf
Lc1f_rn:
i52 v64,v25,s[8:11],s33 offen
i11 v22,v64
i11 v23,v25
i6 s25,s25,1
s_cmp_lt_u32 s25, 63
i22 Lc1f_top
i44 Lc1f_out
Lc1f_rf:
i18 v17,1,v20
i25 s[12:13],0,v17
i18 v17,1,v21
i25 s[14:15],0,v17
i18 v17,1,v22
i25 s[16:17],0,v17
i18 v17,1,v23
i25 s[18:19],0,v17
i53 exec,s[12:13],1
i1 v[52:55],v24,s[8:11],s29 offen sc1
i53 exec,s[14:15],1
i1 v[56:59],v24,s[8:11],s30 offen sc1
i53 exec,s[16:17],1
i1 v[8:11],v24,s[8:11],s31 offen sc1
i53 exec,s[18:19],1
i1 v[12:15],v24,s[8:11],s32 offen sc1
i39 exec,-1
i11 v0,v0
i15 2
i11 v0,v0
i15 2
i11 v0,v0
i15 2
i11 v0,v0
i15 2
Lc1f_rg:
i53 exec,s[12:13],1
i1 v[52:55],v24,s[8:11],s29 offen sc1
i53 exec,s[14:15],1
i1 v[56:59],v24,s[8:11],s30 offen sc1
i53 exec,s[16:17],1
i1 v[8:11],v24,s[8:11],s31 offen sc1
i53 exec,s[18:19],1
i1 v[12:15],v24,s[8:11],s32 offen sc1
i39 exec,-1
i6 s46,s46,1
i35 s46,400000
i22 L_endc
i8 vmcnt(4)
i42 v20,v52,v54,s76 bitop3:0x81
i42 v21,v56,v58,s76 bitop3:0x81
i42 v22,v8,v10,s76 bitop3:0x81
i42 v23,v12,v14,s76 bitop3:0x81
i2 v[64:67],v[52:55],v[72:75],0
i18 v17,1,v20
i25 s[12:13],0,v17
i2 v[64:67],v[56:59],v[72:75],v[64:67]
i18 v17,1,v21
i25 s[14:15],0,v17
i2 v[64:67],v[8:11],v[72:75],v[64:67]
i18 v17,1,v22
i25 s[16:17],0,v17
i2 v[64:67],v[12:15],v[72:75],v[64:67]
i18 v17,1,v23
i25 s[18:19],0,v17
i42 v17,v20,v21,v22 bitop3:0x80
i42 v17,v17,v23,1 bitop3:0x80
i25 vcc,0,v17
i11 v0,v0
i11 v0,v0
i11 v0,v0
i40 v64,v66
i40 v65,v67
v_pk_add_f32 v[64:65], v[64:65], v[66:67]
i3 v64,v64,v65
i49 Lc1f_rg
i44 Lc1f_rn
Lc1f_pb2:
i53 exec,vcc,1
i1 v[52:55],v16,s[8:11],s35 offen sc1
i39 exec,-1
i6 s46,s46,1
i35 s46,400000
i22 L_endc
i11 v0,v0
i15 2
i11 v0,v0
i15 2
i11 v0,v0
i15 2
i11 v0,v0
i15 2
i44 Lc1f_pb
Lc1f_lp:
i53 exec,vcc,1
i1 v[60:63],v16,s[8:11],s37 offen sc1
i1 v[24:27],v16,s[8:11],s36 offen sc1
i39 exec,-1
i11 v0,v0
i15 2
i11 v0,v0
i15 2
i11 v0,v0
i15 2
i11 v0,v0
i15 2
i11 v0,v0
i15 2
Lc1f_lp2:
i53 exec,vcc,1
i1 v[60:63],v16,s[8:11],s37 offen sc1
i1 v[24:27],v16,s[8:11],s36 offen sc1
i39 exec,-1
i6 s46,s46,1
i35 s46,400000
i22 L_endc
i11 v0,v0
i15 2
i11 v0,v0
i15 2
i8 vmcnt(2)
i48 v17,v60,v61,v62
i48 v17,v17,v24,v25
i48 v17,v17,v26,v27
v_max_u32 v17, v17, v63
i25 vcc,-1,v17
i49 Lc1f_lp2
i44 Lc1f_lok
Lc1f_slow:
i38 v28,v8,v9,v10
i38 v29,v11,v56,v57
i38 v28,v28,v58,v59
v_max_f32 v28, v28, v29
i11 v0,v0
i11 v0,v0
v_max_f32_dpp v28, v28, v28 row_ror:8 row_mask:0xf bank_mask:0xf
i11 v29,v28
i11 v0,v0
i11 v0,v0
v_permlane16_swap_b32 v28, v29
v_max_f32 v28, v28, v29
i11 v29,v28
i11 v0,v0
i11 v0,v0
i40 v28,v29
v_max_f32 v28, v28, v29
i33 v8,v8,v28
i19 v8,v8
i33 v9,v9,v28
i19 v9,v9
i33 v10,v10,v28
i19 v10,v10
i33 v11,v11,v28
i19 v11,v11
i33 v56,v56,v28
i19 v56,v56
i33 v57,v57,v28
i19 v57,v57
i33 v58,v58,v28
i19 v58,v58
i33 v59,v59,v28
i19 v59,v59
i3 v48,v56,v57
i3 v49,v58,v59
i3 v50,v8,v9
i3 v51,v10,v11
i14 v[28:29],0
i14 v[36:37],s[48:49]
i14 v[38:39],s[50:51]
i2 v[32:35],v[20:23],v[50:53],0
i2 v[12:15],v[26:29],v[50:53],0
i2 v[28:31],v[16:19],v[48:51],0
i2 v[40:43],v[36:39],v[48:51],0
i2 v[44:47],v[22:25],v[48:51],0
i29 v28,v32,v28 row_ror:8 row_mask:0xf bank_mask:0x3
i29 v29,v33,v29 row_ror:8 row_mask:0xf bank_mask:0x3
i29 v30,v34,v30 row_ror:8 row_mask:0xf bank_mask:0x3
i29 v31,v35,v31 row_ror:8 row_mask:0xf bank_mask:0x3
i29 v40,v40,v40 row_ror:8 row_mask:0xf bank_mask:0xf
v_rcp_f32 v42, v40
v_cmp_nlt_f32 vcc, s54, v40
v_cmp_ngt_f32 s[22:23], s55, v40
i29 v28,v44,v12 row_ror:8 row_mask:0xf bank_mask:0xc
i29 v29,v45,v13 row_ror:8 row_mask:0xf bank_mask:0xc
i29 v30,v46,v14 row_ror:8 row_mask:0xf bank_mask:0xc
i29 v31,v47,v15 row_ror:8 row_mask:0xf bank_mask:0xc
i16 v[28:29],v[28:29],v[42:43] op_sel_hi:[1,0]
i16 v[30:31],v[30:31],v[42:43] op_sel_hi:[1,0]
i3 v28,v28,v29
i3 v29,v30,v31
ds_write_b64 v60, v[28:29] offset:512
i14 v[40:41],0
i14 v[42:43],0
i14 v[12:13],0
i14 v[14:15],0
i14 v[36:37],0
i14 v[38:39],0
i44 Lc1f_cont
Lc1f_out:
i52 v22,v23,s[8:11],s53 offen sc1
i8 vmcnt(0)
i44 L_endc
L_cs1:
i11 v16,v58
i11 v25,v57
i11 v23,0x80000000
i11 v22,0
i11 v5,64
i39 s[72:73],s[100:101]
i54 s74,256
i5 s75,0x20000
i54 s4,64
i6 s5,s38,262144
i5 s35,70255616
i5 s36,70262784
i5 s37,70259712
i18 v56,0x1f0,v0
i31 v56,2,v56
i23 v57,9,v0
i24 v56,v57,24,v56
i36 v56,v56,s[8:11],s38 offen sc1
i14 v[28:29],0
i14 v[30:31],0
i14 v[32:33],0
i14 v[34:35],0
i14 v[44:45],0
i14 v[46:47],0
i14 v[48:49],0
i14 v[50:51],0
i8 lgkmcnt(0)
Lc1s_top:
i1 v[52:55],v16,s[8:11],s35 offen sc1
i9 v[64:67],v4 offset:2048
i9 v[68:71],v4 offset:3072
i9 v[72:75],v4 offset:4096
i9 v[76:79],v4 offset:5120
i14 v[36:37],0
i14 v[38:39],0
i14 v[40:41],0
i14 v[42:43],0
i11 v18,-1
i52 v18,v25,s[8:11],s52 offen sc1
i11 v0,v0
i15 2
i11 v0,v0
i15 2
i11 v0,v0
i15 2
i11 v0,v0
i15 2
i1 v[52:55],v16,s[8:11],s35 offen sc1
i11 v0,v0
i15 2
i11 v0,v0
i15 2
i11 v0,v0
i15 2
i11 v0,v0
i15 2
i11 v0,v0
i15 2
Lc1s_pb:
i8 vmcnt(1)
i48 v17,v52,v53,v54
v_max_u32 v17, v17, v55
i25 vcc,-1,v17
i11 v0,v0
i11 v0,v0
i11 v0,v0
i11 v0,v0
i11 v0,v0
i49 Lc1s_pb2
Lc1s_go:
i4 v[28:31],v[52:55],v[80:87],v1
i21 v6,v[52:55] offset:1024
i5 s52,s34
i4 v[32:35],v[52:55],v[88:95],v1
i1 v[60:63],v16,s[8:11],s37 offen sc1
s_xor_b32 s78, s78, 524288
s_bfe_i32 s76, s25, 0x10001
i4 v[36:39],v[52:55],a[160:167],v1
i8 lgkmcnt(1)
i1 v[24:27],v16,s[8:11],s36 offen sc1
i6 s34,s41,s47
i4 v[40:43],v[52:55],v[64:71],v1
i6 s47,s47,16384
s_and_b32 s47, s47, 65535
i54 s24,1040
i4 v[44:47],v[52:55],v[224:231],v1
i6 s33,s41,s47
i6 s35,s47,70255616
i6 s28,s79,s78
i4 v[48:51],v[52:55],v[232:239],v1
i8 lgkmcnt(0)
s_barrier
i9 v[56:59],v6 offset:2048
i9 v[8:11],v6 offset:3072
i1 v[18:21],v0,s[8:11],s39 offen sc1
i8 lgkmcnt(1)
i4 v[28:31],v[56:59],v[96:103],v1
i9 v[64:67],v4 offset:6144
i6 s26,s28,512
i4 v[32:35],v[56:59],v[104:111],v1
i9 v[68:71],v4 offset:7168
i6 s27,s28,4608
i4 v[36:39],v[56:59],a[168:175],v1
i9 v[12:15],v6 offset:0
i6 s28,s28,8448
i4 v[40:43],v[56:59],v[72:79],v1
i9 v[72:75],v4 offset:0
i8 lgkmcnt(4)
i4 v[44:47],v[56:59],v[240:247],v1
i9 v[76:79],v4 offset:1024
i18 v5,0xf0,v0
i4 v[28:31],v[8:11],v[112:119],v1
i6 s29,s7,s78
i6 s30,s29,73728
i31 v5,3,v5
i4 v[32:35],v[8:11],v[120:127],v1
i6 s31,s29,147456
i6 s32,s29,221184
i34 v17,v0,8,1
i4 v[36:39],v[8:11],a[176:183],v1
i8 lgkmcnt(2)
i24 v5,v17,24,v5
i4 v[40:43],v[8:11],v[64:71],v1
i8 vmcnt(1)
i48 v17,v60,v61,v62
i4 v[28:31],v[12:15],v[128:135],v1
i9 v[64:67],v4 offset:16384
i48 v17,v17,v24,v25
i4 v[32:35],v[12:15],v[136:143],v1
i9 v[68:71],v4 offset:17408
i48 v17,v17,v26,v27
i4 v[36:39],v[12:15],a[184:191],v1
i8 lgkmcnt(2)
v_max_u32 v17, v17, v63
i4 v[40:43],v[12:15],v[72:79],v1
i25 vcc,-1,v17
i4 v[48:51],v[56:59],v[248:255],v1
i49 Lc1s_lp
Lc1s_lok:
i4 v[28:31],v[24:27],v[144:151],v1
i21 v6,v[60:63] offset:5120
i4 v[32:35],v[24:27],v[152:159],v1
i1 v[8:11],v0,s[8:11],s38 offen sc1
i4 v[36:39],v[24:27],a[192:199],v1
i8 lgkmcnt(1)
i4 v[40:43],v[24:27],v[64:71],v1
i9 v[72:75],v4 offset:10240
i4 v[44:47],v[24:27],a[32:39],v1
i9 v[76:79],v4 offset:11264
i1 v[12:15],v0,s[8:11],s38 offen offset:1024 sc1
i4 v[48:51],v[24:27],a[40:47],v1
i1 v[24:27],v0,s[8:11],s39 offen offset:1024 sc1
i8 lgkmcnt(2)
s_barrier
i9 v[56:59],v6 offset:6144
i4 v[44:47],v[60:63],a[48:55],v1
i36 v5,v5,s[8:11],s5 offen sc1
i6 s38,s38,262144
i18 v16,0x70,v0
i4 v[48:51],v[60:63],a[56:63],v1
i9 v[52:55],v6 offset:4096
i31 v16,1,v16
i4 v[28:31],v[60:63],v[160:167],v1
i9 v[64:67],v4 offset:12288
i23 v17,8,v0
i4 v[32:35],v[60:63],v[168:175],v1
i9 v[68:71],v4 offset:13312
i45 v17,v17,s24,v16
i4 v[36:39],v[60:63],a[200:207],v1
i8 vmcnt(4)
i8 lgkmcnt(4)
i20 v17,155648,v17
i4 v[40:43],v[60:63],v[72:79],v1
i9 v[60:63],v6 offset:7168
i8 lgkmcnt(4)
i4 v[28:31],v[56:59],v[176:183],v1
i9 v[72:75],v4 offset:14336
i18 v16,0x80,v0
i4 v[32:35],v[56:59],v[184:191],v1
i9 v[76:79],v4 offset:15360
i17 v16,v16,1,v17
i4 v[36:39],v[56:59],a[208:215],v1
i8 lgkmcnt(3)
i6 s37,s47,70259712
i6 s36,s47,70262784
i4 v[40:43],v[56:59],v[64:71],v1
i9 v[64:67],v4 offset:8192
i8 lgkmcnt(3)
i4 v[28:31],v[60:63],v[192:199],v1
i9 v[68:71],v4 offset:9216
i6 s39,s39,262144
i4 v[32:35],v[60:63],v[200:207],v1
i52 v22,v23,s[8:11],s53 offen sc1
i6 s5,s5,262144
i4 v[36:39],v[60:63],a[216:223],v1
i8 lgkmcnt(2)
i4 v[40:43],v[60:63],v[72:79],v1
i9 v[72:75],v4 offset:20480
i4 v[28:31],v[52:55],v[208:215],v1
i9 v[76:79],v4 offset:21504
i4 v[32:35],v[52:55],v[216:223],v1
i4 v[36:39],v[52:55],a[224:231],v1
i8 lgkmcnt(2)
i4 v[40:43],v[52:55],v[64:71],v1
i9 v[64:67],v4 offset:18432
i3 v28,v28,v29
i3 v29,v30,v31
i3 v30,v32,v33
i3 v31,v34,v35
i3 v36,v36,v37
i3 v37,v38,v39
i27 v[32:35],v[28:29],v[2:3],0
i3 v38,v40,v41
i3 v39,v42,v43
i27 v[40:43],v[30:31],v[2:3],0
i9 v[68:71],v4 offset:19456
i8 vmcnt(3)
i27 v[28:31],v[36:37],v[2:3],0
i3 v32,v32,v33
i3 v33,v34,v35
i27 v[56:59],v[38:39],v[2:3],0
i3 v34,v40,v41
i3 v35,v42,v43
i11 v0,v0
i11 v0,v0
i2 v[40:43],v[8:11],v[32:35],0
i9 v[8:11],v6 offset:3072
i3 v28,v28,v29
i3 v29,v30,v31
i2 v[36:39],v[12:15],v[32:35],0
i9 v[12:15],v6 offset:0
i3 v30,v56,v57
i3 v31,v58,v59
i11 v0,v0
i11 v0,v0
i2 v[56:59],v[28:31],v[32:35],0
i8 lgkmcnt(2)
i3 v40,v40,v41
i3 v41,v42,v43
i3 v36,v36,v37
i3 v37,v38,v39
i4 v[44:47],v[52:55],a[232:239],v1
ds_write_b64 v7, v[40:41] offset:0
ds_write_b64 v7, v[36:37] offset:256
i3 v56,v56,v57
i3 v57,v58,v59
i4 v[48:51],v[52:55],v[64:71],v1
ds_write_b64 v7, v[56:57] offset:512
i4 v[48:51],v[60:63],v[72:79],v1
i9 v[28:31],v6 offset:13312
i4 v[44:47],v[60:63],a[240:247],v1
i9 v[60:63],v6 offset:6144
i8 lgkmcnt(5)
i4 v[44:47],v[12:15],a[16:23],v1
i9 v[32:35],v6 offset:15360
i4 v[48:51],v[12:15],a[24:31],v1
i8 lgkmcnt(3)
s_barrier
i9 v[12:15],v16
i4 v[44:47],v[8:11],a[0:7],v1
i9 v[40:43],v16 offset:16
i6 s53,s53,16384
i4 v[48:51],v[8:11],a[8:15],v1
i9 v[36:39],v17 offset:512
i8 lgkmcnt(4)
i4 v[44:47],v[60:63],a[64:71],v1
i9 v[64:67],v4 offset:24576
i14 v[52:53],0
i4 v[48:51],v[60:63],a[72:79],v1
i9 v[68:71],v4 offset:25600
i8 lgkmcnt(3)
i2 v[8:11],v[28:31],v[12:15],0
i9 v[72:75],v4 offset:26624
i2 v[8:11],v[32:35],v[40:43],v[8:11]
i8 lgkmcnt(3)
i3 v16,v44,v45
i2 v[56:59],v[28:31],v[36:39],0
i3 v17,v46,v47
i3 v22,v48,v49
i2 v[56:59],v[32:35],v[36:39],v[56:59]
i9 v[76:79],v4 offset:27648
i19 v12,v8
i19 v13,v9
i19 v14,v10
i19 v15,v11
i3 v23,v50,v51
i3 v50,v12,v13
i3 v51,v14,v15
i16 v[56:57],v[56:57],s[42:43]
i16 v[58:59],v[58:59],s[42:43]
i19 v40,v56
i8 vmcnt(2)
i2 v[32:35],v[20:23],v[50:53],0
i9 v[60:63],v6 offset:14336
i19 v41,v57
i2 v[12:15],v[26:29],v[50:53],0
i19 v42,v58
i19 v43,v59
i3 v48,v40,v41
i3 v49,v42,v43
i14 v[36:37],s[48:49]
i14 v[38:39],s[50:51]
i2 v[28:31],v[16:19],v[48:51],0
i11 v0,v0
i2 v[40:43],v[36:39],v[48:51],0
i2 v[44:47],v[22:25],v[48:51],0
i8 lgkmcnt(0)
i29 v28,v32,v28 row_ror:8 row_mask:0xf bank_mask:0x3
i29 v29,v33,v29 row_ror:8 row_mask:0xf bank_mask:0x3
i29 v30,v34,v30 row_ror:8 row_mask:0xf bank_mask:0x3
i29 v31,v35,v31 row_ror:8 row_mask:0xf bank_mask:0x3
i29 v40,v40,v40 row_ror:8 row_mask:0xf bank_mask:0xf
v_rcp_f32 v42, v40
v_cmp_nlt_f32 vcc, s54, v40
v_cmp_ngt_f32 s[22:23], s55, v40
i29 v28,v44,v12 row_ror:8 row_mask:0xf bank_mask:0xc
i29 v29,v45,v13 row_ror:8 row_mask:0xf bank_mask:0xc
i29 v30,v46,v14 row_ror:8 row_mask:0xf bank_mask:0xc
i29 v31,v47,v15 row_ror:8 row_mask:0xf bank_mask:0xc
i16 v[28:29],v[28:29],v[42:43] op_sel_hi:[1,0]
i16 v[30:31],v[30:31],v[42:43] op_sel_hi:[1,0]
i3 v28,v28,v29
i3 v29,v30,v31
ds_write_b64 v60, v[28:29] offset:512
i14 v[40:41],0
i14 v[42:43],0
i14 v[12:13],0
i14 v[14:15],0
i14 v[36:37],0
i14 v[38:39],0
i53 vcc,vcc,s[22:23]
i22 Lc1s_slow
Lc1s_cont:
i14 v[56:57],0
i14 v[58:59],0
i14 v[8:9],0
i14 v[10:11],0
i8 lgkmcnt(0)
s_barrier
i9 v[28:31],v61 offset:0
i9 v[32:35],v61 offset:512
i9 v[44:47],v61 offset:1024
i9 v[48:51],v61 offset:1536
i9 v[16:19],v4 offset:22528
i9 v[20:23],v4 offset:23552
i8 lgkmcnt(5)
i4 v[56:59],v[28:31],v[64:71],v1
i9 v[64:67],v4 offset:28672
i8 lgkmcnt(5)
i4 v[56:59],v[32:35],v[72:79],v1
i9 v[68:71],v4 offset:29696
i8 lgkmcnt(5)
i4 v[56:59],v[44:47],a[248:255],v1
i9 v[72:75],v4 offset:30720
i8 lgkmcnt(3)
i4 v[56:59],v[48:51],v[16:23],v1
i9 v[76:79],v4 offset:31744
i9 v[16:19],v62 offset:0
i4 v[36:39],v[28:31],a[80:87],v1
i9 v[20:23],v62 offset:1024
i23 v26,9,v0
i4 v[36:39],v[32:35],a[88:95],v1
i8 lgkmcnt(4)
i3 v56,v56,v57
i4 v[36:39],v[44:47],v[64:71],v1
i8 lgkmcnt(2)
i3 v57,v58,v59
i4 v[36:39],v[48:51],v[72:79],v1
i9 v[64:67],v4 offset:32768
v_bfi_b32 v56, 1, s76, v56
i4 v[8:11],v[28:31],a[96:103],v1
i41 v[56:57],v63,s[8:11],s26 offen offset:0 sc1
i4 v[8:11],v[32:35],a[104:111],v1
i9 v[68:71],v4 offset:33792
i3 v36,v36,v37
i4 v[8:11],v[44:47],a[112:119],v1
i9 v[72:75],v4 offset:34816
i3 v37,v38,v39
i4 v[8:11],v[48:51],a[120:127],v1
i9 v[76:79],v4 offset:35840
v_bfi_b32 v36, 1, s76, v36
i4 v[12:15],v[28:31],a[128:135],v1
i41 v[36:37],v63,s[8:11],s26 offen offset:2048 sc1
i4 v[12:15],v[32:35],a[136:143],v1
i8 lgkmcnt(2)
i3 v8,v8,v9
i4 v[40:43],v[16:19],v[64:71],v1
i8 lgkmcnt(0)
i3 v9,v10,v11
i4 v[40:43],v[20:23],v[72:79],v1
i9 v[72:75],v6 offset:13312
v_bfi_b32 v8, 1, s76, v8
i4 v[12:15],v[44:47],a[144:151],v1
i41 v[8:9],v63,s[8:11],s27 offen offset:0 sc1
i4 v[12:15],v[48:51],a[152:159],v1
i40 v40,v42
i40 v41,v43
v_add_f32 v40, v40, v42
v_add_f32 v41, v41, v43
i3 v40,v40,v41
i18 v27,0xff,v63
v_bfi_b32 v40, 1, s76, v40
i24 v27,v26,2,v27
i3 v12,v12,v13
i3 v13,v14,v15
v_bfi_b32 v12, 1, s76, v12
i41 v[12:13],v63,s[8:11],s27 offen offset:2048 sc1
i52 v40,v27,s[8:11],s28 offen sc1
i23 v24,7,v0
i18 v25,0x70,v0
i45 v24,v24,s77,v25
i11 v0,v0
i15 2
i11 v0,v0
i15 2
i11 v0,v0
i15 2
i11 v0,v0
i15 2
i11 v0,v0
i15 2
i11 v0,v0
i15 2
i11 v0,v0
i15 2
i11 v0,v0
i15 2
i11 v0,v0
i15 2
i11 v0,v0
i15 2
i11 v0,v0
i15 2
i11 v0,v0
i15 2
i11 v0,v0
i15 2
i11 v0,v0
i15 2
i11 v0,v0
i15 2
i11 v0,v0
i15 2
i11 v0,v0
i15 2
i11 v0,v0
i15 2
i11 v0,v0
i15 2
i11 v0,v0
i15 2
i11 v0,v0
i15 2
i11 v0,v0
i15 2
i11 v0,v0
i15 2
i1 v[52:55],v24,s[8:11],s29 offen sc1
i1 v[56:59],v24,s[8:11],s30 offen sc1
i1 v[8:11],v24,s[8:11],s31 offen sc1
i1 v[12:15],v24,s[8:11],s32 offen sc1
i14 v[28:29],0
i14 v[30:31],0
i14 v[32:33],0
i14 v[34:35],0
i14 v[44:45],0
i14 v[46:47],0
i14 v[48:49],0
i14 v[50:51],0
i24 v25,v26,2,v25
i34 v17,v0,8,1
i24 v25,v17,3,v25
i34 v17,v0,7,1
i24 v25,v17,31,v25
i18 v16,0x33f,v0
i24 v16,v17,6,v16
i34 v17,v0,6,1
i24 v16,v17,7,v16
i11 v0,v0
i15 2
i11 v0,v0
i15 2
i11 v0,v0
i15 2
i11 v0,v0
i15 2
i8 lgkmcnt(0)
i8 vmcnt(3)
i2 v[64:67],v[52:55],v[72:75],0
i42 v20,v52,v54,s76 bitop3:0x81
i8 vmcnt(2)
i2 v[64:67],v[56:59],v[72:75],v[64:67]
i42 v21,v56,v58,s76 bitop3:0x81
i8 vmcnt(1)
i2 v[64:67],v[8:11],v[72:75],v[64:67]
i42 v22,v8,v10,s76 bitop3:0x81
i8 vmcnt(0)
i2 v[64:67],v[12:15],v[72:75],v[64:67]
i42 v23,v12,v14,s76 bitop3:0x81
i42 v17,v20,v21,v22 bitop3:0x80
i42 v17,v17,v23,1 bitop3:0x80
i25 vcc,0,v17
i11 v0,v0
i11 v0,v0
i11 v0,v0
i11 v0,v0
i40 v64,v66
i40 v65,v67
v_pk_add_f32 v[64:65], v[64:65], v[66:67]
i3 v64,v64,v65
i49 Lc1s_rf
Lc1s_rn:
i52 v64,v25,s[8:11],s33 offen sc1
i11 v22,v64
i11 v23,v25
i6 s25,s25,1
s_cmp_lt_u32 s25, 63
i22 Lc1s_top
i44 Lc1s_out
Lc1s_rf:
i18 v17,1,v20
i25 s[12:13],0,v17
i18 v17,1,v21
i25 s[14:15],0,v17
i18 v17,1,v22
i25 s[16:17],0,v17
i18 v17,1,v23
i25 s[18:19],0,v17
i53 exec,s[12:13],1
i1 v[52:55],v24,s[8:11],s29 offen sc1
i53 exec,s[14:15],1
i1 v[56:59],v24,s[8:11],s30 offen sc1
i53 exec,s[16:17],1
i1 v[8:11],v24,s[8:11],s31 offen sc1
i53 exec,s[18:19],1
i1 v[12:15],v24,s[8:11],s32 offen sc1
i39 exec,-1
i11 v0,v0
i15 2
i11 v0,v0
i15 2
i11 v0,v0
i15 2
i11 v0,v0
i15 2
Lc1s_rg:
i53 exec,s[12:13],1
i1 v[52:55],v24,s[8:11],s29 offen sc1
i53 exec,s[14:15],1
i1 v[56:59],v24,s[8:11],s30 offen sc1
i53 exec,s[16:17],1
i1 v[8:11],v24,s[8:11],s31 offen sc1
i53 exec,s[18:19],1
i1 v[12:15],v24,s[8:11],s32 offen sc1
i39 exec,-1
i6 s46,s46,1
i35 s46,400000
i22 L_endc
i8 vmcnt(4)
i42 v20,v52,v54,s76 bitop3:0x81
i42 v21,v56,v58,s76 bitop3:0x81
i42 v22,v8,v10,s76 bitop3:0x81
i42 v23,v12,v14,s76 bitop3:0x81
i2 v[64:67],v[52:55],v[72:75],0
i18 v17,1,v20
i25 s[12:13],0,v17
i2 v[64:67],v[56:59],v[72:75],v[64:67]
i18 v17,1,v21
i25 s[14:15],0,v17
i2 v[64:67],v[8:11],v[72:75],v[64:67]
i18 v17,1,v22
i25 s[16:17],0,v17
i2 v[64:67],v[12:15],v[72:75],v[64:67]
i18 v17,1,v23
i25 s[18:19],0,v17
i42 v17,v20,v21,v22 bitop3:0x80
i42 v17,v17,v23,1 bitop3:0x80
i25 vcc,0,v17
i11 v0,v0
i11 v0,v0
i11 v0,v0
i40 v64,v66
i40 v65,v67
v_pk_add_f32 v[64:65], v[64:65], v[66:67]
i3 v64,v64,v65
i49 Lc1s_rg
i44 Lc1s_rn
Lc1s_pb2:
i53 exec,vcc,1
i1 v[52:55],v16,s[8:11],s35 offen sc1
i39 exec,-1
i6 s46,s46,1
i35 s46,400000
i22 L_endc
i11 v0,v0
i15 2
i11 v0,v0
i15 2
i11 v0,v0
i15 2
i11 v0,v0
i15 2
i44 Lc1s_pb
Lc1s_lp:
i53 exec,vcc,1
i1 v[60:63],v16,s[8:11],s37 offen sc1
i1 v[24:27],v16,s[8:11],s36 offen sc1
i39 exec,-1
i11 v0,v0
i15 2
i11 v0,v0
i15 2
i11 v0,v0
i15 2
i11 v0,v0
i15 2
i11 v0,v0
i15 2
Lc1s_lp2:
i53 exec,vcc,1
i1 v[60:63],v16,s[8:11],s37 offen sc1
i1 v[24:27],v16,s[8:11],s36 offen sc1
i39 exec,-1
i6 s46,s46,1
i35 s46,400000
i22 L_endc
i11 v0,v0
i15 2
i11 v0,v0
i15 2
i8 vmcnt(2)
i48 v17,v60,v61,v62
i48 v17,v17,v24,v25
i48 v17,v17,v26,v27
v_max_u32 v17, v17, v63
i25 vcc,-1,v17
i49 Lc1s_lp2
i44 Lc1s_lok
Lc1s_slow:
i38 v28,v8,v9,v10
i38 v29,v11,v56,v57
i38 v28,v28,v58,v59
v_max_f32 v28, v28, v29
i11 v0,v0
i11 v0,v0
v_max_f32_dpp v28, v28, v28 row_ror:8 row_mask:0xf bank_mask:0xf
i11 v29,v28
i11 v0,v0
i11 v0,v0
v_permlane16_swap_b32 v28, v29
v_max_f32 v28, v28, v29
i11 v29,v28
i11 v0,v0
i11 v0,v0
i40 v28,v29
v_max_f32 v28, v28, v29
i33 v8,v8,v28
i19 v8,v8
i33 v9,v9,v28
i19 v9,v9
i33 v10,v10,v28
i19 v10,v10
i33 v11,v11,v28
i19 v11,v11
i33 v56,v56,v28
i19 v56,v56
i33 v57,v57,v28
i19 v57,v57
i33 v58,v58,v28
i19 v58,v58
i33 v59,v59,v28
i19 v59,v59
i3 v48,v56,v57
i3 v49,v58,v59
i3 v50,v8,v9
i3 v51,v10,v11
i14 v[28:29],0
i14 v[36:37],s[48:49]
i14 v[38:39],s[50:51]
i2 v[32:35],v[20:23],v[50:53],0
i2 v[12:15],v[26:29],v[50:53],0
i2 v[28:31],v[16:19],v[48:51],0
i2 v[40:43],v[36:39],v[48:51],0
i2 v[44:47],v[22:25],v[48:51],0
i29 v28,v32,v28 row_ror:8 row_mask:0xf bank_mask:0x3
i29 v29,v33,v29 row_ror:8 row_mask:0xf bank_mask:0x3
i29 v30,v34,v30 row_ror:8 row_mask:0xf bank_mask:0x3
i29 v31,v35,v31 row_ror:8 row_mask:0xf bank_mask:0x3
i29 v40,v40,v40 row_ror:8 row_mask:0xf bank_mask:0xf
v_rcp_f32 v42, v40
v_cmp_nlt_f32 vcc, s54, v40
v_cmp_ngt_f32 s[22:23], s55, v40
i29 v28,v44,v12 row_ror:8 row_mask:0xf bank_mask:0xc
i29 v29,v45,v13 row_ror:8 row_mask:0xf bank_mask:0xc
i29 v30,v46,v14 row_ror:8 row_mask:0xf bank_mask:0xc
i29 v31,v47,v15 row_ror:8 row_mask:0xf bank_mask:0xc
i16 v[28:29],v[28:29],v[42:43] op_sel_hi:[1,0]
i16 v[30:31],v[30:31],v[42:43] op_sel_hi:[1,0]
i3 v28,v28,v29
i3 v29,v30,v31
ds_write_b64 v60, v[28:29] offset:512
i14 v[40:41],0
i14 v[42:43],0
i14 v[12:13],0
i14 v[14:15],0
i14 v[36:37],0
i14 v[38:39],0
i44 Lc1s_cont
Lc1s_out:
i52 v22,v23,s[8:11],s53 offen sc1
i8 vmcnt(0)
i44 L_endc
L_cw2:
i23 v79,4,v0
i23 v28,4,v79
i18 v29,0xf0,v0
i17 v78,v28,13,v29
i32 s22,s20,8
i20 v78,s22,v78
i54 s23,1152
i45 v77,v28,s23,v29
s_mul_i32 s22, s20, 147456
i20 v77,s22,v77
i23 v28,3,v79
i18 v29,0x70,v0
i45 v76,v28,s23,v29
i20 v76,s22,v76
i47 s99,0
i22 Lc2_ptr
i50 s[60:61],s[0:1],56
i50 s[64:65],s[0:1],64
i50 s[68:69],s[0:1],72
i50 s[72:73],s[0:1],80
i8 lgkmcnt(0)
Lc2_ptr:
i5 s62,4718592
i5 s63,0x20000
i5 s66,4718592
i5 s67,0x20000
i5 s70,4718592
i5 s71,0x20000
i5 s74,4718592
i5 s75,0x20000
i5 s42,1040356334
i5 s43,1040356334
i5 s22,262144
i5 s23,73728
Lc2_first:
i6 m0,s23,0
i6 s24,s22,0
i1 v78,s[64:67],s24 offen lds
i6 m0,s23,1024
i6 s24,s22,32768
i1 v78,s[64:67],s24 offen lds
i6 m0,s23,2048
i6 s24,s22,65536
i1 v78,s[64:67],s24 offen lds
i6 m0,s23,3072
i6 s24,s22,98304
i1 v78,s[64:67],s24 offen lds
i6 s22,s22,524288
i6 s23,s23,4096
s_cmp_lt_u32 s23, 110592
i22 Lc2_first
i23 v30,4,v79
i34 v31,v79,2,2
i18 v32,3,v79
i20 v4,73728,v0
i18 v28,1,v30
i17 v28,v28,3,v31
i31 v28,8,v28
i20 v28,128,v28
i17 v68,v32,3,v28
i23 v29,1,v32
i17 v28,v29,5,v28
i18 v29,1,v32
i17 v72,v29,3,v28
i23 v33,1,v30
i23 v29,1,v31
i17 v28,v33,2,v29
i18 v29,1,v31
i31 v34,3,v32
i17 v64,v28,8,v34
i17 v64,v29,5,v64
i20 v64,128,v64
i18 v35,1,v30
i17 v28,v35,4,v28
i17 v60,v28,7,v34
i20 v60,64,v60
i5 s22,36864
i54 s23,4096
i45 v74,v33,s23,v72
i20 v74,147456,v74
i20 v75,8192,v74
i45 v72,v33,s22,v72
i20 v73,73728,v72
i45 v70,v33,s23,v68
i20 v70,147456,v70
i20 v71,8192,v70
i45 v68,v33,s22,v68
i20 v69,73728,v68
i45 v66,v35,s23,v64
i20 v66,147456,v66
i20 v67,8192,v66
i45 v64,v35,s22,v64
i20 v65,73728,v64
i45 v62,v29,s23,v60
i20 v62,147456,v62
i20 v63,8192,v62
i45 v60,v29,s22,v60
i20 v61,73728,v60
i34 v29,v79,3,1
i25 vcc,1,v29
i11 v1,0x8888
i11 v28,0xdddd
i26 v1,v1,v28,vcc
i18 v28,7,v79
i34 v29,v79,4,1
i31 v29,2,v29
v_sub_u32 v28, v28, v29
i18 v29,1,v28
i31 v29,4,v29
i11 v30,0x3f80
i31 v30,v29,v30
v_ashrrev_i32 v28, 1, v28
i25 vcc,0,v28
i15 1
i26 v2,0,v30,vcc
i25 vcc,1,v28
i15 1
i26 v3,0,v30,vcc
i20 v6,147456,v0
i34 v28,v0,8,1
i18 v29,0x70,v0
i23 v7,5,v0
i18 v7,0x18,v7
i17 v7,v29,1,v7
i20 v7,157728,v7
i54 s23,9216
i23 v56,7,v0
i45 v56,v56,s23,v29
i24 v57,v28,3,v29
i23 v30,9,v0
i24 v57,v30,2,v57
i34 v31,v0,7,1
i24 v57,v31,31,v57
i18 v58,0x33f,v0
i24 v58,v31,6,v58
i34 v32,v0,6,1
i24 v58,v32,7,v58
i34 v59,v0,1,8
i24 v59,v30,2,v59
i18 v28,16,v0
i11 v30,0x3f80
i31 v30,v28,v30
i34 v28,v0,5,2
i34 v28,v0,5,3
i25 vcc,0,v28
i15 1
i26 v8,0,v30,vcc
i25 vcc,1,v28
i15 1
i26 v9,0,v30,vcc
i25 vcc,2,v28
i15 1
i26 v10,0,v30,vcc
i25 vcc,3,v28
i15 1
i26 v11,0,v30,vcc
i25 vcc,4,v28
i15 1
i26 v16,0,v30,vcc
i25 vcc,5,v28
i15 1
i26 v17,0,v30,vcc
i25 vcc,6,v28
i15 1
i26 v18,0,v30,vcc
i25 vcc,7,v28
i15 1
i26 v19,0,v30,vcc
i23 v28,8,v0
i24 v28,v28,7,v29
i20 v13,151552,v28
i17 v12,v31,3,v13
i17 v14,v31,9,v13
i23 v15,1,v0
i5 s44,0xff00ff00
i5 s45,0xff00ff00
i5 s48,0x3e803e80
i5 s49,0x3e803e80
i5 s50,0x3f803f80
i5 s51,0x3f803f80
i5 s54,562036736
i5 s55,1568669696
i5 s25,0
i5 s46,0
i5 s47,0
s_mul_i32 s38, s20, 8192
i6 s38,s38,4096
i6 s39,s38,16777216
i6 s40,s38,50331648
s_mul_i32 s79, s20, 9216
i6 s79,s79,67108864
i32 s23,s20,7
i6 s7,s23,67117056
i6 s41,s23,70262784
i5 s78,524288
i54 s77,9216
s_cmp_ge_u32 s20, 8
i28 s22,0x80000000,0
s_or_b32 s41, s41, s22
i6 s34,s41,49152
i6 s52,s41,32768
i6 s53,s41,2097152
i8 vmcnt(32)
s_barrier
i0 a[176:177],v72 offset:0
i0 a[178:179],v72 offset:1024
i0 a[180:181],v73 offset:0
i0 a[182:183],v73 offset:1024
i0 v[48:49],v72 offset:16
i0 v[50:51],v72 offset:1040
i0 v[52:53],v73 offset:16
i0 v[54:55],v73 offset:1040
i8 lgkmcnt(0)
s_barrier
i21 v4,v[48:51] offset:0
i21 v4,v[52:55] offset:1024
i8 lgkmcnt(0)
i8 vmcnt(28)
s_barrier
i5 m0,155648
i5 s22,2359296
i1 v78,s[68:71],s22 offen lds
i5 m0,156672
i5 s22,2392064
i1 v78,s[68:71],s22 offen lds
i5 m0,157696
i5 s22,2424832
i1 v78,s[68:71],s22 offen lds
i5 m0,158720
i5 s22,2457600
i1 v78,s[68:71],s22 offen lds
i0 a[184:185],v72 offset:4096
i0 a[186:187],v72 offset:5120
i0 a[188:189],v73 offset:4096
i0 a[190:191],v73 offset:5120
i0 v[48:49],v72 offset:4112
i0 v[50:51],v72 offset:5136
i0 v[52:53],v73 offset:4112
i0 v[54:55],v73 offset:5136
i8 lgkmcnt(0)
s_barrier
i21 v4,v[48:51] offset:2048
i21 v4,v[52:55] offset:3072
i8 lgkmcnt(0)
i8 vmcnt(28)
s_barrier
i0 a[160:161],v72 offset:8192
i0 a[162:163],v72 offset:9216
i0 a[164:165],v73 offset:8192
i0 a[166:167],v73 offset:9216
i0 v[48:49],v72 offset:8208
i0 v[50:51],v72 offset:9232
i0 v[52:53],v73 offset:8208
i0 v[54:55],v73 offset:9232
i8 lgkmcnt(0)
s_barrier
i21 v4,v[48:51] offset:4096
i21 v4,v[52:55] offset:5120
i8 lgkmcnt(0)
i8 vmcnt(24)
s_barrier
i0 a[168:169],v72 offset:12288
i0 a[170:171],v72 offset:13312
i0 a[172:173],v73 offset:12288
i0 a[174:175],v73 offset:13312
i0 v[48:49],v72 offset:12304
i0 v[50:51],v72 offset:13328
i0 v[52:53],v73 offset:12304
i0 v[54:55],v73 offset:13328
i8 lgkmcnt(0)
s_barrier
i21 v4,v[48:51] offset:6144
i21 v4,v[52:55] offset:7168
i8 lgkmcnt(0)
i8 vmcnt(20)
s_barrier
i0 a[216:217],v72 offset:16384
i0 a[218:219],v72 offset:17408
i0 a[220:221],v73 offset:16384
i0 a[222:223],v73 offset:17408
i0 v[48:49],v72 offset:16400
i0 v[50:51],v72 offset:17424
i0 v[52:53],v73 offset:16400
i0 v[54:55],v73 offset:17424
i8 lgkmcnt(0)
s_barrier
i21 v4,v[48:51] offset:8192
i21 v4,v[52:55] offset:9216
i8 lgkmcnt(0)
i8 vmcnt(16)
s_barrier
i0 a[224:225],v72 offset:20480
i0 a[226:227],v72 offset:21504
i0 a[228:229],v73 offset:20480
i0 a[230:231],v73 offset:21504
i0 v[48:49],v72 offset:20496
i0 v[50:51],v72 offset:21520
i0 v[52:53],v73 offset:20496
i0 v[54:55],v73 offset:21520
i8 lgkmcnt(0)
s_barrier
i21 v4,v[48:51] offset:10240
i21 v4,v[52:55] offset:11264
i8 lgkmcnt(0)
i8 vmcnt(12)
s_barrier
i5 m0,94208
i5 s22,2883584
i1 v78,s[68:71],s22 offen lds
i5 m0,95232
i5 s22,2916352
i1 v78,s[68:71],s22 offen lds
i5 m0,96256
i5 s22,2949120
i1 v78,s[68:71],s22 offen lds
i5 m0,97280
i5 s22,2981888
i1 v78,s[68:71],s22 offen lds
i0 a[200:201],v72 offset:24576
i0 a[202:203],v72 offset:25600
i0 a[204:205],v73 offset:24576
i0 a[206:207],v73 offset:25600
i0 v[48:49],v72 offset:24592
i0 v[50:51],v72 offset:25616
i0 v[52:53],v73 offset:24592
i0 v[54:55],v73 offset:25616
i8 lgkmcnt(0)
s_barrier
i21 v4,v[48:51] offset:12288
i21 v4,v[52:55] offset:13312
i8 lgkmcnt(0)
i8 vmcnt(12)
s_barrier
i5 m0,98304
i5 s22,3407872
i1 v78,s[68:71],s22 offen lds
i5 m0,99328
i5 s22,3440640
i1 v78,s[68:71],s22 offen lds
i5 m0,100352
i5 s22,3473408
i1 v78,s[68:71],s22 offen lds
i5 m0,101376
i5 s22,3506176
i1 v78,s[68:71],s22 offen lds
i0 a[208:209],v72 offset:28672
i0 a[210:211],v72 offset:29696
i0 a[212:213],v73 offset:28672
i0 a[214:215],v73 offset:29696
i0 v[48:49],v72 offset:28688
i0 v[50:51],v72 offset:29712
i0 v[52:53],v73 offset:28688
i0 v[54:55],v73 offset:29712
i8 lgkmcnt(0)
s_barrier
i21 v4,v[48:51] offset:14336
i21 v4,v[52:55] offset:15360
i8 lgkmcnt(0)
i8 vmcnt(12)
s_barrier
i5 m0,102400
i5 s22,3932160
i1 v78,s[68:71],s22 offen lds
i5 m0,103424
i5 s22,3964928
i1 v78,s[68:71],s22 offen lds
i5 m0,104448
i5 s22,3997696
i1 v78,s[68:71],s22 offen lds
i5 m0,105472
i5 s22,4030464
i1 v78,s[68:71],s22 offen lds
i0 a[192:193],v72 offset:32768
i0 a[194:195],v72 offset:33792
i0 a[196:197],v73 offset:32768
i0 a[198:199],v73 offset:33792
i0 v[48:49],v72 offset:32784
i0 v[50:51],v72 offset:33808
i0 v[52:53],v73 offset:32784
i0 v[54:55],v73 offset:33808
i8 lgkmcnt(0)
s_barrier
i21 v4,v[48:51] offset:16384
i21 v4,v[52:55] offset:17408
i8 lgkmcnt(0)
i8 vmcnt(12)
s_barrier
i5 m0,106496
i5 s22,110592
i1 v77,s[72:75],s22 offen lds
i5 m0,107520
i5 s22,115200
i1 v77,s[72:75],s22 offen lds
i5 m0,108544
i5 s22,119808
i1 v77,s[72:75],s22 offen lds
i5 m0,109568
i5 s22,124416
i1 v77,s[72:75],s22 offen lds
i0 a[240:241],v70 offset:0
i0 a[242:243],v70 offset:1024
i0 a[244:245],v71 offset:0
i0 a[246:247],v71 offset:1024
i0 v[48:49],v70 offset:32
i0 v[50:51],v70 offset:1056
i0 v[52:53],v71 offset:32
i0 v[54:55],v71 offset:1056
i8 lgkmcnt(0)
s_barrier
i21 v4,v[48:51] offset:18432
i21 v4,v[52:55] offset:19456
i8 lgkmcnt(0)
i8 vmcnt(12)
s_barrier
i5 m0,155648
i5 s22,262144
i1 v78,s[60:63],s22 offen lds
i5 m0,156672
i5 s22,294912
i1 v78,s[60:63],s22 offen lds
i5 m0,157696
i5 s22,327680
i1 v78,s[60:63],s22 offen lds
i5 m0,158720
i5 s22,360448
i1 v78,s[60:63],s22 offen lds
i0 a[232:233],v68 offset:20480
i0 a[234:235],v68 offset:21504
i0 a[236:237],v69 offset:20480
i0 a[238:239],v69 offset:21504
i0 v[48:49],v68 offset:20512
i0 v[50:51],v68 offset:21536
i0 v[52:53],v69 offset:20512
i0 v[54:55],v69 offset:21536
i8 lgkmcnt(0)
s_barrier
i21 v4,v[48:51] offset:20480
i21 v4,v[52:55] offset:21504
i8 lgkmcnt(0)
i8 vmcnt(12)
s_barrier
i0 a[48:49],v68 offset:24576
i0 a[50:51],v68 offset:25600
i0 a[52:53],v69 offset:24576
i0 a[54:55],v69 offset:25600
i0 a[56:57],v68 offset:24608
i0 a[58:59],v68 offset:25632
i0 a[60:61],v69 offset:24608
i0 a[62:63],v69 offset:25632
i8 lgkmcnt(0)
s_barrier
i8 vmcnt(8)
s_barrier
i5 m0,98304
i5 s22,786432
i1 v78,s[60:63],s22 offen lds
i5 m0,99328
i5 s22,819200
i1 v78,s[60:63],s22 offen lds
i5 m0,100352
i5 s22,851968
i1 v78,s[60:63],s22 offen lds
i5 m0,101376
i5 s22,884736
i1 v78,s[60:63],s22 offen lds
i0 a[64:65],v68 offset:28672
i0 a[66:67],v68 offset:29696
i0 a[68:69],v69 offset:28672
i0 a[70:71],v69 offset:29696
i0 a[72:73],v68 offset:28704
i0 a[74:75],v68 offset:29728
i0 a[76:77],v69 offset:28704
i0 a[78:79],v69 offset:29728
i8 lgkmcnt(0)
s_barrier
i8 vmcnt(8)
s_barrier
i5 m0,102400
i5 s22,1310720
i1 v78,s[60:63],s22 offen lds
i5 m0,103424
i5 s22,1343488
i1 v78,s[60:63],s22 offen lds
i5 m0,104448
i5 s22,1376256
i1 v78,s[60:63],s22 offen lds
i5 m0,105472
i5 s22,1409024
i1 v78,s[60:63],s22 offen lds
i0 a[248:249],v64 offset:32768
i0 a[250:251],v64 offset:33280
i0 a[252:253],v64 offset:34816
i0 a[254:255],v64 offset:35328
i0 v[48:49],v65 offset:32768
i0 v[50:51],v65 offset:33280
i0 v[52:53],v65 offset:34816
i0 v[54:55],v65 offset:35328
i8 lgkmcnt(0)
s_barrier
i21 v4,v[48:51] offset:22528
i21 v4,v[52:55] offset:23552
i8 lgkmcnt(0)
i8 vmcnt(8)
s_barrier
i5 m0,106496
i5 s22,1835008
i1 v78,s[60:63],s22 offen lds
i5 m0,107520
i5 s22,1867776
i1 v78,s[60:63],s22 offen lds
i5 m0,108544
i5 s22,1900544
i1 v78,s[60:63],s22 offen lds
i5 m0,109568
i5 s22,1933312
i1 v78,s[60:63],s22 offen lds
i0 v[112:113],v74 offset:0
i0 v[114:115],v74 offset:1024
i0 v[116:117],v75 offset:0
i0 v[118:119],v75 offset:1024
i0 v[120:121],v74 offset:16
i0 v[122:123],v74 offset:1040
i0 v[124:125],v75 offset:16
i0 v[126:127],v75 offset:1040
i8 lgkmcnt(0)
i8 vmcnt(8)
s_barrier
i5 m0,155648
i5 s22,2359296
i1 v78,s[60:63],s22 offen lds
i5 m0,156672
i5 s22,2392064
i1 v78,s[60:63],s22 offen lds
i5 m0,157696
i5 s22,2424832
i1 v78,s[60:63],s22 offen lds
i5 m0,158720
i5 s22,2457600
i1 v78,s[60:63],s22 offen lds
i0 v[128:129],v72 offset:24576
i0 v[130:131],v72 offset:25600
i0 v[132:133],v73 offset:24576
i0 v[134:135],v73 offset:25600
i0 v[136:137],v72 offset:24592
i0 v[138:139],v72 offset:25616
i0 v[140:141],v73 offset:24592
i0 v[142:143],v73 offset:25616
i8 lgkmcnt(0)
i8 vmcnt(8)
s_barrier
i5 m0,98304
i5 s22,2883584
i1 v78,s[60:63],s22 offen lds
i5 m0,99328
i5 s22,2916352
i1 v78,s[60:63],s22 offen lds
i5 m0,100352
i5 s22,2949120
i1 v78,s[60:63],s22 offen lds
i5 m0,101376
i5 s22,2981888
i1 v78,s[60:63],s22 offen lds
i0 v[80:81],v72 offset:28672
i0 v[82:83],v72 offset:29696
i0 v[84:85],v73 offset:28672
i0 v[86:87],v73 offset:29696
i0 v[88:89],v72 offset:28688
i0 v[90:91],v72 offset:29712
i0 v[92:93],v73 offset:28688
i0 v[94:95],v73 offset:29712
i8 lgkmcnt(0)
i8 vmcnt(8)
s_barrier
i5 m0,102400
i5 s22,3407872
i1 v78,s[60:63],s22 offen lds
i5 m0,103424
i5 s22,3440640
i1 v78,s[60:63],s22 offen lds
i5 m0,104448
i5 s22,3473408
i1 v78,s[60:63],s22 offen lds
i5 m0,105472
i5 s22,3506176
i1 v78,s[60:63],s22 offen lds
i0 v[96:97],v72 offset:32768
i0 v[98:99],v72 offset:33792
i0 v[100:101],v73 offset:32768
i0 v[102:103],v73 offset:33792
i0 v[104:105],v72 offset:32784
i0 v[106:107],v72 offset:33808
i0 v[108:109],v73 offset:32784
i0 v[110:111],v73 offset:33808
i8 lgkmcnt(0)
i8 vmcnt(8)
s_barrier
i5 m0,106496
i5 s22,3932160
i1 v78,s[60:63],s22 offen lds
i5 m0,107520
i5 s22,3964928
i1 v78,s[60:63],s22 offen lds
i5 m0,108544
i5 s22,3997696
i1 v78,s[60:63],s22 offen lds
i5 m0,109568
i5 s22,4030464
i1 v78,s[60:63],s22 offen lds
i0 v[192:193],v74 offset:0
i0 v[194:195],v74 offset:1024
i0 v[196:197],v75 offset:0
i0 v[198:199],v75 offset:1024
i0 v[200:201],v74 offset:16
i0 v[202:203],v74 offset:1040
i0 v[204:205],v75 offset:16
i0 v[206:207],v75 offset:1040
i8 lgkmcnt(0)
i8 vmcnt(8)
s_barrier
i5 m0,155648
i5 s22,4456448
i1 v78,s[60:63],s22 offen lds
i5 m0,156672
i5 s22,4489216
i1 v78,s[60:63],s22 offen lds
i5 m0,157696
i5 s22,4521984
i1 v78,s[60:63],s22 offen lds
i5 m0,158720
i5 s22,4554752
i1 v78,s[60:63],s22 offen lds
i0 v[208:209],v72 offset:24576
i0 v[210:211],v72 offset:25600
i0 v[212:213],v73 offset:24576
i0 v[214:215],v73 offset:25600
i0 v[216:217],v72 offset:24592
i0 v[218:219],v72 offset:25616
i0 v[220:221],v73 offset:24592
i0 v[222:223],v73 offset:25616
i8 lgkmcnt(0)
i8 vmcnt(8)
s_barrier
i5 m0,98304
i5 s22,262144
i1 v78,s[68:71],s22 offen lds
i5 m0,99328
i5 s22,294912
i1 v78,s[68:71],s22 offen lds
i5 m0,100352
i5 s22,327680
i1 v78,s[68:71],s22 offen lds
i5 m0,101376
i5 s22,360448
i1 v78,s[68:71],s22 offen lds
i0 v[160:161],v72 offset:28672
i0 v[162:163],v72 offset:29696
i0 v[164:165],v73 offset:28672
i0 v[166:167],v73 offset:29696
i0 v[168:169],v72 offset:28688
i0 v[170:171],v72 offset:29712
i0 v[172:173],v73 offset:28688
i0 v[174:175],v73 offset:29712
i8 lgkmcnt(0)
i31 v26,2,v0
s_getpc_b64 s[88:89]
Lc2_pc:
i6 s88,s88,Lc2f_top-Lc2_pc
s_addc_u32 s89, s89, 0
i20 v27,4096,v26
i55 v26,v26,s[88:89]
i55 v27,v27,s[88:89]
i8 vmcnt(10)
s_barrier
i5 m0,102400
i5 s22,786432
i1 v78,s[68:71],s22 offen lds
i5 m0,103424
i5 s22,819200
i1 v78,s[68:71],s22 offen lds
i5 m0,104448
i5 s22,851968
i1 v78,s[68:71],s22 offen lds
i5 m0,105472
i5 s22,884736
i1 v78,s[68:71],s22 offen lds
i0 v[176:177],v72 offset:32768
i0 v[178:179],v72 offset:33792
i0 v[180:181],v73 offset:32768
i0 v[182:183],v73 offset:33792
i0 v[184:185],v72 offset:32784
i0 v[186:187],v72 offset:33808
i0 v[188:189],v73 offset:32784
i0 v[190:191],v73 offset:33808
i8 lgkmcnt(0)
i8 vmcnt(10)
s_barrier
i5 m0,106496
i5 s22,1310720
i1 v78,s[68:71],s22 offen lds
i5 m0,107520
i5 s22,1343488
i1 v78,s[68:71],s22 offen lds
i5 m0,108544
i5 s22,1376256
i1 v78,s[68:71],s22 offen lds
i5 m0,109568
i5 s22,1409024
i1 v78,s[68:71],s22 offen lds
i0 v[144:145],v74 offset:0
i0 v[146:147],v74 offset:1024
i0 v[148:149],v75 offset:0
i0 v[150:151],v75 offset:1024
i0 v[152:153],v74 offset:16
i0 v[154:155],v74 offset:1040
i0 v[156:157],v75 offset:16
i0 v[158:159],v75 offset:1040
i8 lgkmcnt(0)
i8 vmcnt(10)
s_barrier
i5 m0,155648
i5 s22,1835008
i1 v78,s[68:71],s22 offen lds
i5 m0,156672
i5 s22,1867776
i1 v78,s[68:71],s22 offen lds
i5 m0,157696
i5 s22,1900544
i1 v78,s[68:71],s22 offen lds
i5 m0,158720
i5 s22,1933312
i1 v78,s[68:71],s22 offen lds
i0 a[0:1],v68 offset:24576
i0 a[2:3],v68 offset:25600
i0 a[4:5],v69 offset:24576
i0 a[6:7],v69 offset:25600
i0 a[8:9],v68 offset:24608
i0 a[10:11],v68 offset:25632
i0 a[12:13],v69 offset:24608
i0 a[14:15],v69 offset:25632
i8 lgkmcnt(0)
i8 vmcnt(8)
s_barrier
i5 m0,98304
i5 s22,4456448
i1 v78,s[68:71],s22 offen lds
i5 m0,99328
i5 s22,4489216
i1 v78,s[68:71],s22 offen lds
i5 m0,100352
i5 s22,4521984
i1 v78,s[68:71],s22 offen lds
i5 m0,101376
i5 s22,4554752
i1 v78,s[68:71],s22 offen lds
i0 a[16:17],v68 offset:28672
i0 a[18:19],v68 offset:29696
i0 a[20:21],v69 offset:28672
i0 a[22:23],v69 offset:29696
i0 a[24:25],v68 offset:28704
i0 a[26:27],v68 offset:29728
i0 a[28:29],v69 offset:28704
i0 a[30:31],v69 offset:29728
i8 lgkmcnt(0)
i8 vmcnt(8)
s_barrier
i5 m0,102400
i5 s22,37120
i1 v77,s[72:75],s22 offen lds
i5 m0,103424
i5 s22,41728
i1 v77,s[72:75],s22 offen lds
i5 m0,104448
i5 s22,46336
i1 v77,s[72:75],s22 offen lds
i5 m0,105472
i5 s22,50944
i1 v77,s[72:75],s22 offen lds
i0 v[224:225],v68 offset:32768
i0 v[226:227],v68 offset:33792
i0 v[228:229],v69 offset:32768
i0 v[230:231],v69 offset:33792
i0 v[232:233],v68 offset:32800
i0 v[234:235],v68 offset:33824
i0 v[236:237],v69 offset:32800
i0 v[238:239],v69 offset:33824
i8 lgkmcnt(0)
i8 vmcnt(8)
s_barrier
i5 m0,106496
i5 s22,37376
i1 v77,s[72:75],s22 offen lds
i5 m0,107520
i5 s22,41984
i1 v77,s[72:75],s22 offen lds
i5 m0,108544
i5 s22,46592
i1 v77,s[72:75],s22 offen lds
i5 m0,109568
i5 s22,51200
i1 v77,s[72:75],s22 offen lds
i0 v[240:241],v70 offset:0
i0 v[242:243],v70 offset:1024
i0 v[244:245],v71 offset:0
i0 v[246:247],v71 offset:1024
i0 v[248:249],v70 offset:32
i0 v[250:251],v70 offset:1056
i0 v[252:253],v71 offset:32
i0 v[254:255],v71 offset:1056
i8 lgkmcnt(0)
i8 vmcnt(8)
s_barrier
i5 m0,155648
i5 s22,111104
i1 v77,s[72:75],s22 offen lds
i5 m0,156672
i5 s22,115712
i1 v77,s[72:75],s22 offen lds
i5 m0,157696
i5 s22,120320
i1 v77,s[72:75],s22 offen lds
i5 m0,158720
i5 s22,124928
i1 v77,s[72:75],s22 offen lds
i0 a[32:33],v68 offset:24576
i0 a[34:35],v68 offset:25600
i0 a[36:37],v69 offset:24576
i0 a[38:39],v69 offset:25600
i0 a[40:41],v68 offset:24608
i0 a[42:43],v68 offset:25632
i0 a[44:45],v69 offset:24608
i0 a[46:47],v69 offset:25632
i8 lgkmcnt(0)
i8 vmcnt(8)
s_barrier
i5 m0,98304
i5 s22,37632
i1 v77,s[72:75],s22 offen lds
i5 m0,99328
i5 s22,42240
i1 v77,s[72:75],s22 offen lds
i5 m0,100352
i5 s22,46848
i1 v77,s[72:75],s22 offen lds
i5 m0,101376
i5 s22,51456
i1 v77,s[72:75],s22 offen lds
i0 a[80:81],v64 offset:28672
i0 a[82:83],v64 offset:29184
i0 a[84:85],v64 offset:30720
i0 a[86:87],v64 offset:31232
i0 a[88:89],v65 offset:28672
i0 a[90:91],v65 offset:29184
i0 a[92:93],v65 offset:30720
i0 a[94:95],v65 offset:31232
i8 lgkmcnt(0)
i8 vmcnt(8)
s_barrier
i5 m0,102400
i5 s22,111360
i1 v77,s[72:75],s22 offen lds
i5 m0,103424
i5 s22,115968
i1 v77,s[72:75],s22 offen lds
i5 m0,104448
i5 s22,120576
i1 v77,s[72:75],s22 offen lds
i5 m0,105472
i5 s22,125184
i1 v77,s[72:75],s22 offen lds
i0 a[96:97],v64 offset:32768
i0 a[98:99],v64 offset:33280
i0 a[100:101],v64 offset:34816
i0 a[102:103],v64 offset:35328
i0 a[104:105],v65 offset:32768
i0 a[106:107],v65 offset:33280
i0 a[108:109],v65 offset:34816
i0 a[110:111],v65 offset:35328
i8 lgkmcnt(0)
i8 vmcnt(8)
s_barrier
i0 a[112:113],v66 offset:0
i0 a[114:115],v66 offset:512
i0 a[116:117],v66 offset:2048
i0 a[118:119],v66 offset:2560
i0 a[120:121],v67 offset:0
i0 a[122:123],v67 offset:512
i0 a[124:125],v67 offset:2048
i0 a[126:127],v67 offset:2560
i8 lgkmcnt(0)
i8 vmcnt(4)
s_barrier
i0 a[128:129],v64 offset:24576
i0 a[130:131],v64 offset:25088
i0 a[132:133],v64 offset:26624
i0 a[134:135],v64 offset:27136
i0 a[136:137],v65 offset:24576
i0 a[138:139],v65 offset:25088
i0 a[140:141],v65 offset:26624
i0 a[142:143],v65 offset:27136
i8 lgkmcnt(0)
i8 vmcnt(0)
s_barrier
i5 m0,98304
i5 s22,36864
i1 v77,s[72:75],s22 offen lds
i5 m0,99328
i5 s22,41472
i1 v77,s[72:75],s22 offen lds
i5 m0,100352
i5 s22,46080
i1 v77,s[72:75],s22 offen lds
i5 m0,101376
i5 s22,50688
i1 v77,s[72:75],s22 offen lds
i0 a[144:145],v64 offset:28672
i0 a[146:147],v64 offset:29184
i0 a[148:149],v64 offset:30720
i0 a[150:151],v64 offset:31232
i0 a[152:153],v65 offset:28672
i0 a[154:155],v65 offset:29184
i0 a[156:157],v65 offset:30720
i0 a[158:159],v65 offset:31232
i8 lgkmcnt(0)
i8 vmcnt(0)
s_barrier
i5 m0,102400
i5 s22,110848
i1 v77,s[72:75],s22 offen lds
i5 m0,103424
i5 s22,115456
i1 v77,s[72:75],s22 offen lds
i5 m0,104448
i5 s22,120064
i1 v77,s[72:75],s22 offen lds
i5 m0,105472
i5 s22,124672
i1 v77,s[72:75],s22 offen lds
i5 m0,106496
i5 s22,74752
i1 v76,s[72:75],s22 offen lds
i5 m0,107520
i5 s22,83968
i1 v76,s[72:75],s22 offen lds
i5 m0,108544
i5 s22,93184
i1 v76,s[72:75],s22 offen lds
i5 m0,109568
i5 s22,102400
i1 v76,s[72:75],s22 offen lds
i0 v[40:41],v64 offset:24576
i0 v[42:43],v64 offset:25088
i0 v[44:45],v64 offset:26624
i0 v[46:47],v64 offset:27136
i0 v[48:49],v65 offset:24576
i0 v[50:51],v65 offset:25088
i0 v[52:53],v65 offset:26624
i0 v[54:55],v65 offset:27136
i8 lgkmcnt(0)
s_barrier
i21 v4,v[40:43] offset:24576
i21 v4,v[44:47] offset:25600
i21 v4,v[48:51] offset:26624
i21 v4,v[52:55] offset:27648
i8 lgkmcnt(0)
i8 vmcnt(4)
s_barrier
i0 v[40:41],v64 offset:28672
i0 v[42:43],v64 offset:29184
i0 v[44:45],v64 offset:30720
i0 v[46:47],v64 offset:31232
i0 v[48:49],v65 offset:28672
i0 v[50:51],v65 offset:29184
i0 v[52:53],v65 offset:30720
i0 v[54:55],v65 offset:31232
i8 lgkmcnt(0)
s_barrier
i21 v4,v[40:43] offset:28672
i21 v4,v[44:47] offset:29696
i21 v4,v[48:51] offset:30720
i21 v4,v[52:55] offset:31744
i8 lgkmcnt(0)
i8 vmcnt(0)
s_barrier
i0 v[40:41],v60 offset:32768
i0 v[42:43],v60 offset:33024
i0 v[44:45],v60 offset:33792
i0 v[46:47],v60 offset:34048
i0 v[48:49],v61 offset:32768
i0 v[50:51],v61 offset:33024
i0 v[52:53],v61 offset:33792
i0 v[54:55],v61 offset:34048
i8 lgkmcnt(0)
s_barrier
i21 v4,v[40:43] offset:32768
i21 v4,v[44:47] offset:33792
i21 v4,v[48:51] offset:34816
i21 v4,v[52:55] offset:35840
i8 lgkmcnt(0)
i8 vmcnt(0)
s_barrier
s_barrier
i11 v44,147456
i9 v[40:43],v44
i8 lgkmcnt(0)
i37 s99,v40
i37 s98,v41
i37 s20,v42
i37 s92,v43
s_barrier
i46 s92,0
i22 L_role2
i47 s99,2
i22 L_cs2
i11 v16,v58
i11 v25,v57
i11 v23,0x80000000
i11 v22,0
i11 v5,64
i39 s[72:73],s[100:101]
i54 s74,256
i5 s75,0x20000
i54 s4,64
i6 s5,s38,262144
i5 s35,70256640
i5 s36,70262784
i5 s37,70260736
i18 v56,0x1f0,v0
i31 v56,2,v56
i23 v57,9,v0
i24 v56,v57,24,v56
i36 v56,v56,s[8:11],s38 offen sc1
i14 v[28:29],0
i14 v[30:31],0
i14 v[32:33],0
i14 v[34:35],0
i14 v[44:45],0
i14 v[46:47],0
i14 v[48:49],0
i14 v[50:51],0
i8 lgkmcnt(0)
Lc2f_top:
i1 v[52:55],v16,s[8:11],s35 offen sc1
i9 v[64:67],v4 offset:4096
i9 v[68:71],v4 offset:5120
i9 v[72:75],v4 offset:6144
i9 v[76:79],v4 offset:7168
i14 v[36:37],0
i14 v[38:39],0
i14 v[40:41],0
i14 v[42:43],0
i11 v18,-1
i52 v18,v25,s[8:11],s52 offen
i11 v0,v0
i15 2
i11 v0,v0
i15 2
i11 v0,v0
i15 2
i11 v0,v0
i15 2
i1 v[52:55],v16,s[8:11],s35 offen sc1
i11 v0,v0
i15 2
i11 v0,v0
i15 2
i11 v0,v0
i15 2
i11 v0,v0
i15 2
i11 v0,v0
i15 2
Lc2f_pb:
i8 vmcnt(1)
i48 v17,v52,v53,v54
v_max_u32 v17, v17, v55
i25 vcc,-1,v17
i11 v0,v0
i11 v0,v0
i11 v0,v0
i11 v0,v0
i11 v0,v0
i49 Lc2f_pb2
Lc2f_go:
i4 v[28:31],v[52:55],v[80:87],v1
i21 v6,v[52:55] offset:2048
i5 s52,s34
i4 v[32:35],v[52:55],v[88:95],v1
i1 v[60:63],v16,s[8:11],s37 offen sc1
s_xor_b32 s78, s78, 524288
s_bfe_i32 s76, s25, 0x10001
i4 v[36:39],v[52:55],a[160:167],v1
i8 lgkmcnt(1)
i1 v[24:27],v16,s[8:11],s36 offen sc1
i6 s34,s41,s47
i4 v[40:43],v[52:55],v[64:71],v1
i6 s47,s47,16384
s_and_b32 s47, s47, 65535
i54 s24,1040
i4 v[44:47],v[52:55],v[224:231],v1
i6 s33,s41,s47
i6 s35,s47,70256640
i6 s28,s79,s78
i4 v[48:51],v[52:55],v[232:239],v1
i8 lgkmcnt(0)
s_barrier
i9 v[56:59],v6 offset:3072
i9 v[8:11],v6 offset:0
i1 v[18:21],v0,s[8:11],s39 offen sc1
i8 lgkmcnt(1)
i4 v[28:31],v[56:59],v[96:103],v1
i9 v[64:67],v4 offset:0
i6 s26,s28,1024
i4 v[32:35],v[56:59],v[104:111],v1
i9 v[68:71],v4 offset:1024
i6 s27,s28,5120
i4 v[36:39],v[56:59],a[168:175],v1
i9 v[12:15],v6 offset:1024
i6 s28,s28,8704
i4 v[40:43],v[56:59],v[72:79],v1
i9 v[72:75],v4 offset:2048
i8 lgkmcnt(4)
i4 v[44:47],v[56:59],v[240:247],v1
i9 v[76:79],v4 offset:3072
i18 v5,0xf0,v0
i4 v[28:31],v[8:11],v[112:119],v1
i6 s29,s7,s78
i6 s30,s29,73728
i31 v5,3,v5
i4 v[32:35],v[8:11],v[120:127],v1
i6 s31,s29,147456
i6 s32,s29,221184
i34 v17,v0,8,1
i4 v[36:39],v[8:11],a[176:183],v1
i8 lgkmcnt(2)
i24 v5,v17,24,v5
i4 v[40:43],v[8:11],v[64:71],v1
i8 vmcnt(1)
i48 v17,v60,v61,v62
i4 v[28:31],v[12:15],v[128:135],v1
i9 v[64:67],v4 offset:16384
i48 v17,v17,v24,v25
i4 v[32:35],v[12:15],v[136:143],v1
i9 v[68:71],v4 offset:17408
i48 v17,v17,v26,v27
i4 v[36:39],v[12:15],a[184:191],v1
i8 lgkmcnt(2)
v_max_u32 v17, v17, v63
i4 v[40:43],v[12:15],v[72:79],v1
i25 vcc,-1,v17
i4 v[48:51],v[56:59],v[248:255],v1
i49 Lc2f_lp
Lc2f_lok:
i4 v[28:31],v[24:27],v[144:151],v1
i21 v6,v[60:63] offset:6144
i4 v[32:35],v[24:27],v[152:159],v1
i1 v[8:11],v0,s[8:11],s38 offen sc1
i4 v[36:39],v[24:27],a[192:199],v1
i8 lgkmcnt(1)
i4 v[40:43],v[24:27],v[64:71],v1
i9 v[72:75],v4 offset:12288
i4 v[44:47],v[24:27],a[32:39],v1
i9 v[76:79],v4 offset:13312
i1 v[12:15],v0,s[8:11],s38 offen offset:1024 sc1
i4 v[48:51],v[24:27],a[40:47],v1
i1 v[24:27],v0,s[8:11],s39 offen offset:1024 sc1
i8 lgkmcnt(2)
s_barrier
i9 v[56:59],v6 offset:7168
i4 v[44:47],v[60:63],a[48:55],v1
i36 v5,v5,s[8:11],s5 offen sc1
i6 s38,s38,262144
i18 v16,0x70,v0
i4 v[48:51],v[60:63],a[56:63],v1
i9 v[52:55],v6 offset:5120
i31 v16,1,v16
i4 v[28:31],v[60:63],v[160:167],v1
i9 v[64:67],v4 offset:14336
i23 v17,8,v0
i4 v[32:35],v[60:63],v[168:175],v1
i9 v[68:71],v4 offset:15360
i45 v17,v17,s24,v16
i4 v[36:39],v[60:63],a[200:207],v1
i8 vmcnt(4)
i8 lgkmcnt(4)
i20 v17,155648,v17
i4 v[40:43],v[60:63],v[72:79],v1
i9 v[60:63],v6 offset:4096
i8 lgkmcnt(4)
i4 v[28:31],v[56:59],v[176:183],v1
i9 v[72:75],v4 offset:8192
i18 v16,0x80,v0
i4 v[32:35],v[56:59],v[184:191],v1
i9 v[76:79],v4 offset:9216
i17 v16,v16,1,v17
i4 v[36:39],v[56:59],a[208:215],v1
i8 lgkmcnt(3)
i6 s37,s47,70260736
i6 s36,s47,70262784
i4 v[40:43],v[56:59],v[64:71],v1
i9 v[64:67],v4 offset:10240
i8 lgkmcnt(3)
i4 v[28:31],v[60:63],v[192:199],v1
i9 v[68:71],v4 offset:11264
i6 s39,s39,262144
i4 v[32:35],v[60:63],v[200:207],v1
i52 v22,v23,s[8:11],s53 offen sc1
i6 s5,s5,262144
i4 v[36:39],v[60:63],a[216:223],v1
i8 lgkmcnt(2)
i4 v[40:43],v[60:63],v[72:79],v1
i9 v[72:75],v4 offset:18432
i4 v[28:31],v[52:55],v[208:215],v1
i9 v[76:79],v4 offset:19456
i4 v[32:35],v[52:55],v[216:223],v1
i4 v[36:39],v[52:55],a[224:231],v1
i8 lgkmcnt(2)
i4 v[40:43],v[52:55],v[64:71],v1
i9 v[64:67],v4 offset:20480
i3 v28,v28,v29
i3 v29,v30,v31
i3 v30,v32,v33
i3 v31,v34,v35
i3 v36,v36,v37
i3 v37,v38,v39
i27 v[32:35],v[28:29],v[2:3],0
i3 v38,v40,v41
i3 v39,v42,v43
i27 v[40:43],v[30:31],v[2:3],0
i9 v[68:71],v4 offset:21504
i8 vmcnt(3)
i27 v[28:31],v[36:37],v[2:3],0
i3 v32,v32,v33
i3 v33,v34,v35
i27 v[56:59],v[38:39],v[2:3],0
i3 v34,v40,v41
i3 v35,v42,v43
i11 v0,v0
i11 v0,v0
i2 v[40:43],v[8:11],v[32:35],0
i9 v[8:11],v6 offset:0
i3 v28,v28,v29
i3 v29,v30,v31
i2 v[36:39],v[12:15],v[32:35],0
i9 v[12:15],v6 offset:1024
i3 v30,v56,v57
i3 v31,v58,v59
i11 v0,v0
i11 v0,v0
i2 v[56:59],v[28:31],v[32:35],0
i8 lgkmcnt(2)
i3 v40,v40,v41
i3 v41,v42,v43
i3 v36,v36,v37
i3 v37,v38,v39
i4 v[44:47],v[52:55],a[232:239],v1
ds_write_b64 v7, v[40:41] offset:0
ds_write_b64 v7, v[36:37] offset:256
i3 v56,v56,v57
i3 v57,v58,v59
i4 v[48:51],v[52:55],v[64:71],v1
ds_write_b64 v7, v[56:57] offset:512
i4 v[48:51],v[60:63],v[72:79],v1
i9 v[28:31],v6 offset:13312
i4 v[44:47],v[60:63],a[240:247],v1
i9 v[60:63],v6 offset:7168
i8 lgkmcnt(5)
i4 v[44:47],v[12:15],a[16:23],v1
i9 v[32:35],v6 offset:15360
i4 v[48:51],v[12:15],a[24:31],v1
i8 lgkmcnt(3)
s_barrier
i9 v[12:15],v16
i4 v[44:47],v[8:11],a[0:7],v1
i9 v[40:43],v16 offset:16
i6 s53,s53,16384
i4 v[48:51],v[8:11],a[8:15],v1
i9 v[36:39],v17 offset:512
i8 lgkmcnt(4)
i4 v[44:47],v[60:63],a[64:71],v1
i9 v[64:67],v4 offset:24576
i14 v[52:53],0
i4 v[48:51],v[60:63],a[72:79],v1
i9 v[68:71],v4 offset:25600
i8 lgkmcnt(3)
i2 v[8:11],v[28:31],v[12:15],0
i9 v[72:75],v4 offset:26624
i2 v[8:11],v[32:35],v[40:43],v[8:11]
i8 lgkmcnt(3)
i3 v16,v44,v45
i2 v[56:59],v[28:31],v[36:39],0
i3 v17,v46,v47
i3 v22,v48,v49
i2 v[56:59],v[32:35],v[36:39],v[56:59]
i9 v[76:79],v4 offset:27648
i19 v12,v8
i19 v13,v9
i19 v14,v10
i19 v15,v11
i3 v23,v50,v51
i3 v50,v12,v13
i3 v51,v14,v15
i16 v[56:57],v[56:57],s[42:43]
i16 v[58:59],v[58:59],s[42:43]
i19 v40,v56
i8 vmcnt(2)
i2 v[32:35],v[20:23],v[50:53],0
i9 v[60:63],v6 offset:14336
i19 v41,v57
i2 v[12:15],v[26:29],v[50:53],0
i19 v42,v58
i19 v43,v59
i3 v48,v40,v41
i3 v49,v42,v43
i14 v[36:37],s[48:49]
i14 v[38:39],s[50:51]
i2 v[28:31],v[16:19],v[48:51],0
i11 v0,v0
i2 v[40:43],v[36:39],v[48:51],0
i2 v[44:47],v[22:25],v[48:51],0
i8 lgkmcnt(0)
i29 v28,v32,v28 row_ror:8 row_mask:0xf bank_mask:0x3
i29 v29,v33,v29 row_ror:8 row_mask:0xf bank_mask:0x3
i29 v30,v34,v30 row_ror:8 row_mask:0xf bank_mask:0x3
i29 v31,v35,v31 row_ror:8 row_mask:0xf bank_mask:0x3
i29 v40,v40,v40 row_ror:8 row_mask:0xf bank_mask:0xf
v_rcp_f32 v42, v40
v_cmp_nlt_f32 vcc, s54, v40
v_cmp_ngt_f32 s[22:23], s55, v40
i29 v28,v44,v12 row_ror:8 row_mask:0xf bank_mask:0xc
i29 v29,v45,v13 row_ror:8 row_mask:0xf bank_mask:0xc
i29 v30,v46,v14 row_ror:8 row_mask:0xf bank_mask:0xc
i29 v31,v47,v15 row_ror:8 row_mask:0xf bank_mask:0xc
i16 v[28:29],v[28:29],v[42:43] op_sel_hi:[1,0]
i16 v[30:31],v[30:31],v[42:43] op_sel_hi:[1,0]
i3 v28,v28,v29
i3 v29,v30,v31
ds_write_b64 v60, v[28:29] offset:1024
i14 v[40:41],0
i14 v[42:43],0
i14 v[12:13],0
i14 v[14:15],0
i14 v[36:37],0
i14 v[38:39],0
i53 vcc,vcc,s[22:23]
i22 Lc2f_slow
Lc2f_cont:
i14 v[56:57],0
i14 v[58:59],0
i14 v[8:9],0
i14 v[10:11],0
i8 lgkmcnt(0)
s_barrier
i9 v[28:31],v61 offset:0
i9 v[32:35],v61 offset:512
i9 v[44:47],v61 offset:1024
i9 v[48:51],v61 offset:1536
i9 v[16:19],v4 offset:22528
i9 v[20:23],v4 offset:23552
i8 lgkmcnt(5)
i4 v[56:59],v[28:31],v[64:71],v1
i9 v[64:67],v4 offset:28672
i8 lgkmcnt(5)
i4 v[56:59],v[32:35],v[72:79],v1
i9 v[68:71],v4 offset:29696
i8 lgkmcnt(5)
i4 v[56:59],v[44:47],a[248:255],v1
i9 v[72:75],v4 offset:30720
i8 lgkmcnt(3)
i4 v[56:59],v[48:51],v[16:23],v1
i9 v[76:79],v4 offset:31744
i9 v[16:19],v62 offset:0
i4 v[36:39],v[28:31],a[80:87],v1
i9 v[20:23],v62 offset:1024
i23 v26,9,v0
i4 v[36:39],v[32:35],a[88:95],v1
i8 lgkmcnt(4)
i3 v56,v56,v57
i4 v[36:39],v[44:47],v[64:71],v1
i8 lgkmcnt(2)
i3 v57,v58,v59
i4 v[36:39],v[48:51],v[72:79],v1
i9 v[64:67],v4 offset:32768
v_bfi_b32 v56, 1, s76, v56
i4 v[8:11],v[28:31],a[96:103],v1
i41 v[56:57],v63,s[8:11],s26 offen offset:0
i4 v[8:11],v[32:35],a[104:111],v1
i9 v[68:71],v4 offset:33792
i3 v36,v36,v37
i4 v[8:11],v[44:47],a[112:119],v1
i9 v[72:75],v4 offset:34816
i3 v37,v38,v39
i4 v[8:11],v[48:51],a[120:127],v1
i9 v[76:79],v4 offset:35840
v_bfi_b32 v36, 1, s76, v36
i4 v[12:15],v[28:31],a[128:135],v1
i41 v[36:37],v63,s[8:11],s26 offen offset:2048
i4 v[12:15],v[32:35],a[136:143],v1
i8 lgkmcnt(2)
i3 v8,v8,v9
i4 v[40:43],v[16:19],v[64:71],v1
i8 lgkmcnt(0)
i3 v9,v10,v11
i4 v[40:43],v[20:23],v[72:79],v1
i9 v[72:75],v6 offset:13312
v_bfi_b32 v8, 1, s76, v8
i4 v[12:15],v[44:47],a[144:151],v1
i41 v[8:9],v63,s[8:11],s27 offen offset:0
i4 v[12:15],v[48:51],a[152:159],v1
i40 v40,v42
i40 v41,v43
v_add_f32 v40, v40, v42
v_add_f32 v41, v41, v43
i3 v40,v40,v41
i18 v27,0xff,v63
v_bfi_b32 v40, 1, s76, v40
i24 v27,v26,2,v27
i3 v12,v12,v13
i3 v13,v14,v15
v_bfi_b32 v12, 1, s76, v12
i41 v[12:13],v63,s[8:11],s27 offen offset:2048
i52 v40,v27,s[8:11],s28 offen
s_cmp_ge_u32 s20, 8
i22 Lc2f_nored
i23 v24,7,v0
i18 v25,0x70,v0
i45 v24,v24,s77,v25
i11 v0,v0
i15 2
i11 v0,v0
i15 2
i11 v0,v0
i15 2
i11 v0,v0
i15 2
i11 v0,v0
i15 2
i11 v0,v0
i15 2
i11 v0,v0
i15 2
i11 v0,v0
i15 2
i11 v0,v0
i15 2
i11 v0,v0
i15 2
i11 v0,v0
i15 2
i11 v0,v0
i15 2
i11 v0,v0
i15 2
i11 v0,v0
i15 2
i11 v0,v0
i15 2
i11 v0,v0
i15 2
i11 v0,v0
i15 2
i11 v0,v0
i15 2
i11 v0,v0
i15 2
i11 v0,v0
i15 2
i11 v0,v0
i15 2
i11 v0,v0
i15 2
i11 v0,v0
i15 2
i1 v[52:55],v24,s[8:11],s29 offen sc1
i1 v[56:59],v24,s[8:11],s30 offen sc1
i1 v[8:11],v24,s[8:11],s31 offen sc1
i1 v[12:15],v24,s[8:11],s32 offen sc1
i14 v[28:29],0
i14 v[30:31],0
i14 v[32:33],0
i14 v[34:35],0
i14 v[44:45],0
i14 v[46:47],0
i14 v[48:49],0
i14 v[50:51],0
i24 v25,v26,2,v25
i34 v17,v0,8,1
i24 v25,v17,3,v25
i34 v17,v0,7,1
i24 v25,v17,31,v25
i18 v16,0x33f,v0
i24 v16,v17,6,v16
i34 v17,v0,6,1
i24 v16,v17,7,v16
i11 v0,v0
i15 2
i11 v0,v0
i15 2
i11 v0,v0
i15 2
i11 v0,v0
i15 2
i8 lgkmcnt(0)
i8 vmcnt(3)
i2 v[64:67],v[52:55],v[72:75],0
i42 v20,v52,v53,s76 bitop3:0x81
i42 v17,v54,v55,s76 bitop3:0x81
i18 v20,v20,v17
i8 vmcnt(2)
i2 v[64:67],v[56:59],v[72:75],v[64:67]
i42 v21,v56,v57,s76 bitop3:0x81
i42 v17,v58,v59,s76 bitop3:0x81
i18 v21,v21,v17
i8 vmcnt(1)
i2 v[64:67],v[8:11],v[72:75],v[64:67]
i42 v22,v8,v9,s76 bitop3:0x81
i42 v17,v10,v11,s76 bitop3:0x81
i18 v22,v22,v17
i8 vmcnt(0)
i2 v[64:67],v[12:15],v[72:75],v[64:67]
i42 v23,v12,v13,s76 bitop3:0x81
i42 v17,v14,v15,s76 bitop3:0x81
i18 v23,v23,v17
i42 v17,v20,v21,v22 bitop3:0x80
i42 v17,v17,v23,1 bitop3:0x80
i25 vcc,0,v17
i11 v0,v0
i11 v0,v0
i40 v64,v66
i40 v65,v67
v_pk_add_f32 v[64:65], v[64:65], v[66:67]
i3 v64,v64,v65
i49 Lc2f_rf
Lc2f_rn:
i52 v64,v25,s[8:11],s33 offen
i11 v22,v64
i11 v23,v25
i44 Lc2f_tail
Lc2f_nored:
i14 v[28:29],0
i14 v[30:31],0
i14 v[32:33],0
i14 v[34:35],0
i14 v[44:45],0
i14 v[46:47],0
i14 v[48:49],0
i14 v[50:51],0
i24 v25,v26,2,v25
i34 v17,v0,8,1
i24 v25,v17,3,v25
i34 v17,v0,7,1
i24 v25,v17,31,v25
i18 v16,0x33f,v0
i24 v16,v17,6,v16
i34 v17,v0,6,1
i24 v16,v17,7,v16
i11 v0,v0
i15 2
i11 v0,v0
i15 2
i11 v0,v0
i15 2
i11 v0,v0
i15 2
i11 v0,v0
i15 2
i11 v0,v0
i15 2
i11 v0,v0
i15 2
i11 v0,v0
i15 2
i11 v0,v0
i15 2
i11 v0,v0
i15 2
i11 v0,v0
i15 2
i11 v0,v0
i15 2
i11 v0,v0
i15 2
i11 v0,v0
i15 2
i11 v0,v0
i15 2
i11 v0,v0
i15 2
i11 v0,v0
i15 2
i11 v0,v0
i15 2
i11 v0,v0
i15 2
i11 v0,v0
i15 2
i11 v0,v0
i15 2
i11 v0,v0
i15 2
i11 v0,v0
i15 2
i11 v0,v0
i15 2
i11 v0,v0
i15 2
i11 v0,v0
i15 2
i11 v0,v0
i15 2
i11 v0,v0
i15 2
i11 v0,v0
i15 2
i11 v0,v0
i15 2
i11 v0,v0
i15 2
i11 v0,v0
i15 2
i11 v0,v0
i15 2
i11 v0,v0
i15 2
i11 v0,v0
i15 2
i11 v0,v0
i15 2
i11 v0,v0
i15 2
i11 v0,v0
i15 2
i11 v0,v0
i15 2
i11 v0,v0
i15 2
i11 v0,v0
i15 2
i11 v0,v0
i15 2
i11 v0,v0
i15 2
i11 v0,v0
i15 2
i11 v0,v0
i15 2
i11 v0,v0
i15 2
i11 v0,v0
i15 2
i11 v0,v0
i15 2
i11 v0,v0
i15 2
i11 v0,v0
i15 2
Lc2f_tail:
i6 s25,s25,1
s_cmp_lt_u32 s25, 63
i22 Lc2f_top
i44 Lc2f_out
Lc2f_rf:
i18 v17,1,v20
i25 s[12:13],0,v17
i18 v17,1,v21
i25 s[14:15],0,v17
i18 v17,1,v22
i25 s[16:17],0,v17
i18 v17,1,v23
i25 s[18:19],0,v17
i53 exec,s[12:13],1
i1 v[52:55],v24,s[8:11],s29 offen sc1
i53 exec,s[14:15],1
i1 v[56:59],v24,s[8:11],s30 offen sc1
i53 exec,s[16:17],1
i1 v[8:11],v24,s[8:11],s31 offen sc1
i53 exec,s[18:19],1
i1 v[12:15],v24,s[8:11],s32 offen sc1
i39 exec,-1
i11 v0,v0
i15 2
i11 v0,v0
i15 2
i11 v0,v0
i15 2
i11 v0,v0
i15 2
Lc2f_rg:
i53 exec,s[12:13],1
i1 v[52:55],v24,s[8:11],s29 offen sc1
i53 exec,s[14:15],1
i1 v[56:59],v24,s[8:11],s30 offen sc1
i53 exec,s[16:17],1
i1 v[8:11],v24,s[8:11],s31 offen sc1
i53 exec,s[18:19],1
i1 v[12:15],v24,s[8:11],s32 offen sc1
i39 exec,-1
i6 s46,s46,1
i35 s46,400000
i22 L_endc
i8 vmcnt(4)
i42 v20,v52,v53,s76 bitop3:0x81
i42 v17,v54,v55,s76 bitop3:0x81
i18 v20,v20,v17
i42 v21,v56,v57,s76 bitop3:0x81
i42 v17,v58,v59,s76 bitop3:0x81
i18 v21,v21,v17
i42 v22,v8,v9,s76 bitop3:0x81
i42 v17,v10,v11,s76 bitop3:0x81
i18 v22,v22,v17
i42 v23,v12,v13,s76 bitop3:0x81
i42 v17,v14,v15,s76 bitop3:0x81
i18 v23,v23,v17
i2 v[64:67],v[52:55],v[72:75],0
i18 v17,1,v20
i25 s[12:13],0,v17
i2 v[64:67],v[56:59],v[72:75],v[64:67]
i18 v17,1,v21
i25 s[14:15],0,v17
i2 v[64:67],v[8:11],v[72:75],v[64:67]
i18 v17,1,v22
i25 s[16:17],0,v17
i2 v[64:67],v[12:15],v[72:75],v[64:67]
i18 v17,1,v23
i25 s[18:19],0,v17
i42 v17,v20,v21,v22 bitop3:0x80
i42 v17,v17,v23,1 bitop3:0x80
i25 vcc,0,v17
i11 v0,v0
i11 v0,v0
i11 v0,v0
i40 v64,v66
i40 v65,v67
v_pk_add_f32 v[64:65], v[64:65], v[66:67]
i3 v64,v64,v65
i49 Lc2f_rg
i44 Lc2f_rn
Lc2f_pb2:
i53 exec,vcc,1
i1 v[52:55],v16,s[8:11],s35 offen sc1
i39 exec,-1
i6 s46,s46,1
i35 s46,400000
i22 L_endc
i11 v0,v0
i15 2
i11 v0,v0
i15 2
i11 v0,v0
i15 2
i11 v0,v0
i15 2
i44 Lc2f_pb
Lc2f_lp:
i53 exec,vcc,1
i1 v[60:63],v16,s[8:11],s37 offen sc1
i1 v[24:27],v16,s[8:11],s36 offen sc1
i39 exec,-1
i11 v0,v0
i15 2
i11 v0,v0
i15 2
i11 v0,v0
i15 2
i11 v0,v0
i15 2
i11 v0,v0
i15 2
Lc2f_lp2:
i53 exec,vcc,1
i1 v[60:63],v16,s[8:11],s37 offen sc1
i1 v[24:27],v16,s[8:11],s36 offen sc1
i39 exec,-1
i6 s46,s46,1
i35 s46,400000
i22 L_endc
i11 v0,v0
i15 2
i11 v0,v0
i15 2
i8 vmcnt(2)
i48 v17,v60,v61,v62
i48 v17,v17,v24,v25
i48 v17,v17,v26,v27
v_max_u32 v17, v17, v63
i25 vcc,-1,v17
i49 Lc2f_lp2
i44 Lc2f_lok
Lc2f_slow:
i38 v28,v8,v9,v10
i38 v29,v11,v56,v57
i38 v28,v28,v58,v59
v_max_f32 v28, v28, v29
i11 v0,v0
i11 v0,v0
v_max_f32_dpp v28, v28, v28 row_ror:8 row_mask:0xf bank_mask:0xf
i11 v29,v28
i11 v0,v0
i11 v0,v0
v_permlane16_swap_b32 v28, v29
v_max_f32 v28, v28, v29
i11 v29,v28
i11 v0,v0
i11 v0,v0
i40 v28,v29
v_max_f32 v28, v28, v29
i33 v8,v8,v28
i19 v8,v8
i33 v9,v9,v28
i19 v9,v9
i33 v10,v10,v28
i19 v10,v10
i33 v11,v11,v28
i19 v11,v11
i33 v56,v56,v28
i19 v56,v56
i33 v57,v57,v28
i19 v57,v57
i33 v58,v58,v28
i19 v58,v58
i33 v59,v59,v28
i19 v59,v59
i3 v48,v56,v57
i3 v49,v58,v59
i3 v50,v8,v9
i3 v51,v10,v11
i14 v[28:29],0
i14 v[36:37],s[48:49]
i14 v[38:39],s[50:51]
i2 v[32:35],v[20:23],v[50:53],0
i2 v[12:15],v[26:29],v[50:53],0
i2 v[28:31],v[16:19],v[48:51],0
i2 v[40:43],v[36:39],v[48:51],0
i2 v[44:47],v[22:25],v[48:51],0
i29 v28,v32,v28 row_ror:8 row_mask:0xf bank_mask:0x3
i29 v29,v33,v29 row_ror:8 row_mask:0xf bank_mask:0x3
i29 v30,v34,v30 row_ror:8 row_mask:0xf bank_mask:0x3
i29 v31,v35,v31 row_ror:8 row_mask:0xf bank_mask:0x3
i29 v40,v40,v40 row_ror:8 row_mask:0xf bank_mask:0xf
v_rcp_f32 v42, v40
v_cmp_nlt_f32 vcc, s54, v40
v_cmp_ngt_f32 s[22:23], s55, v40
i29 v28,v44,v12 row_ror:8 row_mask:0xf bank_mask:0xc
i29 v29,v45,v13 row_ror:8 row_mask:0xf bank_mask:0xc
i29 v30,v46,v14 row_ror:8 row_mask:0xf bank_mask:0xc
i29 v31,v47,v15 row_ror:8 row_mask:0xf bank_mask:0xc
i16 v[28:29],v[28:29],v[42:43] op_sel_hi:[1,0]
i16 v[30:31],v[30:31],v[42:43] op_sel_hi:[1,0]
i3 v28,v28,v29
i3 v29,v30,v31
ds_write_b64 v60, v[28:29] offset:1024
i14 v[40:41],0
i14 v[42:43],0
i14 v[12:13],0
i14 v[14:15],0
i14 v[36:37],0
i14 v[38:39],0
i44 Lc2f_cont
Lc2f_out:
i52 v22,v23,s[8:11],s53 offen sc1
i8 vmcnt(0)
i44 L_endc
L_cs2:
i11 v16,v58
i11 v25,v57
i11 v23,0x80000000
i11 v22,0
i11 v5,64
i39 s[72:73],s[100:101]
i54 s74,256
i5 s75,0x20000
i54 s4,64
i6 s5,s38,262144
i5 s35,70256640
i5 s36,70262784
i5 s37,70260736
i18 v56,0x1f0,v0
i31 v56,2,v56
i23 v57,9,v0
i24 v56,v57,24,v56
i36 v56,v56,s[8:11],s38 offen sc1
i14 v[28:29],0
i14 v[30:31],0
i14 v[32:33],0
i14 v[34:35],0
i14 v[44:45],0
i14 v[46:47],0
i14 v[48:49],0
i14 v[50:51],0
i8 lgkmcnt(0)
Lc2s_top:
i1 v[52:55],v16,s[8:11],s35 offen sc1
i9 v[64:67],v4 offset:4096
i9 v[68:71],v4 offset:5120
i9 v[72:75],v4 offset:6144
i9 v[76:79],v4 offset:7168
i14 v[36:37],0
i14 v[38:39],0
i14 v[40:41],0
i14 v[42:43],0
i11 v18,-1
i52 v18,v25,s[8:11],s52 offen sc1
i11 v0,v0
i15 2
i11 v0,v0
i15 2
i11 v0,v0
i15 2
i11 v0,v0
i15 2
i1 v[52:55],v16,s[8:11],s35 offen sc1
i11 v0,v0
i15 2
i11 v0,v0
i15 2
i11 v0,v0
i15 2
i11 v0,v0
i15 2
i11 v0,v0
i15 2
Lc2s_pb:
i8 vmcnt(1)
i48 v17,v52,v53,v54
v_max_u32 v17, v17, v55
i25 vcc,-1,v17
i11 v0,v0
i11 v0,v0
i11 v0,v0
i11 v0,v0
i11 v0,v0
i49 Lc2s_pb2
Lc2s_go:
i4 v[28:31],v[52:55],v[80:87],v1
i21 v6,v[52:55] offset:2048
i5 s52,s34
i4 v[32:35],v[52:55],v[88:95],v1
i1 v[60:63],v16,s[8:11],s37 offen sc1
s_xor_b32 s78, s78, 524288
s_bfe_i32 s76, s25, 0x10001
i4 v[36:39],v[52:55],a[160:167],v1
i8 lgkmcnt(1)
i1 v[24:27],v16,s[8:11],s36 offen sc1
i6 s34,s41,s47
i4 v[40:43],v[52:55],v[64:71],v1
i6 s47,s47,16384
s_and_b32 s47, s47, 65535
i54 s24,1040
i4 v[44:47],v[52:55],v[224:231],v1
i6 s33,s41,s47
i6 s35,s47,70256640
i6 s28,s79,s78
i4 v[48:51],v[52:55],v[232:239],v1
i8 lgkmcnt(0)
s_barrier
i9 v[56:59],v6 offset:3072
i9 v[8:11],v6 offset:0
i1 v[18:21],v0,s[8:11],s39 offen sc1
i8 lgkmcnt(1)
i4 v[28:31],v[56:59],v[96:103],v1
i9 v[64:67],v4 offset:0
i6 s26,s28,1024
i4 v[32:35],v[56:59],v[104:111],v1
i9 v[68:71],v4 offset:1024
i6 s27,s28,5120
i4 v[36:39],v[56:59],a[168:175],v1
i9 v[12:15],v6 offset:1024
i6 s28,s28,8704
i4 v[40:43],v[56:59],v[72:79],v1
i9 v[72:75],v4 offset:2048
i8 lgkmcnt(4)
i4 v[44:47],v[56:59],v[240:247],v1
i9 v[76:79],v4 offset:3072
i18 v5,0xf0,v0
i4 v[28:31],v[8:11],v[112:119],v1
i6 s29,s7,s78
i6 s30,s29,73728
i31 v5,3,v5
i4 v[32:35],v[8:11],v[120:127],v1
i6 s31,s29,147456
i6 s32,s29,221184
i34 v17,v0,8,1
i4 v[36:39],v[8:11],a[176:183],v1
i8 lgkmcnt(2)
i24 v5,v17,24,v5
i4 v[40:43],v[8:11],v[64:71],v1
i8 vmcnt(1)
i48 v17,v60,v61,v62
i4 v[28:31],v[12:15],v[128:135],v1
i9 v[64:67],v4 offset:16384
i48 v17,v17,v24,v25
i4 v[32:35],v[12:15],v[136:143],v1
i9 v[68:71],v4 offset:17408
i48 v17,v17,v26,v27
i4 v[36:39],v[12:15],a[184:191],v1
i8 lgkmcnt(2)
v_max_u32 v17, v17, v63
i4 v[40:43],v[12:15],v[72:79],v1
i25 vcc,-1,v17
i4 v[48:51],v[56:59],v[248:255],v1
i49 Lc2s_lp
Lc2s_lok:
i4 v[28:31],v[24:27],v[144:151],v1
i21 v6,v[60:63] offset:6144
i4 v[32:35],v[24:27],v[152:159],v1
i1 v[8:11],v0,s[8:11],s38 offen sc1
i4 v[36:39],v[24:27],a[192:199],v1
i8 lgkmcnt(1)
i4 v[40:43],v[24:27],v[64:71],v1
i9 v[72:75],v4 offset:12288
i4 v[44:47],v[24:27],a[32:39],v1
i9 v[76:79],v4 offset:13312
i1 v[12:15],v0,s[8:11],s38 offen offset:1024 sc1
i4 v[48:51],v[24:27],a[40:47],v1
i1 v[24:27],v0,s[8:11],s39 offen offset:1024 sc1
i8 lgkmcnt(2)
s_barrier
i9 v[56:59],v6 offset:7168
i4 v[44:47],v[60:63],a[48:55],v1
i36 v5,v5,s[8:11],s5 offen sc1
i6 s38,s38,262144
i18 v16,0x70,v0
i4 v[48:51],v[60:63],a[56:63],v1
i9 v[52:55],v6 offset:5120
i31 v16,1,v16
i4 v[28:31],v[60:63],v[160:167],v1
i9 v[64:67],v4 offset:14336
i23 v17,8,v0
i4 v[32:35],v[60:63],v[168:175],v1
i9 v[68:71],v4 offset:15360
i45 v17,v17,s24,v16
i4 v[36:39],v[60:63],a[200:207],v1
i8 vmcnt(4)
i8 lgkmcnt(4)
i20 v17,155648,v17
i4 v[40:43],v[60:63],v[72:79],v1
i9 v[60:63],v6 offset:4096
i8 lgkmcnt(4)
i4 v[28:31],v[56:59],v[176:183],v1
i9 v[72:75],v4 offset:8192
i18 v16,0x80,v0
i4 v[32:35],v[56:59],v[184:191],v1
i9 v[76:79],v4 offset:9216
i17 v16,v16,1,v17
i4 v[36:39],v[56:59],a[208:215],v1
i8 lgkmcnt(3)
i6 s37,s47,70260736
i6 s36,s47,70262784
i4 v[40:43],v[56:59],v[64:71],v1
i9 v[64:67],v4 offset:10240
i8 lgkmcnt(3)
i4 v[28:31],v[60:63],v[192:199],v1
i9 v[68:71],v4 offset:11264
i6 s39,s39,262144
i4 v[32:35],v[60:63],v[200:207],v1
i52 v22,v23,s[8:11],s53 offen sc1
i6 s5,s5,262144
i4 v[36:39],v[60:63],a[216:223],v1
i8 lgkmcnt(2)
i4 v[40:43],v[60:63],v[72:79],v1
i9 v[72:75],v4 offset:18432
i4 v[28:31],v[52:55],v[208:215],v1
i9 v[76:79],v4 offset:19456
i4 v[32:35],v[52:55],v[216:223],v1
i4 v[36:39],v[52:55],a[224:231],v1
i8 lgkmcnt(2)
i4 v[40:43],v[52:55],v[64:71],v1
i9 v[64:67],v4 offset:20480
i3 v28,v28,v29
i3 v29,v30,v31
i3 v30,v32,v33
i3 v31,v34,v35
i3 v36,v36,v37
i3 v37,v38,v39
i27 v[32:35],v[28:29],v[2:3],0
i3 v38,v40,v41
i3 v39,v42,v43
i27 v[40:43],v[30:31],v[2:3],0
i9 v[68:71],v4 offset:21504
i8 vmcnt(3)
i27 v[28:31],v[36:37],v[2:3],0
i3 v32,v32,v33
i3 v33,v34,v35
i27 v[56:59],v[38:39],v[2:3],0
i3 v34,v40,v41
i3 v35,v42,v43
i11 v0,v0
i11 v0,v0
i2 v[40:43],v[8:11],v[32:35],0
i9 v[8:11],v6 offset:0
i3 v28,v28,v29
i3 v29,v30,v31
i2 v[36:39],v[12:15],v[32:35],0
i9 v[12:15],v6 offset:1024
i3 v30,v56,v57
i3 v31,v58,v59
i11 v0,v0
i11 v0,v0
i2 v[56:59],v[28:31],v[32:35],0
i8 lgkmcnt(2)
i3 v40,v40,v41
i3 v41,v42,v43
i3 v36,v36,v37
i3 v37,v38,v39
i4 v[44:47],v[52:55],a[232:239],v1
ds_write_b64 v7, v[40:41] offset:0
ds_write_b64 v7, v[36:37] offset:256
i3 v56,v56,v57
i3 v57,v58,v59
i4 v[48:51],v[52:55],v[64:71],v1
ds_write_b64 v7, v[56:57] offset:512
i4 v[48:51],v[60:63],v[72:79],v1
i9 v[28:31],v6 offset:13312
i4 v[44:47],v[60:63],a[240:247],v1
i9 v[60:63],v6 offset:7168
i8 lgkmcnt(5)
i4 v[44:47],v[12:15],a[16:23],v1
i9 v[32:35],v6 offset:15360
i4 v[48:51],v[12:15],a[24:31],v1
i8 lgkmcnt(3)
s_barrier
i9 v[12:15],v16
i4 v[44:47],v[8:11],a[0:7],v1
i9 v[40:43],v16 offset:16
i6 s53,s53,16384
i4 v[48:51],v[8:11],a[8:15],v1
i9 v[36:39],v17 offset:512
i8 lgkmcnt(4)
i4 v[44:47],v[60:63],a[64:71],v1
i9 v[64:67],v4 offset:24576
i14 v[52:53],0
i4 v[48:51],v[60:63],a[72:79],v1
i9 v[68:71],v4 offset:25600
i8 lgkmcnt(3)
i2 v[8:11],v[28:31],v[12:15],0
i9 v[72:75],v4 offset:26624
i2 v[8:11],v[32:35],v[40:43],v[8:11]
i8 lgkmcnt(3)
i3 v16,v44,v45
i2 v[56:59],v[28:31],v[36:39],0
i3 v17,v46,v47
i3 v22,v48,v49
i2 v[56:59],v[32:35],v[36:39],v[56:59]
i9 v[76:79],v4 offset:27648
i19 v12,v8
i19 v13,v9
i19 v14,v10
i19 v15,v11
i3 v23,v50,v51
i3 v50,v12,v13
i3 v51,v14,v15
i16 v[56:57],v[56:57],s[42:43]
i16 v[58:59],v[58:59],s[42:43]
i19 v40,v56
i8 vmcnt(2)
i2 v[32:35],v[20:23],v[50:53],0
i9 v[60:63],v6 offset:14336
i19 v41,v57
i2 v[12:15],v[26:29],v[50:53],0
i19 v42,v58
i19 v43,v59
i3 v48,v40,v41
i3 v49,v42,v43
i14 v[36:37],s[48:49]
i14 v[38:39],s[50:51]
i2 v[28:31],v[16:19],v[48:51],0
i11 v0,v0
i2 v[40:43],v[36:39],v[48:51],0
i2 v[44:47],v[22:25],v[48:51],0
i8 lgkmcnt(0)
i29 v28,v32,v28 row_ror:8 row_mask:0xf bank_mask:0x3
i29 v29,v33,v29 row_ror:8 row_mask:0xf bank_mask:0x3
i29 v30,v34,v30 row_ror:8 row_mask:0xf bank_mask:0x3
i29 v31,v35,v31 row_ror:8 row_mask:0xf bank_mask:0x3
i29 v40,v40,v40 row_ror:8 row_mask:0xf bank_mask:0xf
v_rcp_f32 v42, v40
v_cmp_nlt_f32 vcc, s54, v40
v_cmp_ngt_f32 s[22:23], s55, v40
i29 v28,v44,v12 row_ror:8 row_mask:0xf bank_mask:0xc
i29 v29,v45,v13 row_ror:8 row_mask:0xf bank_mask:0xc
i29 v30,v46,v14 row_ror:8 row_mask:0xf bank_mask:0xc
i29 v31,v47,v15 row_ror:8 row_mask:0xf bank_mask:0xc
i16 v[28:29],v[28:29],v[42:43] op_sel_hi:[1,0]
i16 v[30:31],v[30:31],v[42:43] op_sel_hi:[1,0]
i3 v28,v28,v29
i3 v29,v30,v31
ds_write_b64 v60, v[28:29] offset:1024
i14 v[40:41],0
i14 v[42:43],0
i14 v[12:13],0
i14 v[14:15],0
i14 v[36:37],0
i14 v[38:39],0
i53 vcc,vcc,s[22:23]
i22 Lc2s_slow
Lc2s_cont:
i14 v[56:57],0
i14 v[58:59],0
i14 v[8:9],0
i14 v[10:11],0
i8 lgkmcnt(0)
s_barrier
i9 v[28:31],v61 offset:0
i9 v[32:35],v61 offset:512
i9 v[44:47],v61 offset:1024
i9 v[48:51],v61 offset:1536
i9 v[16:19],v4 offset:22528
i9 v[20:23],v4 offset:23552
i8 lgkmcnt(5)
i4 v[56:59],v[28:31],v[64:71],v1
i9 v[64:67],v4 offset:28672
i8 lgkmcnt(5)
i4 v[56:59],v[32:35],v[72:79],v1
i9 v[68:71],v4 offset:29696
i8 lgkmcnt(5)
i4 v[56:59],v[44:47],a[248:255],v1
i9 v[72:75],v4 offset:30720
i8 lgkmcnt(3)
i4 v[56:59],v[48:51],v[16:23],v1
i9 v[76:79],v4 offset:31744
i9 v[16:19],v62 offset:0
i4 v[36:39],v[28:31],a[80:87],v1
i9 v[20:23],v62 offset:1024
i23 v26,9,v0
i4 v[36:39],v[32:35],a[88:95],v1
i8 lgkmcnt(4)
i3 v56,v56,v57
i4 v[36:39],v[44:47],v[64:71],v1
i8 lgkmcnt(2)
i3 v57,v58,v59
i4 v[36:39],v[48:51],v[72:79],v1
i9 v[64:67],v4 offset:32768
v_bfi_b32 v56, 1, s76, v56
i4 v[8:11],v[28:31],a[96:103],v1
i41 v[56:57],v63,s[8:11],s26 offen offset:0 sc1
i4 v[8:11],v[32:35],a[104:111],v1
i9 v[68:71],v4 offset:33792
i3 v36,v36,v37
i4 v[8:11],v[44:47],a[112:119],v1
i9 v[72:75],v4 offset:34816
i3 v37,v38,v39
i4 v[8:11],v[48:51],a[120:127],v1
i9 v[76:79],v4 offset:35840
v_bfi_b32 v36, 1, s76, v36
i4 v[12:15],v[28:31],a[128:135],v1
i41 v[36:37],v63,s[8:11],s26 offen offset:2048 sc1
i4 v[12:15],v[32:35],a[136:143],v1
i8 lgkmcnt(2)
i3 v8,v8,v9
i4 v[40:43],v[16:19],v[64:71],v1
i8 lgkmcnt(0)
i3 v9,v10,v11
i4 v[40:43],v[20:23],v[72:79],v1
i9 v[72:75],v6 offset:13312
v_bfi_b32 v8, 1, s76, v8
i4 v[12:15],v[44:47],a[144:151],v1
i41 v[8:9],v63,s[8:11],s27 offen offset:0 sc1
i4 v[12:15],v[48:51],a[152:159],v1
i40 v40,v42
i40 v41,v43
v_add_f32 v40, v40, v42
v_add_f32 v41, v41, v43
i3 v40,v40,v41
i18 v27,0xff,v63
v_bfi_b32 v40, 1, s76, v40
i24 v27,v26,2,v27
i3 v12,v12,v13
i3 v13,v14,v15
v_bfi_b32 v12, 1, s76, v12
i41 v[12:13],v63,s[8:11],s27 offen offset:2048 sc1
i52 v40,v27,s[8:11],s28 offen sc1
s_cmp_ge_u32 s20, 8
i22 Lc2s_nored
i23 v24,7,v0
i18 v25,0x70,v0
i45 v24,v24,s77,v25
i11 v0,v0
i15 2
i11 v0,v0
i15 2
i11 v0,v0
i15 2
i11 v0,v0
i15 2
i11 v0,v0
i15 2
i11 v0,v0
i15 2
i11 v0,v0
i15 2
i11 v0,v0
i15 2
i11 v0,v0
i15 2
i11 v0,v0
i15 2
i11 v0,v0
i15 2
i11 v0,v0
i15 2
i11 v0,v0
i15 2
i11 v0,v0
i15 2
i11 v0,v0
i15 2
i11 v0,v0
i15 2
i11 v0,v0
i15 2
i11 v0,v0
i15 2
i11 v0,v0
i15 2
i11 v0,v0
i15 2
i11 v0,v0
i15 2
i11 v0,v0
i15 2
i11 v0,v0
i15 2
i1 v[52:55],v24,s[8:11],s29 offen sc1
i1 v[56:59],v24,s[8:11],s30 offen sc1
i1 v[8:11],v24,s[8:11],s31 offen sc1
i1 v[12:15],v24,s[8:11],s32 offen sc1
i14 v[28:29],0
i14 v[30:31],0
i14 v[32:33],0
i14 v[34:35],0
i14 v[44:45],0
i14 v[46:47],0
i14 v[48:49],0
i14 v[50:51],0
i24 v25,v26,2,v25
i34 v17,v0,8,1
i24 v25,v17,3,v25
i34 v17,v0,7,1
i24 v25,v17,31,v25
i18 v16,0x33f,v0
i24 v16,v17,6,v16
i34 v17,v0,6,1
i24 v16,v17,7,v16
i11 v0,v0
i15 2
i11 v0,v0
i15 2
i11 v0,v0
i15 2
i11 v0,v0
i15 2
i8 lgkmcnt(0)
i8 vmcnt(3)
i2 v[64:67],v[52:55],v[72:75],0
i42 v20,v52,v53,s76 bitop3:0x81
i42 v17,v54,v55,s76 bitop3:0x81
i18 v20,v20,v17
i8 vmcnt(2)
i2 v[64:67],v[56:59],v[72:75],v[64:67]
i42 v21,v56,v57,s76 bitop3:0x81
i42 v17,v58,v59,s76 bitop3:0x81
i18 v21,v21,v17
i8 vmcnt(1)
i2 v[64:67],v[8:11],v[72:75],v[64:67]
i42 v22,v8,v9,s76 bitop3:0x81
i42 v17,v10,v11,s76 bitop3:0x81
i18 v22,v22,v17
i8 vmcnt(0)
i2 v[64:67],v[12:15],v[72:75],v[64:67]
i42 v23,v12,v13,s76 bitop3:0x81
i42 v17,v14,v15,s76 bitop3:0x81
i18 v23,v23,v17
i42 v17,v20,v21,v22 bitop3:0x80
i42 v17,v17,v23,1 bitop3:0x80
i25 vcc,0,v17
i11 v0,v0
i11 v0,v0
i40 v64,v66
i40 v65,v67
v_pk_add_f32 v[64:65], v[64:65], v[66:67]
i3 v64,v64,v65
i49 Lc2s_rf
Lc2s_rn:
i52 v64,v25,s[8:11],s33 offen sc1
i11 v22,v64
i11 v23,v25
i44 Lc2s_tail
Lc2s_nored:
i14 v[28:29],0
i14 v[30:31],0
i14 v[32:33],0
i14 v[34:35],0
i14 v[44:45],0
i14 v[46:47],0
i14 v[48:49],0
i14 v[50:51],0
i24 v25,v26,2,v25
i34 v17,v0,8,1
i24 v25,v17,3,v25
i34 v17,v0,7,1
i24 v25,v17,31,v25
i18 v16,0x33f,v0
i24 v16,v17,6,v16
i34 v17,v0,6,1
i24 v16,v17,7,v16
i11 v0,v0
i15 2
i11 v0,v0
i15 2
i11 v0,v0
i15 2
i11 v0,v0
i15 2
i11 v0,v0
i15 2
i11 v0,v0
i15 2
i11 v0,v0
i15 2
i11 v0,v0
i15 2
i11 v0,v0
i15 2
i11 v0,v0
i15 2
i11 v0,v0
i15 2
i11 v0,v0
i15 2
i11 v0,v0
i15 2
i11 v0,v0
i15 2
i11 v0,v0
i15 2
i11 v0,v0
i15 2
i11 v0,v0
i15 2
i11 v0,v0
i15 2
i11 v0,v0
i15 2
i11 v0,v0
i15 2
i11 v0,v0
i15 2
i11 v0,v0
i15 2
i11 v0,v0
i15 2
i11 v0,v0
i15 2
i11 v0,v0
i15 2
i11 v0,v0
i15 2
i11 v0,v0
i15 2
i11 v0,v0
i15 2
i11 v0,v0
i15 2
i11 v0,v0
i15 2
i11 v0,v0
i15 2
i11 v0,v0
i15 2
i11 v0,v0
i15 2
i11 v0,v0
i15 2
i11 v0,v0
i15 2
i11 v0,v0
i15 2
i11 v0,v0
i15 2
i11 v0,v0
i15 2
i11 v0,v0
i15 2
i11 v0,v0
i15 2
i11 v0,v0
i15 2
i11 v0,v0
i15 2
i11 v0,v0
i15 2
i11 v0,v0
i15 2
i11 v0,v0
i15 2
i11 v0,v0
i15 2
i11 v0,v0
i15 2
i11 v0,v0
i15 2
i11 v0,v0
i15 2
i11 v0,v0
i15 2
Lc2s_tail:
i6 s25,s25,1
s_cmp_lt_u32 s25, 63
i22 Lc2s_top
i44 Lc2s_out
Lc2s_rf:
i18 v17,1,v20
i25 s[12:13],0,v17
i18 v17,1,v21
i25 s[14:15],0,v17
i18 v17,1,v22
i25 s[16:17],0,v17
i18 v17,1,v23
i25 s[18:19],0,v17
i53 exec,s[12:13],1
i1 v[52:55],v24,s[8:11],s29 offen sc1
i53 exec,s[14:15],1
i1 v[56:59],v24,s[8:11],s30 offen sc1
i53 exec,s[16:17],1
i1 v[8:11],v24,s[8:11],s31 offen sc1
i53 exec,s[18:19],1
i1 v[12:15],v24,s[8:11],s32 offen sc1
i39 exec,-1
i11 v0,v0
i15 2
i11 v0,v0
i15 2
i11 v0,v0
i15 2
i11 v0,v0
i15 2
Lc2s_rg:
i53 exec,s[12:13],1
i1 v[52:55],v24,s[8:11],s29 offen sc1
i53 exec,s[14:15],1
i1 v[56:59],v24,s[8:11],s30 offen sc1
i53 exec,s[16:17],1
i1 v[8:11],v24,s[8:11],s31 offen sc1
i53 exec,s[18:19],1
i1 v[12:15],v24,s[8:11],s32 offen sc1
i39 exec,-1
i6 s46,s46,1
i35 s46,400000
i22 L_endc
i8 vmcnt(4)
i42 v20,v52,v53,s76 bitop3:0x81
i42 v17,v54,v55,s76 bitop3:0x81
i18 v20,v20,v17
i42 v21,v56,v57,s76 bitop3:0x81
i42 v17,v58,v59,s76 bitop3:0x81
i18 v21,v21,v17
i42 v22,v8,v9,s76 bitop3:0x81
i42 v17,v10,v11,s76 bitop3:0x81
i18 v22,v22,v17
i42 v23,v12,v13,s76 bitop3:0x81
i42 v17,v14,v15,s76 bitop3:0x81
i18 v23,v23,v17
i2 v[64:67],v[52:55],v[72:75],0
i18 v17,1,v20
i25 s[12:13],0,v17
i2 v[64:67],v[56:59],v[72:75],v[64:67]
i18 v17,1,v21
i25 s[14:15],0,v17
i2 v[64:67],v[8:11],v[72:75],v[64:67]
i18 v17,1,v22
i25 s[16:17],0,v17
i2 v[64:67],v[12:15],v[72:75],v[64:67]
i18 v17,1,v23
i25 s[18:19],0,v17
i42 v17,v20,v21,v22 bitop3:0x80
i42 v17,v17,v23,1 bitop3:0x80
i25 vcc,0,v17
i11 v0,v0
i11 v0,v0
i11 v0,v0
i40 v64,v66
i40 v65,v67
v_pk_add_f32 v[64:65], v[64:65], v[66:67]
i3 v64,v64,v65
i49 Lc2s_rg
i44 Lc2s_rn
Lc2s_pb2:
i53 exec,vcc,1
i1 v[52:55],v16,s[8:11],s35 offen sc1
i39 exec,-1
i6 s46,s46,1
i35 s46,400000
i22 L_endc
i11 v0,v0
i15 2
i11 v0,v0
i15 2
i11 v0,v0
i15 2
i11 v0,v0
i15 2
i44 Lc2s_pb
Lc2s_lp:
i53 exec,vcc,1
i1 v[60:63],v16,s[8:11],s37 offen sc1
i1 v[24:27],v16,s[8:11],s36 offen sc1
i39 exec,-1
i11 v0,v0
i15 2
i11 v0,v0
i15 2
i11 v0,v0
i15 2
i11 v0,v0
i15 2
i11 v0,v0
i15 2
Lc2s_lp2:
i53 exec,vcc,1
i1 v[60:63],v16,s[8:11],s37 offen sc1
i1 v[24:27],v16,s[8:11],s36 offen sc1
i39 exec,-1
i6 s46,s46,1
i35 s46,400000
i22 L_endc
i11 v0,v0
i15 2
i11 v0,v0
i15 2
i8 vmcnt(2)
i48 v17,v60,v61,v62
i48 v17,v17,v24,v25
i48 v17,v17,v26,v27
v_max_u32 v17, v17, v63
i25 vcc,-1,v17
i49 Lc2s_lp2
i44 Lc2s_lok
Lc2s_slow:
i38 v28,v8,v9,v10
i38 v29,v11,v56,v57
i38 v28,v28,v58,v59
v_max_f32 v28, v28, v29
i11 v0,v0
i11 v0,v0
v_max_f32_dpp v28, v28, v28 row_ror:8 row_mask:0xf bank_mask:0xf
i11 v29,v28
i11 v0,v0
i11 v0,v0
v_permlane16_swap_b32 v28, v29
v_max_f32 v28, v28, v29
i11 v29,v28
i11 v0,v0
i11 v0,v0
i40 v28,v29
v_max_f32 v28, v28, v29
i33 v8,v8,v28
i19 v8,v8
i33 v9,v9,v28
i19 v9,v9
i33 v10,v10,v28
i19 v10,v10
i33 v11,v11,v28
i19 v11,v11
i33 v56,v56,v28
i19 v56,v56
i33 v57,v57,v28
i19 v57,v57
i33 v58,v58,v28
i19 v58,v58
i33 v59,v59,v28
i19 v59,v59
i3 v48,v56,v57
i3 v49,v58,v59
i3 v50,v8,v9
i3 v51,v10,v11
i14 v[28:29],0
i14 v[36:37],s[48:49]
i14 v[38:39],s[50:51]
i2 v[32:35],v[20:23],v[50:53],0
i2 v[12:15],v[26:29],v[50:53],0
i2 v[28:31],v[16:19],v[48:51],0
i2 v[40:43],v[36:39],v[48:51],0
i2 v[44:47],v[22:25],v[48:51],0
i29 v28,v32,v28 row_ror:8 row_mask:0xf bank_mask:0x3
i29 v29,v33,v29 row_ror:8 row_mask:0xf bank_mask:0x3
i29 v30,v34,v30 row_ror:8 row_mask:0xf bank_mask:0x3
i29 v31,v35,v31 row_ror:8 row_mask:0xf bank_mask:0x3
i29 v40,v40,v40 row_ror:8 row_mask:0xf bank_mask:0xf
v_rcp_f32 v42, v40
v_cmp_nlt_f32 vcc, s54, v40
v_cmp_ngt_f32 s[22:23], s55, v40
i29 v28,v44,v12 row_ror:8 row_mask:0xf bank_mask:0xc
i29 v29,v45,v13 row_ror:8 row_mask:0xf bank_mask:0xc
i29 v30,v46,v14 row_ror:8 row_mask:0xf bank_mask:0xc
i29 v31,v47,v15 row_ror:8 row_mask:0xf bank_mask:0xc
i16 v[28:29],v[28:29],v[42:43] op_sel_hi:[1,0]
i16 v[30:31],v[30:31],v[42:43] op_sel_hi:[1,0]
i3 v28,v28,v29
i3 v29,v30,v31
ds_write_b64 v60, v[28:29] offset:1024
i14 v[40:41],0
i14 v[42:43],0
i14 v[12:13],0
i14 v[14:15],0
i14 v[36:37],0
i14 v[38:39],0
i44 Lc2s_cont
Lc2s_out:
i52 v22,v23,s[8:11],s53 offen sc1
i8 vmcnt(0)
i44 L_endc
L_endc:
s_endpgm
.section .rodata,"a"
.p2align 6
.amdhsa_kernel concat_heads__grouped_kv_mqa__memory_aug_recurrent_mem_tr__prompt_kernel
  .amdhsa_next_free_vgpr 512
  .amdhsa_next_free_sgpr 102
  .amdhsa_accum_offset 256
  .amdhsa_group_segment_fixed_size 0
  .amdhsa_kernarg_size 120
  .amdhsa_user_sgpr_count 2
  .amdhsa_user_sgpr_kernarg_segment_ptr 1
  .amdhsa_system_sgpr_workgroup_id_x 1
.end_amdhsa_kernel
```
